```python
import torch

def _softmax(x, axis=-1):
    return torch.softmax(x, dim=axis)
def _gelu(x):
    return torch.nn.functional.gelu(x, approximate="tanh")
def _silu(x):
    return torch.nn.functional.silu(x)
def _sigmoid(x):
    return torch.sigmoid(x)
def _layernorm(x, axis=-1, eps=1e-5):
    m = x.mean(dim=axis, keepdim=True)
    v = x.var(dim=axis, keepdim=True, unbiased=False)
    return (x - m) / torch.sqrt(v + eps)
def _scatter_add(tgt, idx, src, axis=0):
    return tgt.clone().index_add_(axis, idx, src)
def _segment_sum(src, seg, n):
    out = torch.zeros((n,) + src.shape[1:], dtype=src.dtype)
    return out.index_add_(0, seg, src)
def _pad(x, pw):
    flat = tuple(v for pair in reversed(pw) for v in pair)
    return torch.nn.functional.pad(x, flat)

kernel_name = 'sequential_preLN__compressed_kv_cla__moe_arch_mod__prompt'

def setup_inputs():

    _w = (lambda a: (lambda t: t.to(torch.bfloat16) if t.is_floating_point() else t)(torch.as_tensor(a)))
    def _A_setup():
        B, H, Sq, Sk, D, M = 1, 32, 2048, 2048, 128, 640
        Dc = 4 * D
        return {
            "x": _w((lambda *s: torch.randn(*s, dtype=torch.bfloat16) * 0.05)(B, Sq, M)),
            "c_kv": _w((lambda *s: torch.randn(*s, dtype=torch.bfloat16) * 0.4)(B, Sk, Dc)),
            "w_q": _w((lambda *s: torch.randn(*s, dtype=torch.bfloat16) * 3.2)(M, H, D) * (M ** -0.5)),
            "w_uk": _w((lambda *s: torch.randn(*s, dtype=torch.bfloat16) * 3.2)(Dc, H, D) * (Dc ** -0.5)),
            "w_uv": _w((lambda *s: torch.randn(*s, dtype=torch.bfloat16) * 0.4)(Dc, H, D) * (Dc ** -0.5)),
            "w_o": _w((lambda *s: torch.randn(*s, dtype=torch.bfloat16) * 0.4)(H, D, M) * ((H * D) ** -0.5)),
        }
    _A_in = _A_setup()

    def _B_setup():
        B, S, D, F, C = 1, 2048, 640, 1728, 1
        return {
            "x": _w((lambda *s: torch.randn(*s, dtype=torch.bfloat16) * 0.05)(B, S, D)),
            "w_r": _w((lambda *s: torch.randn(*s, dtype=torch.bfloat16) * 0.05)(D)),
            "w_gate": _w((lambda *s: torch.randn(*s, dtype=torch.bfloat16) * 0.05)(D, F)),
            "w_up": _w((lambda *s: torch.randn(*s, dtype=torch.bfloat16) * 0.05)(D, F)),
            "w_down": _w((lambda *s: torch.randn(*s, dtype=torch.bfloat16) * 0.05)(F, D)),
        }
    _B_in = _B_setup()

    return {
        "A_x": _A_in["x"],
        "A_c_kv": _A_in["c_kv"],
        "A_w_q": _A_in["w_q"],
        "A_w_uk": _A_in["w_uk"],
        "A_w_uv": _A_in["w_uv"],
        "A_w_o": _A_in["w_o"],
        "B_x": _B_in["x"],
        "B_w_r": _B_in["w_r"],
        "B_w_gate": _B_in["w_gate"],
        "B_w_up": _B_in["w_up"],
        "B_w_down": _B_in["w_down"],
    }

def reference(A_x, A_c_kv, A_w_q, A_w_uk, A_w_uv, A_w_o, B_x, B_w_r, B_w_gate, B_w_up, B_w_down):
    def _A_ref(x, c_kv, w_q, w_uk, w_uv, w_o):
        B, Sq, M = x.shape[0], x.shape[1], x.shape[2]
        Sk = c_kv.shape[1]
        H, D = w_q.shape[1], w_q.shape[2]
        q = torch.einsum("bqm,mhd->bhqd", x, w_q)
        k = torch.einsum("bkc,chd->bhkd", c_kv, w_uk)
        v = torch.einsum("bkc,chd->bhkd", c_kv, w_uv)
        scores = torch.einsum("bhqd,bhkd->bhqk", q, k) * (D ** -0.5)
        off = Sk - Sq
        qi = torch.arange(Sq)[:, None]
        kj = torch.arange(Sk)[None, :]
        cmask = kj <= (qi + off)
        scores = torch.where(cmask[None, None], scores, -1e9)
        p = _softmax(scores, axis=-1)
        ctx = torch.einsum("bhqk,bhkd->bhqd", p, v)
        return torch.einsum("bhqd,hdm->bqm", ctx, w_o)

    def _B_ref(x, w_r, w_gate, w_up, w_down):
        B, S, D = x.shape
        C = 1
        r = x @ w_r
        idx = torch.argsort(-r, axis=-1)[:, :C]
        idx_e = (lambda x, n, axis: torch.repeat_interleave(x, n, dim=axis))(idx.reshape(B, C, 1), D, axis=2)
        x_sel = (lambda x, i, axis: torch.take_along_dim(x, i, dim=axis))(x, idx_e, axis=1)
        g = _silu(x_sel @ w_gate)
        u = x_sel @ w_up
        y = (g * u) @ w_down
        r_sel = _sigmoid((lambda x, i, axis: torch.take_along_dim(x, i, dim=axis))(r, idx, axis=1))
        y = y * r_sel.reshape(B, C, 1)
        b_off = (torch.arange(B) * S).reshape(B, 1)
        flat_idx = (idx + b_off).reshape(B * C)
        zero = (x * 0.0).reshape(B * S, D)
        upd = _scatter_add(zero, flat_idx, y.reshape(B * C, D), axis=0)
        return x + upd.reshape(B, S, D)

    x = A_x
    h = x + _A_ref(_layernorm(x, axis=-1), A_c_kv, A_w_q, A_w_uk, A_w_uv, A_w_o)
    h2 = h + _B_ref(_layernorm(h, axis=-1), B_w_r, B_w_gate, B_w_up, B_w_down)
    return h2
```

```asm
; @launch kernel=sequential_preLN__compressed_kv_cla__moe_arch_mod__prompt_kernel grid=(256,1,1) block=(256,1,1) lds=163840
.amdgcn_target "amdgcn-amd-amdhsa--gfx950"
.text
.globl sequential_preLN__compressed_kv_cla__moe_arch_mod__prompt_kernel
.p2align 8
.type sequential_preLN__compressed_kv_cla__moe_arch_mod__prompt_kernel,@function
sequential_preLN__compressed_kv_cla__moe_arch_mod__prompt_kernel:
s_cmp_ge_u32 s2, 256
s_cbranch_scc1 L_exit
s_load_dwordx16 s[16:31], s[0:1], 0
s_load_dwordx8 s[32:39], s[0:1], 64
s_load_dwordx4 s[40:43], s[0:1], 96
s_getpc_b64 s[4:5]
L_pc:
s_lshr_b32 s6, s2, 3
s_lshl_b32 s6, s6, 12
v_lshlrev_b32 v2, 4, v0
v_add_u32 v2, s6, v2
v_min_u32 v2, L_code_end-L_pc-16, v2
v_mov_b32 v3, s5
v_add_co_u32 v2, vcc, s4, v2
s_nop 1
v_addc_co_u32 v3, vcc, 0, v3, vcc
global_load_dwordx4 v[248:251], v[2:3], off
v_lshrrev_b32 v1, 6, v0
v_mov_b32 v30, 0
v_readfirstlane_b32 s64, v1
s_and_b32 s70, s2, 7
s_lshr_b32 s71, s2, 3
s_and_b32 s68, s71, 7
s_lshr_b32 s72, s71, 3
s_lshr_b32 s67, s70, 1
s_and_b32 s73, s70, 1
s_lshl_b32 s73, s73, 2
s_add_u32 s66, s73, s72
s_lshl_b32 s65, s67, 3
s_add_u32 s65, s65, s68
s_mov_b32 s69, s2
v_and_b32 v1, 63, v0
v_and_b32 v16, 15, v1
v_lshrrev_b32 v17, 4, v1
v_lshlrev_b32 v10, 4, v1
v_lshrrev_b32 v18, 3, v1
v_lshrrev_b32 v19, 2, v18
v_and_b32 v20, 3, v18
v_lshl_add_u32 v19, v19, 3, v20
v_lshlrev_b32 v19, 13, v19
v_bfe_u32 v20, v1, 1, 2
v_xor_b32 v20, v20, v17
v_lshl_add_u32 v19, v20, 5, v19
v_and_b32 v20, 1, v1
v_lshl_add_u32 v19, v20, 4, v19
v_add_u32 v6, 0, v19
v_add_u32 v7, 130048, v19
v_add_u32 v8, 30720, v19
v_add_u32 v9, 160768, v19
v_lshrrev_b32 v18, 3, v1
v_and_b32 v19, 7, v1
v_add_u32 v20, 0, v17
v_xor_b32 v20, v20, v19
v_and_b32 v20, 7, v20
v_lshlrev_b32 v20, 4, v20
v_lshl_add_u32 v11, v18, 10, v20
v_add_u32 v20, 4, v17
v_xor_b32 v20, v20, v19
v_and_b32 v20, 7, v20
v_lshlrev_b32 v20, 4, v20
v_lshl_add_u32 v12, v18, 10, v20
s_mul_i32 s75, s64, 24576
s_add_u32 s75, s75, 65536
s_lshl_b32 s70, s66, 8
s_lshl_b32 s71, s64, 6
s_add_u32 s70, s70, s71
s_lshl_b32 s74, s70, 10
s_lshl_b32 s72, s65, 8
s_lshl_b32 s82, s64, 13
s_lshr_b32 s3, s2, 6
s_lshl_b32 s89, s3, 1
s_add_u32 s89, s89, s68
s_and_b32 s89, s89, 7
s_mov_b32 s89, 0
s_lshl_b32 s89, s89, 1
s_add_u32 s77, s64, s89
s_lshl_b32 s78, s64, 1
s_add_u32 s78, s78, s89
s_lshl_b32 s73, s65, 8
s_waitcnt lgkmcnt(0)
s_mov_b32 s44, s42
s_and_b32 s45, s43, 0xffff
s_mov_b32 s46, 0x10000000
s_mov_b32 s47, 0x20000
s_mov_b32 s52, s18
s_and_b32 s53, s19, 0xffff
s_mov_b32 s54, 0x200000
s_mov_b32 s55, 0x20000
s_mov_b32 s56, s22
s_and_b32 s57, s23, 0xffff
s_mov_b32 s58, 0x400000
s_mov_b32 s59, 0x20000
s_add_u32 s81, s77, 0
s_and_b32 s81, s81, 15
s_lshl_b32 s81, s81, 18
s_add_u32 s81, s81, s73
s_add_u32 m0, s82, 0
s_nop 0
buffer_load_dwordx4 v6, s[56:59], s81 offen offset:0 lds
buffer_load_dwordx4 v7, s[56:59], s81 offen offset:1024 lds
buffer_load_dwordx4 v8, s[56:59], s81 offen offset:2048 lds
buffer_load_dwordx4 v9, s[56:59], s81 offen offset:3072 lds
s_add_u32 s81, s77, 0
s_and_b32 s81, s81, 15
s_lshl_b32 s81, s81, 18
s_add_u32 s81, s81, s73
s_add_u32 s81, s81, 128
s_add_u32 m0, s82, 4096
s_nop 0
buffer_load_dwordx4 v6, s[56:59], s81 offen offset:0 lds
buffer_load_dwordx4 v7, s[56:59], s81 offen offset:1024 lds
buffer_load_dwordx4 v8, s[56:59], s81 offen offset:2048 lds
buffer_load_dwordx4 v9, s[56:59], s81 offen offset:3072 lds
s_add_u32 s72, s89, 0
s_and_b32 s72, s72, 15
s_lshl_b32 s72, s72, 6
s_add_u32 s72, s72, s74
s_add_u32 m0, s75, 0
s_add_u32 s76, s72, 0
buffer_load_dwordx4 v11, s[52:55], s76 offen offset:0 lds
s_add_u32 s76, s72, 7168
buffer_load_dwordx4 v12, s[52:55], s76 offen offset:1024 lds
s_add_u32 s76, s72, 14336
buffer_load_dwordx4 v11, s[52:55], s76 offen offset:2048 lds
s_add_u32 s76, s72, 21504
buffer_load_dwordx4 v12, s[52:55], s76 offen offset:3072 lds
s_add_u32 m0, s75, 4096
s_add_u32 s76, s72, 32768
buffer_load_dwordx4 v11, s[52:55], s76 offen offset:0 lds
s_add_u32 s76, s72, 39936
buffer_load_dwordx4 v12, s[52:55], s76 offen offset:1024 lds
s_add_u32 s76, s72, 47104
buffer_load_dwordx4 v11, s[52:55], s76 offen offset:2048 lds
s_add_u32 s76, s72, 54272
buffer_load_dwordx4 v12, s[52:55], s76 offen offset:3072 lds
s_add_u32 s72, s89, 2
s_and_b32 s72, s72, 15
s_lshl_b32 s72, s72, 6
s_add_u32 s72, s72, s74
s_add_u32 m0, s75, 8192
s_add_u32 s76, s72, 0
buffer_load_dwordx4 v11, s[52:55], s76 offen offset:0 lds
s_add_u32 s76, s72, 7168
buffer_load_dwordx4 v12, s[52:55], s76 offen offset:1024 lds
s_add_u32 s76, s72, 14336
buffer_load_dwordx4 v11, s[52:55], s76 offen offset:2048 lds
s_add_u32 s76, s72, 21504
buffer_load_dwordx4 v12, s[52:55], s76 offen offset:3072 lds
s_add_u32 m0, s75, 12288
s_add_u32 s76, s72, 32768
buffer_load_dwordx4 v11, s[52:55], s76 offen offset:0 lds
s_add_u32 s76, s72, 39936
buffer_load_dwordx4 v12, s[52:55], s76 offen offset:1024 lds
s_add_u32 s76, s72, 47104
buffer_load_dwordx4 v11, s[52:55], s76 offen offset:2048 lds
s_add_u32 s76, s72, 54272
buffer_load_dwordx4 v12, s[52:55], s76 offen offset:3072 lds
s_add_u32 s81, s77, 4
s_and_b32 s81, s81, 15
s_lshl_b32 s81, s81, 18
s_add_u32 s81, s81, s73
s_add_u32 m0, s82, 32768
s_nop 0
buffer_load_dwordx4 v6, s[56:59], s81 offen offset:0 lds
buffer_load_dwordx4 v7, s[56:59], s81 offen offset:1024 lds
buffer_load_dwordx4 v8, s[56:59], s81 offen offset:2048 lds
buffer_load_dwordx4 v9, s[56:59], s81 offen offset:3072 lds
s_add_u32 s81, s77, 4
s_and_b32 s81, s81, 15
s_lshl_b32 s81, s81, 18
s_add_u32 s81, s81, s73
s_add_u32 s81, s81, 128
s_add_u32 m0, s82, 36864
s_nop 0
buffer_load_dwordx4 v6, s[56:59], s81 offen offset:0 lds
buffer_load_dwordx4 v7, s[56:59], s81 offen offset:1024 lds
buffer_load_dwordx4 v8, s[56:59], s81 offen offset:2048 lds
buffer_load_dwordx4 v9, s[56:59], s81 offen offset:3072 lds
s_add_u32 s72, s89, 4
s_and_b32 s72, s72, 15
s_lshl_b32 s72, s72, 6
s_add_u32 s72, s72, s74
s_add_u32 m0, s75, 16384
s_add_u32 s76, s72, 0
buffer_load_dwordx4 v11, s[52:55], s76 offen offset:0 lds
s_add_u32 s76, s72, 7168
buffer_load_dwordx4 v12, s[52:55], s76 offen offset:1024 lds
s_add_u32 s76, s72, 14336
buffer_load_dwordx4 v11, s[52:55], s76 offen offset:2048 lds
s_add_u32 s76, s72, 21504
buffer_load_dwordx4 v12, s[52:55], s76 offen offset:3072 lds
s_add_u32 m0, s75, 20480
s_add_u32 s76, s72, 32768
buffer_load_dwordx4 v11, s[52:55], s76 offen offset:0 lds
s_add_u32 s76, s72, 39936
buffer_load_dwordx4 v12, s[52:55], s76 offen offset:1024 lds
s_add_u32 s76, s72, 47104
buffer_load_dwordx4 v11, s[52:55], s76 offen offset:2048 lds
s_add_u32 s76, s72, 54272
buffer_load_dwordx4 v12, s[52:55], s76 offen offset:3072 lds
s_mov_b32 s60, s24
s_and_b32 s61, s25, 0xffff
s_mov_b32 s62, 0x400000
s_mov_b32 s63, 0x20000
s_mov_b32 s48, s16
s_and_b32 s49, s17, 0xffff
s_mov_b32 s50, 0x280000
s_mov_b32 s51, 0x20000
v_lshrrev_b32 v194, 5, v1
v_and_b32 v195, 31, v1
v_mul_u32_u24 v192, 1280, v194
v_lshrrev_b32 v193, 2, v195
v_lshl_add_u32 v192, v193, 6, v192
v_and_b32 v193, 3, v195
v_lshl_add_u32 v192, v193, 3, v192
v_lshlrev_b32 v238, 8, v193
v_lshl_add_u32 v238, v194, 4, v238
v_lshrrev_b32 v193, 2, v195
v_lshl_add_u32 v238, v193, 10, v238
v_cmp_gt_u32 vcc, 16, v195
v_mov_b32 v193, 536870912
s_nop 0
v_cndmask_b32 v193, v193, v192, vcc
s_lshl_b32 s70, s69, 3
s_lshl_b32 s71, s64, 1
s_add_u32 s70, s70, s71
s_mul_i32 s70, s70, 1280
buffer_load_dwordx2 v[196:197], v192, s[48:51], s70 offen offset:0
buffer_load_dwordx2 v[198:199], v192, s[48:51], s70 offen offset:32
buffer_load_dwordx2 v[200:201], v192, s[48:51], s70 offen offset:512
buffer_load_dwordx2 v[202:203], v192, s[48:51], s70 offen offset:544
buffer_load_dwordx2 v[204:205], v193, s[48:51], s70 offen offset:1024
buffer_load_dwordx2 v[206:207], v193, s[48:51], s70 offen offset:1056
v_lshrrev_b32 v29, 1, v1
v_lshlrev_b32 v29, 13, v29
v_and_b32 v16, 1, v1
v_lshl_add_u32 v29, v16, 7, v29
s_lshl_b32 s70, s3, 7
s_lshl_b32 s71, s64, 5
s_add_u32 s70, s70, s71
s_lshl_b32 s70, s70, 13
s_add_u32 s91, s70, s73
buffer_load_dword v31, v29, s[60:63], s91 offen
v_mov_b32 v240, 0
v_mov_b32 v241, 0
v_mov_b32 v242, 0
v_mov_b32 v243, 0
v_lshlrev_b32 v244, 4, v0
s_mul_i32 s70, s69, 5120
s_add_u32 s70, s70, 67108864
buffer_store_dwordx4 v[240:243], v244, s[44:47], s70 offen sc1
v_cmp_gt_u32 vcc, 64, v0
v_mov_b32 v245, 536870912
s_nop 0
v_cndmask_b32 v245, v245, v244, vcc
s_add_u32 s70, s70, 4096
buffer_store_dwordx4 v[240:243], v245, s[44:47], s70 offen sc1
v_cmp_gt_u32 vcc, 68, v0
v_mov_b32 v245, 536870912
s_nop 0
v_cndmask_b32 v245, v245, v244, vcc
s_mul_i32 s70, s69, 1088
s_add_u32 s70, s70, 68681728
buffer_store_dwordx4 v[240:243], v245, s[44:47], s70 offen sc1
v_cmp_gt_u32 vcc, 8, v0
v_mov_b32 v245, 536870912
s_nop 0
v_cndmask_b32 v245, v245, v244, vcc
s_lshl_b32 s70, s69, 7
s_add_u32 s70, s70, 69206016
buffer_store_dwordx4 v[240:243], v245, s[44:47], s70 offen sc1
v_and_b32 v16, 15, v1
v_lshrrev_b32 v17, 4, v1
v_lshrrev_b32 v18, 2, v16
v_and_b32 v19, 3, v16
v_lshrrev_b32 v20, 1, v17
v_and_b32 v21, 1, v17
v_lshlrev_b32 v22, 3, v20
v_lshl_add_u32 v22, v21, 2, v22
v_add_u32 v22, v22, v18
v_lshlrev_b32 v22, 7, v22
v_lshl_add_u32 v22, v19, 3, v22
v_lshrrev_b32 v23, 1, v18
v_lshl_add_u32 v23, v21, 1, v23
v_xor_b32 v18, 0, v23
v_lshl_add_u32 v2, v18, 5, v22
v_xor_b32 v18, 1, v23
v_lshl_add_u32 v3, v18, 5, v22
v_xor_b32 v18, 2, v23
v_lshl_add_u32 v4, v18, 5, v22
v_xor_b32 v18, 3, v23
v_lshl_add_u32 v5, v18, 5, v22
v_lshrrev_b32 v18, 1, v16
v_add_u32 v19, 0, v17
v_xor_b32 v19, v19, v18
v_lshlrev_b32 v19, 4, v19
v_lshl_add_u32 v19, v16, 7, v19
v_add_u32 v13, s75, v19
v_add_u32 v19, 4, v17
v_xor_b32 v19, v19, v18
v_lshlrev_b32 v19, 4, v19
v_lshl_add_u32 v19, v16, 7, v19
v_add_u32 v14, s75, v19
s_mov_b32 s96, s40
s_and_b32 s97, s41, 0xffff
s_mov_b32 s98, 0x100
s_mov_b32 s99, 0x20000
s_waitcnt vmcnt(43)
s_waitcnt vmcnt(35)
s_barrier
ds_read_b128 a[0:3], v13 offset:0
ds_read_b128 a[64:67], v13 offset:2048
ds_read_b128 a[128:131], v13 offset:4096
ds_read_b128 a[192:195], v13 offset:6144
ds_read_b128 a[4:7], v14 offset:0
ds_read_b128 a[68:71], v14 offset:2048
ds_read_b128 a[132:135], v14 offset:4096
ds_read_b128 a[196:199], v14 offset:6144
ds_read_b64_tr_b16 v[32:33], v2 offset:0
ds_read_b64_tr_b16 v[34:35], v2 offset:2048
ds_read_b64_tr_b16 v[36:37], v3 offset:0
ds_read_b64_tr_b16 v[38:39], v3 offset:2048
ds_read_b64_tr_b16 v[40:41], v4 offset:0
ds_read_b64_tr_b16 v[42:43], v4 offset:2048
ds_read_b64_tr_b16 v[44:45], v5 offset:0
ds_read_b64_tr_b16 v[46:47], v5 offset:2048
ds_read_b64_tr_b16 v[48:49], v2 offset:4096
ds_read_b64_tr_b16 v[50:51], v2 offset:6144
ds_read_b64_tr_b16 v[52:53], v3 offset:4096
ds_read_b64_tr_b16 v[54:55], v3 offset:6144
ds_read_b64_tr_b16 v[56:57], v4 offset:4096
ds_read_b64_tr_b16 v[58:59], v4 offset:6144
ds_read_b64_tr_b16 v[60:61], v5 offset:4096
ds_read_b64_tr_b16 v[62:63], v5 offset:6144
s_waitcnt lgkmcnt(14)
v_mfma_f32_16x16x32_bf16 v[64:67], v[32:35], a[0:3], 0
s_lshl_b32 s70, s65, 20
s_lshl_b32 s71, s66, 17
v_mfma_f32_16x16x32_bf16 v[68:71], v[32:35], a[64:67], 0
s_waitcnt vmcnt(27)
ds_read_b128 a[8:11], v13 offset:8192
s_add_u32 s72, s89, 6
s_and_b32 s72, s72, 15
s_lshl_b32 s72, s72, 6
s_add_u32 s72, s72, s74
s_add_u32 s76, s72, 0
v_mfma_f32_16x16x32_bf16 v[72:75], v[32:35], a[128:131], 0
s_add_u32 s70, s70, s71
s_lshl_b32 s71, s64, 15
s_add_u32 m0, s75, 0
s_nop 0
buffer_load_dwordx4 v11, s[52:55], s76 offen offset:0 lds
v_mfma_f32_16x16x32_bf16 v[76:79], v[32:35], a[192:195], 0
ds_read_b64_tr_b16 v[32:33], v2 offset:8192
s_add_u32 s70, s70, s71
s_add_u32 s79, s70, 4194304
s_waitcnt lgkmcnt(14)
v_mfma_f32_16x16x32_bf16 v[80:83], v[36:39], a[0:3], 0
ds_read_b64_tr_b16 v[34:35], v2 offset:10240
s_add_u32 s80, s79, 16384
s_mov_b32 s4, s20
v_mfma_f32_16x16x32_bf16 v[84:87], v[36:39], a[64:67], 0
s_add_u32 s76, s72, 7168
s_and_b32 s5, s21, 0xffff
v_mfma_f32_16x16x32_bf16 v[88:91], v[36:39], a[128:131], 0
s_mov_b32 s6, 0x500000
s_mov_b32 s7, 0x20000
s_add_u32 m0, s75, 0
s_nop 0
buffer_load_dwordx4 v12, s[52:55], s76 offen offset:1024 lds
v_mfma_f32_16x16x32_bf16 v[92:95], v[36:39], a[192:195], 0
ds_read_b64_tr_b16 v[36:37], v3 offset:8192
v_and_b32 v16, 15, v1
s_waitcnt lgkmcnt(14)
v_mfma_f32_16x16x32_bf16 v[96:99], v[40:43], a[0:3], 0
ds_read_b64_tr_b16 v[38:39], v3 offset:10240
v_lshrrev_b32 v17, 4, v1
v_mfma_f32_16x16x32_bf16 v[100:103], v[40:43], a[64:67], 0
ds_read_b128 a[72:75], v13 offset:10240
s_add_u32 s76, s72, 14336
v_lshrrev_b32 v18, 1, v16
v_mfma_f32_16x16x32_bf16 v[104:107], v[40:43], a[128:131], 0
s_add_u32 m0, s75, 0
s_nop 0
buffer_load_dwordx4 v11, s[52:55], s76 offen offset:2048 lds
v_mfma_f32_16x16x32_bf16 v[108:111], v[40:43], a[192:195], 0
ds_read_b64_tr_b16 v[40:41], v4 offset:8192
v_and_b32 v19, 1, v1
s_waitcnt lgkmcnt(15)
v_mfma_f32_16x16x32_bf16 v[112:115], v[44:47], a[0:3], 0
ds_read_b64_tr_b16 v[42:43], v4 offset:10240
v_add_u32 v20, 0, v17
v_mfma_f32_16x16x32_bf16 v[116:119], v[44:47], a[64:67], 0
s_add_u32 s76, s72, 21504
v_and_b32 v21, 7, v20
v_mfma_f32_16x16x32_bf16 v[120:123], v[44:47], a[128:131], 0
s_add_u32 m0, s75, 0
s_nop 0
buffer_load_dwordx4 v12, s[52:55], s76 offen offset:3072 lds
v_mfma_f32_16x16x32_bf16 v[124:127], v[44:47], a[192:195], 0
ds_read_b64_tr_b16 v[44:45], v5 offset:8192
s_waitcnt lgkmcnt(15)
v_mfma_f32_16x16x32_bf16 v[128:131], v[48:51], a[0:3], 0
ds_read_b64_tr_b16 v[46:47], v5 offset:10240
v_mfma_f32_16x16x32_bf16 v[132:135], v[48:51], a[64:67], 0
ds_read_b128 a[136:139], v13 offset:12288
v_mfma_f32_16x16x32_bf16 v[136:139], v[48:51], a[128:131], 0
v_mfma_f32_16x16x32_bf16 v[140:143], v[48:51], a[192:195], 0
ds_read_b64_tr_b16 v[48:49], v2 offset:12288
s_waitcnt lgkmcnt(15)
v_mfma_f32_16x16x32_bf16 v[144:147], v[52:55], a[0:3], 0
ds_read_b64_tr_b16 v[50:51], v2 offset:14336
v_mfma_f32_16x16x32_bf16 v[148:151], v[52:55], a[64:67], 0
v_mfma_f32_16x16x32_bf16 v[152:155], v[52:55], a[128:131], 0
v_mfma_f32_16x16x32_bf16 v[156:159], v[52:55], a[192:195], 0
ds_read_b64_tr_b16 v[52:53], v3 offset:12288
s_waitcnt lgkmcnt(15)
v_mfma_f32_16x16x32_bf16 v[160:163], v[56:59], a[0:3], 0
ds_read_b64_tr_b16 v[54:55], v3 offset:14336
v_mfma_f32_16x16x32_bf16 v[164:167], v[56:59], a[64:67], 0
ds_read_b128 a[200:203], v13 offset:14336
v_mfma_f32_16x16x32_bf16 v[168:171], v[56:59], a[128:131], 0
v_mfma_f32_16x16x32_bf16 v[172:175], v[56:59], a[192:195], 0
ds_read_b64_tr_b16 v[56:57], v4 offset:12288
s_waitcnt lgkmcnt(15)
v_mfma_f32_16x16x32_bf16 v[176:179], v[60:63], a[0:3], 0
ds_read_b64_tr_b16 v[58:59], v4 offset:14336
v_mfma_f32_16x16x32_bf16 v[180:183], v[60:63], a[64:67], 0
v_mfma_f32_16x16x32_bf16 v[184:187], v[60:63], a[128:131], 0
v_mfma_f32_16x16x32_bf16 v[188:191], v[60:63], a[192:195], 0
ds_read_b64_tr_b16 v[60:61], v5 offset:12288
s_waitcnt lgkmcnt(15)
v_mfma_f32_16x16x32_bf16 v[64:67], v[32:35], a[4:7], v[64:67]
ds_read_b64_tr_b16 v[62:63], v5 offset:14336
s_waitcnt vmcnt(9)
v_xor_b32 v21, v21, v18
v_mfma_f32_16x16x32_bf16 v[68:71], v[32:35], a[68:71], v[68:71]
ds_read_b128 a[12:15], v14 offset:8192
s_add_u32 s76, s72, 32768
v_lshlrev_b32 v20, 13, v20
v_mfma_f32_16x16x32_bf16 v[72:75], v[32:35], a[132:135], v[72:75]
s_add_u32 m0, s75, 4096
s_nop 0
buffer_load_dwordx4 v11, s[52:55], s76 offen offset:0 lds
v_mfma_f32_16x16x32_bf16 v[76:79], v[32:35], a[196:199], v[76:79]
ds_read_b64_tr_b16 v[32:33], v2 offset:16384
v_lshl_add_u32 v20, v21, 5, v20
s_waitcnt lgkmcnt(15)
v_mfma_f32_16x16x32_bf16 v[80:83], v[36:39], a[4:7], v[80:83]
ds_read_b64_tr_b16 v[34:35], v2 offset:18432
v_lshl_add_u32 v20, v19, 4, v20
v_mfma_f32_16x16x32_bf16 v[84:87], v[36:39], a[68:71], v[84:87]
s_add_u32 s76, s72, 39936
v_mov_b32 v24, v20
v_mfma_f32_16x16x32_bf16 v[88:91], v[36:39], a[132:135], v[88:91]
s_add_u32 m0, s75, 4096
s_nop 0
buffer_load_dwordx4 v12, s[52:55], s76 offen offset:1024 lds
v_mfma_f32_16x16x32_bf16 v[92:95], v[36:39], a[196:199], v[92:95]
ds_read_b64_tr_b16 v[36:37], v3 offset:16384
v_add_u32 v20, 4, v17
s_waitcnt lgkmcnt(15)
v_mfma_f32_16x16x32_bf16 v[96:99], v[40:43], a[4:7], v[96:99]
ds_read_b64_tr_b16 v[38:39], v3 offset:18432
v_lshlrev_b32 v208, 16, v196
v_mfma_f32_16x16x32_bf16 v[100:103], v[40:43], a[68:71], v[100:103]
ds_read_b128 a[76:79], v14 offset:10240
s_add_u32 s76, s72, 47104
v_and_b32 v209, 0xffff0000, v196
v_mfma_f32_16x16x32_bf16 v[104:107], v[40:43], a[132:135], v[104:107]
s_add_u32 m0, s75, 4096
s_nop 0
buffer_load_dwordx4 v11, s[52:55], s76 offen offset:2048 lds
v_mfma_f32_16x16x32_bf16 v[108:111], v[40:43], a[196:199], v[108:111]
ds_read_b64_tr_b16 v[40:41], v4 offset:16384
v_lshlrev_b32 v210, 16, v197
s_waitcnt lgkmcnt(15)
v_mfma_f32_16x16x32_bf16 v[112:115], v[44:47], a[4:7], v[112:115]
ds_read_b64_tr_b16 v[42:43], v4 offset:18432
v_and_b32 v211, 0xffff0000, v197
v_mfma_f32_16x16x32_bf16 v[116:119], v[44:47], a[68:71], v[116:119]
s_add_u32 s76, s72, 54272
v_lshlrev_b32 v212, 16, v198
v_mfma_f32_16x16x32_bf16 v[120:123], v[44:47], a[132:135], v[120:123]
s_add_u32 m0, s75, 4096
s_nop 0
buffer_load_dwordx4 v12, s[52:55], s76 offen offset:3072 lds
v_mfma_f32_16x16x32_bf16 v[124:127], v[44:47], a[196:199], v[124:127]
ds_read_b64_tr_b16 v[44:45], v5 offset:16384
v_and_b32 v213, 0xffff0000, v198
s_waitcnt lgkmcnt(15)
v_mfma_f32_16x16x32_bf16 v[128:131], v[48:51], a[4:7], v[128:131]
ds_read_b64_tr_b16 v[46:47], v5 offset:18432
v_lshlrev_b32 v214, 16, v199
v_mfma_f32_16x16x32_bf16 v[132:135], v[48:51], a[68:71], v[132:135]
ds_read_b128 a[140:143], v14 offset:12288
v_and_b32 v215, 0xffff0000, v199
v_mfma_f32_16x16x32_bf16 v[136:139], v[48:51], a[132:135], v[136:139]
v_lshlrev_b32 v216, 16, v200
v_mfma_f32_16x16x32_bf16 v[140:143], v[48:51], a[196:199], v[140:143]
ds_read_b64_tr_b16 v[48:49], v2 offset:20480
v_and_b32 v217, 0xffff0000, v200
s_waitcnt lgkmcnt(15)
v_mfma_f32_16x16x32_bf16 v[144:147], v[52:55], a[4:7], v[144:147]
ds_read_b64_tr_b16 v[50:51], v2 offset:22528
v_lshlrev_b32 v218, 16, v201
v_mfma_f32_16x16x32_bf16 v[148:151], v[52:55], a[68:71], v[148:151]
v_and_b32 v219, 0xffff0000, v201
v_mfma_f32_16x16x32_bf16 v[152:155], v[52:55], a[132:135], v[152:155]
v_lshlrev_b32 v220, 16, v202
v_mfma_f32_16x16x32_bf16 v[156:159], v[52:55], a[196:199], v[156:159]
ds_read_b64_tr_b16 v[52:53], v3 offset:20480
v_and_b32 v221, 0xffff0000, v202
s_waitcnt lgkmcnt(15)
v_mfma_f32_16x16x32_bf16 v[160:163], v[56:59], a[4:7], v[160:163]
ds_read_b64_tr_b16 v[54:55], v3 offset:22528
v_lshlrev_b32 v222, 16, v203
v_mfma_f32_16x16x32_bf16 v[164:167], v[56:59], a[68:71], v[164:167]
ds_read_b128 a[204:207], v14 offset:14336
v_and_b32 v223, 0xffff0000, v203
v_mfma_f32_16x16x32_bf16 v[168:171], v[56:59], a[132:135], v[168:171]
v_lshlrev_b32 v224, 16, v204
v_mfma_f32_16x16x32_bf16 v[172:175], v[56:59], a[196:199], v[172:175]
ds_read_b64_tr_b16 v[56:57], v4 offset:20480
v_and_b32 v225, 0xffff0000, v204
s_waitcnt lgkmcnt(15)
v_mfma_f32_16x16x32_bf16 v[176:179], v[60:63], a[4:7], v[176:179]
ds_read_b64_tr_b16 v[58:59], v4 offset:22528
v_lshlrev_b32 v226, 16, v205
v_mfma_f32_16x16x32_bf16 v[180:183], v[60:63], a[68:71], v[180:183]
v_and_b32 v227, 0xffff0000, v205
v_mfma_f32_16x16x32_bf16 v[184:187], v[60:63], a[132:135], v[184:187]
v_lshlrev_b32 v228, 16, v206
v_mfma_f32_16x16x32_bf16 v[188:191], v[60:63], a[196:199], v[188:191]
ds_read_b64_tr_b16 v[60:61], v5 offset:20480
v_and_b32 v229, 0xffff0000, v206
s_waitcnt lgkmcnt(15)
v_mfma_f32_16x16x32_bf16 v[64:67], v[32:35], a[8:11], v[64:67]
ds_read_b64_tr_b16 v[62:63], v5 offset:22528
v_and_b32 v21, 7, v20
v_mfma_f32_16x16x32_bf16 v[68:71], v[32:35], a[72:75], v[68:71]
ds_read_b128 a[16:19], v13 offset:16384
s_add_u32 s72, s89, 8
s_and_b32 s72, s72, 15
s_lshl_b32 s72, s72, 6
s_add_u32 s72, s72, s74
s_add_u32 s76, s72, 0
v_xor_b32 v21, v21, v18
v_mfma_f32_16x16x32_bf16 v[72:75], v[32:35], a[136:139], v[72:75]
s_add_u32 m0, s75, 8192
s_nop 0
buffer_load_dwordx4 v11, s[52:55], s76 offen offset:0 lds
v_mfma_f32_16x16x32_bf16 v[76:79], v[32:35], a[200:203], v[76:79]
ds_read_b64_tr_b16 v[32:33], v2 offset:24576
v_lshlrev_b32 v20, 13, v20
s_waitcnt lgkmcnt(15)
v_mfma_f32_16x16x32_bf16 v[80:83], v[36:39], a[8:11], v[80:83]
ds_read_b64_tr_b16 v[34:35], v2 offset:26624
v_lshl_add_u32 v20, v21, 5, v20
v_mfma_f32_16x16x32_bf16 v[84:87], v[36:39], a[72:75], v[84:87]
s_add_u32 s76, s72, 7168
v_lshl_add_u32 v20, v19, 4, v20
v_mfma_f32_16x16x32_bf16 v[88:91], v[36:39], a[136:139], v[88:91]
s_add_u32 m0, s75, 8192
s_nop 0
buffer_load_dwordx4 v12, s[52:55], s76 offen offset:1024 lds
v_mfma_f32_16x16x32_bf16 v[92:95], v[36:39], a[200:203], v[92:95]
ds_read_b64_tr_b16 v[36:37], v3 offset:24576
v_subrev_u32 v25, 1024, v20
s_waitcnt lgkmcnt(15)
v_mfma_f32_16x16x32_bf16 v[96:99], v[40:43], a[8:11], v[96:99]
ds_read_b64_tr_b16 v[38:39], v3 offset:26624
v_lshlrev_b32 v230, 16, v207
v_mfma_f32_16x16x32_bf16 v[100:103], v[40:43], a[72:75], v[100:103]
ds_read_b128 a[80:83], v13 offset:18432
s_add_u32 s76, s72, 14336
v_and_b32 v231, 0xffff0000, v207
v_mfma_f32_16x16x32_bf16 v[104:107], v[40:43], a[136:139], v[104:107]
s_add_u32 m0, s75, 8192
s_nop 0
buffer_load_dwordx4 v11, s[52:55], s76 offen offset:2048 lds
v_mfma_f32_16x16x32_bf16 v[108:111], v[40:43], a[200:203], v[108:111]
ds_read_b64_tr_b16 v[40:41], v4 offset:24576
v_add_f32 v232, v208, v209
s_waitcnt lgkmcnt(15)
v_mfma_f32_16x16x32_bf16 v[112:115], v[44:47], a[8:11], v[112:115]
ds_read_b64_tr_b16 v[42:43], v4 offset:26624
v_add_f32 v237, v210, v211
v_mfma_f32_16x16x32_bf16 v[116:119], v[44:47], a[72:75], v[116:119]
s_add_u32 s76, s72, 21504
v_add_f32 v232, v232, v212
v_mfma_f32_16x16x32_bf16 v[120:123], v[44:47], a[136:139], v[120:123]
s_add_u32 m0, s75, 8192
s_nop 0
buffer_load_dwordx4 v12, s[52:55], s76 offen offset:3072 lds
v_mfma_f32_16x16x32_bf16 v[124:127], v[44:47], a[200:203], v[124:127]
ds_read_b64_tr_b16 v[44:45], v5 offset:24576
v_add_f32 v237, v237, v213
s_waitcnt lgkmcnt(15)
v_mfma_f32_16x16x32_bf16 v[128:131], v[48:51], a[8:11], v[128:131]
ds_read_b64_tr_b16 v[46:47], v5 offset:26624
v_add_f32 v232, v232, v214
v_mfma_f32_16x16x32_bf16 v[132:135], v[48:51], a[72:75], v[132:135]
ds_read_b128 a[144:147], v13 offset:20480
v_add_f32 v237, v237, v215
v_mfma_f32_16x16x32_bf16 v[136:139], v[48:51], a[136:139], v[136:139]
v_add_f32 v232, v232, v216
v_mfma_f32_16x16x32_bf16 v[140:143], v[48:51], a[200:203], v[140:143]
ds_read_b64_tr_b16 v[48:49], v2 offset:28672
v_add_f32 v237, v237, v217
s_waitcnt lgkmcnt(15)
v_mfma_f32_16x16x32_bf16 v[144:147], v[52:55], a[8:11], v[144:147]
ds_read_b64_tr_b16 v[50:51], v2 offset:30720
v_add_f32 v232, v232, v218
v_mfma_f32_16x16x32_bf16 v[148:151], v[52:55], a[72:75], v[148:151]
v_add_f32 v237, v237, v219
v_mfma_f32_16x16x32_bf16 v[152:155], v[52:55], a[136:139], v[152:155]
v_add_f32 v232, v232, v220
v_mfma_f32_16x16x32_bf16 v[156:159], v[52:55], a[200:203], v[156:159]
ds_read_b64_tr_b16 v[52:53], v3 offset:28672
v_add_f32 v237, v237, v221
s_waitcnt lgkmcnt(15)
v_mfma_f32_16x16x32_bf16 v[160:163], v[56:59], a[8:11], v[160:163]
ds_read_b64_tr_b16 v[54:55], v3 offset:30720
v_add_f32 v232, v232, v222
v_mfma_f32_16x16x32_bf16 v[164:167], v[56:59], a[72:75], v[164:167]
ds_read_b128 a[208:211], v13 offset:22528
v_add_f32 v237, v237, v223
v_mfma_f32_16x16x32_bf16 v[168:171], v[56:59], a[136:139], v[168:171]
v_add_f32 v232, v232, v224
v_mfma_f32_16x16x32_bf16 v[172:175], v[56:59], a[200:203], v[172:175]
ds_read_b64_tr_b16 v[56:57], v4 offset:28672
v_add_f32 v237, v237, v225
s_waitcnt lgkmcnt(15)
v_mfma_f32_16x16x32_bf16 v[176:179], v[60:63], a[8:11], v[176:179]
ds_read_b64_tr_b16 v[58:59], v4 offset:30720
v_add_f32 v232, v232, v226
v_mfma_f32_16x16x32_bf16 v[180:183], v[60:63], a[72:75], v[180:183]
v_add_f32 v237, v237, v227
v_mfma_f32_16x16x32_bf16 v[184:187], v[60:63], a[136:139], v[184:187]
v_add_f32 v232, v232, v228
v_mfma_f32_16x16x32_bf16 v[188:191], v[60:63], a[200:203], v[188:191]
ds_read_b64_tr_b16 v[60:61], v5 offset:28672
ds_read_b64_tr_b16 v[62:63], v5 offset:30720
v_add_f32 v237, v237, v229
s_waitcnt lgkmcnt(15)
v_mfma_f32_16x16x32_bf16 v[64:67], v[32:35], a[12:15], v[64:67]
v_add_u32 v20, 8, v17
v_mfma_f32_16x16x32_bf16 v[68:71], v[32:35], a[76:79], v[68:71]
s_waitcnt lgkmcnt(0)
s_barrier
v_and_b32 v21, 7, v20
v_mfma_f32_16x16x32_bf16 v[72:75], v[32:35], a[140:143], v[72:75]
ds_read_b128 a[20:23], v14 offset:16384
v_xor_b32 v21, v21, v18
v_mfma_f32_16x16x32_bf16 v[76:79], v[32:35], a[204:207], v[76:79]
ds_read_b64_tr_b16 v[32:33], v2 offset:32768
v_lshlrev_b32 v20, 13, v20
v_mfma_f32_16x16x32_bf16 v[80:83], v[36:39], a[12:15], v[80:83]
ds_read_b64_tr_b16 v[34:35], v2 offset:34816
v_lshl_add_u32 v20, v21, 5, v20
v_mfma_f32_16x16x32_bf16 v[84:87], v[36:39], a[76:79], v[84:87]
s_add_u32 s76, s72, 32768
v_lshl_add_u32 v20, v19, 4, v20
v_mfma_f32_16x16x32_bf16 v[88:91], v[36:39], a[140:143], v[88:91]
s_add_u32 m0, s75, 12288
s_nop 0
buffer_load_dwordx4 v11, s[52:55], s76 offen offset:0 lds
v_mfma_f32_16x16x32_bf16 v[92:95], v[36:39], a[204:207], v[92:95]
ds_read_b64_tr_b16 v[36:37], v3 offset:32768
v_add_f32 v232, v232, v230
v_mfma_f32_16x16x32_bf16 v[96:99], v[40:43], a[12:15], v[96:99]
ds_read_b64_tr_b16 v[38:39], v3 offset:34816
v_add_f32 v237, v237, v231
v_mfma_f32_16x16x32_bf16 v[100:103], v[40:43], a[76:79], v[100:103]
ds_read_b128 a[84:87], v14 offset:18432
s_add_u32 s81, s77, 8
s_and_b32 s81, s81, 15
s_lshl_b32 s81, s81, 18
s_add_u32 s81, s81, s73
v_add_f32 v232, v232, v237
v_mfma_f32_16x16x32_bf16 v[104:107], v[40:43], a[140:143], v[104:107]
s_add_u32 m0, s82, 0
s_nop 0
buffer_load_dwordx4 v6, s[56:59], s81 offen offset:0 lds
v_mfma_f32_16x16x32_bf16 v[108:111], v[40:43], a[204:207], v[108:111]
ds_read_b64_tr_b16 v[40:41], v4 offset:32768
v_add_f32_dpp v232, v232, v232 row_ror:8 row_mask:0xf bank_mask:0xf
v_mfma_f32_16x16x32_bf16 v[112:115], v[44:47], a[12:15], v[112:115]
ds_read_b64_tr_b16 v[42:43], v4 offset:34816
v_add_f32_dpp v232, v232, v232 row_ror:4 row_mask:0xf bank_mask:0xf
v_mfma_f32_16x16x32_bf16 v[116:119], v[44:47], a[76:79], v[116:119]
s_add_u32 s76, s72, 39936
v_add_f32_dpp v232, v232, v232 row_ror:2 row_mask:0xf bank_mask:0xf
v_mfma_f32_16x16x32_bf16 v[120:123], v[44:47], a[140:143], v[120:123]
s_add_u32 m0, s75, 12288
s_nop 0
buffer_load_dwordx4 v12, s[52:55], s76 offen offset:1024 lds
v_mfma_f32_16x16x32_bf16 v[124:127], v[44:47], a[204:207], v[124:127]
ds_read_b64_tr_b16 v[44:45], v5 offset:32768
v_add_f32_dpp v232, v232, v232 row_ror:1 row_mask:0xf bank_mask:0xf
v_mfma_f32_16x16x32_bf16 v[128:131], v[48:51], a[12:15], v[128:131]
ds_read_b64_tr_b16 v[46:47], v5 offset:34816
v_mov_b32 v194, v232
v_mfma_f32_16x16x32_bf16 v[132:135], v[48:51], a[76:79], v[132:135]
ds_read_b128 a[148:151], v14 offset:20480
v_permlane16_swap_b32 v232, v194
v_mfma_f32_16x16x32_bf16 v[136:139], v[48:51], a[140:143], v[136:139]
s_add_u32 m0, s82, 0
s_nop 0
buffer_load_dwordx4 v7, s[56:59], s81 offen offset:1024 lds
v_mfma_f32_16x16x32_bf16 v[140:143], v[48:51], a[204:207], v[140:143]
ds_read_b64_tr_b16 v[48:49], v2 offset:36864
v_add_f32 v232, v232, v194
v_mfma_f32_16x16x32_bf16 v[144:147], v[52:55], a[12:15], v[144:147]
ds_read_b64_tr_b16 v[50:51], v2 offset:38912
v_mul_f32 v233, 0.0015625, v232
v_mfma_f32_16x16x32_bf16 v[148:151], v[52:55], a[76:79], v[148:151]
s_add_u32 s76, s72, 47104
v_cvt_pk_bf16_f32 v234, v233, v233
v_mfma_f32_16x16x32_bf16 v[152:155], v[52:55], a[140:143], v[152:155]
s_add_u32 m0, s75, 12288
s_nop 0
buffer_load_dwordx4 v11, s[52:55], s76 offen offset:2048 lds
v_mfma_f32_16x16x32_bf16 v[156:159], v[52:55], a[204:207], v[156:159]
ds_read_b64_tr_b16 v[52:53], v3 offset:36864
v_lshlrev_b32 v234, 16, v234
v_mfma_f32_16x16x32_bf16 v[160:163], v[56:59], a[12:15], v[160:163]
ds_read_b64_tr_b16 v[54:55], v3 offset:38912
v_mov_b32 v235, 0
v_mfma_f32_16x16x32_bf16 v[164:167], v[56:59], a[76:79], v[164:167]
ds_read_b128 a[212:215], v14 offset:22528
s_add_u32 s76, s72, 54272
v_mov_b32 v237, 0
v_mfma_f32_16x16x32_bf16 v[168:171], v[56:59], a[140:143], v[168:171]
s_add_u32 m0, s75, 12288
s_nop 0
buffer_load_dwordx4 v12, s[52:55], s76 offen offset:3072 lds
v_mfma_f32_16x16x32_bf16 v[172:175], v[56:59], a[204:207], v[172:175]
ds_read_b64_tr_b16 v[56:57], v4 offset:36864
v_sub_f32 v194, v208, v233
v_mfma_f32_16x16x32_bf16 v[176:179], v[60:63], a[12:15], v[176:179]
ds_read_b64_tr_b16 v[58:59], v4 offset:38912
v_fmac_f32 v235, v194, v194
v_mfma_f32_16x16x32_bf16 v[180:183], v[60:63], a[76:79], v[180:183]
v_sub_f32 v194, v209, v233
v_mfma_f32_16x16x32_bf16 v[184:187], v[60:63], a[140:143], v[184:187]
v_fmac_f32 v235, v194, v194
v_mfma_f32_16x16x32_bf16 v[188:191], v[60:63], a[204:207], v[188:191]
ds_read_b64_tr_b16 v[60:61], v5 offset:36864
v_sub_f32 v194, v210, v233
s_waitcnt lgkmcnt(15)
v_mfma_f32_16x16x32_bf16 v[64:67], v[32:35], a[16:19], v[64:67]
ds_read_b64_tr_b16 v[62:63], v5 offset:38912
v_subrev_u32 v26, 2048, v20
v_mfma_f32_16x16x32_bf16 v[68:71], v[32:35], a[80:83], v[68:71]
s_waitcnt vmcnt(10)
ds_read_b128 a[24:27], v13 offset:0
s_add_u32 s72, s89, 10
s_and_b32 s72, s72, 15
s_lshl_b32 s72, s72, 6
s_add_u32 s72, s72, s74
s_add_u32 s76, s72, 0
v_add_u32 v20, 12, v17
v_mfma_f32_16x16x32_bf16 v[72:75], v[32:35], a[144:147], v[72:75]
s_add_u32 m0, s75, 16384
s_nop 0
buffer_load_dwordx4 v11, s[52:55], s76 offen offset:0 lds
v_mfma_f32_16x16x32_bf16 v[76:79], v[32:35], a[208:211], v[76:79]
ds_read_b64_tr_b16 v[32:33], v2 offset:40960
v_and_b32 v21, 7, v20
s_waitcnt lgkmcnt(15)
v_mfma_f32_16x16x32_bf16 v[80:83], v[36:39], a[16:19], v[80:83]
ds_read_b64_tr_b16 v[34:35], v2 offset:43008
v_xor_b32 v21, v21, v18
v_mfma_f32_16x16x32_bf16 v[84:87], v[36:39], a[80:83], v[84:87]
v_lshlrev_b32 v20, 13, v20
v_mfma_f32_16x16x32_bf16 v[88:91], v[36:39], a[144:147], v[88:91]
s_add_u32 m0, s82, 0
s_nop 0
buffer_load_dwordx4 v8, s[56:59], s81 offen offset:2048 lds
v_mfma_f32_16x16x32_bf16 v[92:95], v[36:39], a[208:211], v[92:95]
ds_read_b64_tr_b16 v[36:37], v3 offset:40960
v_lshl_add_u32 v20, v21, 5, v20
s_waitcnt lgkmcnt(15)
v_mfma_f32_16x16x32_bf16 v[96:99], v[40:43], a[16:19], v[96:99]
ds_read_b64_tr_b16 v[38:39], v3 offset:43008
v_fmac_f32 v235, v194, v194
v_mfma_f32_16x16x32_bf16 v[100:103], v[40:43], a[80:83], v[100:103]
ds_read_b128 a[88:91], v13 offset:2048
s_add_u32 s76, s72, 7168
v_sub_f32 v194, v211, v233
v_mfma_f32_16x16x32_bf16 v[104:107], v[40:43], a[144:147], v[104:107]
s_add_u32 m0, s75, 16384
s_nop 0
buffer_load_dwordx4 v12, s[52:55], s76 offen offset:1024 lds
v_mfma_f32_16x16x32_bf16 v[108:111], v[40:43], a[208:211], v[108:111]
ds_read_b64_tr_b16 v[40:41], v4 offset:40960
v_fmac_f32 v235, v194, v194
s_waitcnt lgkmcnt(15)
v_mfma_f32_16x16x32_bf16 v[112:115], v[44:47], a[16:19], v[112:115]
ds_read_b64_tr_b16 v[42:43], v4 offset:43008
v_sub_f32 v194, v212, v233
v_mfma_f32_16x16x32_bf16 v[116:119], v[44:47], a[80:83], v[116:119]
v_fmac_f32 v235, v194, v194
v_mfma_f32_16x16x32_bf16 v[120:123], v[44:47], a[144:147], v[120:123]
s_add_u32 m0, s82, 0
s_nop 0
buffer_load_dwordx4 v9, s[56:59], s81 offen offset:3072 lds
v_mfma_f32_16x16x32_bf16 v[124:127], v[44:47], a[208:211], v[124:127]
ds_read_b64_tr_b16 v[44:45], v5 offset:40960
v_sub_f32 v194, v213, v233
s_waitcnt lgkmcnt(15)
v_mfma_f32_16x16x32_bf16 v[128:131], v[48:51], a[16:19], v[128:131]
ds_read_b64_tr_b16 v[46:47], v5 offset:43008
v_fmac_f32 v235, v194, v194
v_mfma_f32_16x16x32_bf16 v[132:135], v[48:51], a[80:83], v[132:135]
ds_read_b128 a[152:155], v13 offset:4096
s_add_u32 s76, s72, 14336
v_sub_f32 v194, v214, v233
v_mfma_f32_16x16x32_bf16 v[136:139], v[48:51], a[144:147], v[136:139]
s_add_u32 m0, s75, 16384
s_nop 0
buffer_load_dwordx4 v11, s[52:55], s76 offen offset:2048 lds
v_mfma_f32_16x16x32_bf16 v[140:143], v[48:51], a[208:211], v[140:143]
ds_read_b64_tr_b16 v[48:49], v2 offset:45056
v_fmac_f32 v235, v194, v194
s_waitcnt lgkmcnt(15)
v_mfma_f32_16x16x32_bf16 v[144:147], v[52:55], a[16:19], v[144:147]
ds_read_b64_tr_b16 v[50:51], v2 offset:47104
v_sub_f32 v194, v215, v233
v_mfma_f32_16x16x32_bf16 v[148:151], v[52:55], a[80:83], v[148:151]
s_add_u32 s76, s72, 21504
v_fmac_f32 v235, v194, v194
v_mfma_f32_16x16x32_bf16 v[152:155], v[52:55], a[144:147], v[152:155]
s_add_u32 m0, s75, 16384
s_nop 0
buffer_load_dwordx4 v12, s[52:55], s76 offen offset:3072 lds
v_mfma_f32_16x16x32_bf16 v[156:159], v[52:55], a[208:211], v[156:159]
ds_read_b64_tr_b16 v[52:53], v3 offset:45056
v_sub_f32 v194, v216, v233
s_waitcnt lgkmcnt(15)
v_mfma_f32_16x16x32_bf16 v[160:163], v[56:59], a[16:19], v[160:163]
ds_read_b64_tr_b16 v[54:55], v3 offset:47104
v_fmac_f32 v235, v194, v194
v_mfma_f32_16x16x32_bf16 v[164:167], v[56:59], a[80:83], v[164:167]
ds_read_b128 a[216:219], v13 offset:6144
v_sub_f32 v194, v217, v233
v_mfma_f32_16x16x32_bf16 v[168:171], v[56:59], a[144:147], v[168:171]
v_fmac_f32 v235, v194, v194
v_mfma_f32_16x16x32_bf16 v[172:175], v[56:59], a[208:211], v[172:175]
ds_read_b64_tr_b16 v[56:57], v4 offset:45056
v_sub_f32 v194, v218, v233
s_waitcnt lgkmcnt(15)
v_mfma_f32_16x16x32_bf16 v[176:179], v[60:63], a[16:19], v[176:179]
ds_read_b64_tr_b16 v[58:59], v4 offset:47104
v_fmac_f32 v235, v194, v194
v_mfma_f32_16x16x32_bf16 v[180:183], v[60:63], a[80:83], v[180:183]
v_sub_f32 v194, v219, v233
v_mfma_f32_16x16x32_bf16 v[184:187], v[60:63], a[144:147], v[184:187]
v_fmac_f32 v235, v194, v194
v_mfma_f32_16x16x32_bf16 v[188:191], v[60:63], a[208:211], v[188:191]
ds_read_b64_tr_b16 v[60:61], v5 offset:45056
v_sub_f32 v194, v220, v233
s_waitcnt lgkmcnt(15)
v_mfma_f32_16x16x32_bf16 v[64:67], v[32:35], a[20:23], v[64:67]
ds_read_b64_tr_b16 v[62:63], v5 offset:47104
v_lshl_add_u32 v20, v19, 4, v20
v_mfma_f32_16x16x32_bf16 v[68:71], v[32:35], a[84:87], v[68:71]
ds_read_b128 a[28:31], v14 offset:0
s_add_u32 s76, s72, 32768
v_subrev_u32 v27, 3072, v20
v_mfma_f32_16x16x32_bf16 v[72:75], v[32:35], a[148:151], v[72:75]
s_lshl_b32 s86, s64, 17
s_lshl_b32 s70, s65, 8
s_add_u32 m0, s75, 20480
s_nop 0
buffer_load_dwordx4 v11, s[52:55], s76 offen offset:0 lds
v_mfma_f32_16x16x32_bf16 v[76:79], v[32:35], a[212:215], v[76:79]
ds_read_b64_tr_b16 v[32:33], v2 offset:49152
s_add_u32 s86, s86, s70
s_lshl_b32 s88, s64, 12
v_add_u32 v20, 0x10000, v2
s_waitcnt lgkmcnt(15)
v_mfma_f32_16x16x32_bf16 v[80:83], v[36:39], a[20:23], v[80:83]
ds_read_b64_tr_b16 v[34:35], v2 offset:51200
v_add_u32 v21, 0x10000, v3
v_mfma_f32_16x16x32_bf16 v[84:87], v[36:39], a[84:87], v[84:87]
s_add_u32 s81, s77, 8
s_and_b32 s81, s81, 15
s_lshl_b32 s81, s81, 18
s_add_u32 s81, s81, s73
s_add_u32 s81, s81, 128
v_add_u32 v22, 0x10000, v4
v_mfma_f32_16x16x32_bf16 v[88:91], v[36:39], a[148:151], v[88:91]
s_add_u32 m0, s82, 4096
s_nop 0
buffer_load_dwordx4 v6, s[56:59], s81 offen offset:0 lds
v_mfma_f32_16x16x32_bf16 v[92:95], v[36:39], a[212:215], v[92:95]
ds_read_b64_tr_b16 v[36:37], v3 offset:49152
v_add_u32 v23, 0x10000, v5
s_waitcnt lgkmcnt(15)
v_mfma_f32_16x16x32_bf16 v[96:99], v[40:43], a[20:23], v[96:99]
ds_read_b64_tr_b16 v[38:39], v3 offset:51200
v_fmac_f32 v235, v194, v194
v_mfma_f32_16x16x32_bf16 v[100:103], v[40:43], a[84:87], v[100:103]
ds_read_b128 a[92:95], v14 offset:2048
s_add_u32 s76, s72, 39936
v_sub_f32 v194, v221, v233
v_mfma_f32_16x16x32_bf16 v[104:107], v[40:43], a[148:151], v[104:107]
s_add_u32 m0, s75, 20480
s_nop 0
buffer_load_dwordx4 v12, s[52:55], s76 offen offset:1024 lds
v_mfma_f32_16x16x32_bf16 v[108:111], v[40:43], a[212:215], v[108:111]
ds_read_b64_tr_b16 v[40:41], v4 offset:49152
v_fmac_f32 v235, v194, v194
s_waitcnt lgkmcnt(15)
v_mfma_f32_16x16x32_bf16 v[112:115], v[44:47], a[20:23], v[112:115]
ds_read_b64_tr_b16 v[42:43], v4 offset:51200
v_sub_f32 v194, v222, v233
v_mfma_f32_16x16x32_bf16 v[116:119], v[44:47], a[84:87], v[116:119]
v_fmac_f32 v235, v194, v194
v_mfma_f32_16x16x32_bf16 v[120:123], v[44:47], a[148:151], v[120:123]
s_add_u32 m0, s82, 4096
s_nop 0
buffer_load_dwordx4 v7, s[56:59], s81 offen offset:1024 lds
v_mfma_f32_16x16x32_bf16 v[124:127], v[44:47], a[212:215], v[124:127]
ds_read_b64_tr_b16 v[44:45], v5 offset:49152
v_sub_f32 v194, v223, v233
s_waitcnt lgkmcnt(15)
v_mfma_f32_16x16x32_bf16 v[128:131], v[48:51], a[20:23], v[128:131]
ds_read_b64_tr_b16 v[46:47], v5 offset:51200
v_fmac_f32 v235, v194, v194
v_mfma_f32_16x16x32_bf16 v[132:135], v[48:51], a[84:87], v[132:135]
ds_read_b128 a[156:159], v14 offset:4096
s_add_u32 s76, s72, 47104
v_sub_f32 v194, v224, v233
v_mfma_f32_16x16x32_bf16 v[136:139], v[48:51], a[148:151], v[136:139]
s_add_u32 m0, s75, 20480
s_nop 0
buffer_load_dwordx4 v11, s[52:55], s76 offen offset:2048 lds
v_mfma_f32_16x16x32_bf16 v[140:143], v[48:51], a[212:215], v[140:143]
ds_read_b64_tr_b16 v[48:49], v2 offset:53248
v_fmac_f32 v237, v194, v194
s_waitcnt lgkmcnt(15)
v_mfma_f32_16x16x32_bf16 v[144:147], v[52:55], a[20:23], v[144:147]
ds_read_b64_tr_b16 v[50:51], v2 offset:55296
v_sub_f32 v194, v225, v233
v_mfma_f32_16x16x32_bf16 v[148:151], v[52:55], a[84:87], v[148:151]
s_add_u32 s76, s72, 54272
v_fmac_f32 v237, v194, v194
v_mfma_f32_16x16x32_bf16 v[152:155], v[52:55], a[148:151], v[152:155]
s_add_u32 m0, s75, 20480
s_nop 0
buffer_load_dwordx4 v12, s[52:55], s76 offen offset:3072 lds
v_mfma_f32_16x16x32_bf16 v[156:159], v[52:55], a[212:215], v[156:159]
ds_read_b64_tr_b16 v[52:53], v3 offset:53248
v_sub_f32 v194, v226, v233
s_waitcnt lgkmcnt(15)
v_mfma_f32_16x16x32_bf16 v[160:163], v[56:59], a[20:23], v[160:163]
ds_read_b64_tr_b16 v[54:55], v3 offset:55296
v_fmac_f32 v237, v194, v194
v_mfma_f32_16x16x32_bf16 v[164:167], v[56:59], a[84:87], v[164:167]
ds_read_b128 a[220:223], v14 offset:6144
v_sub_f32 v194, v227, v233
v_mfma_f32_16x16x32_bf16 v[168:171], v[56:59], a[148:151], v[168:171]
v_fmac_f32 v237, v194, v194
v_mfma_f32_16x16x32_bf16 v[172:175], v[56:59], a[212:215], v[172:175]
ds_read_b64_tr_b16 v[56:57], v4 offset:53248
v_sub_f32 v194, v228, v233
s_waitcnt lgkmcnt(15)
v_mfma_f32_16x16x32_bf16 v[176:179], v[60:63], a[20:23], v[176:179]
ds_read_b64_tr_b16 v[58:59], v4 offset:55296
v_fmac_f32 v237, v194, v194
v_mfma_f32_16x16x32_bf16 v[180:183], v[60:63], a[84:87], v[180:183]
v_sub_f32 v194, v229, v233
v_mfma_f32_16x16x32_bf16 v[184:187], v[60:63], a[148:151], v[184:187]
v_fmac_f32 v237, v194, v194
v_mfma_f32_16x16x32_bf16 v[188:191], v[60:63], a[212:215], v[188:191]
ds_read_b64_tr_b16 v[60:61], v5 offset:53248
v_sub_f32 v194, v230, v233
s_waitcnt lgkmcnt(15)
v_mfma_f32_16x16x32_bf16 v[64:67], v[32:35], a[24:27], v[64:67]
ds_read_b64_tr_b16 v[62:63], v5 offset:55296
v_lshrrev_b32 v28, 4, v1
v_mfma_f32_16x16x32_bf16 v[68:71], v[32:35], a[88:91], v[68:71]
s_waitcnt vmcnt(12)
ds_read_b128 a[32:35], v13 offset:8192
s_add_u32 s72, s89, 12
s_and_b32 s72, s72, 15
s_lshl_b32 s72, s72, 6
s_add_u32 s72, s72, s74
s_add_u32 s76, s72, 0
v_lshlrev_b32 v28, 13, v28
v_mfma_f32_16x16x32_bf16 v[72:75], v[32:35], a[152:155], v[72:75]
s_add_u32 m0, s75, 0
s_nop 0
buffer_load_dwordx4 v11, s[52:55], s76 offen offset:0 lds
v_mfma_f32_16x16x32_bf16 v[76:79], v[32:35], a[216:219], v[76:79]
ds_read_b64_tr_b16 v[32:33], v2 offset:57344
v_and_b32 v29, 15, v1
s_waitcnt lgkmcnt(15)
v_mfma_f32_16x16x32_bf16 v[80:83], v[36:39], a[24:27], v[80:83]
ds_read_b64_tr_b16 v[34:35], v2 offset:59392
v_lshl_add_u32 v28, v29, 4, v28
v_mfma_f32_16x16x32_bf16 v[84:87], v[36:39], a[88:91], v[84:87]
s_mul_i32 s70, s3, 160
s_mul_i32 s71, s64, 40
v_fmac_f32 v237, v194, v194
v_mfma_f32_16x16x32_bf16 v[88:91], v[36:39], a[152:155], v[88:91]
s_add_u32 s70, s70, s71
s_lshl_b32 s70, s70, 13
s_add_u32 m0, s82, 4096
s_nop 0
buffer_load_dwordx4 v8, s[56:59], s81 offen offset:2048 lds
v_mfma_f32_16x16x32_bf16 v[92:95], v[36:39], a[216:219], v[92:95]
ds_read_b64_tr_b16 v[36:37], v3 offset:57344
s_lshl_b32 s71, s65, 8
s_add_u32 s90, s70, s71
v_sub_f32 v194, v231, v233
s_waitcnt lgkmcnt(15)
v_mfma_f32_16x16x32_bf16 v[96:99], v[40:43], a[24:27], v[96:99]
ds_read_b64_tr_b16 v[38:39], v3 offset:59392
v_fmac_f32 v237, v194, v194
v_mfma_f32_16x16x32_bf16 v[100:103], v[40:43], a[88:91], v[100:103]
ds_read_b128 a[96:99], v13 offset:10240
s_add_u32 s76, s72, 7168
v_bfe_u32 v195, v1, 4, 1
v_mfma_f32_16x16x32_bf16 v[104:107], v[40:43], a[152:155], v[104:107]
s_add_u32 m0, s75, 0
s_nop 0
buffer_load_dwordx4 v12, s[52:55], s76 offen offset:1024 lds
v_mfma_f32_16x16x32_bf16 v[108:111], v[40:43], a[216:219], v[108:111]
ds_read_b64_tr_b16 v[40:41], v4 offset:57344
v_xor_b32 v195, 1, v195
s_waitcnt lgkmcnt(15)
v_mfma_f32_16x16x32_bf16 v[112:115], v[44:47], a[24:27], v[112:115]
ds_read_b64_tr_b16 v[42:43], v4 offset:59392
v_cvt_f32_u32 v195, v195
v_mfma_f32_16x16x32_bf16 v[116:119], v[44:47], a[88:91], v[116:119]
v_fmac_f32 v235, v237, v195
v_mfma_f32_16x16x32_bf16 v[120:123], v[44:47], a[152:155], v[120:123]
s_add_u32 m0, s82, 4096
s_nop 0
buffer_load_dwordx4 v9, s[56:59], s81 offen offset:3072 lds
v_mfma_f32_16x16x32_bf16 v[124:127], v[44:47], a[216:219], v[124:127]
ds_read_b64_tr_b16 v[44:45], v5 offset:57344
v_add_f32_dpp v235, v235, v235 row_ror:8 row_mask:0xf bank_mask:0xf
s_waitcnt lgkmcnt(15)
v_mfma_f32_16x16x32_bf16 v[128:131], v[48:51], a[24:27], v[128:131]
ds_read_b64_tr_b16 v[46:47], v5 offset:59392
v_add_f32_dpp v235, v235, v235 row_ror:4 row_mask:0xf bank_mask:0xf
v_mfma_f32_16x16x32_bf16 v[132:135], v[48:51], a[88:91], v[132:135]
ds_read_b128 a[160:163], v13 offset:12288
s_add_u32 s76, s72, 14336
v_add_f32_dpp v235, v235, v235 row_ror:2 row_mask:0xf bank_mask:0xf
v_mfma_f32_16x16x32_bf16 v[136:139], v[48:51], a[152:155], v[136:139]
s_add_u32 m0, s75, 0
s_nop 0
buffer_load_dwordx4 v11, s[52:55], s76 offen offset:2048 lds
v_mfma_f32_16x16x32_bf16 v[140:143], v[48:51], a[216:219], v[140:143]
ds_read_b64_tr_b16 v[48:49], v2 offset:61440
v_add_f32_dpp v235, v235, v235 row_ror:1 row_mask:0xf bank_mask:0xf
s_waitcnt lgkmcnt(15)
v_mfma_f32_16x16x32_bf16 v[144:147], v[52:55], a[24:27], v[144:147]
ds_read_b64_tr_b16 v[50:51], v2 offset:63488
v_mov_b32 v194, v235
v_mfma_f32_16x16x32_bf16 v[148:151], v[52:55], a[88:91], v[148:151]
s_add_u32 s76, s72, 21504
v_permlane16_swap_b32 v235, v194
v_mfma_f32_16x16x32_bf16 v[152:155], v[52:55], a[152:155], v[152:155]
s_add_u32 m0, s75, 0
s_nop 0
buffer_load_dwordx4 v12, s[52:55], s76 offen offset:3072 lds
v_mfma_f32_16x16x32_bf16 v[156:159], v[52:55], a[216:219], v[156:159]
ds_read_b64_tr_b16 v[52:53], v3 offset:61440
v_add_f32 v235, v235, v194
s_waitcnt lgkmcnt(15)
v_mfma_f32_16x16x32_bf16 v[160:163], v[56:59], a[24:27], v[160:163]
ds_read_b64_tr_b16 v[54:55], v3 offset:63488
v_mul_f32 v235, 0.0015625, v235
v_mfma_f32_16x16x32_bf16 v[164:167], v[56:59], a[88:91], v[164:167]
ds_read_b128 a[224:227], v13 offset:14336
v_cvt_pk_bf16_f32 v235, v235, v235
v_mfma_f32_16x16x32_bf16 v[168:171], v[56:59], a[152:155], v[168:171]
v_lshlrev_b32 v235, 16, v235
v_mfma_f32_16x16x32_bf16 v[172:175], v[56:59], a[216:219], v[172:175]
ds_read_b64_tr_b16 v[56:57], v4 offset:61440
v_add_f32 v235, 1e-05, v235
s_waitcnt lgkmcnt(15)
v_mfma_f32_16x16x32_bf16 v[176:179], v[60:63], a[24:27], v[176:179]
ds_read_b64_tr_b16 v[58:59], v4 offset:63488
v_cvt_pk_bf16_f32 v235, v235, v235
v_mfma_f32_16x16x32_bf16 v[180:183], v[60:63], a[88:91], v[180:183]
v_lshlrev_b32 v235, 16, v235
v_mfma_f32_16x16x32_bf16 v[184:187], v[60:63], a[152:155], v[184:187]
v_sqrt_f32 v235, v235
v_mfma_f32_16x16x32_bf16 v[188:191], v[60:63], a[216:219], v[188:191]
ds_read_b64_tr_b16 v[60:61], v5 offset:61440
ds_read_b64_tr_b16 v[62:63], v5 offset:63488
v_cvt_pk_bf16_f32 v235, v235, v235
s_waitcnt lgkmcnt(15)
v_mfma_f32_16x16x32_bf16 v[64:67], v[32:35], a[28:31], v[64:67]
v_mfma_f32_16x16x32_bf16 v[68:71], v[32:35], a[92:95], v[68:71]
s_waitcnt lgkmcnt(0)
s_waitcnt vmcnt(2)
s_barrier
v_mfma_f32_16x16x32_bf16 v[72:75], v[32:35], a[156:159], v[72:75]
ds_read_b128 a[36:39], v14 offset:8192
v_lshlrev_b32 v235, 16, v235
v_mfma_f32_16x16x32_bf16 v[76:79], v[32:35], a[220:223], v[76:79]
ds_read_b64_tr_b16 v[32:33], v2 offset:0
v_rcp_f32 v236, v235
v_mfma_f32_16x16x32_bf16 v[80:83], v[36:39], a[28:31], v[80:83]
ds_read_b64_tr_b16 v[34:35], v2 offset:2048
v_mul_f32 v236, 0.12751743082459868, v236
v_mfma_f32_16x16x32_bf16 v[84:87], v[36:39], a[92:95], v[84:87]
s_add_u32 s76, s72, 32768
v_sub_f32 v208, v208, v234
v_mfma_f32_16x16x32_bf16 v[88:91], v[36:39], a[156:159], v[88:91]
s_add_u32 m0, s75, 4096
s_nop 0
buffer_load_dwordx4 v11, s[52:55], s76 offen offset:0 lds
v_mfma_f32_16x16x32_bf16 v[92:95], v[36:39], a[220:223], v[92:95]
ds_read_b64_tr_b16 v[36:37], v3 offset:0
v_sub_f32 v209, v209, v234
v_mfma_f32_16x16x32_bf16 v[96:99], v[40:43], a[28:31], v[96:99]
ds_read_b64_tr_b16 v[38:39], v3 offset:2048
v_cvt_pk_bf16_f32 v194, v208, v209
v_mfma_f32_16x16x32_bf16 v[100:103], v[40:43], a[92:95], v[100:103]
ds_read_b128 a[100:103], v14 offset:10240
s_add_u32 s81, s77, 12
s_and_b32 s81, s81, 15
s_lshl_b32 s81, s81, 18
s_add_u32 s81, s81, s73
v_lshlrev_b32 v208, 16, v194
v_mfma_f32_16x16x32_bf16 v[104:107], v[40:43], a[156:159], v[104:107]
s_add_u32 m0, s82, 32768
s_nop 0
buffer_load_dwordx4 v6, s[56:59], s81 offen offset:0 lds
v_mfma_f32_16x16x32_bf16 v[108:111], v[40:43], a[220:223], v[108:111]
ds_read_b64_tr_b16 v[40:41], v4 offset:0
v_and_b32 v209, 0xffff0000, v194
v_mfma_f32_16x16x32_bf16 v[112:115], v[44:47], a[28:31], v[112:115]
ds_read_b64_tr_b16 v[42:43], v4 offset:2048
v_mul_f32 v208, v208, v236
v_mfma_f32_16x16x32_bf16 v[116:119], v[44:47], a[92:95], v[116:119]
s_add_u32 s76, s72, 39936
v_mul_f32 v209, v209, v236
v_mfma_f32_16x16x32_bf16 v[120:123], v[44:47], a[156:159], v[120:123]
s_add_u32 m0, s75, 4096
s_nop 0
buffer_load_dwordx4 v12, s[52:55], s76 offen offset:1024 lds
v_mfma_f32_16x16x32_bf16 v[124:127], v[44:47], a[220:223], v[124:127]
ds_read_b64_tr_b16 v[44:45], v5 offset:0
v_cvt_pk_bf16_f32 v196, v208, v209
v_mfma_f32_16x16x32_bf16 v[128:131], v[48:51], a[28:31], v[128:131]
ds_read_b64_tr_b16 v[46:47], v5 offset:2048
v_sub_f32 v210, v210, v234
v_mfma_f32_16x16x32_bf16 v[132:135], v[48:51], a[92:95], v[132:135]
ds_read_b128 a[164:167], v14 offset:12288
v_sub_f32 v211, v211, v234
v_mfma_f32_16x16x32_bf16 v[136:139], v[48:51], a[156:159], v[136:139]
s_add_u32 m0, s82, 32768
s_nop 0
buffer_load_dwordx4 v7, s[56:59], s81 offen offset:1024 lds
v_mfma_f32_16x16x32_bf16 v[140:143], v[48:51], a[220:223], v[140:143]
ds_read_b64_tr_b16 v[48:49], v2 offset:4096
v_cvt_pk_bf16_f32 v194, v210, v211
v_mfma_f32_16x16x32_bf16 v[144:147], v[52:55], a[28:31], v[144:147]
ds_read_b64_tr_b16 v[50:51], v2 offset:6144
v_lshlrev_b32 v210, 16, v194
v_mfma_f32_16x16x32_bf16 v[148:151], v[52:55], a[92:95], v[148:151]
s_add_u32 s76, s72, 47104
v_and_b32 v211, 0xffff0000, v194
v_mfma_f32_16x16x32_bf16 v[152:155], v[52:55], a[156:159], v[152:155]
s_add_u32 m0, s75, 4096
s_nop 0
buffer_load_dwordx4 v11, s[52:55], s76 offen offset:2048 lds
v_mfma_f32_16x16x32_bf16 v[156:159], v[52:55], a[220:223], v[156:159]
ds_read_b64_tr_b16 v[52:53], v3 offset:4096
v_mul_f32 v210, v210, v236
v_mfma_f32_16x16x32_bf16 v[160:163], v[56:59], a[28:31], v[160:163]
ds_read_b64_tr_b16 v[54:55], v3 offset:6144
v_mul_f32 v211, v211, v236
v_mfma_f32_16x16x32_bf16 v[164:167], v[56:59], a[92:95], v[164:167]
ds_read_b128 a[228:231], v14 offset:14336
s_add_u32 s76, s72, 54272
v_cvt_pk_bf16_f32 v197, v210, v211
v_mfma_f32_16x16x32_bf16 v[168:171], v[56:59], a[156:159], v[168:171]
s_add_u32 m0, s75, 4096
s_nop 0
buffer_load_dwordx4 v12, s[52:55], s76 offen offset:3072 lds
v_mfma_f32_16x16x32_bf16 v[172:175], v[56:59], a[220:223], v[172:175]
ds_read_b64_tr_b16 v[56:57], v4 offset:4096
v_sub_f32 v212, v212, v234
v_mfma_f32_16x16x32_bf16 v[176:179], v[60:63], a[28:31], v[176:179]
ds_read_b64_tr_b16 v[58:59], v4 offset:6144
v_sub_f32 v213, v213, v234
v_mfma_f32_16x16x32_bf16 v[180:183], v[60:63], a[92:95], v[180:183]
v_cvt_pk_bf16_f32 v194, v212, v213
v_mfma_f32_16x16x32_bf16 v[184:187], v[60:63], a[156:159], v[184:187]
v_lshlrev_b32 v212, 16, v194
v_mfma_f32_16x16x32_bf16 v[188:191], v[60:63], a[220:223], v[188:191]
ds_read_b64_tr_b16 v[60:61], v5 offset:4096
v_and_b32 v213, 0xffff0000, v194
s_waitcnt lgkmcnt(15)
v_mfma_f32_16x16x32_bf16 v[64:67], v[32:35], a[32:35], v[64:67]
ds_read_b64_tr_b16 v[62:63], v5 offset:6144
v_mul_f32 v212, v212, v236
v_mfma_f32_16x16x32_bf16 v[68:71], v[32:35], a[96:99], v[68:71]
ds_read_b128 a[40:43], v13 offset:16384
s_add_u32 s72, s89, 14
s_and_b32 s72, s72, 15
s_lshl_b32 s72, s72, 6
s_add_u32 s72, s72, s74
s_add_u32 s76, s72, 0
v_mul_f32 v213, v213, v236
v_mfma_f32_16x16x32_bf16 v[72:75], v[32:35], a[160:163], v[72:75]
s_add_u32 m0, s75, 8192
s_nop 0
buffer_load_dwordx4 v11, s[52:55], s76 offen offset:0 lds
v_mfma_f32_16x16x32_bf16 v[76:79], v[32:35], a[224:227], v[76:79]
ds_read_b64_tr_b16 v[32:33], v2 offset:8192
v_cvt_pk_bf16_f32 v198, v212, v213
s_waitcnt lgkmcnt(15)
v_mfma_f32_16x16x32_bf16 v[80:83], v[36:39], a[32:35], v[80:83]
ds_read_b64_tr_b16 v[34:35], v2 offset:10240
v_sub_f32 v214, v214, v234
v_mfma_f32_16x16x32_bf16 v[84:87], v[36:39], a[96:99], v[84:87]
v_sub_f32 v215, v215, v234
v_mfma_f32_16x16x32_bf16 v[88:91], v[36:39], a[160:163], v[88:91]
s_add_u32 m0, s82, 32768
s_nop 0
buffer_load_dwordx4 v8, s[56:59], s81 offen offset:2048 lds
v_mfma_f32_16x16x32_bf16 v[92:95], v[36:39], a[224:227], v[92:95]
ds_read_b64_tr_b16 v[36:37], v3 offset:8192
v_cvt_pk_bf16_f32 v194, v214, v215
s_waitcnt lgkmcnt(15)
v_mfma_f32_16x16x32_bf16 v[96:99], v[40:43], a[32:35], v[96:99]
ds_read_b64_tr_b16 v[38:39], v3 offset:10240
v_lshlrev_b32 v214, 16, v194
v_mfma_f32_16x16x32_bf16 v[100:103], v[40:43], a[96:99], v[100:103]
ds_read_b128 a[104:107], v13 offset:18432
s_add_u32 s76, s72, 7168
v_and_b32 v215, 0xffff0000, v194
v_mfma_f32_16x16x32_bf16 v[104:107], v[40:43], a[160:163], v[104:107]
s_add_u32 m0, s75, 8192
s_nop 0
buffer_load_dwordx4 v12, s[52:55], s76 offen offset:1024 lds
v_mfma_f32_16x16x32_bf16 v[108:111], v[40:43], a[224:227], v[108:111]
ds_read_b64_tr_b16 v[40:41], v4 offset:8192
v_mul_f32 v214, v214, v236
s_waitcnt lgkmcnt(15)
v_mfma_f32_16x16x32_bf16 v[112:115], v[44:47], a[32:35], v[112:115]
ds_read_b64_tr_b16 v[42:43], v4 offset:10240
v_mul_f32 v215, v215, v236
v_mfma_f32_16x16x32_bf16 v[116:119], v[44:47], a[96:99], v[116:119]
v_cvt_pk_bf16_f32 v199, v214, v215
v_mfma_f32_16x16x32_bf16 v[120:123], v[44:47], a[160:163], v[120:123]
s_add_u32 m0, s82, 32768
s_nop 0
buffer_load_dwordx4 v9, s[56:59], s81 offen offset:3072 lds
v_mfma_f32_16x16x32_bf16 v[124:127], v[44:47], a[224:227], v[124:127]
ds_read_b64_tr_b16 v[44:45], v5 offset:8192
v_sub_f32 v216, v216, v234
s_waitcnt lgkmcnt(15)
v_mfma_f32_16x16x32_bf16 v[128:131], v[48:51], a[32:35], v[128:131]
ds_read_b64_tr_b16 v[46:47], v5 offset:10240
v_sub_f32 v217, v217, v234
v_mfma_f32_16x16x32_bf16 v[132:135], v[48:51], a[96:99], v[132:135]
ds_read_b128 a[168:171], v13 offset:20480
s_add_u32 s76, s72, 14336
v_cvt_pk_bf16_f32 v194, v216, v217
v_mfma_f32_16x16x32_bf16 v[136:139], v[48:51], a[160:163], v[136:139]
s_add_u32 m0, s75, 8192
s_nop 0
buffer_load_dwordx4 v11, s[52:55], s76 offen offset:2048 lds
v_mfma_f32_16x16x32_bf16 v[140:143], v[48:51], a[224:227], v[140:143]
ds_read_b64_tr_b16 v[48:49], v2 offset:12288
v_lshlrev_b32 v216, 16, v194
s_waitcnt lgkmcnt(15)
v_mfma_f32_16x16x32_bf16 v[144:147], v[52:55], a[32:35], v[144:147]
ds_read_b64_tr_b16 v[50:51], v2 offset:14336
v_and_b32 v217, 0xffff0000, v194
v_mfma_f32_16x16x32_bf16 v[148:151], v[52:55], a[96:99], v[148:151]
s_add_u32 s76, s72, 21504
v_mul_f32 v216, v216, v236
v_mfma_f32_16x16x32_bf16 v[152:155], v[52:55], a[160:163], v[152:155]
s_add_u32 m0, s75, 8192
s_nop 0
buffer_load_dwordx4 v12, s[52:55], s76 offen offset:3072 lds
v_mfma_f32_16x16x32_bf16 v[156:159], v[52:55], a[224:227], v[156:159]
ds_read_b64_tr_b16 v[52:53], v3 offset:12288
v_mul_f32 v217, v217, v236
s_waitcnt lgkmcnt(15)
v_mfma_f32_16x16x32_bf16 v[160:163], v[56:59], a[32:35], v[160:163]
ds_read_b64_tr_b16 v[54:55], v3 offset:14336
v_cvt_pk_bf16_f32 v200, v216, v217
v_mfma_f32_16x16x32_bf16 v[164:167], v[56:59], a[96:99], v[164:167]
ds_read_b128 a[232:235], v13 offset:22528
v_sub_f32 v218, v218, v234
v_mfma_f32_16x16x32_bf16 v[168:171], v[56:59], a[160:163], v[168:171]
v_sub_f32 v219, v219, v234
v_mfma_f32_16x16x32_bf16 v[172:175], v[56:59], a[224:227], v[172:175]
ds_read_b64_tr_b16 v[56:57], v4 offset:12288
v_cvt_pk_bf16_f32 v194, v218, v219
s_waitcnt lgkmcnt(15)
v_mfma_f32_16x16x32_bf16 v[176:179], v[60:63], a[32:35], v[176:179]
ds_read_b64_tr_b16 v[58:59], v4 offset:14336
v_lshlrev_b32 v218, 16, v194
v_mfma_f32_16x16x32_bf16 v[180:183], v[60:63], a[96:99], v[180:183]
v_and_b32 v219, 0xffff0000, v194
v_mfma_f32_16x16x32_bf16 v[184:187], v[60:63], a[160:163], v[184:187]
v_mfma_f32_16x16x32_bf16 v[188:191], v[60:63], a[224:227], v[188:191]
ds_read_b64_tr_b16 v[60:61], v5 offset:12288
s_waitcnt lgkmcnt(15)
v_mfma_f32_16x16x32_bf16 v[64:67], v[32:35], a[36:39], v[64:67]
ds_read_b64_tr_b16 v[62:63], v5 offset:14336
v_mul_f32 v218, v218, v236
v_mfma_f32_16x16x32_bf16 v[68:71], v[32:35], a[100:103], v[68:71]
ds_read_b128 a[44:47], v14 offset:16384
s_add_u32 s76, s72, 32768
v_mul_f32 v219, v219, v236
v_mfma_f32_16x16x32_bf16 v[72:75], v[32:35], a[164:167], v[72:75]
s_add_u32 m0, s75, 12288
s_nop 0
buffer_load_dwordx4 v11, s[52:55], s76 offen offset:0 lds
v_mfma_f32_16x16x32_bf16 v[76:79], v[32:35], a[228:231], v[76:79]
ds_read_b64_tr_b16 v[32:33], v2 offset:16384
v_cvt_pk_bf16_f32 v201, v218, v219
s_waitcnt lgkmcnt(15)
v_mfma_f32_16x16x32_bf16 v[80:83], v[36:39], a[36:39], v[80:83]
ds_read_b64_tr_b16 v[34:35], v2 offset:18432
v_sub_f32 v220, v220, v234
v_mfma_f32_16x16x32_bf16 v[84:87], v[36:39], a[100:103], v[84:87]
s_add_u32 s81, s77, 12
s_and_b32 s81, s81, 15
s_lshl_b32 s81, s81, 18
s_add_u32 s81, s81, s73
s_add_u32 s81, s81, 128
v_sub_f32 v221, v221, v234
v_mfma_f32_16x16x32_bf16 v[88:91], v[36:39], a[164:167], v[88:91]
s_add_u32 m0, s82, 36864
s_nop 0
buffer_load_dwordx4 v6, s[56:59], s81 offen offset:0 lds
v_mfma_f32_16x16x32_bf16 v[92:95], v[36:39], a[228:231], v[92:95]
ds_read_b64_tr_b16 v[36:37], v3 offset:16384
v_cvt_pk_bf16_f32 v194, v220, v221
s_waitcnt lgkmcnt(15)
v_mfma_f32_16x16x32_bf16 v[96:99], v[40:43], a[36:39], v[96:99]
ds_read_b64_tr_b16 v[38:39], v3 offset:18432
v_lshlrev_b32 v220, 16, v194
v_mfma_f32_16x16x32_bf16 v[100:103], v[40:43], a[100:103], v[100:103]
ds_read_b128 a[108:111], v14 offset:18432
s_add_u32 s76, s72, 39936
v_and_b32 v221, 0xffff0000, v194
v_mfma_f32_16x16x32_bf16 v[104:107], v[40:43], a[164:167], v[104:107]
s_add_u32 m0, s75, 12288
s_nop 0
buffer_load_dwordx4 v12, s[52:55], s76 offen offset:1024 lds
v_mfma_f32_16x16x32_bf16 v[108:111], v[40:43], a[228:231], v[108:111]
ds_read_b64_tr_b16 v[40:41], v4 offset:16384
v_mul_f32 v220, v220, v236
s_waitcnt lgkmcnt(15)
v_mfma_f32_16x16x32_bf16 v[112:115], v[44:47], a[36:39], v[112:115]
ds_read_b64_tr_b16 v[42:43], v4 offset:18432
v_mul_f32 v221, v221, v236
v_mfma_f32_16x16x32_bf16 v[116:119], v[44:47], a[100:103], v[116:119]
v_cvt_pk_bf16_f32 v202, v220, v221
v_mfma_f32_16x16x32_bf16 v[120:123], v[44:47], a[164:167], v[120:123]
s_add_u32 m0, s82, 36864
s_nop 0
buffer_load_dwordx4 v7, s[56:59], s81 offen offset:1024 lds
v_mfma_f32_16x16x32_bf16 v[124:127], v[44:47], a[228:231], v[124:127]
ds_read_b64_tr_b16 v[44:45], v5 offset:16384
v_sub_f32 v222, v222, v234
s_waitcnt lgkmcnt(15)
v_mfma_f32_16x16x32_bf16 v[128:131], v[48:51], a[36:39], v[128:131]
ds_read_b64_tr_b16 v[46:47], v5 offset:18432
v_sub_f32 v223, v223, v234
v_mfma_f32_16x16x32_bf16 v[132:135], v[48:51], a[100:103], v[132:135]
ds_read_b128 a[172:175], v14 offset:20480
s_add_u32 s76, s72, 47104
v_cvt_pk_bf16_f32 v194, v222, v223
v_mfma_f32_16x16x32_bf16 v[136:139], v[48:51], a[164:167], v[136:139]
s_add_u32 m0, s75, 12288
s_nop 0
buffer_load_dwordx4 v11, s[52:55], s76 offen offset:2048 lds
v_mfma_f32_16x16x32_bf16 v[140:143], v[48:51], a[228:231], v[140:143]
ds_read_b64_tr_b16 v[48:49], v2 offset:20480
v_lshlrev_b32 v222, 16, v194
s_waitcnt lgkmcnt(15)
v_mfma_f32_16x16x32_bf16 v[144:147], v[52:55], a[36:39], v[144:147]
ds_read_b64_tr_b16 v[50:51], v2 offset:22528
v_and_b32 v223, 0xffff0000, v194
v_mfma_f32_16x16x32_bf16 v[148:151], v[52:55], a[100:103], v[148:151]
s_add_u32 s76, s72, 54272
v_mul_f32 v222, v222, v236
v_mfma_f32_16x16x32_bf16 v[152:155], v[52:55], a[164:167], v[152:155]
s_add_u32 m0, s75, 12288
s_nop 0
buffer_load_dwordx4 v12, s[52:55], s76 offen offset:3072 lds
v_mfma_f32_16x16x32_bf16 v[156:159], v[52:55], a[228:231], v[156:159]
ds_read_b64_tr_b16 v[52:53], v3 offset:20480
v_mul_f32 v223, v223, v236
s_waitcnt lgkmcnt(15)
v_mfma_f32_16x16x32_bf16 v[160:163], v[56:59], a[36:39], v[160:163]
ds_read_b64_tr_b16 v[54:55], v3 offset:22528
v_cvt_pk_bf16_f32 v203, v222, v223
v_mfma_f32_16x16x32_bf16 v[164:167], v[56:59], a[100:103], v[164:167]
ds_read_b128 a[236:239], v14 offset:22528
v_sub_f32 v224, v224, v234
v_mfma_f32_16x16x32_bf16 v[168:171], v[56:59], a[164:167], v[168:171]
v_sub_f32 v225, v225, v234
v_mfma_f32_16x16x32_bf16 v[172:175], v[56:59], a[228:231], v[172:175]
ds_read_b64_tr_b16 v[56:57], v4 offset:20480
v_cvt_pk_bf16_f32 v194, v224, v225
s_waitcnt lgkmcnt(15)
v_mfma_f32_16x16x32_bf16 v[176:179], v[60:63], a[36:39], v[176:179]
ds_read_b64_tr_b16 v[58:59], v4 offset:22528
v_lshlrev_b32 v224, 16, v194
v_mfma_f32_16x16x32_bf16 v[180:183], v[60:63], a[100:103], v[180:183]
v_and_b32 v225, 0xffff0000, v194
v_mfma_f32_16x16x32_bf16 v[184:187], v[60:63], a[164:167], v[184:187]
v_mfma_f32_16x16x32_bf16 v[188:191], v[60:63], a[228:231], v[188:191]
ds_read_b64_tr_b16 v[60:61], v5 offset:20480
s_waitcnt lgkmcnt(15)
v_mfma_f32_16x16x32_bf16 v[64:67], v[32:35], a[40:43], v[64:67]
ds_read_b64_tr_b16 v[62:63], v5 offset:22528
v_mul_f32 v224, v224, v236
v_mfma_f32_16x16x32_bf16 v[68:71], v[32:35], a[104:107], v[68:71]
s_waitcnt vmcnt(12)
ds_read_b128 a[48:51], v13 offset:0
v_mul_f32 v225, v225, v236
v_mfma_f32_16x16x32_bf16 v[72:75], v[32:35], a[168:171], v[72:75]
s_add_u32 m0, s82, 36864
s_nop 0
buffer_load_dwordx4 v8, s[56:59], s81 offen offset:2048 lds
v_mfma_f32_16x16x32_bf16 v[76:79], v[32:35], a[232:235], v[76:79]
ds_read_b64_tr_b16 v[32:33], v2 offset:24576
v_cvt_pk_bf16_f32 v204, v224, v225
s_waitcnt lgkmcnt(15)
v_mfma_f32_16x16x32_bf16 v[80:83], v[36:39], a[40:43], v[80:83]
ds_read_b64_tr_b16 v[34:35], v2 offset:26624
v_sub_f32 v226, v226, v234
v_mfma_f32_16x16x32_bf16 v[84:87], v[36:39], a[104:107], v[84:87]
v_sub_f32 v227, v227, v234
v_mfma_f32_16x16x32_bf16 v[88:91], v[36:39], a[168:171], v[88:91]
s_add_u32 m0, s82, 36864
s_nop 0
buffer_load_dwordx4 v9, s[56:59], s81 offen offset:3072 lds
v_mfma_f32_16x16x32_bf16 v[92:95], v[36:39], a[232:235], v[92:95]
ds_read_b64_tr_b16 v[36:37], v3 offset:24576
v_cvt_pk_bf16_f32 v194, v226, v227
s_waitcnt lgkmcnt(15)
v_mfma_f32_16x16x32_bf16 v[96:99], v[40:43], a[40:43], v[96:99]
ds_read_b64_tr_b16 v[38:39], v3 offset:26624
v_lshlrev_b32 v226, 16, v194
v_mfma_f32_16x16x32_bf16 v[100:103], v[40:43], a[104:107], v[100:103]
ds_read_b128 a[112:115], v13 offset:2048
s_add_u32 s91, s90, 0
v_and_b32 v227, 0xffff0000, v194
v_mfma_f32_16x16x32_bf16 v[104:107], v[40:43], a[168:171], v[104:107]
buffer_load_dwordx4 v[16:19], v28, s[4:7], s91 offen
v_mul_f32 v226, v226, v236
v_mfma_f32_16x16x32_bf16 v[108:111], v[40:43], a[232:235], v[108:111]
ds_read_b64_tr_b16 v[40:41], v4 offset:24576
v_mul_f32 v227, v227, v236
s_waitcnt lgkmcnt(15)
v_mfma_f32_16x16x32_bf16 v[112:115], v[44:47], a[40:43], v[112:115]
ds_read_b64_tr_b16 v[42:43], v4 offset:26624
v_cvt_pk_bf16_f32 v205, v226, v227
v_mfma_f32_16x16x32_bf16 v[116:119], v[44:47], a[104:107], v[116:119]
s_add_u32 s91, s90, 32768
v_sub_f32 v228, v228, v234
v_mfma_f32_16x16x32_bf16 v[120:123], v[44:47], a[168:171], v[120:123]
buffer_load_dwordx4 v[16:19], v28, s[4:7], s91 offen
v_sub_f32 v229, v229, v234
v_mfma_f32_16x16x32_bf16 v[124:127], v[44:47], a[232:235], v[124:127]
ds_read_b64_tr_b16 v[44:45], v5 offset:24576
v_cvt_pk_bf16_f32 v194, v228, v229
s_waitcnt lgkmcnt(15)
v_mfma_f32_16x16x32_bf16 v[128:131], v[48:51], a[40:43], v[128:131]
ds_read_b64_tr_b16 v[46:47], v5 offset:26624
v_lshlrev_b32 v228, 16, v194
v_mfma_f32_16x16x32_bf16 v[132:135], v[48:51], a[104:107], v[132:135]
ds_read_b128 a[176:179], v13 offset:4096
s_add_u32 s91, s90, 65536
v_and_b32 v229, 0xffff0000, v194
v_mfma_f32_16x16x32_bf16 v[136:139], v[48:51], a[168:171], v[136:139]
buffer_load_dwordx4 v[16:19], v28, s[4:7], s91 offen
v_mul_f32 v228, v228, v236
v_mfma_f32_16x16x32_bf16 v[140:143], v[48:51], a[232:235], v[140:143]
ds_read_b64_tr_b16 v[48:49], v2 offset:28672
v_mul_f32 v229, v229, v236
s_waitcnt lgkmcnt(15)
v_mfma_f32_16x16x32_bf16 v[144:147], v[52:55], a[40:43], v[144:147]
ds_read_b64_tr_b16 v[50:51], v2 offset:30720
v_cvt_pk_bf16_f32 v206, v228, v229
v_mfma_f32_16x16x32_bf16 v[148:151], v[52:55], a[104:107], v[148:151]
s_add_u32 s91, s90, 98304
v_sub_f32 v230, v230, v234
v_mfma_f32_16x16x32_bf16 v[152:155], v[52:55], a[168:171], v[152:155]
buffer_load_dwordx4 v[16:19], v28, s[4:7], s91 offen
v_sub_f32 v231, v231, v234
v_mfma_f32_16x16x32_bf16 v[156:159], v[52:55], a[232:235], v[156:159]
ds_read_b64_tr_b16 v[52:53], v3 offset:28672
v_cvt_pk_bf16_f32 v194, v230, v231
s_waitcnt lgkmcnt(15)
v_mfma_f32_16x16x32_bf16 v[160:163], v[56:59], a[40:43], v[160:163]
ds_read_b64_tr_b16 v[54:55], v3 offset:30720
v_lshlrev_b32 v230, 16, v194
v_mfma_f32_16x16x32_bf16 v[164:167], v[56:59], a[104:107], v[164:167]
ds_read_b128 a[240:243], v13 offset:6144
s_add_u32 s91, s90, 131072
v_and_b32 v231, 0xffff0000, v194
v_mfma_f32_16x16x32_bf16 v[168:171], v[56:59], a[168:171], v[168:171]
buffer_load_dwordx4 v[16:19], v28, s[4:7], s91 offen
v_mfma_f32_16x16x32_bf16 v[172:175], v[56:59], a[232:235], v[172:175]
ds_read_b64_tr_b16 v[56:57], v4 offset:28672
s_waitcnt lgkmcnt(15)
v_mfma_f32_16x16x32_bf16 v[176:179], v[60:63], a[40:43], v[176:179]
ds_read_b64_tr_b16 v[58:59], v4 offset:30720
v_mfma_f32_16x16x32_bf16 v[180:183], v[60:63], a[104:107], v[180:183]
s_add_u32 s91, s90, 163840
v_mfma_f32_16x16x32_bf16 v[184:187], v[60:63], a[168:171], v[184:187]
buffer_load_dwordx4 v[16:19], v28, s[4:7], s91 offen
v_mfma_f32_16x16x32_bf16 v[188:191], v[60:63], a[232:235], v[188:191]
ds_read_b64_tr_b16 v[60:61], v5 offset:28672
ds_read_b64_tr_b16 v[62:63], v5 offset:30720
s_waitcnt lgkmcnt(15)
v_mfma_f32_16x16x32_bf16 v[64:67], v[32:35], a[44:47], v[64:67]
v_mfma_f32_16x16x32_bf16 v[68:71], v[32:35], a[108:111], v[68:71]
s_waitcnt lgkmcnt(0)
s_waitcnt vmcnt(6)
s_barrier
v_mfma_f32_16x16x32_bf16 v[72:75], v[32:35], a[172:175], v[72:75]
ds_read_b128 a[52:55], v14 offset:0
v_mul_f32 v230, v230, v236
v_mfma_f32_16x16x32_bf16 v[76:79], v[32:35], a[236:239], v[76:79]
ds_read_b64_tr_b16 v[32:33], v2 offset:32768
v_mul_f32 v231, v231, v236
v_mfma_f32_16x16x32_bf16 v[80:83], v[36:39], a[44:47], v[80:83]
ds_read_b64_tr_b16 v[34:35], v2 offset:34816
v_cvt_pk_bf16_f32 v207, v230, v231
v_mfma_f32_16x16x32_bf16 v[84:87], v[36:39], a[108:111], v[84:87]
s_add_u32 s81, s78, 0
s_and_b32 s81, s81, 15
s_lshl_b32 s81, s81, 18
s_add_u32 s81, s81, s73
v_bfe_u32 v195, v1, 4, 1
v_mfma_f32_16x16x32_bf16 v[88:91], v[36:39], a[172:175], v[88:91]
s_add_u32 m0, s82, 0
s_nop 0
buffer_load_dwordx4 v6, s[60:63], s81 offen offset:0 lds
v_mfma_f32_16x16x32_bf16 v[92:95], v[36:39], a[236:239], v[92:95]
ds_read_b64_tr_b16 v[36:37], v3 offset:32768
v_lshlrev_b32 v195, 29, v195
v_mfma_f32_16x16x32_bf16 v[96:99], v[40:43], a[44:47], v[96:99]
ds_read_b64_tr_b16 v[38:39], v3 offset:34816
v_or_b32 v195, v195, v238
v_mfma_f32_16x16x32_bf16 v[100:103], v[40:43], a[108:111], v[100:103]
ds_read_b128 a[116:119], v14 offset:2048
s_lshr_b32 s84, s69, 1
s_mul_i32 s84, s84, 20480
v_mfma_f32_16x16x32_bf16 v[104:107], v[40:43], a[172:175], v[104:107]
s_and_b32 s85, s69, 1
s_lshl_b32 s85, s85, 7
s_add_u32 m0, s82, 0
s_nop 0
buffer_load_dwordx4 v7, s[60:63], s81 offen offset:1024 lds
v_mfma_f32_16x16x32_bf16 v[108:111], v[40:43], a[236:239], v[108:111]
ds_read_b64_tr_b16 v[40:41], v4 offset:32768
s_add_u32 s84, s84, s85
s_lshl_b32 s85, s64, 5
v_mfma_f32_16x16x32_bf16 v[112:115], v[44:47], a[44:47], v[112:115]
ds_read_b64_tr_b16 v[42:43], v4 offset:34816
s_add_u32 s84, s84, s85
s_add_u32 s84, s84, 0
v_mfma_f32_16x16x32_bf16 v[116:119], v[44:47], a[108:111], v[116:119]
s_add_u32 s91, s90, 196608
v_mfma_f32_16x16x32_bf16 v[120:123], v[44:47], a[172:175], v[120:123]
buffer_store_dwordx4 v[196:199], v238, s[44:47], s84 offen sc1
buffer_load_dwordx4 v[16:19], v28, s[4:7], s91 offen
v_mfma_f32_16x16x32_bf16 v[124:127], v[44:47], a[236:239], v[124:127]
ds_read_b64_tr_b16 v[44:45], v5 offset:32768
s_add_u32 s85, s84, 8192
v_mfma_f32_16x16x32_bf16 v[128:131], v[48:51], a[44:47], v[128:131]
ds_read_b64_tr_b16 v[46:47], v5 offset:34816
v_mfma_f32_16x16x32_bf16 v[132:135], v[48:51], a[108:111], v[132:135]
ds_read_b128 a[180:183], v14 offset:4096
s_add_u32 s91, s90, 229376
v_mfma_f32_16x16x32_bf16 v[136:139], v[48:51], a[172:175], v[136:139]
buffer_store_dwordx4 v[200:203], v238, s[44:47], s85 offen sc1
buffer_load_dwordx4 v[16:19], v28, s[4:7], s91 offen
v_mfma_f32_16x16x32_bf16 v[140:143], v[48:51], a[236:239], v[140:143]
ds_read_b64_tr_b16 v[48:49], v2 offset:36864
s_add_u32 s84, s84, 16384
v_mfma_f32_16x16x32_bf16 v[144:147], v[52:55], a[44:47], v[144:147]
ds_read_b64_tr_b16 v[50:51], v2 offset:38912
v_mfma_f32_16x16x32_bf16 v[148:151], v[52:55], a[108:111], v[148:151]
s_add_u32 s91, s90, 262144
v_mfma_f32_16x16x32_bf16 v[152:155], v[52:55], a[172:175], v[152:155]
buffer_store_dwordx4 v[204:207], v195, s[44:47], s84 offen sc1
buffer_load_dwordx4 v[16:19], v28, s[4:7], s91 offen
v_mfma_f32_16x16x32_bf16 v[156:159], v[52:55], a[236:239], v[156:159]
ds_read_b64_tr_b16 v[52:53], v3 offset:36864
v_mfma_f32_16x16x32_bf16 v[160:163], v[56:59], a[44:47], v[160:163]
ds_read_b64_tr_b16 v[54:55], v3 offset:38912
v_mfma_f32_16x16x32_bf16 v[164:167], v[56:59], a[108:111], v[164:167]
ds_read_b128 a[244:247], v14 offset:6144
s_add_u32 s91, s90, 294912
v_mfma_f32_16x16x32_bf16 v[168:171], v[56:59], a[172:175], v[168:171]
buffer_load_dwordx4 v[16:19], v28, s[4:7], s91 offen
v_mfma_f32_16x16x32_bf16 v[172:175], v[56:59], a[236:239], v[172:175]
ds_read_b64_tr_b16 v[56:57], v4 offset:36864
v_mfma_f32_16x16x32_bf16 v[176:179], v[60:63], a[44:47], v[176:179]
ds_read_b64_tr_b16 v[58:59], v4 offset:38912
v_mfma_f32_16x16x32_bf16 v[180:183], v[60:63], a[108:111], v[180:183]
v_mfma_f32_16x16x32_bf16 v[184:187], v[60:63], a[172:175], v[184:187]
v_mfma_f32_16x16x32_bf16 v[188:191], v[60:63], a[236:239], v[188:191]
ds_read_b64_tr_b16 v[60:61], v5 offset:36864
s_waitcnt lgkmcnt(15)
v_mfma_f32_16x16x32_bf16 v[64:67], v[32:35], a[48:51], v[64:67]
ds_read_b64_tr_b16 v[62:63], v5 offset:38912
v_mfma_f32_16x16x32_bf16 v[68:71], v[32:35], a[112:115], v[68:71]
ds_read_b128 a[56:59], v13 offset:8192
v_mfma_f32_16x16x32_bf16 v[72:75], v[32:35], a[176:179], v[72:75]
s_add_u32 m0, s82, 0
s_nop 0
buffer_load_dwordx4 v8, s[60:63], s81 offen offset:2048 lds
v_mfma_f32_16x16x32_bf16 v[76:79], v[32:35], a[240:243], v[76:79]
ds_read_b64_tr_b16 v[32:33], v2 offset:40960
s_waitcnt lgkmcnt(15)
v_mfma_f32_16x16x32_bf16 v[80:83], v[36:39], a[48:51], v[80:83]
ds_read_b64_tr_b16 v[34:35], v2 offset:43008
v_mfma_f32_16x16x32_bf16 v[84:87], v[36:39], a[112:115], v[84:87]
v_mfma_f32_16x16x32_bf16 v[88:91], v[36:39], a[176:179], v[88:91]
s_add_u32 m0, s82, 0
s_nop 0
buffer_load_dwordx4 v9, s[60:63], s81 offen offset:3072 lds
v_mfma_f32_16x16x32_bf16 v[92:95], v[36:39], a[240:243], v[92:95]
ds_read_b64_tr_b16 v[36:37], v3 offset:40960
s_waitcnt lgkmcnt(15)
v_mfma_f32_16x16x32_bf16 v[96:99], v[40:43], a[48:51], v[96:99]
ds_read_b64_tr_b16 v[38:39], v3 offset:43008
v_mfma_f32_16x16x32_bf16 v[100:103], v[40:43], a[112:115], v[100:103]
ds_read_b128 a[120:123], v13 offset:10240
v_mfma_f32_16x16x32_bf16 v[104:107], v[40:43], a[176:179], v[104:107]
v_mfma_f32_16x16x32_bf16 v[108:111], v[40:43], a[240:243], v[108:111]
ds_read_b64_tr_b16 v[40:41], v4 offset:40960
s_waitcnt lgkmcnt(15)
v_mfma_f32_16x16x32_bf16 v[112:115], v[44:47], a[48:51], v[112:115]
ds_read_b64_tr_b16 v[42:43], v4 offset:43008
v_mfma_f32_16x16x32_bf16 v[116:119], v[44:47], a[112:115], v[116:119]
v_mfma_f32_16x16x32_bf16 v[120:123], v[44:47], a[176:179], v[120:123]
v_mfma_f32_16x16x32_bf16 v[124:127], v[44:47], a[240:243], v[124:127]
ds_read_b64_tr_b16 v[44:45], v5 offset:40960
s_waitcnt lgkmcnt(15)
v_mfma_f32_16x16x32_bf16 v[128:131], v[48:51], a[48:51], v[128:131]
ds_read_b64_tr_b16 v[46:47], v5 offset:43008
v_mfma_f32_16x16x32_bf16 v[132:135], v[48:51], a[112:115], v[132:135]
ds_read_b128 a[184:187], v13 offset:12288
v_mfma_f32_16x16x32_bf16 v[136:139], v[48:51], a[176:179], v[136:139]
v_mfma_f32_16x16x32_bf16 v[140:143], v[48:51], a[240:243], v[140:143]
ds_read_b64_tr_b16 v[48:49], v2 offset:45056
s_waitcnt lgkmcnt(15)
v_mfma_f32_16x16x32_bf16 v[144:147], v[52:55], a[48:51], v[144:147]
ds_read_b64_tr_b16 v[50:51], v2 offset:47104
v_mfma_f32_16x16x32_bf16 v[148:151], v[52:55], a[112:115], v[148:151]
v_mfma_f32_16x16x32_bf16 v[152:155], v[52:55], a[176:179], v[152:155]
v_mfma_f32_16x16x32_bf16 v[156:159], v[52:55], a[240:243], v[156:159]
ds_read_b64_tr_b16 v[52:53], v3 offset:45056
s_waitcnt lgkmcnt(15)
v_mfma_f32_16x16x32_bf16 v[160:163], v[56:59], a[48:51], v[160:163]
ds_read_b64_tr_b16 v[54:55], v3 offset:47104
v_mfma_f32_16x16x32_bf16 v[164:167], v[56:59], a[112:115], v[164:167]
ds_read_b128 a[248:251], v13 offset:14336
v_mfma_f32_16x16x32_bf16 v[168:171], v[56:59], a[176:179], v[168:171]
v_mfma_f32_16x16x32_bf16 v[172:175], v[56:59], a[240:243], v[172:175]
ds_read_b64_tr_b16 v[56:57], v4 offset:45056
s_waitcnt lgkmcnt(15)
v_mfma_f32_16x16x32_bf16 v[176:179], v[60:63], a[48:51], v[176:179]
ds_read_b64_tr_b16 v[58:59], v4 offset:47104
v_mfma_f32_16x16x32_bf16 v[180:183], v[60:63], a[112:115], v[180:183]
v_mfma_f32_16x16x32_bf16 v[184:187], v[60:63], a[176:179], v[184:187]
v_mfma_f32_16x16x32_bf16 v[188:191], v[60:63], a[240:243], v[188:191]
ds_read_b64_tr_b16 v[60:61], v5 offset:45056
s_waitcnt lgkmcnt(15)
v_mfma_f32_16x16x32_bf16 v[64:67], v[32:35], a[52:55], v[64:67]
ds_read_b64_tr_b16 v[62:63], v5 offset:47104
v_mfma_f32_16x16x32_bf16 v[68:71], v[32:35], a[116:119], v[68:71]
ds_read_b128 a[60:63], v14 offset:8192
s_add_u32 s81, s78, 1
s_and_b32 s81, s81, 15
s_lshl_b32 s81, s81, 18
s_add_u32 s81, s81, s73
v_mfma_f32_16x16x32_bf16 v[72:75], v[32:35], a[180:183], v[72:75]
s_add_u32 m0, s82, 4096
s_nop 0
buffer_load_dwordx4 v6, s[60:63], s81 offen offset:0 lds
v_mfma_f32_16x16x32_bf16 v[76:79], v[32:35], a[244:247], v[76:79]
ds_read_b64_tr_b16 v[32:33], v2 offset:49152
s_waitcnt lgkmcnt(15)
v_mfma_f32_16x16x32_bf16 v[80:83], v[36:39], a[52:55], v[80:83]
ds_read_b64_tr_b16 v[34:35], v2 offset:51200
v_mfma_f32_16x16x32_bf16 v[84:87], v[36:39], a[116:119], v[84:87]
v_mfma_f32_16x16x32_bf16 v[88:91], v[36:39], a[180:183], v[88:91]
s_add_u32 m0, s82, 4096
s_nop 0
buffer_load_dwordx4 v7, s[60:63], s81 offen offset:1024 lds
v_mfma_f32_16x16x32_bf16 v[92:95], v[36:39], a[244:247], v[92:95]
ds_read_b64_tr_b16 v[36:37], v3 offset:49152
s_waitcnt lgkmcnt(15)
v_mfma_f32_16x16x32_bf16 v[96:99], v[40:43], a[52:55], v[96:99]
ds_read_b64_tr_b16 v[38:39], v3 offset:51200
v_mfma_f32_16x16x32_bf16 v[100:103], v[40:43], a[116:119], v[100:103]
ds_read_b128 a[124:127], v14 offset:10240
v_mfma_f32_16x16x32_bf16 v[104:107], v[40:43], a[180:183], v[104:107]
v_mfma_f32_16x16x32_bf16 v[108:111], v[40:43], a[244:247], v[108:111]
ds_read_b64_tr_b16 v[40:41], v4 offset:49152
s_waitcnt lgkmcnt(15)
v_mfma_f32_16x16x32_bf16 v[112:115], v[44:47], a[52:55], v[112:115]
ds_read_b64_tr_b16 v[42:43], v4 offset:51200
v_mfma_f32_16x16x32_bf16 v[116:119], v[44:47], a[116:119], v[116:119]
v_mfma_f32_16x16x32_bf16 v[120:123], v[44:47], a[180:183], v[120:123]
v_mfma_f32_16x16x32_bf16 v[124:127], v[44:47], a[244:247], v[124:127]
ds_read_b64_tr_b16 v[44:45], v5 offset:49152
s_waitcnt lgkmcnt(15)
v_mfma_f32_16x16x32_bf16 v[128:131], v[48:51], a[52:55], v[128:131]
ds_read_b64_tr_b16 v[46:47], v5 offset:51200
v_mfma_f32_16x16x32_bf16 v[132:135], v[48:51], a[116:119], v[132:135]
ds_read_b128 a[188:191], v14 offset:12288
v_mfma_f32_16x16x32_bf16 v[136:139], v[48:51], a[180:183], v[136:139]
v_mfma_f32_16x16x32_bf16 v[140:143], v[48:51], a[244:247], v[140:143]
ds_read_b64_tr_b16 v[48:49], v2 offset:53248
s_waitcnt lgkmcnt(15)
v_mfma_f32_16x16x32_bf16 v[144:147], v[52:55], a[52:55], v[144:147]
ds_read_b64_tr_b16 v[50:51], v2 offset:55296
v_mfma_f32_16x16x32_bf16 v[148:151], v[52:55], a[116:119], v[148:151]
v_mfma_f32_16x16x32_bf16 v[152:155], v[52:55], a[180:183], v[152:155]
v_mfma_f32_16x16x32_bf16 v[156:159], v[52:55], a[244:247], v[156:159]
ds_read_b64_tr_b16 v[52:53], v3 offset:53248
s_waitcnt lgkmcnt(15)
v_mfma_f32_16x16x32_bf16 v[160:163], v[56:59], a[52:55], v[160:163]
ds_read_b64_tr_b16 v[54:55], v3 offset:55296
v_mfma_f32_16x16x32_bf16 v[164:167], v[56:59], a[116:119], v[164:167]
ds_read_b128 a[252:255], v14 offset:14336
v_mfma_f32_16x16x32_bf16 v[168:171], v[56:59], a[180:183], v[168:171]
v_mfma_f32_16x16x32_bf16 v[172:175], v[56:59], a[244:247], v[172:175]
ds_read_b64_tr_b16 v[56:57], v4 offset:53248
s_waitcnt lgkmcnt(15)
v_mfma_f32_16x16x32_bf16 v[176:179], v[60:63], a[52:55], v[176:179]
ds_read_b64_tr_b16 v[58:59], v4 offset:55296
v_mfma_f32_16x16x32_bf16 v[180:183], v[60:63], a[116:119], v[180:183]
v_mfma_f32_16x16x32_bf16 v[184:187], v[60:63], a[180:183], v[184:187]
v_mfma_f32_16x16x32_bf16 v[188:191], v[60:63], a[244:247], v[188:191]
ds_read_b64_tr_b16 v[60:61], v5 offset:53248
s_waitcnt lgkmcnt(15)
v_mfma_f32_16x16x32_bf16 v[64:67], v[32:35], a[56:59], v[64:67]
ds_read_b64_tr_b16 v[62:63], v5 offset:55296
v_mfma_f32_16x16x32_bf16 v[68:71], v[32:35], a[120:123], v[68:71]
v_mfma_f32_16x16x32_bf16 v[72:75], v[32:35], a[184:187], v[72:75]
s_add_u32 m0, s82, 4096
s_nop 0
buffer_load_dwordx4 v8, s[60:63], s81 offen offset:2048 lds
v_mfma_f32_16x16x32_bf16 v[76:79], v[32:35], a[248:251], v[76:79]
ds_read_b64_tr_b16 v[32:33], v2 offset:57344
s_waitcnt lgkmcnt(15)
v_mfma_f32_16x16x32_bf16 v[80:83], v[36:39], a[56:59], v[80:83]
ds_read_b64_tr_b16 v[34:35], v2 offset:59392
v_mfma_f32_16x16x32_bf16 v[84:87], v[36:39], a[120:123], v[84:87]
v_mfma_f32_16x16x32_bf16 v[88:91], v[36:39], a[184:187], v[88:91]
s_add_u32 m0, s82, 4096
s_nop 0
buffer_load_dwordx4 v9, s[60:63], s81 offen offset:3072 lds
v_mfma_f32_16x16x32_bf16 v[92:95], v[36:39], a[248:251], v[92:95]
ds_read_b64_tr_b16 v[36:37], v3 offset:57344
s_waitcnt lgkmcnt(15)
v_mfma_f32_16x16x32_bf16 v[96:99], v[40:43], a[56:59], v[96:99]
ds_read_b64_tr_b16 v[38:39], v3 offset:59392
v_mfma_f32_16x16x32_bf16 v[100:103], v[40:43], a[120:123], v[100:103]
v_mfma_f32_16x16x32_bf16 v[104:107], v[40:43], a[184:187], v[104:107]
v_mfma_f32_16x16x32_bf16 v[108:111], v[40:43], a[248:251], v[108:111]
ds_read_b64_tr_b16 v[40:41], v4 offset:57344
s_waitcnt lgkmcnt(15)
v_mfma_f32_16x16x32_bf16 v[112:115], v[44:47], a[56:59], v[112:115]
ds_read_b64_tr_b16 v[42:43], v4 offset:59392
v_mfma_f32_16x16x32_bf16 v[116:119], v[44:47], a[120:123], v[116:119]
v_mfma_f32_16x16x32_bf16 v[120:123], v[44:47], a[184:187], v[120:123]
v_mfma_f32_16x16x32_bf16 v[124:127], v[44:47], a[248:251], v[124:127]
ds_read_b64_tr_b16 v[44:45], v5 offset:57344
s_waitcnt lgkmcnt(14)
v_mfma_f32_16x16x32_bf16 v[128:131], v[48:51], a[56:59], v[128:131]
ds_read_b64_tr_b16 v[46:47], v5 offset:59392
v_mfma_f32_16x16x32_bf16 v[132:135], v[48:51], a[120:123], v[132:135]
v_mfma_f32_16x16x32_bf16 v[136:139], v[48:51], a[184:187], v[136:139]
v_mfma_f32_16x16x32_bf16 v[140:143], v[48:51], a[248:251], v[140:143]
ds_read_b64_tr_b16 v[48:49], v2 offset:61440
s_waitcnt lgkmcnt(14)
v_mfma_f32_16x16x32_bf16 v[144:147], v[52:55], a[56:59], v[144:147]
ds_read_b64_tr_b16 v[50:51], v2 offset:63488
v_mfma_f32_16x16x32_bf16 v[148:151], v[52:55], a[120:123], v[148:151]
v_mfma_f32_16x16x32_bf16 v[152:155], v[52:55], a[184:187], v[152:155]
v_mfma_f32_16x16x32_bf16 v[156:159], v[52:55], a[248:251], v[156:159]
ds_read_b64_tr_b16 v[52:53], v3 offset:61440
s_waitcnt lgkmcnt(13)
v_mfma_f32_16x16x32_bf16 v[160:163], v[56:59], a[56:59], v[160:163]
ds_read_b64_tr_b16 v[54:55], v3 offset:63488
v_mfma_f32_16x16x32_bf16 v[164:167], v[56:59], a[120:123], v[164:167]
v_mfma_f32_16x16x32_bf16 v[168:171], v[56:59], a[184:187], v[168:171]
v_mfma_f32_16x16x32_bf16 v[172:175], v[56:59], a[248:251], v[172:175]
ds_read_b64_tr_b16 v[56:57], v4 offset:61440
s_waitcnt lgkmcnt(13)
v_mfma_f32_16x16x32_bf16 v[176:179], v[60:63], a[56:59], v[176:179]
ds_read_b64_tr_b16 v[58:59], v4 offset:63488
v_mfma_f32_16x16x32_bf16 v[180:183], v[60:63], a[120:123], v[180:183]
v_mfma_f32_16x16x32_bf16 v[184:187], v[60:63], a[184:187], v[184:187]
v_mfma_f32_16x16x32_bf16 v[188:191], v[60:63], a[248:251], v[188:191]
ds_read_b64_tr_b16 v[60:61], v5 offset:61440
ds_read_b64_tr_b16 v[62:63], v5 offset:63488
s_waitcnt lgkmcnt(14)
v_mfma_f32_16x16x32_bf16 v[64:67], v[32:35], a[60:63], v[64:67]
v_mfma_f32_16x16x32_bf16 v[68:71], v[32:35], a[124:127], v[68:71]
s_waitcnt lgkmcnt(0)
s_waitcnt vmcnt(0)
s_barrier
s_mov_b32 s70, 0
s_cmp_lg_u32 s64, 0
s_cbranch_scc1 L_sig_1
v_mov_b32 v28, 1
v_mov_b32 v29, 0
s_mov_b64 exec, 1
buffer_atomic_add v28, v29, s[96:99], s70 offen sc1
s_mov_b64 exec, -1
L_sig_1:
v_mfma_f32_16x16x32_bf16 v[72:75], v[32:35], a[188:191], v[72:75]
v_mfma_f32_16x16x32_bf16 v[76:79], v[32:35], a[252:255], v[76:79]
ds_read_b64_tr_b16 v[32:33], v2 offset:0
v_mfma_f32_16x16x32_bf16 v[80:83], v[36:39], a[60:63], v[80:83]
ds_read_b64_tr_b16 v[34:35], v2 offset:2048
v_mfma_f32_16x16x32_bf16 v[84:87], v[36:39], a[124:127], v[84:87]
s_add_u32 s81, s78, 8
s_and_b32 s81, s81, 15
s_lshl_b32 s81, s81, 18
s_add_u32 s81, s81, s73
v_mfma_f32_16x16x32_bf16 v[88:91], v[36:39], a[188:191], v[88:91]
s_add_u32 m0, s82, 32768
s_nop 0
buffer_load_dwordx4 v6, s[60:63], s81 offen offset:0 lds
v_mfma_f32_16x16x32_bf16 v[92:95], v[36:39], a[252:255], v[92:95]
ds_read_b64_tr_b16 v[36:37], v3 offset:0
v_mfma_f32_16x16x32_bf16 v[96:99], v[40:43], a[60:63], v[96:99]
ds_read_b64_tr_b16 v[38:39], v3 offset:2048
v_mfma_f32_16x16x32_bf16 v[100:103], v[40:43], a[124:127], v[100:103]
v_mfma_f32_16x16x32_bf16 v[104:107], v[40:43], a[188:191], v[104:107]
s_add_u32 m0, s82, 32768
s_nop 0
buffer_load_dwordx4 v7, s[60:63], s81 offen offset:1024 lds
v_mfma_f32_16x16x32_bf16 v[108:111], v[40:43], a[252:255], v[108:111]
ds_read_b64_tr_b16 v[40:41], v4 offset:0
v_mfma_f32_16x16x32_bf16 v[112:115], v[44:47], a[60:63], v[112:115]
ds_read_b64_tr_b16 v[42:43], v4 offset:2048
v_mfma_f32_16x16x32_bf16 v[116:119], v[44:47], a[124:127], v[116:119]
v_mfma_f32_16x16x32_bf16 v[120:123], v[44:47], a[188:191], v[120:123]
v_mfma_f32_16x16x32_bf16 v[124:127], v[44:47], a[252:255], v[124:127]
ds_read_b64_tr_b16 v[44:45], v5 offset:0
v_mfma_f32_16x16x32_bf16 v[128:131], v[48:51], a[60:63], v[128:131]
ds_read_b64_tr_b16 v[46:47], v5 offset:2048
v_mfma_f32_16x16x32_bf16 v[132:135], v[48:51], a[124:127], v[132:135]
v_mfma_f32_16x16x32_bf16 v[136:139], v[48:51], a[188:191], v[136:139]
v_mfma_f32_16x16x32_bf16 v[140:143], v[48:51], a[252:255], v[140:143]
v_mfma_f32_16x16x32_bf16 v[144:147], v[52:55], a[60:63], v[144:147]
v_mfma_f32_16x16x32_bf16 v[148:151], v[52:55], a[124:127], v[148:151]
v_mfma_f32_16x16x32_bf16 v[152:155], v[52:55], a[188:191], v[152:155]
v_mfma_f32_16x16x32_bf16 v[156:159], v[52:55], a[252:255], v[156:159]
v_mfma_f32_16x16x32_bf16 v[160:163], v[56:59], a[60:63], v[160:163]
v_mfma_f32_16x16x32_bf16 v[164:167], v[56:59], a[124:127], v[164:167]
v_mfma_f32_16x16x32_bf16 v[168:171], v[56:59], a[188:191], v[168:171]
v_mfma_f32_16x16x32_bf16 v[172:175], v[56:59], a[252:255], v[172:175]
v_mfma_f32_16x16x32_bf16 v[176:179], v[60:63], a[60:63], v[176:179]
v_mfma_f32_16x16x32_bf16 v[180:183], v[60:63], a[124:127], v[180:183]
v_mfma_f32_16x16x32_bf16 v[184:187], v[60:63], a[188:191], v[184:187]
v_mfma_f32_16x16x32_bf16 v[188:191], v[60:63], a[252:255], v[188:191]
s_waitcnt lgkmcnt(6)
v_mfma_f32_16x16x32_bf16 v[192:195], a[0:3], v[32:35], 0
ds_read_b64_tr_b16 v[48:49], v2 offset:4096
v_mfma_f32_16x16x32_bf16 v[196:199], a[64:67], v[32:35], 0
v_mfma_f32_16x16x32_bf16 v[200:203], a[128:131], v[32:35], 0
ds_read_b64_tr_b16 v[50:51], v2 offset:6144
v_mfma_f32_16x16x32_bf16 v[204:207], a[192:195], v[32:35], 0
s_add_u32 m0, s82, 32768
s_nop 0
buffer_load_dwordx4 v8, s[60:63], s81 offen offset:2048 lds
s_waitcnt lgkmcnt(6)
v_mfma_f32_16x16x32_bf16 v[208:211], a[0:3], v[36:39], 0
ds_read_b64_tr_b16 v[52:53], v3 offset:4096
v_mfma_f32_16x16x32_bf16 v[212:215], a[64:67], v[36:39], 0
v_mfma_f32_16x16x32_bf16 v[216:219], a[128:131], v[36:39], 0
ds_read_b64_tr_b16 v[54:55], v3 offset:6144
v_mfma_f32_16x16x32_bf16 v[220:223], a[192:195], v[36:39], 0
s_waitcnt lgkmcnt(6)
v_mfma_f32_16x16x32_bf16 v[224:227], a[0:3], v[40:43], 0
ds_read_b64_tr_b16 v[56:57], v4 offset:4096
s_add_u32 m0, s82, 32768
s_nop 0
buffer_load_dwordx4 v9, s[60:63], s81 offen offset:3072 lds
v_mfma_f32_16x16x32_bf16 v[228:231], a[64:67], v[40:43], 0
v_mfma_f32_16x16x32_bf16 v[232:235], a[128:131], v[40:43], 0
ds_read_b64_tr_b16 v[58:59], v4 offset:6144
v_mfma_f32_16x16x32_bf16 v[236:239], a[192:195], v[40:43], 0
s_waitcnt lgkmcnt(6)
v_mfma_f32_16x16x32_bf16 v[240:243], a[0:3], v[44:47], 0
ds_read_b64_tr_b16 v[60:61], v5 offset:4096
s_add_u32 s81, s78, 9
s_and_b32 s81, s81, 15
s_lshl_b32 s81, s81, 18
s_add_u32 s81, s81, s73
v_mfma_f32_16x16x32_bf16 v[244:247], a[64:67], v[44:47], 0
s_add_u32 m0, s82, 36864
s_nop 0
buffer_load_dwordx4 v6, s[60:63], s81 offen offset:0 lds
v_mfma_f32_16x16x32_bf16 v[248:251], a[128:131], v[44:47], 0
ds_read_b64_tr_b16 v[62:63], v5 offset:6144
v_mfma_f32_16x16x32_bf16 v[252:255], a[192:195], v[44:47], 0
s_waitcnt lgkmcnt(6)
v_mfma_f32_16x16x32_bf16 v[192:195], a[4:7], v[48:51], v[192:195]
ds_read_b64_tr_b16 v[32:33], v2 offset:8192
v_cvt_pk_bf16_f32 v128, v128, v129
v_mfma_f32_16x16x32_bf16 v[196:199], a[68:71], v[48:51], v[196:199]
v_cvt_pk_bf16_f32 v129, v130, v131
v_mfma_f32_16x16x32_bf16 v[200:203], a[132:135], v[48:51], v[200:203]
ds_read_b64_tr_b16 v[34:35], v2 offset:10240
v_cvt_pk_bf16_f32 v130, v144, v145
v_mfma_f32_16x16x32_bf16 v[204:207], a[196:199], v[48:51], v[204:207]
s_add_u32 m0, s82, 36864
s_nop 0
buffer_load_dwordx4 v7, s[60:63], s81 offen offset:1024 lds
s_waitcnt lgkmcnt(6)
v_mfma_f32_16x16x32_bf16 v[208:211], a[4:7], v[52:55], v[208:211]
ds_read_b64_tr_b16 v[36:37], v3 offset:8192
v_cvt_pk_bf16_f32 v131, v146, v147
v_mfma_f32_16x16x32_bf16 v[212:215], a[68:71], v[52:55], v[212:215]
v_cvt_pk_bf16_f32 v132, v132, v133
v_mfma_f32_16x16x32_bf16 v[216:219], a[132:135], v[52:55], v[216:219]
ds_read_b64_tr_b16 v[38:39], v3 offset:10240
v_cvt_pk_bf16_f32 v133, v134, v135
v_mfma_f32_16x16x32_bf16 v[220:223], a[196:199], v[52:55], v[220:223]
s_waitcnt lgkmcnt(6)
v_mfma_f32_16x16x32_bf16 v[224:227], a[4:7], v[56:59], v[224:227]
ds_read_b64_tr_b16 v[40:41], v4 offset:8192
s_add_u32 m0, s82, 36864
s_nop 0
buffer_load_dwordx4 v8, s[60:63], s81 offen offset:2048 lds
v_mfma_f32_16x16x32_bf16 v[228:231], a[68:71], v[56:59], v[228:231]
v_mfma_f32_16x16x32_bf16 v[232:235], a[132:135], v[56:59], v[232:235]
ds_read_b64_tr_b16 v[42:43], v4 offset:10240
v_mfma_f32_16x16x32_bf16 v[236:239], a[196:199], v[56:59], v[236:239]
s_waitcnt lgkmcnt(6)
v_mfma_f32_16x16x32_bf16 v[240:243], a[4:7], v[60:63], v[240:243]
ds_read_b64_tr_b16 v[44:45], v5 offset:8192
v_mfma_f32_16x16x32_bf16 v[244:247], a[68:71], v[60:63], v[244:247]
s_add_u32 m0, s82, 36864
s_nop 0
buffer_load_dwordx4 v9, s[60:63], s81 offen offset:3072 lds
v_mfma_f32_16x16x32_bf16 v[248:251], a[132:135], v[60:63], v[248:251]
ds_read_b64_tr_b16 v[46:47], v5 offset:10240
v_mfma_f32_16x16x32_bf16 v[252:255], a[196:199], v[60:63], v[252:255]
s_waitcnt lgkmcnt(6)
v_mfma_f32_16x16x32_bf16 v[192:195], a[8:11], v[32:35], v[192:195]
ds_read_b64_tr_b16 v[48:49], v2 offset:12288
v_cvt_pk_bf16_f32 v134, v148, v149
v_mfma_f32_16x16x32_bf16 v[196:199], a[72:75], v[32:35], v[196:199]
v_cvt_pk_bf16_f32 v135, v150, v151
v_mfma_f32_16x16x32_bf16 v[200:203], a[136:139], v[32:35], v[200:203]
ds_read_b64_tr_b16 v[50:51], v2 offset:14336
s_add_u32 s81, s78, 0
s_and_b32 s81, s81, 15
s_lshl_b32 s81, s81, 18
s_add_u32 s81, s81, s73
s_add_u32 s81, s81, 128
v_cvt_pk_bf16_f32 v136, v136, v137
v_mfma_f32_16x16x32_bf16 v[204:207], a[200:203], v[32:35], v[204:207]
s_add_u32 m0, s82, 65536
s_nop 0
buffer_load_dwordx4 v6, s[60:63], s81 offen offset:0 lds
s_waitcnt lgkmcnt(6)
v_mfma_f32_16x16x32_bf16 v[208:211], a[8:11], v[36:39], v[208:211]
ds_read_b64_tr_b16 v[52:53], v3 offset:12288
v_cvt_pk_bf16_f32 v137, v138, v139
v_mfma_f32_16x16x32_bf16 v[212:215], a[72:75], v[36:39], v[212:215]
v_cvt_pk_bf16_f32 v138, v152, v153
v_mfma_f32_16x16x32_bf16 v[216:219], a[136:139], v[36:39], v[216:219]
ds_read_b64_tr_b16 v[54:55], v3 offset:14336
v_cvt_pk_bf16_f32 v139, v154, v155
v_mfma_f32_16x16x32_bf16 v[220:223], a[200:203], v[36:39], v[220:223]
s_waitcnt lgkmcnt(6)
v_mfma_f32_16x16x32_bf16 v[224:227], a[8:11], v[40:43], v[224:227]
ds_read_b64_tr_b16 v[56:57], v4 offset:12288
s_add_u32 m0, s82, 65536
s_nop 0
buffer_load_dwordx4 v7, s[60:63], s81 offen offset:1024 lds
v_mfma_f32_16x16x32_bf16 v[228:231], a[72:75], v[40:43], v[228:231]
v_mfma_f32_16x16x32_bf16 v[232:235], a[136:139], v[40:43], v[232:235]
ds_read_b64_tr_b16 v[58:59], v4 offset:14336
v_mfma_f32_16x16x32_bf16 v[236:239], a[200:203], v[40:43], v[236:239]
s_waitcnt lgkmcnt(6)
v_mfma_f32_16x16x32_bf16 v[240:243], a[8:11], v[44:47], v[240:243]
ds_read_b64_tr_b16 v[60:61], v5 offset:12288
v_mfma_f32_16x16x32_bf16 v[244:247], a[72:75], v[44:47], v[244:247]
s_add_u32 m0, s82, 65536
s_nop 0
buffer_load_dwordx4 v8, s[60:63], s81 offen offset:2048 lds
v_mfma_f32_16x16x32_bf16 v[248:251], a[136:139], v[44:47], v[248:251]
ds_read_b64_tr_b16 v[62:63], v5 offset:14336
v_mfma_f32_16x16x32_bf16 v[252:255], a[200:203], v[44:47], v[252:255]
s_waitcnt lgkmcnt(6)
v_mfma_f32_16x16x32_bf16 v[192:195], a[12:15], v[48:51], v[192:195]
ds_read_b64_tr_b16 v[32:33], v2 offset:16384
v_cvt_pk_bf16_f32 v140, v140, v141
v_mfma_f32_16x16x32_bf16 v[196:199], a[76:79], v[48:51], v[196:199]
v_cvt_pk_bf16_f32 v141, v142, v143
v_mfma_f32_16x16x32_bf16 v[200:203], a[140:143], v[48:51], v[200:203]
ds_read_b64_tr_b16 v[34:35], v2 offset:18432
v_cvt_pk_bf16_f32 v142, v156, v157
v_mfma_f32_16x16x32_bf16 v[204:207], a[204:207], v[48:51], v[204:207]
s_add_u32 m0, s82, 65536
s_nop 0
buffer_load_dwordx4 v9, s[60:63], s81 offen offset:3072 lds
s_waitcnt lgkmcnt(6)
v_mfma_f32_16x16x32_bf16 v[208:211], a[12:15], v[52:55], v[208:211]
ds_read_b64_tr_b16 v[36:37], v3 offset:16384
v_cvt_pk_bf16_f32 v143, v158, v159
v_mfma_f32_16x16x32_bf16 v[212:215], a[76:79], v[52:55], v[212:215]
v_cvt_pk_bf16_f32 v160, v160, v161
v_mfma_f32_16x16x32_bf16 v[216:219], a[140:143], v[52:55], v[216:219]
ds_read_b64_tr_b16 v[38:39], v3 offset:18432
v_cvt_pk_bf16_f32 v161, v162, v163
v_mfma_f32_16x16x32_bf16 v[220:223], a[204:207], v[52:55], v[220:223]
s_add_u32 s81, s78, 1
s_and_b32 s81, s81, 15
s_lshl_b32 s81, s81, 18
s_add_u32 s81, s81, s73
s_add_u32 s81, s81, 128
s_waitcnt lgkmcnt(6)
v_mfma_f32_16x16x32_bf16 v[224:227], a[12:15], v[56:59], v[224:227]
ds_read_b64_tr_b16 v[40:41], v4 offset:16384
s_add_u32 m0, s82, 69632
s_nop 0
buffer_load_dwordx4 v6, s[60:63], s81 offen offset:0 lds
v_mfma_f32_16x16x32_bf16 v[228:231], a[76:79], v[56:59], v[228:231]
v_mfma_f32_16x16x32_bf16 v[232:235], a[140:143], v[56:59], v[232:235]
ds_read_b64_tr_b16 v[42:43], v4 offset:18432
v_mfma_f32_16x16x32_bf16 v[236:239], a[204:207], v[56:59], v[236:239]
s_waitcnt lgkmcnt(6)
v_mfma_f32_16x16x32_bf16 v[240:243], a[12:15], v[60:63], v[240:243]
ds_read_b64_tr_b16 v[44:45], v5 offset:16384
s_add_u32 s83, s79, 2048
v_mfma_f32_16x16x32_bf16 v[244:247], a[76:79], v[60:63], v[244:247]
buffer_store_dwordx4 v[128:131], v10, s[44:47], s83 offen sc1
v_mfma_f32_16x16x32_bf16 v[248:251], a[140:143], v[60:63], v[248:251]
ds_read_b64_tr_b16 v[46:47], v5 offset:18432
v_mfma_f32_16x16x32_bf16 v[252:255], a[204:207], v[60:63], v[252:255]
s_waitcnt lgkmcnt(6)
v_mfma_f32_16x16x32_bf16 v[192:195], a[16:19], v[32:35], v[192:195]
ds_read_b64_tr_b16 v[48:49], v2 offset:20480
v_cvt_pk_bf16_f32 v162, v176, v177
v_mfma_f32_16x16x32_bf16 v[196:199], a[80:83], v[32:35], v[196:199]
v_cvt_pk_bf16_f32 v163, v178, v179
v_mfma_f32_16x16x32_bf16 v[200:203], a[144:147], v[32:35], v[200:203]
ds_read_b64_tr_b16 v[50:51], v2 offset:22528
v_cvt_pk_bf16_f32 v164, v164, v165
v_mfma_f32_16x16x32_bf16 v[204:207], a[208:211], v[32:35], v[204:207]
s_add_u32 m0, s82, 69632
s_nop 0
buffer_load_dwordx4 v7, s[60:63], s81 offen offset:1024 lds
s_waitcnt lgkmcnt(6)
v_mfma_f32_16x16x32_bf16 v[208:211], a[16:19], v[36:39], v[208:211]
ds_read_b64_tr_b16 v[52:53], v3 offset:20480
v_cvt_pk_bf16_f32 v165, v166, v167
v_mfma_f32_16x16x32_bf16 v[212:215], a[80:83], v[36:39], v[212:215]
v_cvt_pk_bf16_f32 v166, v180, v181
v_mfma_f32_16x16x32_bf16 v[216:219], a[144:147], v[36:39], v[216:219]
ds_read_b64_tr_b16 v[54:55], v3 offset:22528
v_cvt_pk_bf16_f32 v167, v182, v183
v_mfma_f32_16x16x32_bf16 v[220:223], a[208:211], v[36:39], v[220:223]
s_waitcnt lgkmcnt(6)
v_mfma_f32_16x16x32_bf16 v[224:227], a[16:19], v[40:43], v[224:227]
ds_read_b64_tr_b16 v[56:57], v4 offset:20480
s_add_u32 m0, s82, 69632
s_nop 0
buffer_load_dwordx4 v8, s[60:63], s81 offen offset:2048 lds
v_mfma_f32_16x16x32_bf16 v[228:231], a[80:83], v[40:43], v[228:231]
v_mfma_f32_16x16x32_bf16 v[232:235], a[144:147], v[40:43], v[232:235]
ds_read_b64_tr_b16 v[58:59], v4 offset:22528
v_mfma_f32_16x16x32_bf16 v[236:239], a[208:211], v[40:43], v[236:239]
s_waitcnt lgkmcnt(6)
v_mfma_f32_16x16x32_bf16 v[240:243], a[16:19], v[44:47], v[240:243]
ds_read_b64_tr_b16 v[60:61], v5 offset:20480
s_add_u32 s83, s79, 6144
v_mfma_f32_16x16x32_bf16 v[244:247], a[80:83], v[44:47], v[244:247]
buffer_store_dwordx4 v[132:135], v10, s[44:47], s83 offen sc1
v_mfma_f32_16x16x32_bf16 v[248:251], a[144:147], v[44:47], v[248:251]
ds_read_b64_tr_b16 v[62:63], v5 offset:22528
v_mfma_f32_16x16x32_bf16 v[252:255], a[208:211], v[44:47], v[252:255]
s_waitcnt lgkmcnt(6)
v_mfma_f32_16x16x32_bf16 v[192:195], a[20:23], v[48:51], v[192:195]
ds_read_b64_tr_b16 v[32:33], v2 offset:24576
v_cvt_pk_bf16_f32 v168, v168, v169
v_mfma_f32_16x16x32_bf16 v[196:199], a[84:87], v[48:51], v[196:199]
v_cvt_pk_bf16_f32 v169, v170, v171
v_mfma_f32_16x16x32_bf16 v[200:203], a[148:151], v[48:51], v[200:203]
ds_read_b64_tr_b16 v[34:35], v2 offset:26624
v_cvt_pk_bf16_f32 v170, v184, v185
v_mfma_f32_16x16x32_bf16 v[204:207], a[212:215], v[48:51], v[204:207]
s_add_u32 m0, s82, 69632
s_nop 0
buffer_load_dwordx4 v9, s[60:63], s81 offen offset:3072 lds
s_waitcnt lgkmcnt(6)
v_mfma_f32_16x16x32_bf16 v[208:211], a[20:23], v[52:55], v[208:211]
ds_read_b64_tr_b16 v[36:37], v3 offset:24576
v_cvt_pk_bf16_f32 v171, v186, v187
v_mfma_f32_16x16x32_bf16 v[212:215], a[84:87], v[52:55], v[212:215]
v_cvt_pk_bf16_f32 v172, v172, v173
v_mfma_f32_16x16x32_bf16 v[216:219], a[148:151], v[52:55], v[216:219]
ds_read_b64_tr_b16 v[38:39], v3 offset:26624
v_cvt_pk_bf16_f32 v173, v174, v175
v_mfma_f32_16x16x32_bf16 v[220:223], a[212:215], v[52:55], v[220:223]
s_add_u32 s81, s78, 8
s_and_b32 s81, s81, 15
s_lshl_b32 s81, s81, 18
s_add_u32 s81, s81, s73
s_add_u32 s81, s81, 128
s_waitcnt lgkmcnt(6)
v_mfma_f32_16x16x32_bf16 v[224:227], a[20:23], v[56:59], v[224:227]
ds_read_b64_tr_b16 v[40:41], v4 offset:24576
s_add_u32 m0, s82, 98304
s_nop 0
buffer_load_dwordx4 v6, s[60:63], s81 offen offset:0 lds
v_mfma_f32_16x16x32_bf16 v[228:231], a[84:87], v[56:59], v[228:231]
v_mfma_f32_16x16x32_bf16 v[232:235], a[148:151], v[56:59], v[232:235]
ds_read_b64_tr_b16 v[42:43], v4 offset:26624
v_mfma_f32_16x16x32_bf16 v[236:239], a[212:215], v[56:59], v[236:239]
s_waitcnt lgkmcnt(6)
v_mfma_f32_16x16x32_bf16 v[240:243], a[20:23], v[60:63], v[240:243]
ds_read_b64_tr_b16 v[44:45], v5 offset:24576
v_mfma_f32_16x16x32_bf16 v[244:247], a[84:87], v[60:63], v[244:247]
s_add_u32 m0, s82, 98304
s_nop 0
buffer_load_dwordx4 v7, s[60:63], s81 offen offset:1024 lds
v_mfma_f32_16x16x32_bf16 v[248:251], a[148:151], v[60:63], v[248:251]
ds_read_b64_tr_b16 v[46:47], v5 offset:26624
v_mfma_f32_16x16x32_bf16 v[252:255], a[212:215], v[60:63], v[252:255]
s_waitcnt lgkmcnt(6)
v_mfma_f32_16x16x32_bf16 v[192:195], a[24:27], v[32:35], v[192:195]
ds_read_b64_tr_b16 v[48:49], v2 offset:28672
v_cvt_pk_bf16_f32 v174, v188, v189
v_mfma_f32_16x16x32_bf16 v[196:199], a[88:91], v[32:35], v[196:199]
v_cvt_pk_bf16_f32 v175, v190, v191
v_mfma_f32_16x16x32_bf16 v[200:203], a[152:155], v[32:35], v[200:203]
ds_read_b64_tr_b16 v[50:51], v2 offset:30720
v_cvt_pk_bf16_f32 v144, v64, v65
v_mfma_f32_16x16x32_bf16 v[204:207], a[216:219], v[32:35], v[204:207]
s_add_u32 m0, s82, 98304
s_nop 0
buffer_load_dwordx4 v8, s[60:63], s81 offen offset:2048 lds
s_waitcnt lgkmcnt(6)
v_mfma_f32_16x16x32_bf16 v[208:211], a[24:27], v[36:39], v[208:211]
ds_read_b64_tr_b16 v[52:53], v3 offset:28672
v_cvt_pk_bf16_f32 v145, v66, v67
v_mfma_f32_16x16x32_bf16 v[212:215], a[88:91], v[36:39], v[212:215]
v_cvt_pk_bf16_f32 v146, v80, v81
v_mfma_f32_16x16x32_bf16 v[216:219], a[152:155], v[36:39], v[216:219]
ds_read_b64_tr_b16 v[54:55], v3 offset:30720
v_cvt_pk_bf16_f32 v147, v82, v83
v_mfma_f32_16x16x32_bf16 v[220:223], a[216:219], v[36:39], v[220:223]
s_waitcnt lgkmcnt(6)
v_mfma_f32_16x16x32_bf16 v[224:227], a[24:27], v[40:43], v[224:227]
ds_read_b64_tr_b16 v[56:57], v4 offset:28672
s_add_u32 m0, s82, 98304
s_nop 0
buffer_load_dwordx4 v9, s[60:63], s81 offen offset:3072 lds
v_mfma_f32_16x16x32_bf16 v[228:231], a[88:91], v[40:43], v[228:231]
v_mfma_f32_16x16x32_bf16 v[232:235], a[152:155], v[40:43], v[232:235]
ds_read_b64_tr_b16 v[58:59], v4 offset:30720
v_mfma_f32_16x16x32_bf16 v[236:239], a[216:219], v[40:43], v[236:239]
s_waitcnt lgkmcnt(6)
v_mfma_f32_16x16x32_bf16 v[240:243], a[24:27], v[44:47], v[240:243]
ds_read_b64_tr_b16 v[60:61], v5 offset:28672
s_add_u32 s83, s80, 2048
v_mfma_f32_16x16x32_bf16 v[244:247], a[88:91], v[44:47], v[244:247]
buffer_store_dwordx4 v[136:139], v10, s[44:47], s83 offen sc1
v_mfma_f32_16x16x32_bf16 v[248:251], a[152:155], v[44:47], v[248:251]
ds_read_b64_tr_b16 v[62:63], v5 offset:30720
v_mfma_f32_16x16x32_bf16 v[252:255], a[216:219], v[44:47], v[252:255]
s_waitcnt lgkmcnt(6)
v_mfma_f32_16x16x32_bf16 v[192:195], a[28:31], v[48:51], v[192:195]
v_cvt_pk_bf16_f32 v148, v68, v69
v_mfma_f32_16x16x32_bf16 v[196:199], a[92:95], v[48:51], v[196:199]
s_waitcnt lgkmcnt(0)
s_waitcnt vmcnt(15)
s_barrier
v_cvt_pk_bf16_f32 v149, v70, v71
v_mfma_f32_16x16x32_bf16 v[200:203], a[156:159], v[48:51], v[200:203]
ds_read_b64_tr_b16 v[32:33], v2 offset:32768
s_add_u32 s81, s78, 9
s_and_b32 s81, s81, 15
s_lshl_b32 s81, s81, 18
s_add_u32 s81, s81, s73
s_add_u32 s81, s81, 128
v_cvt_pk_bf16_f32 v150, v84, v85
v_mfma_f32_16x16x32_bf16 v[204:207], a[220:223], v[48:51], v[204:207]
ds_read_b64_tr_b16 v[34:35], v2 offset:34816
s_add_u32 m0, s82, 102400
s_nop 0
buffer_load_dwordx4 v6, s[60:63], s81 offen offset:0 lds
v_mfma_f32_16x16x32_bf16 v[208:211], a[28:31], v[52:55], v[208:211]
v_cvt_pk_bf16_f32 v151, v86, v87
v_mfma_f32_16x16x32_bf16 v[212:215], a[92:95], v[52:55], v[212:215]
ds_read_b64_tr_b16 v[36:37], v3 offset:32768
v_cvt_pk_bf16_f32 v152, v72, v73
v_mfma_f32_16x16x32_bf16 v[216:219], a[156:159], v[52:55], v[216:219]
v_cvt_pk_bf16_f32 v153, v74, v75
v_mfma_f32_16x16x32_bf16 v[220:223], a[220:223], v[52:55], v[220:223]
ds_read_b64_tr_b16 v[38:39], v3 offset:34816
v_mfma_f32_16x16x32_bf16 v[224:227], a[28:31], v[56:59], v[224:227]
s_add_u32 m0, s82, 102400
s_nop 0
buffer_load_dwordx4 v7, s[60:63], s81 offen offset:1024 lds
v_mfma_f32_16x16x32_bf16 v[228:231], a[92:95], v[56:59], v[228:231]
ds_read_b64_tr_b16 v[40:41], v4 offset:32768
v_mfma_f32_16x16x32_bf16 v[232:235], a[156:159], v[56:59], v[232:235]
ds_read_b64_tr_b16 v[42:43], v4 offset:34816
v_mfma_f32_16x16x32_bf16 v[236:239], a[220:223], v[56:59], v[236:239]
v_mfma_f32_16x16x32_bf16 v[240:243], a[28:31], v[60:63], v[240:243]
ds_read_b64_tr_b16 v[44:45], v5 offset:32768
s_add_u32 s83, s80, 6144
v_mfma_f32_16x16x32_bf16 v[244:247], a[92:95], v[60:63], v[244:247]
buffer_store_dwordx4 v[140:143], v10, s[44:47], s83 offen sc1
v_mfma_f32_16x16x32_bf16 v[248:251], a[156:159], v[60:63], v[248:251]
ds_read_b64_tr_b16 v[46:47], v5 offset:34816
v_mfma_f32_16x16x32_bf16 v[252:255], a[220:223], v[60:63], v[252:255]
s_waitcnt lgkmcnt(6)
v_mfma_f32_16x16x32_bf16 v[192:195], a[32:35], v[32:35], v[192:195]
ds_read_b64_tr_b16 v[48:49], v2 offset:36864
v_cvt_pk_bf16_f32 v154, v88, v89
v_mfma_f32_16x16x32_bf16 v[196:199], a[96:99], v[32:35], v[196:199]
v_cvt_pk_bf16_f32 v155, v90, v91
v_mfma_f32_16x16x32_bf16 v[200:203], a[160:163], v[32:35], v[200:203]
ds_read_b64_tr_b16 v[50:51], v2 offset:38912
v_cvt_pk_bf16_f32 v156, v76, v77
v_mfma_f32_16x16x32_bf16 v[204:207], a[224:227], v[32:35], v[204:207]
s_add_u32 m0, s82, 102400
s_nop 0
buffer_load_dwordx4 v8, s[60:63], s81 offen offset:2048 lds
s_waitcnt lgkmcnt(6)
v_mfma_f32_16x16x32_bf16 v[208:211], a[32:35], v[36:39], v[208:211]
ds_read_b64_tr_b16 v[52:53], v3 offset:36864
v_cvt_pk_bf16_f32 v157, v78, v79
v_mfma_f32_16x16x32_bf16 v[212:215], a[96:99], v[36:39], v[212:215]
v_cvt_pk_bf16_f32 v158, v92, v93
v_mfma_f32_16x16x32_bf16 v[216:219], a[160:163], v[36:39], v[216:219]
ds_read_b64_tr_b16 v[54:55], v3 offset:38912
v_cvt_pk_bf16_f32 v159, v94, v95
v_mfma_f32_16x16x32_bf16 v[220:223], a[224:227], v[36:39], v[220:223]
s_waitcnt lgkmcnt(6)
v_mfma_f32_16x16x32_bf16 v[224:227], a[32:35], v[40:43], v[224:227]
ds_read_b64_tr_b16 v[56:57], v4 offset:36864
s_add_u32 m0, s82, 102400
s_nop 0
buffer_load_dwordx4 v9, s[60:63], s81 offen offset:3072 lds
v_mfma_f32_16x16x32_bf16 v[228:231], a[96:99], v[40:43], v[228:231]
v_mfma_f32_16x16x32_bf16 v[232:235], a[160:163], v[40:43], v[232:235]
ds_read_b64_tr_b16 v[58:59], v4 offset:38912
v_mfma_f32_16x16x32_bf16 v[236:239], a[224:227], v[40:43], v[236:239]
s_waitcnt lgkmcnt(6)
v_mfma_f32_16x16x32_bf16 v[240:243], a[32:35], v[44:47], v[240:243]
ds_read_b64_tr_b16 v[60:61], v5 offset:36864
s_add_u32 s83, s79, 3072
v_mfma_f32_16x16x32_bf16 v[244:247], a[96:99], v[44:47], v[244:247]
buffer_store_dwordx4 v[160:163], v10, s[44:47], s83 offen sc1
v_mfma_f32_16x16x32_bf16 v[248:251], a[160:163], v[44:47], v[248:251]
ds_read_b64_tr_b16 v[62:63], v5 offset:38912
v_mfma_f32_16x16x32_bf16 v[252:255], a[224:227], v[44:47], v[252:255]
s_waitcnt lgkmcnt(6)
v_mfma_f32_16x16x32_bf16 v[192:195], a[36:39], v[48:51], v[192:195]
ds_read_b64_tr_b16 v[32:33], v2 offset:40960
v_cvt_pk_bf16_f32 v176, v96, v97
v_mfma_f32_16x16x32_bf16 v[196:199], a[100:103], v[48:51], v[196:199]
v_cvt_pk_bf16_f32 v177, v98, v99
v_mfma_f32_16x16x32_bf16 v[200:203], a[164:167], v[48:51], v[200:203]
ds_read_b64_tr_b16 v[34:35], v2 offset:43008
s_add_u32 s87, s86, 0
v_cvt_pk_bf16_f32 v178, v112, v113
v_mfma_f32_16x16x32_bf16 v[204:207], a[228:231], v[48:51], v[204:207]
s_add_u32 m0, s88, 131072
s_nop 0
buffer_load_dwordx4 v24, s[4:7], s87 offen offset:0 lds
v_cvt_pk_bf16_f32 v179, v114, v115
s_waitcnt lgkmcnt(6)
v_mfma_f32_16x16x32_bf16 v[208:211], a[36:39], v[52:55], v[208:211]
ds_read_b64_tr_b16 v[36:37], v3 offset:40960
v_cvt_pk_bf16_f32 v180, v100, v101
v_mfma_f32_16x16x32_bf16 v[212:215], a[100:103], v[52:55], v[212:215]
v_cvt_pk_bf16_f32 v181, v102, v103
v_mfma_f32_16x16x32_bf16 v[216:219], a[164:167], v[52:55], v[216:219]
ds_read_b64_tr_b16 v[38:39], v3 offset:43008
v_mfma_f32_16x16x32_bf16 v[220:223], a[228:231], v[52:55], v[220:223]
s_waitcnt lgkmcnt(6)
v_mfma_f32_16x16x32_bf16 v[224:227], a[36:39], v[56:59], v[224:227]
ds_read_b64_tr_b16 v[40:41], v4 offset:40960
s_add_u32 m0, s88, 131072
s_nop 0
buffer_load_dwordx4 v25, s[4:7], s87 offen offset:1024 lds
v_mfma_f32_16x16x32_bf16 v[228:231], a[100:103], v[56:59], v[228:231]
v_mfma_f32_16x16x32_bf16 v[232:235], a[164:167], v[56:59], v[232:235]
ds_read_b64_tr_b16 v[42:43], v4 offset:43008
v_mfma_f32_16x16x32_bf16 v[236:239], a[228:231], v[56:59], v[236:239]
s_waitcnt lgkmcnt(6)
v_mfma_f32_16x16x32_bf16 v[240:243], a[36:39], v[60:63], v[240:243]
ds_read_b64_tr_b16 v[44:45], v5 offset:40960
v_mfma_f32_16x16x32_bf16 v[244:247], a[100:103], v[60:63], v[244:247]
s_add_u32 m0, s88, 131072
s_nop 0
buffer_load_dwordx4 v26, s[4:7], s87 offen offset:2048 lds
v_mfma_f32_16x16x32_bf16 v[248:251], a[164:167], v[60:63], v[248:251]
ds_read_b64_tr_b16 v[46:47], v5 offset:43008
v_mfma_f32_16x16x32_bf16 v[252:255], a[228:231], v[60:63], v[252:255]
s_waitcnt lgkmcnt(6)
v_mfma_f32_16x16x32_bf16 v[192:195], a[40:43], v[32:35], v[192:195]
ds_read_b64_tr_b16 v[48:49], v2 offset:45056
v_cvt_pk_bf16_f32 v182, v116, v117
v_mfma_f32_16x16x32_bf16 v[196:199], a[104:107], v[32:35], v[196:199]
v_cvt_pk_bf16_f32 v183, v118, v119
v_mfma_f32_16x16x32_bf16 v[200:203], a[168:171], v[32:35], v[200:203]
ds_read_b64_tr_b16 v[50:51], v2 offset:47104
s_add_u32 s83, s79, 7168
v_cvt_pk_bf16_f32 v184, v104, v105
v_mfma_f32_16x16x32_bf16 v[204:207], a[232:235], v[32:35], v[204:207]
buffer_store_dwordx4 v[164:167], v10, s[44:47], s83 offen sc1
v_cvt_pk_bf16_f32 v185, v106, v107
s_waitcnt lgkmcnt(6)
v_mfma_f32_16x16x32_bf16 v[208:211], a[40:43], v[36:39], v[208:211]
ds_read_b64_tr_b16 v[52:53], v3 offset:45056
v_cvt_pk_bf16_f32 v186, v120, v121
v_mfma_f32_16x16x32_bf16 v[212:215], a[104:107], v[36:39], v[212:215]
v_cvt_pk_bf16_f32 v187, v122, v123
v_mfma_f32_16x16x32_bf16 v[216:219], a[168:171], v[36:39], v[216:219]
ds_read_b64_tr_b16 v[54:55], v3 offset:47104
v_mfma_f32_16x16x32_bf16 v[220:223], a[232:235], v[36:39], v[220:223]
s_waitcnt lgkmcnt(6)
v_mfma_f32_16x16x32_bf16 v[224:227], a[40:43], v[40:43], v[224:227]
ds_read_b64_tr_b16 v[56:57], v4 offset:45056
s_add_u32 m0, s88, 131072
s_nop 0
buffer_load_dwordx4 v27, s[4:7], s87 offen offset:3072 lds
v_mfma_f32_16x16x32_bf16 v[228:231], a[104:107], v[40:43], v[228:231]
v_mfma_f32_16x16x32_bf16 v[232:235], a[168:171], v[40:43], v[232:235]
ds_read_b64_tr_b16 v[58:59], v4 offset:47104
v_mfma_f32_16x16x32_bf16 v[236:239], a[232:235], v[40:43], v[236:239]
s_waitcnt lgkmcnt(6)
v_mfma_f32_16x16x32_bf16 v[240:243], a[40:43], v[44:47], v[240:243]
ds_read_b64_tr_b16 v[60:61], v5 offset:45056
s_add_u32 s87, s86, 524288
v_mfma_f32_16x16x32_bf16 v[244:247], a[104:107], v[44:47], v[244:247]
s_add_u32 m0, s88, 147456
s_nop 0
buffer_load_dwordx4 v24, s[4:7], s87 offen offset:0 lds
v_mfma_f32_16x16x32_bf16 v[248:251], a[168:171], v[44:47], v[248:251]
ds_read_b64_tr_b16 v[62:63], v5 offset:47104
v_mfma_f32_16x16x32_bf16 v[252:255], a[232:235], v[44:47], v[252:255]
s_waitcnt lgkmcnt(6)
v_mfma_f32_16x16x32_bf16 v[192:195], a[44:47], v[48:51], v[192:195]
ds_read_b64_tr_b16 v[32:33], v2 offset:49152
v_cvt_pk_bf16_f32 v188, v108, v109
v_mfma_f32_16x16x32_bf16 v[196:199], a[108:111], v[48:51], v[196:199]
v_cvt_pk_bf16_f32 v189, v110, v111
v_mfma_f32_16x16x32_bf16 v[200:203], a[172:175], v[48:51], v[200:203]
ds_read_b64_tr_b16 v[34:35], v2 offset:51200
s_add_u32 s83, s80, 3072
v_cvt_pk_bf16_f32 v190, v124, v125
v_mfma_f32_16x16x32_bf16 v[204:207], a[236:239], v[48:51], v[204:207]
buffer_store_dwordx4 v[168:171], v10, s[44:47], s83 offen sc1
v_cvt_pk_bf16_f32 v191, v126, v127
s_waitcnt lgkmcnt(6)
v_mfma_f32_16x16x32_bf16 v[208:211], a[44:47], v[52:55], v[208:211]
ds_read_b64_tr_b16 v[36:37], v3 offset:49152
v_mfma_f32_16x16x32_bf16 v[212:215], a[108:111], v[52:55], v[212:215]
v_mfma_f32_16x16x32_bf16 v[216:219], a[172:175], v[52:55], v[216:219]
ds_read_b64_tr_b16 v[38:39], v3 offset:51200
v_mfma_f32_16x16x32_bf16 v[220:223], a[236:239], v[52:55], v[220:223]
s_waitcnt lgkmcnt(6)
v_mfma_f32_16x16x32_bf16 v[224:227], a[44:47], v[56:59], v[224:227]
ds_read_b64_tr_b16 v[40:41], v4 offset:49152
s_add_u32 m0, s88, 147456
s_nop 0
buffer_load_dwordx4 v25, s[4:7], s87 offen offset:1024 lds
v_mfma_f32_16x16x32_bf16 v[228:231], a[108:111], v[56:59], v[228:231]
v_mfma_f32_16x16x32_bf16 v[232:235], a[172:175], v[56:59], v[232:235]
ds_read_b64_tr_b16 v[42:43], v4 offset:51200
v_mfma_f32_16x16x32_bf16 v[236:239], a[236:239], v[56:59], v[236:239]
s_waitcnt lgkmcnt(6)
v_mfma_f32_16x16x32_bf16 v[240:243], a[44:47], v[60:63], v[240:243]
ds_read_b64_tr_b16 v[44:45], v5 offset:49152
v_mfma_f32_16x16x32_bf16 v[244:247], a[108:111], v[60:63], v[244:247]
s_add_u32 m0, s88, 147456
s_nop 0
buffer_load_dwordx4 v26, s[4:7], s87 offen offset:2048 lds
v_mfma_f32_16x16x32_bf16 v[248:251], a[172:175], v[60:63], v[248:251]
ds_read_b64_tr_b16 v[46:47], v5 offset:51200
v_mfma_f32_16x16x32_bf16 v[252:255], a[236:239], v[60:63], v[252:255]
s_waitcnt lgkmcnt(6)
v_mfma_f32_16x16x32_bf16 v[192:195], a[48:51], v[32:35], v[192:195]
ds_read_b64_tr_b16 v[48:49], v2 offset:53248
v_mfma_f32_16x16x32_bf16 v[196:199], a[112:115], v[32:35], v[196:199]
v_mfma_f32_16x16x32_bf16 v[200:203], a[176:179], v[32:35], v[200:203]
ds_read_b64_tr_b16 v[50:51], v2 offset:55296
s_add_u32 s83, s80, 7168
v_mfma_f32_16x16x32_bf16 v[204:207], a[240:243], v[32:35], v[204:207]
buffer_store_dwordx4 v[172:175], v10, s[44:47], s83 offen sc1
s_waitcnt lgkmcnt(6)
v_mfma_f32_16x16x32_bf16 v[208:211], a[48:51], v[36:39], v[208:211]
ds_read_b64_tr_b16 v[52:53], v3 offset:53248
v_mfma_f32_16x16x32_bf16 v[212:215], a[112:115], v[36:39], v[212:215]
v_mfma_f32_16x16x32_bf16 v[216:219], a[176:179], v[36:39], v[216:219]
ds_read_b64_tr_b16 v[54:55], v3 offset:55296
v_mfma_f32_16x16x32_bf16 v[220:223], a[240:243], v[36:39], v[220:223]
s_waitcnt lgkmcnt(6)
v_mfma_f32_16x16x32_bf16 v[224:227], a[48:51], v[40:43], v[224:227]
ds_read_b64_tr_b16 v[56:57], v4 offset:53248
s_add_u32 m0, s88, 147456
s_nop 0
buffer_load_dwordx4 v27, s[4:7], s87 offen offset:3072 lds
v_mfma_f32_16x16x32_bf16 v[228:231], a[112:115], v[40:43], v[228:231]
v_mfma_f32_16x16x32_bf16 v[232:235], a[176:179], v[40:43], v[232:235]
ds_read_b64_tr_b16 v[58:59], v4 offset:55296
v_mfma_f32_16x16x32_bf16 v[236:239], a[240:243], v[40:43], v[236:239]
s_waitcnt lgkmcnt(6)
v_mfma_f32_16x16x32_bf16 v[240:243], a[48:51], v[44:47], v[240:243]
ds_read_b64_tr_b16 v[60:61], v5 offset:53248
s_add_u32 s87, s86, 1048576
v_mfma_f32_16x16x32_bf16 v[244:247], a[112:115], v[44:47], v[244:247]
s_add_u32 m0, s88, 0
s_nop 0
buffer_load_dwordx4 v24, s[4:7], s87 offen offset:0 lds
v_mfma_f32_16x16x32_bf16 v[248:251], a[176:179], v[44:47], v[248:251]
ds_read_b64_tr_b16 v[62:63], v5 offset:55296
v_mfma_f32_16x16x32_bf16 v[252:255], a[240:243], v[44:47], v[252:255]
s_waitcnt lgkmcnt(6)
v_mfma_f32_16x16x32_bf16 v[192:195], a[52:55], v[48:51], v[192:195]
ds_read_b64_tr_b16 v[32:33], v2 offset:57344
v_mfma_f32_16x16x32_bf16 v[196:199], a[116:119], v[48:51], v[196:199]
v_mfma_f32_16x16x32_bf16 v[200:203], a[180:183], v[48:51], v[200:203]
ds_read_b64_tr_b16 v[34:35], v2 offset:59392
s_add_u32 s83, s79, 0
v_mfma_f32_16x16x32_bf16 v[204:207], a[244:247], v[48:51], v[204:207]
buffer_store_dwordx4 v[144:147], v10, s[44:47], s83 offen sc1
s_waitcnt lgkmcnt(6)
v_mfma_f32_16x16x32_bf16 v[208:211], a[52:55], v[52:55], v[208:211]
ds_read_b64_tr_b16 v[36:37], v3 offset:57344
v_mfma_f32_16x16x32_bf16 v[212:215], a[116:119], v[52:55], v[212:215]
v_mfma_f32_16x16x32_bf16 v[216:219], a[180:183], v[52:55], v[216:219]
ds_read_b64_tr_b16 v[38:39], v3 offset:59392
v_mfma_f32_16x16x32_bf16 v[220:223], a[244:247], v[52:55], v[220:223]
s_waitcnt lgkmcnt(6)
v_mfma_f32_16x16x32_bf16 v[224:227], a[52:55], v[56:59], v[224:227]
ds_read_b64_tr_b16 v[40:41], v4 offset:57344
s_add_u32 m0, s88, 0
s_nop 0
buffer_load_dwordx4 v25, s[4:7], s87 offen offset:1024 lds
v_mfma_f32_16x16x32_bf16 v[228:231], a[116:119], v[56:59], v[228:231]
v_mfma_f32_16x16x32_bf16 v[232:235], a[180:183], v[56:59], v[232:235]
ds_read_b64_tr_b16 v[42:43], v4 offset:59392
v_mfma_f32_16x16x32_bf16 v[236:239], a[244:247], v[56:59], v[236:239]
s_waitcnt lgkmcnt(6)
v_mfma_f32_16x16x32_bf16 v[240:243], a[52:55], v[60:63], v[240:243]
ds_read_b64_tr_b16 v[44:45], v5 offset:57344
v_mfma_f32_16x16x32_bf16 v[244:247], a[116:119], v[60:63], v[244:247]
s_add_u32 m0, s88, 0
s_nop 0
buffer_load_dwordx4 v26, s[4:7], s87 offen offset:2048 lds
v_mfma_f32_16x16x32_bf16 v[248:251], a[180:183], v[60:63], v[248:251]
ds_read_b64_tr_b16 v[46:47], v5 offset:59392
v_mfma_f32_16x16x32_bf16 v[252:255], a[244:247], v[60:63], v[252:255]
s_waitcnt lgkmcnt(6)
v_mfma_f32_16x16x32_bf16 v[192:195], a[56:59], v[32:35], v[192:195]
ds_read_b64_tr_b16 v[48:49], v2 offset:61440
v_mfma_f32_16x16x32_bf16 v[196:199], a[120:123], v[32:35], v[196:199]
v_mfma_f32_16x16x32_bf16 v[200:203], a[184:187], v[32:35], v[200:203]
ds_read_b64_tr_b16 v[50:51], v2 offset:63488
s_add_u32 s83, s79, 4096
v_mfma_f32_16x16x32_bf16 v[204:207], a[248:251], v[32:35], v[204:207]
buffer_store_dwordx4 v[148:151], v10, s[44:47], s83 offen sc1
s_waitcnt lgkmcnt(6)
v_mfma_f32_16x16x32_bf16 v[208:211], a[56:59], v[36:39], v[208:211]
ds_read_b64_tr_b16 v[52:53], v3 offset:61440
v_mfma_f32_16x16x32_bf16 v[212:215], a[120:123], v[36:39], v[212:215]
v_mfma_f32_16x16x32_bf16 v[216:219], a[184:187], v[36:39], v[216:219]
ds_read_b64_tr_b16 v[54:55], v3 offset:63488
v_mfma_f32_16x16x32_bf16 v[220:223], a[248:251], v[36:39], v[220:223]
s_waitcnt lgkmcnt(6)
v_mfma_f32_16x16x32_bf16 v[224:227], a[56:59], v[40:43], v[224:227]
ds_read_b64_tr_b16 v[56:57], v4 offset:61440
s_add_u32 m0, s88, 0
s_nop 0
buffer_load_dwordx4 v27, s[4:7], s87 offen offset:3072 lds
v_mfma_f32_16x16x32_bf16 v[228:231], a[120:123], v[40:43], v[228:231]
v_mfma_f32_16x16x32_bf16 v[232:235], a[184:187], v[40:43], v[232:235]
ds_read_b64_tr_b16 v[58:59], v4 offset:63488
v_mfma_f32_16x16x32_bf16 v[236:239], a[248:251], v[40:43], v[236:239]
s_waitcnt lgkmcnt(6)
v_mfma_f32_16x16x32_bf16 v[240:243], a[56:59], v[44:47], v[240:243]
ds_read_b64_tr_b16 v[60:61], v5 offset:61440
s_add_u32 s87, s86, 1572864
v_mfma_f32_16x16x32_bf16 v[244:247], a[120:123], v[44:47], v[244:247]
s_add_u32 m0, s88, 16384
s_nop 0
buffer_load_dwordx4 v24, s[4:7], s87 offen offset:0 lds
v_mfma_f32_16x16x32_bf16 v[248:251], a[184:187], v[44:47], v[248:251]
ds_read_b64_tr_b16 v[62:63], v5 offset:63488
v_mfma_f32_16x16x32_bf16 v[252:255], a[248:251], v[44:47], v[252:255]
s_waitcnt lgkmcnt(6)
v_mfma_f32_16x16x32_bf16 v[192:195], a[60:63], v[48:51], v[192:195]
v_mfma_f32_16x16x32_bf16 v[196:199], a[124:127], v[48:51], v[196:199]
s_waitcnt lgkmcnt(0)
s_waitcnt vmcnt(29)
s_barrier
v_mfma_f32_16x16x32_bf16 v[200:203], a[188:191], v[48:51], v[200:203]
ds_read_b64_tr_b16 v[32:33], v20 offset:0
s_add_u32 s83, s80, 0
v_mfma_f32_16x16x32_bf16 v[204:207], a[252:255], v[48:51], v[204:207]
ds_read_b64_tr_b16 v[34:35], v20 offset:2048
buffer_store_dwordx4 v[152:155], v10, s[44:47], s83 offen sc1
v_mfma_f32_16x16x32_bf16 v[208:211], a[60:63], v[52:55], v[208:211]
v_mfma_f32_16x16x32_bf16 v[212:215], a[124:127], v[52:55], v[212:215]
ds_read_b64_tr_b16 v[36:37], v21 offset:0
v_mfma_f32_16x16x32_bf16 v[216:219], a[188:191], v[52:55], v[216:219]
v_mfma_f32_16x16x32_bf16 v[220:223], a[252:255], v[52:55], v[220:223]
ds_read_b64_tr_b16 v[38:39], v21 offset:2048
v_mfma_f32_16x16x32_bf16 v[224:227], a[60:63], v[56:59], v[224:227]
s_add_u32 m0, s88, 16384
s_nop 0
buffer_load_dwordx4 v25, s[4:7], s87 offen offset:1024 lds
v_mfma_f32_16x16x32_bf16 v[228:231], a[124:127], v[56:59], v[228:231]
ds_read_b64_tr_b16 v[40:41], v22 offset:0
v_mfma_f32_16x16x32_bf16 v[232:235], a[188:191], v[56:59], v[232:235]
ds_read_b64_tr_b16 v[42:43], v22 offset:2048
v_mfma_f32_16x16x32_bf16 v[236:239], a[252:255], v[56:59], v[236:239]
v_mfma_f32_16x16x32_bf16 v[240:243], a[60:63], v[60:63], v[240:243]
ds_read_b64_tr_b16 v[44:45], v23 offset:0
v_mfma_f32_16x16x32_bf16 v[244:247], a[124:127], v[60:63], v[244:247]
s_add_u32 m0, s88, 16384
s_nop 0
buffer_load_dwordx4 v26, s[4:7], s87 offen offset:2048 lds
v_mfma_f32_16x16x32_bf16 v[248:251], a[188:191], v[60:63], v[248:251]
ds_read_b64_tr_b16 v[46:47], v23 offset:2048
v_mfma_f32_16x16x32_bf16 v[252:255], a[252:255], v[60:63], v[252:255]
s_waitcnt lgkmcnt(6)
v_mfma_f32_16x16x32_bf16 v[64:67], a[0:3], v[32:35], 0
ds_read_b64_tr_b16 v[48:49], v20 offset:4096
v_mfma_f32_16x16x32_bf16 v[68:71], a[64:67], v[32:35], 0
v_mfma_f32_16x16x32_bf16 v[72:75], a[128:131], v[32:35], 0
ds_read_b64_tr_b16 v[50:51], v20 offset:6144
s_add_u32 s83, s80, 4096
v_mfma_f32_16x16x32_bf16 v[76:79], a[192:195], v[32:35], 0
buffer_store_dwordx4 v[156:159], v10, s[44:47], s83 offen sc1
s_waitcnt lgkmcnt(6)
v_mfma_f32_16x16x32_bf16 v[80:83], a[0:3], v[36:39], 0
ds_read_b64_tr_b16 v[52:53], v21 offset:4096
v_mfma_f32_16x16x32_bf16 v[84:87], a[64:67], v[36:39], 0
v_mfma_f32_16x16x32_bf16 v[88:91], a[128:131], v[36:39], 0
ds_read_b64_tr_b16 v[54:55], v21 offset:6144
v_mfma_f32_16x16x32_bf16 v[92:95], a[192:195], v[36:39], 0
s_waitcnt lgkmcnt(6)
v_mfma_f32_16x16x32_bf16 v[96:99], a[0:3], v[40:43], 0
ds_read_b64_tr_b16 v[56:57], v22 offset:4096
s_add_u32 m0, s88, 16384
s_nop 0
buffer_load_dwordx4 v27, s[4:7], s87 offen offset:3072 lds
v_mfma_f32_16x16x32_bf16 v[100:103], a[64:67], v[40:43], 0
v_mfma_f32_16x16x32_bf16 v[104:107], a[128:131], v[40:43], 0
ds_read_b64_tr_b16 v[58:59], v22 offset:6144
v_mfma_f32_16x16x32_bf16 v[108:111], a[192:195], v[40:43], 0
s_waitcnt lgkmcnt(6)
v_mfma_f32_16x16x32_bf16 v[112:115], a[0:3], v[44:47], 0
ds_read_b64_tr_b16 v[60:61], v23 offset:4096
s_add_u32 s87, s86, 2097152
v_mfma_f32_16x16x32_bf16 v[116:119], a[64:67], v[44:47], 0
s_add_u32 m0, s88, 32768
s_nop 0
buffer_load_dwordx4 v24, s[4:7], s87 offen offset:0 lds
v_mfma_f32_16x16x32_bf16 v[120:123], a[128:131], v[44:47], 0
ds_read_b64_tr_b16 v[62:63], v23 offset:6144
v_mfma_f32_16x16x32_bf16 v[124:127], a[192:195], v[44:47], 0
s_waitcnt lgkmcnt(6)
v_mfma_f32_16x16x32_bf16 v[64:67], a[4:7], v[48:51], v[64:67]
ds_read_b64_tr_b16 v[32:33], v20 offset:8192
v_cvt_pk_bf16_f32 v192, v192, v193
v_mfma_f32_16x16x32_bf16 v[68:71], a[68:71], v[48:51], v[68:71]
v_cvt_pk_bf16_f32 v193, v194, v195
v_mfma_f32_16x16x32_bf16 v[72:75], a[132:135], v[48:51], v[72:75]
ds_read_b64_tr_b16 v[34:35], v20 offset:10240
v_cvt_pk_bf16_f32 v194, v196, v197
v_mfma_f32_16x16x32_bf16 v[76:79], a[196:199], v[48:51], v[76:79]
s_add_u32 m0, s88, 32768
s_nop 0
buffer_load_dwordx4 v25, s[4:7], s87 offen offset:1024 lds
v_cvt_pk_bf16_f32 v195, v198, v199
s_waitcnt lgkmcnt(6)
v_mfma_f32_16x16x32_bf16 v[80:83], a[4:7], v[52:55], v[80:83]
ds_read_b64_tr_b16 v[36:37], v21 offset:8192
v_mfma_f32_16x16x32_bf16 v[84:87], a[68:71], v[52:55], v[84:87]
v_mfma_f32_16x16x32_bf16 v[88:91], a[132:135], v[52:55], v[88:91]
ds_read_b64_tr_b16 v[38:39], v21 offset:10240
v_mfma_f32_16x16x32_bf16 v[92:95], a[196:199], v[52:55], v[92:95]
s_waitcnt lgkmcnt(6)
v_mfma_f32_16x16x32_bf16 v[96:99], a[4:7], v[56:59], v[96:99]
ds_read_b64_tr_b16 v[40:41], v22 offset:8192
s_add_u32 m0, s88, 32768
s_nop 0
buffer_load_dwordx4 v26, s[4:7], s87 offen offset:2048 lds
v_mfma_f32_16x16x32_bf16 v[100:103], a[68:71], v[56:59], v[100:103]
v_mfma_f32_16x16x32_bf16 v[104:107], a[132:135], v[56:59], v[104:107]
ds_read_b64_tr_b16 v[42:43], v22 offset:10240
v_mfma_f32_16x16x32_bf16 v[108:111], a[196:199], v[56:59], v[108:111]
s_waitcnt lgkmcnt(6)
v_mfma_f32_16x16x32_bf16 v[112:115], a[4:7], v[60:63], v[112:115]
ds_read_b64_tr_b16 v[44:45], v23 offset:8192
v_mfma_f32_16x16x32_bf16 v[116:119], a[68:71], v[60:63], v[116:119]
s_add_u32 m0, s88, 32768
s_nop 0
buffer_load_dwordx4 v27, s[4:7], s87 offen offset:3072 lds
v_mfma_f32_16x16x32_bf16 v[120:123], a[132:135], v[60:63], v[120:123]
ds_read_b64_tr_b16 v[46:47], v23 offset:10240
v_mfma_f32_16x16x32_bf16 v[124:127], a[196:199], v[60:63], v[124:127]
s_waitcnt lgkmcnt(6)
v_mfma_f32_16x16x32_bf16 v[64:67], a[8:11], v[32:35], v[64:67]
ds_read_b64_tr_b16 v[48:49], v20 offset:12288
v_cvt_pk_bf16_f32 v208, v208, v209
v_mfma_f32_16x16x32_bf16 v[68:71], a[72:75], v[32:35], v[68:71]
v_cvt_pk_bf16_f32 v209, v210, v211
v_mfma_f32_16x16x32_bf16 v[72:75], a[136:139], v[32:35], v[72:75]
ds_read_b64_tr_b16 v[50:51], v20 offset:14336
s_add_u32 s83, s79, 1024
v_cvt_pk_bf16_f32 v210, v212, v213
v_mfma_f32_16x16x32_bf16 v[76:79], a[200:203], v[32:35], v[76:79]
buffer_store_dwordx4 v[176:179], v10, s[44:47], s83 offen sc1
v_cvt_pk_bf16_f32 v211, v214, v215
s_waitcnt lgkmcnt(6)
v_mfma_f32_16x16x32_bf16 v[80:83], a[8:11], v[36:39], v[80:83]
ds_read_b64_tr_b16 v[52:53], v21 offset:12288
v_mfma_f32_16x16x32_bf16 v[84:87], a[72:75], v[36:39], v[84:87]
v_mfma_f32_16x16x32_bf16 v[88:91], a[136:139], v[36:39], v[88:91]
ds_read_b64_tr_b16 v[54:55], v21 offset:14336
v_mfma_f32_16x16x32_bf16 v[92:95], a[200:203], v[36:39], v[92:95]
s_add_u32 s87, s86, 2621440
s_waitcnt lgkmcnt(6)
v_mfma_f32_16x16x32_bf16 v[96:99], a[8:11], v[40:43], v[96:99]
ds_read_b64_tr_b16 v[56:57], v22 offset:12288
s_add_u32 m0, s88, 49152
s_nop 0
buffer_load_dwordx4 v24, s[4:7], s87 offen offset:0 lds
v_mfma_f32_16x16x32_bf16 v[100:103], a[72:75], v[40:43], v[100:103]
v_mfma_f32_16x16x32_bf16 v[104:107], a[136:139], v[40:43], v[104:107]
ds_read_b64_tr_b16 v[58:59], v22 offset:14336
v_mfma_f32_16x16x32_bf16 v[108:111], a[200:203], v[40:43], v[108:111]
s_waitcnt lgkmcnt(6)
v_mfma_f32_16x16x32_bf16 v[112:115], a[8:11], v[44:47], v[112:115]
ds_read_b64_tr_b16 v[60:61], v23 offset:12288
v_mfma_f32_16x16x32_bf16 v[116:119], a[72:75], v[44:47], v[116:119]
s_add_u32 m0, s88, 49152
s_nop 0
buffer_load_dwordx4 v25, s[4:7], s87 offen offset:1024 lds
v_mfma_f32_16x16x32_bf16 v[120:123], a[136:139], v[44:47], v[120:123]
ds_read_b64_tr_b16 v[62:63], v23 offset:14336
v_mfma_f32_16x16x32_bf16 v[124:127], a[200:203], v[44:47], v[124:127]
s_waitcnt lgkmcnt(6)
v_mfma_f32_16x16x32_bf16 v[64:67], a[12:15], v[48:51], v[64:67]
ds_read_b64_tr_b16 v[32:33], v20 offset:16384
v_cvt_pk_bf16_f32 v224, v224, v225
v_mfma_f32_16x16x32_bf16 v[68:71], a[76:79], v[48:51], v[68:71]
v_cvt_pk_bf16_f32 v225, v226, v227
v_mfma_f32_16x16x32_bf16 v[72:75], a[140:143], v[48:51], v[72:75]
ds_read_b64_tr_b16 v[34:35], v20 offset:18432
v_cvt_pk_bf16_f32 v226, v228, v229
v_mfma_f32_16x16x32_bf16 v[76:79], a[204:207], v[48:51], v[76:79]
s_add_u32 m0, s88, 49152
s_nop 0
buffer_load_dwordx4 v26, s[4:7], s87 offen offset:2048 lds
v_cvt_pk_bf16_f32 v227, v230, v231
s_waitcnt lgkmcnt(6)
v_mfma_f32_16x16x32_bf16 v[80:83], a[12:15], v[52:55], v[80:83]
ds_read_b64_tr_b16 v[36:37], v21 offset:16384
v_mfma_f32_16x16x32_bf16 v[84:87], a[76:79], v[52:55], v[84:87]
v_mfma_f32_16x16x32_bf16 v[88:91], a[140:143], v[52:55], v[88:91]
ds_read_b64_tr_b16 v[38:39], v21 offset:18432
v_mfma_f32_16x16x32_bf16 v[92:95], a[204:207], v[52:55], v[92:95]
s_waitcnt lgkmcnt(6)
v_mfma_f32_16x16x32_bf16 v[96:99], a[12:15], v[56:59], v[96:99]
ds_read_b64_tr_b16 v[40:41], v22 offset:16384
s_add_u32 m0, s88, 49152
s_nop 0
buffer_load_dwordx4 v27, s[4:7], s87 offen offset:3072 lds
v_mfma_f32_16x16x32_bf16 v[100:103], a[76:79], v[56:59], v[100:103]
v_mfma_f32_16x16x32_bf16 v[104:107], a[140:143], v[56:59], v[104:107]
ds_read_b64_tr_b16 v[42:43], v22 offset:18432
v_mfma_f32_16x16x32_bf16 v[108:111], a[204:207], v[56:59], v[108:111]
s_waitcnt lgkmcnt(6)
v_mfma_f32_16x16x32_bf16 v[112:115], a[12:15], v[60:63], v[112:115]
ds_read_b64_tr_b16 v[44:45], v23 offset:16384
v_mfma_f32_16x16x32_bf16 v[116:119], a[76:79], v[60:63], v[116:119]
v_mfma_f32_16x16x32_bf16 v[120:123], a[140:143], v[60:63], v[120:123]
ds_read_b64_tr_b16 v[46:47], v23 offset:18432
v_mfma_f32_16x16x32_bf16 v[124:127], a[204:207], v[60:63], v[124:127]
s_waitcnt lgkmcnt(6)
v_mfma_f32_16x16x32_bf16 v[64:67], a[16:19], v[32:35], v[64:67]
ds_read_b64_tr_b16 v[48:49], v20 offset:20480
v_cvt_pk_bf16_f32 v240, v240, v241
v_mfma_f32_16x16x32_bf16 v[68:71], a[80:83], v[32:35], v[68:71]
v_cvt_pk_bf16_f32 v241, v242, v243
v_mfma_f32_16x16x32_bf16 v[72:75], a[144:147], v[32:35], v[72:75]
ds_read_b64_tr_b16 v[50:51], v20 offset:22528
s_add_u32 s83, s79, 5120
v_cvt_pk_bf16_f32 v242, v244, v245
v_mfma_f32_16x16x32_bf16 v[76:79], a[208:211], v[32:35], v[76:79]
buffer_store_dwordx4 v[180:183], v10, s[44:47], s83 offen sc1
v_cvt_pk_bf16_f32 v243, v246, v247
s_waitcnt lgkmcnt(6)
v_mfma_f32_16x16x32_bf16 v[80:83], a[16:19], v[36:39], v[80:83]
ds_read_b64_tr_b16 v[52:53], v21 offset:20480
v_mfma_f32_16x16x32_bf16 v[84:87], a[80:83], v[36:39], v[84:87]
v_mfma_f32_16x16x32_bf16 v[88:91], a[144:147], v[36:39], v[88:91]
ds_read_b64_tr_b16 v[54:55], v21 offset:22528
v_mfma_f32_16x16x32_bf16 v[92:95], a[208:211], v[36:39], v[92:95]
s_waitcnt lgkmcnt(6)
v_mfma_f32_16x16x32_bf16 v[96:99], a[16:19], v[40:43], v[96:99]
ds_read_b64_tr_b16 v[56:57], v22 offset:20480
v_mfma_f32_16x16x32_bf16 v[100:103], a[80:83], v[40:43], v[100:103]
v_mfma_f32_16x16x32_bf16 v[104:107], a[144:147], v[40:43], v[104:107]
ds_read_b64_tr_b16 v[58:59], v22 offset:22528
v_mfma_f32_16x16x32_bf16 v[108:111], a[208:211], v[40:43], v[108:111]
s_waitcnt lgkmcnt(6)
v_mfma_f32_16x16x32_bf16 v[112:115], a[16:19], v[44:47], v[112:115]
ds_read_b64_tr_b16 v[60:61], v23 offset:20480
v_mfma_f32_16x16x32_bf16 v[116:119], a[80:83], v[44:47], v[116:119]
v_mfma_f32_16x16x32_bf16 v[120:123], a[144:147], v[44:47], v[120:123]
ds_read_b64_tr_b16 v[62:63], v23 offset:22528
v_mfma_f32_16x16x32_bf16 v[124:127], a[208:211], v[44:47], v[124:127]
s_waitcnt lgkmcnt(6)
v_mfma_f32_16x16x32_bf16 v[64:67], a[20:23], v[48:51], v[64:67]
ds_read_b64_tr_b16 v[32:33], v20 offset:24576
v_cvt_pk_bf16_f32 v200, v200, v201
v_mfma_f32_16x16x32_bf16 v[68:71], a[84:87], v[48:51], v[68:71]
v_cvt_pk_bf16_f32 v201, v202, v203
v_mfma_f32_16x16x32_bf16 v[72:75], a[148:151], v[48:51], v[72:75]
ds_read_b64_tr_b16 v[34:35], v20 offset:26624
s_add_u32 s83, s79, 8192
v_cvt_pk_bf16_f32 v202, v204, v205
v_mfma_f32_16x16x32_bf16 v[76:79], a[212:215], v[48:51], v[76:79]
buffer_store_dwordx4 v[192:195], v10, s[44:47], s83 offen sc1
v_cvt_pk_bf16_f32 v203, v206, v207
s_waitcnt lgkmcnt(6)
v_mfma_f32_16x16x32_bf16 v[80:83], a[20:23], v[52:55], v[80:83]
ds_read_b64_tr_b16 v[36:37], v21 offset:24576
v_mfma_f32_16x16x32_bf16 v[84:87], a[84:87], v[52:55], v[84:87]
v_mfma_f32_16x16x32_bf16 v[88:91], a[148:151], v[52:55], v[88:91]
ds_read_b64_tr_b16 v[38:39], v21 offset:26624
v_mfma_f32_16x16x32_bf16 v[92:95], a[212:215], v[52:55], v[92:95]
s_waitcnt lgkmcnt(6)
v_mfma_f32_16x16x32_bf16 v[96:99], a[20:23], v[56:59], v[96:99]
ds_read_b64_tr_b16 v[40:41], v22 offset:24576
v_mfma_f32_16x16x32_bf16 v[100:103], a[84:87], v[56:59], v[100:103]
v_mfma_f32_16x16x32_bf16 v[104:107], a[148:151], v[56:59], v[104:107]
ds_read_b64_tr_b16 v[42:43], v22 offset:26624
v_mfma_f32_16x16x32_bf16 v[108:111], a[212:215], v[56:59], v[108:111]
s_waitcnt lgkmcnt(6)
v_mfma_f32_16x16x32_bf16 v[112:115], a[20:23], v[60:63], v[112:115]
ds_read_b64_tr_b16 v[44:45], v23 offset:24576
v_mfma_f32_16x16x32_bf16 v[116:119], a[84:87], v[60:63], v[116:119]
v_mfma_f32_16x16x32_bf16 v[120:123], a[148:151], v[60:63], v[120:123]
ds_read_b64_tr_b16 v[46:47], v23 offset:26624
v_mfma_f32_16x16x32_bf16 v[124:127], a[212:215], v[60:63], v[124:127]
s_waitcnt lgkmcnt(6)
v_mfma_f32_16x16x32_bf16 v[64:67], a[24:27], v[32:35], v[64:67]
ds_read_b64_tr_b16 v[48:49], v20 offset:28672
v_cvt_pk_bf16_f32 v216, v216, v217
v_mfma_f32_16x16x32_bf16 v[68:71], a[88:91], v[32:35], v[68:71]
v_cvt_pk_bf16_f32 v217, v218, v219
v_mfma_f32_16x16x32_bf16 v[72:75], a[152:155], v[32:35], v[72:75]
ds_read_b64_tr_b16 v[50:51], v20 offset:30720
s_add_u32 s83, s80, 1024
v_cvt_pk_bf16_f32 v218, v220, v221
v_mfma_f32_16x16x32_bf16 v[76:79], a[216:219], v[32:35], v[76:79]
buffer_store_dwordx4 v[184:187], v10, s[44:47], s83 offen sc1
v_cvt_pk_bf16_f32 v219, v222, v223
s_waitcnt lgkmcnt(6)
v_mfma_f32_16x16x32_bf16 v[80:83], a[24:27], v[36:39], v[80:83]
ds_read_b64_tr_b16 v[52:53], v21 offset:28672
v_mfma_f32_16x16x32_bf16 v[84:87], a[88:91], v[36:39], v[84:87]
v_mfma_f32_16x16x32_bf16 v[88:91], a[152:155], v[36:39], v[88:91]
ds_read_b64_tr_b16 v[54:55], v21 offset:30720
v_mfma_f32_16x16x32_bf16 v[92:95], a[216:219], v[36:39], v[92:95]
s_waitcnt lgkmcnt(6)
v_mfma_f32_16x16x32_bf16 v[96:99], a[24:27], v[40:43], v[96:99]
ds_read_b64_tr_b16 v[56:57], v22 offset:28672
v_mfma_f32_16x16x32_bf16 v[100:103], a[88:91], v[40:43], v[100:103]
v_mfma_f32_16x16x32_bf16 v[104:107], a[152:155], v[40:43], v[104:107]
ds_read_b64_tr_b16 v[58:59], v22 offset:30720
v_mfma_f32_16x16x32_bf16 v[108:111], a[216:219], v[40:43], v[108:111]
s_waitcnt lgkmcnt(6)
v_mfma_f32_16x16x32_bf16 v[112:115], a[24:27], v[44:47], v[112:115]
ds_read_b64_tr_b16 v[60:61], v23 offset:28672
v_mfma_f32_16x16x32_bf16 v[116:119], a[88:91], v[44:47], v[116:119]
v_mfma_f32_16x16x32_bf16 v[120:123], a[152:155], v[44:47], v[120:123]
ds_read_b64_tr_b16 v[62:63], v23 offset:30720
v_mfma_f32_16x16x32_bf16 v[124:127], a[216:219], v[44:47], v[124:127]
s_waitcnt lgkmcnt(6)
v_mfma_f32_16x16x32_bf16 v[64:67], a[28:31], v[48:51], v[64:67]
v_cvt_pk_bf16_f32 v232, v232, v233
v_mfma_f32_16x16x32_bf16 v[68:71], a[92:95], v[48:51], v[68:71]
s_waitcnt lgkmcnt(0)
s_waitcnt vmcnt(36)
s_barrier
v_cvt_pk_bf16_f32 v233, v234, v235
v_mfma_f32_16x16x32_bf16 v[72:75], a[156:159], v[48:51], v[72:75]
ds_read_b64_tr_b16 v[32:33], v20 offset:32768
s_add_u32 s83, s79, 9216
v_cvt_pk_bf16_f32 v234, v236, v237
v_mfma_f32_16x16x32_bf16 v[76:79], a[220:223], v[48:51], v[76:79]
ds_read_b64_tr_b16 v[34:35], v20 offset:34816
buffer_store_dwordx4 v[208:211], v10, s[44:47], s83 offen sc1
v_cvt_pk_bf16_f32 v235, v238, v239
v_mfma_f32_16x16x32_bf16 v[80:83], a[28:31], v[52:55], v[80:83]
v_mfma_f32_16x16x32_bf16 v[84:87], a[92:95], v[52:55], v[84:87]
ds_read_b64_tr_b16 v[36:37], v21 offset:32768
v_mfma_f32_16x16x32_bf16 v[88:91], a[156:159], v[52:55], v[88:91]
v_mfma_f32_16x16x32_bf16 v[92:95], a[220:223], v[52:55], v[92:95]
ds_read_b64_tr_b16 v[38:39], v21 offset:34816
s_add_u32 s87, s86, 3145728
v_mfma_f32_16x16x32_bf16 v[96:99], a[28:31], v[56:59], v[96:99]
s_add_u32 m0, s88, 65536
s_nop 0
buffer_load_dwordx4 v24, s[4:7], s87 offen offset:0 lds
v_mfma_f32_16x16x32_bf16 v[100:103], a[92:95], v[56:59], v[100:103]
ds_read_b64_tr_b16 v[40:41], v22 offset:32768
v_mfma_f32_16x16x32_bf16 v[104:107], a[156:159], v[56:59], v[104:107]
ds_read_b64_tr_b16 v[42:43], v22 offset:34816
v_mfma_f32_16x16x32_bf16 v[108:111], a[220:223], v[56:59], v[108:111]
v_mfma_f32_16x16x32_bf16 v[112:115], a[28:31], v[60:63], v[112:115]
ds_read_b64_tr_b16 v[44:45], v23 offset:32768
v_mfma_f32_16x16x32_bf16 v[116:119], a[92:95], v[60:63], v[116:119]
s_add_u32 m0, s88, 65536
s_nop 0
buffer_load_dwordx4 v25, s[4:7], s87 offen offset:1024 lds
v_mfma_f32_16x16x32_bf16 v[120:123], a[156:159], v[60:63], v[120:123]
ds_read_b64_tr_b16 v[46:47], v23 offset:34816
v_mfma_f32_16x16x32_bf16 v[124:127], a[220:223], v[60:63], v[124:127]
s_waitcnt lgkmcnt(6)
v_mfma_f32_16x16x32_bf16 v[64:67], a[32:35], v[32:35], v[64:67]
ds_read_b64_tr_b16 v[48:49], v20 offset:36864
v_cvt_pk_bf16_f32 v248, v248, v249
v_mfma_f32_16x16x32_bf16 v[68:71], a[96:99], v[32:35], v[68:71]
v_cvt_pk_bf16_f32 v249, v250, v251
v_mfma_f32_16x16x32_bf16 v[72:75], a[160:163], v[32:35], v[72:75]
ds_read_b64_tr_b16 v[50:51], v20 offset:38912
s_add_u32 s83, s80, 5120
v_cvt_pk_bf16_f32 v250, v252, v253
v_mfma_f32_16x16x32_bf16 v[76:79], a[224:227], v[32:35], v[76:79]
buffer_store_dwordx4 v[188:191], v10, s[44:47], s83 offen sc1
v_cvt_pk_bf16_f32 v251, v254, v255
s_waitcnt lgkmcnt(6)
v_mfma_f32_16x16x32_bf16 v[80:83], a[32:35], v[36:39], v[80:83]
ds_read_b64_tr_b16 v[52:53], v21 offset:36864
v_mfma_f32_16x16x32_bf16 v[84:87], a[96:99], v[36:39], v[84:87]
v_mfma_f32_16x16x32_bf16 v[88:91], a[160:163], v[36:39], v[88:91]
ds_read_b64_tr_b16 v[54:55], v21 offset:38912
v_mfma_f32_16x16x32_bf16 v[92:95], a[224:227], v[36:39], v[92:95]
s_waitcnt lgkmcnt(6)
v_mfma_f32_16x16x32_bf16 v[96:99], a[32:35], v[40:43], v[96:99]
ds_read_b64_tr_b16 v[56:57], v22 offset:36864
s_add_u32 m0, s88, 65536
s_nop 0
buffer_load_dwordx4 v26, s[4:7], s87 offen offset:2048 lds
v_mfma_f32_16x16x32_bf16 v[100:103], a[96:99], v[40:43], v[100:103]
v_mfma_f32_16x16x32_bf16 v[104:107], a[160:163], v[40:43], v[104:107]
ds_read_b64_tr_b16 v[58:59], v22 offset:38912
v_mfma_f32_16x16x32_bf16 v[108:111], a[224:227], v[40:43], v[108:111]
s_waitcnt lgkmcnt(6)
v_mfma_f32_16x16x32_bf16 v[112:115], a[32:35], v[44:47], v[112:115]
ds_read_b64_tr_b16 v[60:61], v23 offset:36864
s_mov_b32 s92, 0
v_mfma_f32_16x16x32_bf16 v[116:119], a[96:99], v[44:47], v[116:119]
buffer_load_dword v29, v30, s[96:99], s92 offen sc1
v_mfma_f32_16x16x32_bf16 v[120:123], a[160:163], v[44:47], v[120:123]
ds_read_b64_tr_b16 v[62:63], v23 offset:38912
v_mfma_f32_16x16x32_bf16 v[124:127], a[224:227], v[44:47], v[124:127]
s_waitcnt lgkmcnt(6)
v_mfma_f32_16x16x32_bf16 v[64:67], a[36:39], v[48:51], v[64:67]
ds_read_b64_tr_b16 v[32:33], v20 offset:40960
v_mfma_f32_16x16x32_bf16 v[68:71], a[100:103], v[48:51], v[68:71]
v_mfma_f32_16x16x32_bf16 v[72:75], a[164:167], v[48:51], v[72:75]
ds_read_b64_tr_b16 v[34:35], v20 offset:43008
s_add_u32 s83, s79, 10240
v_mfma_f32_16x16x32_bf16 v[76:79], a[228:231], v[48:51], v[76:79]
buffer_store_dwordx4 v[224:227], v10, s[44:47], s83 offen sc1
s_waitcnt lgkmcnt(6)
v_mfma_f32_16x16x32_bf16 v[80:83], a[36:39], v[52:55], v[80:83]
ds_read_b64_tr_b16 v[36:37], v21 offset:40960
v_mfma_f32_16x16x32_bf16 v[84:87], a[100:103], v[52:55], v[84:87]
v_mfma_f32_16x16x32_bf16 v[88:91], a[164:167], v[52:55], v[88:91]
ds_read_b64_tr_b16 v[38:39], v21 offset:43008
v_mfma_f32_16x16x32_bf16 v[92:95], a[228:231], v[52:55], v[92:95]
s_waitcnt lgkmcnt(6)
v_mfma_f32_16x16x32_bf16 v[96:99], a[36:39], v[56:59], v[96:99]
ds_read_b64_tr_b16 v[40:41], v22 offset:40960
s_add_u32 m0, s88, 65536
s_nop 0
buffer_load_dwordx4 v27, s[4:7], s87 offen offset:3072 lds
v_mfma_f32_16x16x32_bf16 v[100:103], a[100:103], v[56:59], v[100:103]
v_mfma_f32_16x16x32_bf16 v[104:107], a[164:167], v[56:59], v[104:107]
ds_read_b64_tr_b16 v[42:43], v22 offset:43008
v_mfma_f32_16x16x32_bf16 v[108:111], a[228:231], v[56:59], v[108:111]
s_waitcnt lgkmcnt(6)
v_mfma_f32_16x16x32_bf16 v[112:115], a[36:39], v[60:63], v[112:115]
ds_read_b64_tr_b16 v[44:45], v23 offset:40960
s_add_u32 s87, s86, 3670016
v_mfma_f32_16x16x32_bf16 v[116:119], a[100:103], v[60:63], v[116:119]
s_add_u32 m0, s88, 81920
s_nop 0
buffer_load_dwordx4 v24, s[4:7], s87 offen offset:0 lds
v_mfma_f32_16x16x32_bf16 v[120:123], a[164:167], v[60:63], v[120:123]
ds_read_b64_tr_b16 v[46:47], v23 offset:43008
v_mfma_f32_16x16x32_bf16 v[124:127], a[228:231], v[60:63], v[124:127]
s_waitcnt lgkmcnt(6)
v_mfma_f32_16x16x32_bf16 v[64:67], a[40:43], v[32:35], v[64:67]
ds_read_b64_tr_b16 v[48:49], v20 offset:45056
v_mfma_f32_16x16x32_bf16 v[68:71], a[104:107], v[32:35], v[68:71]
v_mfma_f32_16x16x32_bf16 v[72:75], a[168:171], v[32:35], v[72:75]
ds_read_b64_tr_b16 v[50:51], v20 offset:47104
v_mfma_f32_16x16x32_bf16 v[76:79], a[232:235], v[32:35], v[76:79]
s_add_u32 m0, s88, 81920
s_nop 0
buffer_load_dwordx4 v25, s[4:7], s87 offen offset:1024 lds
s_waitcnt lgkmcnt(6)
v_mfma_f32_16x16x32_bf16 v[80:83], a[40:43], v[36:39], v[80:83]
ds_read_b64_tr_b16 v[52:53], v21 offset:45056
v_mfma_f32_16x16x32_bf16 v[84:87], a[104:107], v[36:39], v[84:87]
v_mfma_f32_16x16x32_bf16 v[88:91], a[168:171], v[36:39], v[88:91]
ds_read_b64_tr_b16 v[54:55], v21 offset:47104
v_mfma_f32_16x16x32_bf16 v[92:95], a[232:235], v[36:39], v[92:95]
s_waitcnt lgkmcnt(6)
v_mfma_f32_16x16x32_bf16 v[96:99], a[40:43], v[40:43], v[96:99]
ds_read_b64_tr_b16 v[56:57], v22 offset:45056
s_add_u32 m0, s88, 81920
s_nop 0
buffer_load_dwordx4 v26, s[4:7], s87 offen offset:2048 lds
v_mfma_f32_16x16x32_bf16 v[100:103], a[104:107], v[40:43], v[100:103]
v_mfma_f32_16x16x32_bf16 v[104:107], a[168:171], v[40:43], v[104:107]
ds_read_b64_tr_b16 v[58:59], v22 offset:47104
v_mfma_f32_16x16x32_bf16 v[108:111], a[232:235], v[40:43], v[108:111]
s_waitcnt lgkmcnt(6)
v_mfma_f32_16x16x32_bf16 v[112:115], a[40:43], v[44:47], v[112:115]
ds_read_b64_tr_b16 v[60:61], v23 offset:45056
v_mfma_f32_16x16x32_bf16 v[116:119], a[104:107], v[44:47], v[116:119]
s_add_u32 m0, s88, 81920
s_nop 0
buffer_load_dwordx4 v27, s[4:7], s87 offen offset:3072 lds
v_mfma_f32_16x16x32_bf16 v[120:123], a[168:171], v[44:47], v[120:123]
ds_read_b64_tr_b16 v[62:63], v23 offset:47104
v_mfma_f32_16x16x32_bf16 v[124:127], a[232:235], v[44:47], v[124:127]
s_waitcnt lgkmcnt(6)
v_mfma_f32_16x16x32_bf16 v[64:67], a[44:47], v[48:51], v[64:67]
ds_read_b64_tr_b16 v[32:33], v20 offset:49152
v_mfma_f32_16x16x32_bf16 v[68:71], a[108:111], v[48:51], v[68:71]
v_mfma_f32_16x16x32_bf16 v[72:75], a[172:175], v[48:51], v[72:75]
ds_read_b64_tr_b16 v[34:35], v20 offset:51200
s_add_u32 s83, s79, 11264
v_mfma_f32_16x16x32_bf16 v[76:79], a[236:239], v[48:51], v[76:79]
buffer_store_dwordx4 v[240:243], v10, s[44:47], s83 offen sc1
s_waitcnt lgkmcnt(6)
v_mfma_f32_16x16x32_bf16 v[80:83], a[44:47], v[52:55], v[80:83]
ds_read_b64_tr_b16 v[36:37], v21 offset:49152
v_mfma_f32_16x16x32_bf16 v[84:87], a[108:111], v[52:55], v[84:87]
v_mfma_f32_16x16x32_bf16 v[88:91], a[172:175], v[52:55], v[88:91]
ds_read_b64_tr_b16 v[38:39], v21 offset:51200
v_mfma_f32_16x16x32_bf16 v[92:95], a[236:239], v[52:55], v[92:95]
s_waitcnt lgkmcnt(6)
v_mfma_f32_16x16x32_bf16 v[96:99], a[44:47], v[56:59], v[96:99]
ds_read_b64_tr_b16 v[40:41], v22 offset:49152
v_mfma_f32_16x16x32_bf16 v[100:103], a[108:111], v[56:59], v[100:103]
v_mfma_f32_16x16x32_bf16 v[104:107], a[172:175], v[56:59], v[104:107]
ds_read_b64_tr_b16 v[42:43], v22 offset:51200
v_mfma_f32_16x16x32_bf16 v[108:111], a[236:239], v[56:59], v[108:111]
s_waitcnt lgkmcnt(6)
v_mfma_f32_16x16x32_bf16 v[112:115], a[44:47], v[60:63], v[112:115]
ds_read_b64_tr_b16 v[44:45], v23 offset:49152
v_mfma_f32_16x16x32_bf16 v[116:119], a[108:111], v[60:63], v[116:119]
v_mfma_f32_16x16x32_bf16 v[120:123], a[172:175], v[60:63], v[120:123]
ds_read_b64_tr_b16 v[46:47], v23 offset:51200
v_mfma_f32_16x16x32_bf16 v[124:127], a[236:239], v[60:63], v[124:127]
s_waitcnt lgkmcnt(6)
v_mfma_f32_16x16x32_bf16 v[64:67], a[48:51], v[32:35], v[64:67]
ds_read_b64_tr_b16 v[48:49], v20 offset:53248
v_mfma_f32_16x16x32_bf16 v[68:71], a[112:115], v[32:35], v[68:71]
v_mfma_f32_16x16x32_bf16 v[72:75], a[176:179], v[32:35], v[72:75]
ds_read_b64_tr_b16 v[50:51], v20 offset:55296
v_mfma_f32_16x16x32_bf16 v[76:79], a[240:243], v[32:35], v[76:79]
s_waitcnt lgkmcnt(6)
v_mfma_f32_16x16x32_bf16 v[80:83], a[48:51], v[36:39], v[80:83]
ds_read_b64_tr_b16 v[52:53], v21 offset:53248
v_mfma_f32_16x16x32_bf16 v[84:87], a[112:115], v[36:39], v[84:87]
v_mfma_f32_16x16x32_bf16 v[88:91], a[176:179], v[36:39], v[88:91]
ds_read_b64_tr_b16 v[54:55], v21 offset:55296
v_mfma_f32_16x16x32_bf16 v[92:95], a[240:243], v[36:39], v[92:95]
s_waitcnt lgkmcnt(6)
v_mfma_f32_16x16x32_bf16 v[96:99], a[48:51], v[40:43], v[96:99]
ds_read_b64_tr_b16 v[56:57], v22 offset:53248
v_mfma_f32_16x16x32_bf16 v[100:103], a[112:115], v[40:43], v[100:103]
v_mfma_f32_16x16x32_bf16 v[104:107], a[176:179], v[40:43], v[104:107]
ds_read_b64_tr_b16 v[58:59], v22 offset:55296
v_mfma_f32_16x16x32_bf16 v[108:111], a[240:243], v[40:43], v[108:111]
s_waitcnt lgkmcnt(6)
v_mfma_f32_16x16x32_bf16 v[112:115], a[48:51], v[44:47], v[112:115]
ds_read_b64_tr_b16 v[60:61], v23 offset:53248
v_mfma_f32_16x16x32_bf16 v[116:119], a[112:115], v[44:47], v[116:119]
v_mfma_f32_16x16x32_bf16 v[120:123], a[176:179], v[44:47], v[120:123]
ds_read_b64_tr_b16 v[62:63], v23 offset:55296
v_mfma_f32_16x16x32_bf16 v[124:127], a[240:243], v[44:47], v[124:127]
s_waitcnt lgkmcnt(6)
v_mfma_f32_16x16x32_bf16 v[64:67], a[52:55], v[48:51], v[64:67]
ds_read_b64_tr_b16 v[32:33], v20 offset:57344
v_mfma_f32_16x16x32_bf16 v[68:71], a[116:119], v[48:51], v[68:71]
v_mfma_f32_16x16x32_bf16 v[72:75], a[180:183], v[48:51], v[72:75]
ds_read_b64_tr_b16 v[34:35], v20 offset:59392
s_add_u32 s83, s80, 8192
v_mfma_f32_16x16x32_bf16 v[76:79], a[244:247], v[48:51], v[76:79]
buffer_store_dwordx4 v[200:203], v10, s[44:47], s83 offen sc1
s_waitcnt lgkmcnt(6)
v_mfma_f32_16x16x32_bf16 v[80:83], a[52:55], v[52:55], v[80:83]
ds_read_b64_tr_b16 v[36:37], v21 offset:57344
v_mfma_f32_16x16x32_bf16 v[84:87], a[116:119], v[52:55], v[84:87]
v_mfma_f32_16x16x32_bf16 v[88:91], a[180:183], v[52:55], v[88:91]
ds_read_b64_tr_b16 v[38:39], v21 offset:59392
v_mfma_f32_16x16x32_bf16 v[92:95], a[244:247], v[52:55], v[92:95]
s_waitcnt lgkmcnt(6)
v_mfma_f32_16x16x32_bf16 v[96:99], a[52:55], v[56:59], v[96:99]
ds_read_b64_tr_b16 v[40:41], v22 offset:57344
v_mfma_f32_16x16x32_bf16 v[100:103], a[116:119], v[56:59], v[100:103]
v_mfma_f32_16x16x32_bf16 v[104:107], a[180:183], v[56:59], v[104:107]
ds_read_b64_tr_b16 v[42:43], v22 offset:59392
v_mfma_f32_16x16x32_bf16 v[108:111], a[244:247], v[56:59], v[108:111]
s_waitcnt lgkmcnt(6)
v_mfma_f32_16x16x32_bf16 v[112:115], a[52:55], v[60:63], v[112:115]
ds_read_b64_tr_b16 v[44:45], v23 offset:57344
v_mfma_f32_16x16x32_bf16 v[116:119], a[116:119], v[60:63], v[116:119]
v_mfma_f32_16x16x32_bf16 v[120:123], a[180:183], v[60:63], v[120:123]
ds_read_b64_tr_b16 v[46:47], v23 offset:59392
v_mfma_f32_16x16x32_bf16 v[124:127], a[244:247], v[60:63], v[124:127]
s_waitcnt lgkmcnt(6)
v_mfma_f32_16x16x32_bf16 v[64:67], a[56:59], v[32:35], v[64:67]
ds_read_b64_tr_b16 v[48:49], v20 offset:61440
v_mfma_f32_16x16x32_bf16 v[68:71], a[120:123], v[32:35], v[68:71]
v_mfma_f32_16x16x32_bf16 v[72:75], a[184:187], v[32:35], v[72:75]
ds_read_b64_tr_b16 v[50:51], v20 offset:63488
v_mfma_f32_16x16x32_bf16 v[76:79], a[248:251], v[32:35], v[76:79]
s_waitcnt lgkmcnt(6)
v_mfma_f32_16x16x32_bf16 v[80:83], a[56:59], v[36:39], v[80:83]
ds_read_b64_tr_b16 v[52:53], v21 offset:61440
v_mfma_f32_16x16x32_bf16 v[84:87], a[120:123], v[36:39], v[84:87]
v_mfma_f32_16x16x32_bf16 v[88:91], a[184:187], v[36:39], v[88:91]
ds_read_b64_tr_b16 v[54:55], v21 offset:63488
v_mfma_f32_16x16x32_bf16 v[92:95], a[248:251], v[36:39], v[92:95]
s_waitcnt lgkmcnt(6)
v_mfma_f32_16x16x32_bf16 v[96:99], a[56:59], v[40:43], v[96:99]
ds_read_b64_tr_b16 v[56:57], v22 offset:61440
v_mfma_f32_16x16x32_bf16 v[100:103], a[120:123], v[40:43], v[100:103]
v_mfma_f32_16x16x32_bf16 v[104:107], a[184:187], v[40:43], v[104:107]
ds_read_b64_tr_b16 v[58:59], v22 offset:63488
v_mfma_f32_16x16x32_bf16 v[108:111], a[248:251], v[40:43], v[108:111]
s_waitcnt lgkmcnt(6)
v_mfma_f32_16x16x32_bf16 v[112:115], a[56:59], v[44:47], v[112:115]
ds_read_b64_tr_b16 v[60:61], v23 offset:61440
v_mfma_f32_16x16x32_bf16 v[116:119], a[120:123], v[44:47], v[116:119]
v_mfma_f32_16x16x32_bf16 v[120:123], a[184:187], v[44:47], v[120:123]
ds_read_b64_tr_b16 v[62:63], v23 offset:63488
v_mfma_f32_16x16x32_bf16 v[124:127], a[248:251], v[44:47], v[124:127]
s_waitcnt lgkmcnt(6)
v_mfma_f32_16x16x32_bf16 v[64:67], a[60:63], v[48:51], v[64:67]
v_mfma_f32_16x16x32_bf16 v[68:71], a[124:127], v[48:51], v[68:71]
v_mfma_f32_16x16x32_bf16 v[72:75], a[188:191], v[48:51], v[72:75]
s_add_u32 s83, s80, 9216
v_mfma_f32_16x16x32_bf16 v[76:79], a[252:255], v[48:51], v[76:79]
buffer_store_dwordx4 v[216:219], v10, s[44:47], s83 offen sc1
s_waitcnt lgkmcnt(4)
v_mfma_f32_16x16x32_bf16 v[80:83], a[60:63], v[52:55], v[80:83]
v_mfma_f32_16x16x32_bf16 v[84:87], a[124:127], v[52:55], v[84:87]
v_mfma_f32_16x16x32_bf16 v[88:91], a[188:191], v[52:55], v[88:91]
v_mfma_f32_16x16x32_bf16 v[92:95], a[252:255], v[52:55], v[92:95]
s_waitcnt lgkmcnt(2)
v_mfma_f32_16x16x32_bf16 v[96:99], a[60:63], v[56:59], v[96:99]
v_mfma_f32_16x16x32_bf16 v[100:103], a[124:127], v[56:59], v[100:103]
v_mfma_f32_16x16x32_bf16 v[104:107], a[188:191], v[56:59], v[104:107]
v_mfma_f32_16x16x32_bf16 v[108:111], a[252:255], v[56:59], v[108:111]
s_waitcnt lgkmcnt(0)
v_mfma_f32_16x16x32_bf16 v[112:115], a[60:63], v[60:63], v[112:115]
v_mfma_f32_16x16x32_bf16 v[116:119], a[124:127], v[60:63], v[116:119]
v_mfma_f32_16x16x32_bf16 v[120:123], a[188:191], v[60:63], v[120:123]
v_mfma_f32_16x16x32_bf16 v[124:127], a[252:255], v[60:63], v[124:127]
s_nop 3
v_cvt_pk_bf16_f32 v64, v64, v65
v_cvt_pk_bf16_f32 v65, v66, v67
v_cvt_pk_bf16_f32 v66, v68, v69
v_cvt_pk_bf16_f32 v67, v70, v71
v_cvt_pk_bf16_f32 v80, v80, v81
v_cvt_pk_bf16_f32 v81, v82, v83
v_cvt_pk_bf16_f32 v82, v84, v85
v_cvt_pk_bf16_f32 v83, v86, v87
v_cvt_pk_bf16_f32 v96, v96, v97
v_cvt_pk_bf16_f32 v97, v98, v99
v_cvt_pk_bf16_f32 v98, v100, v101
v_cvt_pk_bf16_f32 v99, v102, v103
v_cvt_pk_bf16_f32 v112, v112, v113
v_cvt_pk_bf16_f32 v113, v114, v115
v_cvt_pk_bf16_f32 v114, v116, v117
v_cvt_pk_bf16_f32 v115, v118, v119
v_cvt_pk_bf16_f32 v72, v72, v73
v_cvt_pk_bf16_f32 v73, v74, v75
v_cvt_pk_bf16_f32 v74, v76, v77
v_cvt_pk_bf16_f32 v75, v78, v79
v_cvt_pk_bf16_f32 v88, v88, v89
v_cvt_pk_bf16_f32 v89, v90, v91
v_cvt_pk_bf16_f32 v90, v92, v93
v_cvt_pk_bf16_f32 v91, v94, v95
v_cvt_pk_bf16_f32 v104, v104, v105
v_cvt_pk_bf16_f32 v105, v106, v107
v_cvt_pk_bf16_f32 v106, v108, v109
v_cvt_pk_bf16_f32 v107, v110, v111
v_cvt_pk_bf16_f32 v120, v120, v121
v_cvt_pk_bf16_f32 v121, v122, v123
v_cvt_pk_bf16_f32 v122, v124, v125
v_cvt_pk_bf16_f32 v123, v126, v127
v_mov_b32 v68, v232
v_mov_b32 v69, v233
v_mov_b32 v70, v234
v_mov_b32 v71, v235
v_mov_b32 v84, v248
v_mov_b32 v85, v249
v_mov_b32 v86, v250
v_mov_b32 v87, v251
v_and_b32 v32, 15, v1
v_lshrrev_b32 v33, 4, v1
v_lshrrev_b32 v34, 2, v32
v_and_b32 v35, 3, v32
v_lshl_add_u32 v36, v33, 2, v34
v_and_b32 v37, 7, v36
v_lshlrev_b32 v36, 8, v36
v_lshl_add_u32 v36, v37, 5, v36
v_lshl_add_u32 v36, v35, 3, v36
v_xor_b32 v2, 0, v36
v_add_u32 v16, 131072, v2
v_xor_b32 v3, 32, v36
v_add_u32 v17, 131072, v3
v_xor_b32 v8, 64, v36
v_add_u32 v18, 131072, v8
v_xor_b32 v9, 96, v36
v_add_u32 v19, 131072, v9
v_xor_b32 v11, 128, v36
v_add_u32 v20, 131072, v11
v_xor_b32 v12, 160, v36
v_add_u32 v21, 131072, v12
v_xor_b32 v13, 192, v36
v_add_u32 v22, 131072, v13
v_xor_b32 v14, 224, v36
v_add_u32 v23, 131072, v14
s_sub_u32 s70, 7, s64
s_lshl_b32 s71, s66, 3
s_sub_u32 s72, 120, s71
s_add_u32 s92, s71, s70
s_mul_i32 s74, s92, 20480
s_add_u32 s93, s71, s64
s_mul_i32 s75, s93, 20480
s_add_u32 s94, s72, s70
s_mul_i32 s76, s94, 20480
s_add_u32 s95, s72, s64
s_mul_i32 s77, s95, 20480
s_mov_b32 s73, 0
s_waitcnt vmcnt(9)
v_readfirstlane_b32 s71, v29
s_nop 0
s_cmp_ge_u32 s71, 256
s_cbranch_scc1 L_pk_2
v_mov_b32 v33, 0
s_mov_b32 s72, 0
L_spin_3:
buffer_load_dword v32, v33, s[96:99], s73 offen sc1
s_waitcnt vmcnt(0)
v_readfirstlane_b32 s71, v32
s_add_u32 s72, s72, 1
s_cmp_ge_u32 s71, 256
s_cbranch_scc1 L_spine_4
s_sleep 2
s_cmp_lt_u32 s72, 262144
s_cbranch_scc1 L_spin_3
L_spine_4:
L_pk_2:
buffer_load_dwordx4 a[144:147], v10, s[44:47], s74 offen offset:0 sc1
buffer_load_dwordx4 a[148:151], v10, s[44:47], s75 offen offset:0 sc1
buffer_load_dwordx4 a[152:155], v10, s[44:47], s76 offen offset:0 sc1
buffer_load_dwordx4 a[156:159], v10, s[44:47], s77 offen offset:0 sc1
buffer_load_dwordx4 a[160:163], v10, s[44:47], s74 offen offset:1024 sc1
buffer_load_dwordx4 a[164:167], v10, s[44:47], s75 offen offset:1024 sc1
buffer_load_dwordx4 a[168:171], v10, s[44:47], s76 offen offset:1024 sc1
buffer_load_dwordx4 a[172:175], v10, s[44:47], s77 offen offset:1024 sc1
buffer_load_dwordx4 a[176:179], v10, s[44:47], s74 offen offset:2048 sc1
buffer_load_dwordx4 a[180:183], v10, s[44:47], s75 offen offset:2048 sc1
buffer_load_dwordx4 a[184:187], v10, s[44:47], s76 offen offset:2048 sc1
buffer_load_dwordx4 a[188:191], v10, s[44:47], s77 offen offset:2048 sc1
s_barrier
ds_read_b64_tr_b16 v[32:33], v16 offset:0
ds_read_b64_tr_b16 v[34:35], v16 offset:4096
ds_read_b64_tr_b16 v[36:37], v17 offset:0
ds_read_b64_tr_b16 v[38:39], v17 offset:4096
ds_read_b64_tr_b16 v[40:41], v18 offset:0
ds_read_b64_tr_b16 v[42:43], v18 offset:4096
ds_read_b64_tr_b16 v[44:45], v19 offset:0
ds_read_b64_tr_b16 v[46:47], v19 offset:4096
ds_read_b64_tr_b16 v[48:49], v20 offset:0
ds_read_b64_tr_b16 v[50:51], v20 offset:4096
ds_read_b64_tr_b16 v[52:53], v21 offset:0
ds_read_b64_tr_b16 v[54:55], v21 offset:4096
ds_read_b64_tr_b16 v[56:57], v22 offset:0
ds_read_b64_tr_b16 v[58:59], v22 offset:4096
ds_read_b64_tr_b16 v[60:61], v23 offset:0
ds_read_b64_tr_b16 v[62:63], v23 offset:4096
s_waitcnt vmcnt(8)
s_waitcnt lgkmcnt(14)
v_mfma_f32_16x16x32_bf16 v[128:131], v[32:35], a[144:147], 0
s_add_u32 s83, s80, 11264
v_accvgpr_write_b32 a0, 0
v_mfma_f32_16x16x32_bf16 v[132:135], v[32:35], a[148:151], 0
buffer_store_dwordx4 v[84:87], v10, s[44:47], s83 offen sc1
v_mfma_f32_16x16x32_bf16 v[136:139], v[32:35], a[152:155], 0
v_accvgpr_write_b32 a1, 0
v_mfma_f32_16x16x32_bf16 v[140:143], v[32:35], a[156:159], 0
ds_read_b64_tr_b16 v[32:33], v16 offset:8192
v_accvgpr_write_b32 a2, 0
s_waitcnt lgkmcnt(13)
v_mfma_f32_16x16x32_bf16 v[144:147], v[36:39], a[144:147], 0
ds_read_b64_tr_b16 v[34:35], v16 offset:12288
v_accvgpr_write_b32 a3, 0
v_mfma_f32_16x16x32_bf16 v[148:151], v[36:39], a[148:151], 0
buffer_load_dwordx4 a[192:195], v10, s[44:47], s74 offen offset:3072 sc1
v_mfma_f32_16x16x32_bf16 v[152:155], v[36:39], a[152:155], 0
v_accvgpr_write_b32 a4, 0
v_mfma_f32_16x16x32_bf16 v[156:159], v[36:39], a[156:159], 0
ds_read_b64_tr_b16 v[36:37], v17 offset:8192
v_accvgpr_write_b32 a5, 0
s_waitcnt lgkmcnt(13)
v_mfma_f32_16x16x32_bf16 v[160:163], v[40:43], a[144:147], 0
ds_read_b64_tr_b16 v[38:39], v17 offset:12288
s_add_u32 s83, s80, 10240
v_accvgpr_write_b32 a6, 0
v_mfma_f32_16x16x32_bf16 v[164:167], v[40:43], a[148:151], 0
buffer_store_dwordx4 v[68:71], v10, s[44:47], s83 offen sc1
v_mfma_f32_16x16x32_bf16 v[168:171], v[40:43], a[152:155], 0
v_accvgpr_write_b32 a7, 0
v_mfma_f32_16x16x32_bf16 v[172:175], v[40:43], a[156:159], 0
ds_read_b64_tr_b16 v[40:41], v18 offset:8192
v_accvgpr_write_b32 a8, 0
s_waitcnt lgkmcnt(13)
v_mfma_f32_16x16x32_bf16 v[176:179], v[44:47], a[144:147], 0
ds_read_b64_tr_b16 v[42:43], v18 offset:12288
v_accvgpr_write_b32 a9, 0
v_mfma_f32_16x16x32_bf16 v[180:183], v[44:47], a[148:151], 0
buffer_load_dwordx4 a[196:199], v10, s[44:47], s75 offen offset:3072 sc1
v_mfma_f32_16x16x32_bf16 v[184:187], v[44:47], a[152:155], 0
v_accvgpr_write_b32 a10, 0
v_mfma_f32_16x16x32_bf16 v[188:191], v[44:47], a[156:159], 0
ds_read_b64_tr_b16 v[44:45], v19 offset:8192
v_accvgpr_write_b32 a11, 0
s_waitcnt lgkmcnt(13)
v_mfma_f32_16x16x32_bf16 v[192:195], v[48:51], a[144:147], 0
ds_read_b64_tr_b16 v[46:47], v19 offset:12288
s_add_u32 s87, s86, 4194304
v_mfma_f32_16x16x32_bf16 v[196:199], v[48:51], a[148:151], 0
s_add_u32 m0, s88, 98304
s_nop 0
buffer_load_dwordx4 v24, s[4:7], s87 offen offset:0 lds
v_mfma_f32_16x16x32_bf16 v[200:203], v[48:51], a[152:155], 0
v_mfma_f32_16x16x32_bf16 v[204:207], v[48:51], a[156:159], 0
ds_read_b64_tr_b16 v[48:49], v20 offset:8192
s_waitcnt lgkmcnt(13)
v_mfma_f32_16x16x32_bf16 v[208:211], v[52:55], a[144:147], 0
ds_read_b64_tr_b16 v[50:51], v20 offset:12288
v_mfma_f32_16x16x32_bf16 v[212:215], v[52:55], a[148:151], 0
buffer_load_dwordx4 a[200:203], v10, s[44:47], s76 offen offset:3072 sc1
v_mfma_f32_16x16x32_bf16 v[216:219], v[52:55], a[152:155], 0
v_mfma_f32_16x16x32_bf16 v[220:223], v[52:55], a[156:159], 0
ds_read_b64_tr_b16 v[52:53], v21 offset:8192
s_waitcnt lgkmcnt(13)
v_mfma_f32_16x16x32_bf16 v[224:227], v[56:59], a[144:147], 0
ds_read_b64_tr_b16 v[54:55], v21 offset:12288
v_mfma_f32_16x16x32_bf16 v[228:231], v[56:59], a[148:151], 0
s_add_u32 m0, s88, 98304
s_nop 0
buffer_load_dwordx4 v25, s[4:7], s87 offen offset:1024 lds
v_mfma_f32_16x16x32_bf16 v[232:235], v[56:59], a[152:155], 0
v_mfma_f32_16x16x32_bf16 v[236:239], v[56:59], a[156:159], 0
ds_read_b64_tr_b16 v[56:57], v22 offset:8192
s_waitcnt lgkmcnt(13)
v_mfma_f32_16x16x32_bf16 v[240:243], v[60:63], a[144:147], 0
ds_read_b64_tr_b16 v[58:59], v22 offset:12288
v_mfma_f32_16x16x32_bf16 v[244:247], v[60:63], a[148:151], 0
buffer_load_dwordx4 a[204:207], v10, s[44:47], s77 offen offset:3072 sc1
v_mfma_f32_16x16x32_bf16 v[248:251], v[60:63], a[152:155], 0
v_mfma_f32_16x16x32_bf16 v[252:255], v[60:63], a[156:159], 0
ds_read_b64_tr_b16 v[60:61], v23 offset:8192
s_waitcnt vmcnt(12)
s_waitcnt lgkmcnt(13)
v_mfma_f32_16x16x32_bf16 v[128:131], v[32:35], a[160:163], v[128:131]
ds_read_b64_tr_b16 v[62:63], v23 offset:12288
s_add_u32 s74, s74, 4096
s_add_u32 s83, s79, 12288
v_accvgpr_write_b32 a12, 0
v_mfma_f32_16x16x32_bf16 v[132:135], v[32:35], a[164:167], v[132:135]
buffer_store_dwordx4 v[64:67], v10, s[44:47], s83 offen sc1
v_mfma_f32_16x16x32_bf16 v[136:139], v[32:35], a[168:171], v[136:139]
v_accvgpr_write_b32 a13, 0
v_mfma_f32_16x16x32_bf16 v[140:143], v[32:35], a[172:175], v[140:143]
ds_read_b64_tr_b16 v[32:33], v16 offset:16384
v_accvgpr_write_b32 a14, 0
s_waitcnt lgkmcnt(13)
v_mfma_f32_16x16x32_bf16 v[144:147], v[36:39], a[160:163], v[144:147]
ds_read_b64_tr_b16 v[34:35], v16 offset:20480
s_add_u32 s75, s75, 4096
v_accvgpr_write_b32 a15, 0
v_mfma_f32_16x16x32_bf16 v[148:151], v[36:39], a[164:167], v[148:151]
buffer_load_dwordx4 a[144:147], v10, s[44:47], s74 offen offset:0 sc1
v_mfma_f32_16x16x32_bf16 v[152:155], v[36:39], a[168:171], v[152:155]
v_accvgpr_write_b32 a16, 0
v_mfma_f32_16x16x32_bf16 v[156:159], v[36:39], a[172:175], v[156:159]
ds_read_b64_tr_b16 v[36:37], v17 offset:16384
v_accvgpr_write_b32 a17, 0
s_waitcnt lgkmcnt(13)
v_mfma_f32_16x16x32_bf16 v[160:163], v[40:43], a[160:163], v[160:163]
ds_read_b64_tr_b16 v[38:39], v17 offset:20480
s_add_u32 s76, s76, 4096
s_add_u32 s83, s79, 13312
v_accvgpr_write_b32 a18, 0
v_mfma_f32_16x16x32_bf16 v[164:167], v[40:43], a[164:167], v[164:167]
buffer_store_dwordx4 v[80:83], v10, s[44:47], s83 offen sc1
v_mfma_f32_16x16x32_bf16 v[168:171], v[40:43], a[168:171], v[168:171]
v_accvgpr_write_b32 a19, 0
v_mfma_f32_16x16x32_bf16 v[172:175], v[40:43], a[172:175], v[172:175]
ds_read_b64_tr_b16 v[40:41], v18 offset:16384
v_accvgpr_write_b32 a20, 0
s_waitcnt lgkmcnt(13)
v_mfma_f32_16x16x32_bf16 v[176:179], v[44:47], a[160:163], v[176:179]
ds_read_b64_tr_b16 v[42:43], v18 offset:20480
s_add_u32 s77, s77, 4096
v_accvgpr_write_b32 a21, 0
v_mfma_f32_16x16x32_bf16 v[180:183], v[44:47], a[164:167], v[180:183]
buffer_load_dwordx4 a[148:151], v10, s[44:47], s75 offen offset:0 sc1
v_mfma_f32_16x16x32_bf16 v[184:187], v[44:47], a[168:171], v[184:187]
v_accvgpr_write_b32 a22, 0
v_mfma_f32_16x16x32_bf16 v[188:191], v[44:47], a[172:175], v[188:191]
ds_read_b64_tr_b16 v[44:45], v19 offset:16384
v_accvgpr_write_b32 a23, 0
s_waitcnt lgkmcnt(13)
v_mfma_f32_16x16x32_bf16 v[192:195], v[48:51], a[160:163], v[192:195]
ds_read_b64_tr_b16 v[46:47], v19 offset:20480
v_mfma_f32_16x16x32_bf16 v[196:199], v[48:51], a[164:167], v[196:199]
s_add_u32 m0, s88, 98304
s_nop 0
buffer_load_dwordx4 v26, s[4:7], s87 offen offset:2048 lds
v_mfma_f32_16x16x32_bf16 v[200:203], v[48:51], a[168:171], v[200:203]
v_mfma_f32_16x16x32_bf16 v[204:207], v[48:51], a[172:175], v[204:207]
ds_read_b64_tr_b16 v[48:49], v20 offset:16384
s_waitcnt lgkmcnt(13)
v_mfma_f32_16x16x32_bf16 v[208:211], v[52:55], a[160:163], v[208:211]
ds_read_b64_tr_b16 v[50:51], v20 offset:20480
v_mfma_f32_16x16x32_bf16 v[212:215], v[52:55], a[164:167], v[212:215]
buffer_load_dwordx4 a[152:155], v10, s[44:47], s76 offen offset:0 sc1
v_mfma_f32_16x16x32_bf16 v[216:219], v[52:55], a[168:171], v[216:219]
v_mfma_f32_16x16x32_bf16 v[220:223], v[52:55], a[172:175], v[220:223]
ds_read_b64_tr_b16 v[52:53], v21 offset:16384
s_waitcnt lgkmcnt(13)
v_mfma_f32_16x16x32_bf16 v[224:227], v[56:59], a[160:163], v[224:227]
ds_read_b64_tr_b16 v[54:55], v21 offset:20480
v_mfma_f32_16x16x32_bf16 v[228:231], v[56:59], a[164:167], v[228:231]
s_add_u32 m0, s88, 98304
s_nop 0
buffer_load_dwordx4 v27, s[4:7], s87 offen offset:3072 lds
v_mfma_f32_16x16x32_bf16 v[232:235], v[56:59], a[168:171], v[232:235]
v_mfma_f32_16x16x32_bf16 v[236:239], v[56:59], a[172:175], v[236:239]
ds_read_b64_tr_b16 v[56:57], v22 offset:16384
s_waitcnt lgkmcnt(13)
v_mfma_f32_16x16x32_bf16 v[240:243], v[60:63], a[160:163], v[240:243]
ds_read_b64_tr_b16 v[58:59], v22 offset:20480
v_mfma_f32_16x16x32_bf16 v[244:247], v[60:63], a[164:167], v[244:247]
buffer_load_dwordx4 a[156:159], v10, s[44:47], s77 offen offset:0 sc1
v_mfma_f32_16x16x32_bf16 v[248:251], v[60:63], a[168:171], v[248:251]
v_mfma_f32_16x16x32_bf16 v[252:255], v[60:63], a[172:175], v[252:255]
ds_read_b64_tr_b16 v[60:61], v23 offset:16384
s_waitcnt vmcnt(16)
s_waitcnt lgkmcnt(13)
v_mfma_f32_16x16x32_bf16 v[128:131], v[32:35], a[176:179], v[128:131]
ds_read_b64_tr_b16 v[62:63], v23 offset:20480
s_add_u32 s83, s79, 14336
v_accvgpr_write_b32 a24, 0
v_mfma_f32_16x16x32_bf16 v[132:135], v[32:35], a[180:183], v[132:135]
buffer_store_dwordx4 v[96:99], v10, s[44:47], s83 offen sc1
v_mfma_f32_16x16x32_bf16 v[136:139], v[32:35], a[184:187], v[136:139]
v_accvgpr_write_b32 a25, 0
v_mfma_f32_16x16x32_bf16 v[140:143], v[32:35], a[188:191], v[140:143]
ds_read_b64_tr_b16 v[32:33], v16 offset:24576
v_accvgpr_write_b32 a26, 0
s_waitcnt lgkmcnt(13)
v_mfma_f32_16x16x32_bf16 v[144:147], v[36:39], a[176:179], v[144:147]
ds_read_b64_tr_b16 v[34:35], v16 offset:28672
v_accvgpr_write_b32 a27, 0
v_mfma_f32_16x16x32_bf16 v[148:151], v[36:39], a[180:183], v[148:151]
buffer_load_dwordx4 a[160:163], v10, s[44:47], s74 offen offset:1024 sc1
v_mfma_f32_16x16x32_bf16 v[152:155], v[36:39], a[184:187], v[152:155]
v_accvgpr_write_b32 a28, 0
v_mfma_f32_16x16x32_bf16 v[156:159], v[36:39], a[188:191], v[156:159]
ds_read_b64_tr_b16 v[36:37], v17 offset:24576
v_accvgpr_write_b32 a29, 0
s_waitcnt lgkmcnt(13)
v_mfma_f32_16x16x32_bf16 v[160:163], v[40:43], a[176:179], v[160:163]
ds_read_b64_tr_b16 v[38:39], v17 offset:28672
s_add_u32 s83, s79, 15360
v_accvgpr_write_b32 a30, 0
v_mfma_f32_16x16x32_bf16 v[164:167], v[40:43], a[180:183], v[164:167]
buffer_store_dwordx4 v[112:115], v10, s[44:47], s83 offen sc1
v_mfma_f32_16x16x32_bf16 v[168:171], v[40:43], a[184:187], v[168:171]
v_accvgpr_write_b32 a31, 0
v_mfma_f32_16x16x32_bf16 v[172:175], v[40:43], a[188:191], v[172:175]
ds_read_b64_tr_b16 v[40:41], v18 offset:24576
v_accvgpr_write_b32 a32, 0
s_waitcnt lgkmcnt(13)
v_mfma_f32_16x16x32_bf16 v[176:179], v[44:47], a[176:179], v[176:179]
ds_read_b64_tr_b16 v[42:43], v18 offset:28672
v_accvgpr_write_b32 a33, 0
v_mfma_f32_16x16x32_bf16 v[180:183], v[44:47], a[180:183], v[180:183]
buffer_load_dwordx4 a[164:167], v10, s[44:47], s75 offen offset:1024 sc1
v_mfma_f32_16x16x32_bf16 v[184:187], v[44:47], a[184:187], v[184:187]
v_accvgpr_write_b32 a34, 0
v_mfma_f32_16x16x32_bf16 v[188:191], v[44:47], a[188:191], v[188:191]
ds_read_b64_tr_b16 v[44:45], v19 offset:24576
v_accvgpr_write_b32 a35, 0
s_waitcnt lgkmcnt(13)
v_mfma_f32_16x16x32_bf16 v[192:195], v[48:51], a[176:179], v[192:195]
ds_read_b64_tr_b16 v[46:47], v19 offset:28672
s_add_u32 s87, s86, 4718592
v_mfma_f32_16x16x32_bf16 v[196:199], v[48:51], a[180:183], v[196:199]
s_add_u32 m0, s88, 114688
s_nop 0
buffer_load_dwordx4 v24, s[4:7], s87 offen offset:0 lds
v_mfma_f32_16x16x32_bf16 v[200:203], v[48:51], a[184:187], v[200:203]
v_mfma_f32_16x16x32_bf16 v[204:207], v[48:51], a[188:191], v[204:207]
ds_read_b64_tr_b16 v[48:49], v20 offset:24576
s_waitcnt lgkmcnt(13)
v_mfma_f32_16x16x32_bf16 v[208:211], v[52:55], a[176:179], v[208:211]
ds_read_b64_tr_b16 v[50:51], v20 offset:28672
v_mfma_f32_16x16x32_bf16 v[212:215], v[52:55], a[180:183], v[212:215]
buffer_load_dwordx4 a[168:171], v10, s[44:47], s76 offen offset:1024 sc1
v_mfma_f32_16x16x32_bf16 v[216:219], v[52:55], a[184:187], v[216:219]
v_mfma_f32_16x16x32_bf16 v[220:223], v[52:55], a[188:191], v[220:223]
ds_read_b64_tr_b16 v[52:53], v21 offset:24576
s_waitcnt lgkmcnt(13)
v_mfma_f32_16x16x32_bf16 v[224:227], v[56:59], a[176:179], v[224:227]
ds_read_b64_tr_b16 v[54:55], v21 offset:28672
v_mfma_f32_16x16x32_bf16 v[228:231], v[56:59], a[180:183], v[228:231]
s_add_u32 m0, s88, 114688
s_nop 0
buffer_load_dwordx4 v25, s[4:7], s87 offen offset:1024 lds
v_mfma_f32_16x16x32_bf16 v[232:235], v[56:59], a[184:187], v[232:235]
v_mfma_f32_16x16x32_bf16 v[236:239], v[56:59], a[188:191], v[236:239]
ds_read_b64_tr_b16 v[56:57], v22 offset:24576
s_waitcnt lgkmcnt(13)
v_mfma_f32_16x16x32_bf16 v[240:243], v[60:63], a[176:179], v[240:243]
ds_read_b64_tr_b16 v[58:59], v22 offset:28672
v_mfma_f32_16x16x32_bf16 v[244:247], v[60:63], a[180:183], v[244:247]
buffer_load_dwordx4 a[172:175], v10, s[44:47], s77 offen offset:1024 sc1
v_mfma_f32_16x16x32_bf16 v[248:251], v[60:63], a[184:187], v[248:251]
v_mfma_f32_16x16x32_bf16 v[252:255], v[60:63], a[188:191], v[252:255]
ds_read_b64_tr_b16 v[60:61], v23 offset:24576
s_waitcnt vmcnt(16)
s_waitcnt lgkmcnt(13)
v_mfma_f32_16x16x32_bf16 v[128:131], v[32:35], a[192:195], v[128:131]
ds_read_b64_tr_b16 v[62:63], v23 offset:28672
s_add_u32 s83, s80, 12288
v_accvgpr_write_b32 a36, 0
v_mfma_f32_16x16x32_bf16 v[132:135], v[32:35], a[196:199], v[132:135]
buffer_store_dwordx4 v[72:75], v10, s[44:47], s83 offen sc1
v_mfma_f32_16x16x32_bf16 v[136:139], v[32:35], a[200:203], v[136:139]
v_accvgpr_write_b32 a37, 0
v_mfma_f32_16x16x32_bf16 v[140:143], v[32:35], a[204:207], v[140:143]
ds_read_b64_tr_b16 v[32:33], v2 offset:0
v_accvgpr_write_b32 a38, 0
s_waitcnt lgkmcnt(13)
v_mfma_f32_16x16x32_bf16 v[144:147], v[36:39], a[192:195], v[144:147]
ds_read_b64_tr_b16 v[34:35], v2 offset:4096
v_accvgpr_write_b32 a39, 0
v_mfma_f32_16x16x32_bf16 v[148:151], v[36:39], a[196:199], v[148:151]
buffer_load_dwordx4 a[176:179], v10, s[44:47], s74 offen offset:2048 sc1
v_mfma_f32_16x16x32_bf16 v[152:155], v[36:39], a[200:203], v[152:155]
v_accvgpr_write_b32 a40, 0
v_mfma_f32_16x16x32_bf16 v[156:159], v[36:39], a[204:207], v[156:159]
ds_read_b64_tr_b16 v[36:37], v3 offset:0
v_accvgpr_write_b32 a41, 0
s_waitcnt lgkmcnt(13)
v_mfma_f32_16x16x32_bf16 v[160:163], v[40:43], a[192:195], v[160:163]
ds_read_b64_tr_b16 v[38:39], v3 offset:4096
v_accvgpr_write_b32 a42, 0
v_mfma_f32_16x16x32_bf16 v[164:167], v[40:43], a[196:199], v[164:167]
s_add_u32 m0, s88, 114688
s_nop 0
buffer_load_dwordx4 v26, s[4:7], s87 offen offset:2048 lds
v_mfma_f32_16x16x32_bf16 v[168:171], v[40:43], a[200:203], v[168:171]
v_accvgpr_write_b32 a43, 0
v_mfma_f32_16x16x32_bf16 v[172:175], v[40:43], a[204:207], v[172:175]
ds_read_b64_tr_b16 v[40:41], v8 offset:0
v_accvgpr_write_b32 a44, 0
s_waitcnt lgkmcnt(13)
v_mfma_f32_16x16x32_bf16 v[176:179], v[44:47], a[192:195], v[176:179]
ds_read_b64_tr_b16 v[42:43], v8 offset:4096
v_accvgpr_write_b32 a45, 0
v_mfma_f32_16x16x32_bf16 v[180:183], v[44:47], a[196:199], v[180:183]
buffer_load_dwordx4 a[180:183], v10, s[44:47], s75 offen offset:2048 sc1
v_mfma_f32_16x16x32_bf16 v[184:187], v[44:47], a[200:203], v[184:187]
v_accvgpr_write_b32 a46, 0
v_mfma_f32_16x16x32_bf16 v[188:191], v[44:47], a[204:207], v[188:191]
ds_read_b64_tr_b16 v[44:45], v9 offset:0
v_accvgpr_write_b32 a47, 0
s_waitcnt lgkmcnt(13)
v_mfma_f32_16x16x32_bf16 v[192:195], v[48:51], a[192:195], v[192:195]
ds_read_b64_tr_b16 v[46:47], v9 offset:4096
v_mfma_f32_16x16x32_bf16 v[196:199], v[48:51], a[196:199], v[196:199]
s_add_u32 m0, s88, 114688
s_nop 0
buffer_load_dwordx4 v27, s[4:7], s87 offen offset:3072 lds
v_mfma_f32_16x16x32_bf16 v[200:203], v[48:51], a[200:203], v[200:203]
v_mfma_f32_16x16x32_bf16 v[204:207], v[48:51], a[204:207], v[204:207]
ds_read_b64_tr_b16 v[48:49], v11 offset:0
s_waitcnt lgkmcnt(13)
v_mfma_f32_16x16x32_bf16 v[208:211], v[52:55], a[192:195], v[208:211]
ds_read_b64_tr_b16 v[50:51], v11 offset:4096
v_mfma_f32_16x16x32_bf16 v[212:215], v[52:55], a[196:199], v[212:215]
buffer_load_dwordx4 a[184:187], v10, s[44:47], s76 offen offset:2048 sc1
v_mfma_f32_16x16x32_bf16 v[216:219], v[52:55], a[200:203], v[216:219]
v_mfma_f32_16x16x32_bf16 v[220:223], v[52:55], a[204:207], v[220:223]
ds_read_b64_tr_b16 v[52:53], v12 offset:0
s_waitcnt lgkmcnt(13)
v_mfma_f32_16x16x32_bf16 v[224:227], v[56:59], a[192:195], v[224:227]
ds_read_b64_tr_b16 v[54:55], v12 offset:4096
v_mfma_f32_16x16x32_bf16 v[228:231], v[56:59], a[196:199], v[228:231]
v_mfma_f32_16x16x32_bf16 v[232:235], v[56:59], a[200:203], v[232:235]
v_mfma_f32_16x16x32_bf16 v[236:239], v[56:59], a[204:207], v[236:239]
ds_read_b64_tr_b16 v[56:57], v13 offset:0
s_waitcnt lgkmcnt(13)
v_mfma_f32_16x16x32_bf16 v[240:243], v[60:63], a[192:195], v[240:243]
ds_read_b64_tr_b16 v[58:59], v13 offset:4096
v_mfma_f32_16x16x32_bf16 v[244:247], v[60:63], a[196:199], v[244:247]
buffer_load_dwordx4 a[188:191], v10, s[44:47], s77 offen offset:2048 sc1
v_mfma_f32_16x16x32_bf16 v[248:251], v[60:63], a[200:203], v[248:251]
v_mfma_f32_16x16x32_bf16 v[252:255], v[60:63], a[204:207], v[252:255]
ds_read_b64_tr_b16 v[60:61], v14 offset:0
s_waitcnt vmcnt(15)
s_waitcnt lgkmcnt(13)
v_mfma_f32_16x16x32_bf16 v[128:131], v[32:35], a[144:147], v[128:131]
ds_read_b64_tr_b16 v[62:63], v14 offset:4096
s_add_u32 s83, s80, 13312
v_accvgpr_write_b32 a48, 0
v_mfma_f32_16x16x32_bf16 v[132:135], v[32:35], a[148:151], v[132:135]
buffer_store_dwordx4 v[88:91], v10, s[44:47], s83 offen sc1
v_mfma_f32_16x16x32_bf16 v[136:139], v[32:35], a[152:155], v[136:139]
v_accvgpr_write_b32 a49, 0
v_mfma_f32_16x16x32_bf16 v[140:143], v[32:35], a[156:159], v[140:143]
ds_read_b64_tr_b16 v[32:33], v2 offset:8192
v_accvgpr_write_b32 a50, 0
s_waitcnt lgkmcnt(13)
v_mfma_f32_16x16x32_bf16 v[144:147], v[36:39], a[144:147], v[144:147]
ds_read_b64_tr_b16 v[34:35], v2 offset:12288
v_accvgpr_write_b32 a51, 0
v_mfma_f32_16x16x32_bf16 v[148:151], v[36:39], a[148:151], v[148:151]
buffer_load_dwordx4 a[192:195], v10, s[44:47], s74 offen offset:3072 sc1
v_mfma_f32_16x16x32_bf16 v[152:155], v[36:39], a[152:155], v[152:155]
v_accvgpr_write_b32 a52, 0
v_mfma_f32_16x16x32_bf16 v[156:159], v[36:39], a[156:159], v[156:159]
ds_read_b64_tr_b16 v[36:37], v3 offset:8192
v_accvgpr_write_b32 a53, 0
s_waitcnt lgkmcnt(13)
v_mfma_f32_16x16x32_bf16 v[160:163], v[40:43], a[144:147], v[160:163]
ds_read_b64_tr_b16 v[38:39], v3 offset:12288
v_accvgpr_write_b32 a54, 0
v_mfma_f32_16x16x32_bf16 v[164:167], v[40:43], a[148:151], v[164:167]
v_accvgpr_write_b32 a55, 0
v_mfma_f32_16x16x32_bf16 v[168:171], v[40:43], a[152:155], v[168:171]
v_accvgpr_write_b32 a56, 0
v_mfma_f32_16x16x32_bf16 v[172:175], v[40:43], a[156:159], v[172:175]
ds_read_b64_tr_b16 v[40:41], v8 offset:8192
v_accvgpr_write_b32 a57, 0
s_waitcnt lgkmcnt(13)
v_mfma_f32_16x16x32_bf16 v[176:179], v[44:47], a[144:147], v[176:179]
ds_read_b64_tr_b16 v[42:43], v8 offset:12288
v_accvgpr_write_b32 a58, 0
v_mfma_f32_16x16x32_bf16 v[180:183], v[44:47], a[148:151], v[180:183]
buffer_load_dwordx4 a[196:199], v10, s[44:47], s75 offen offset:3072 sc1
v_mfma_f32_16x16x32_bf16 v[184:187], v[44:47], a[152:155], v[184:187]
v_accvgpr_write_b32 a59, 0
v_mfma_f32_16x16x32_bf16 v[188:191], v[44:47], a[156:159], v[188:191]
ds_read_b64_tr_b16 v[44:45], v9 offset:8192
s_waitcnt lgkmcnt(13)
v_mfma_f32_16x16x32_bf16 v[192:195], v[48:51], a[144:147], v[192:195]
ds_read_b64_tr_b16 v[46:47], v9 offset:12288
v_mfma_f32_16x16x32_bf16 v[196:199], v[48:51], a[148:151], v[196:199]
v_mfma_f32_16x16x32_bf16 v[200:203], v[48:51], a[152:155], v[200:203]
v_mfma_f32_16x16x32_bf16 v[204:207], v[48:51], a[156:159], v[204:207]
ds_read_b64_tr_b16 v[48:49], v11 offset:8192
s_waitcnt lgkmcnt(13)
v_mfma_f32_16x16x32_bf16 v[208:211], v[52:55], a[144:147], v[208:211]
ds_read_b64_tr_b16 v[50:51], v11 offset:12288
v_mfma_f32_16x16x32_bf16 v[212:215], v[52:55], a[148:151], v[212:215]
buffer_load_dwordx4 a[200:203], v10, s[44:47], s76 offen offset:3072 sc1
v_mfma_f32_16x16x32_bf16 v[216:219], v[52:55], a[152:155], v[216:219]
v_mfma_f32_16x16x32_bf16 v[220:223], v[52:55], a[156:159], v[220:223]
ds_read_b64_tr_b16 v[52:53], v12 offset:8192
s_waitcnt lgkmcnt(13)
v_mfma_f32_16x16x32_bf16 v[224:227], v[56:59], a[144:147], v[224:227]
ds_read_b64_tr_b16 v[54:55], v12 offset:12288
v_mfma_f32_16x16x32_bf16 v[228:231], v[56:59], a[148:151], v[228:231]
v_mfma_f32_16x16x32_bf16 v[232:235], v[56:59], a[152:155], v[232:235]
v_mfma_f32_16x16x32_bf16 v[236:239], v[56:59], a[156:159], v[236:239]
ds_read_b64_tr_b16 v[56:57], v13 offset:8192
s_waitcnt lgkmcnt(13)
v_mfma_f32_16x16x32_bf16 v[240:243], v[60:63], a[144:147], v[240:243]
ds_read_b64_tr_b16 v[58:59], v13 offset:12288
v_mfma_f32_16x16x32_bf16 v[244:247], v[60:63], a[148:151], v[244:247]
buffer_load_dwordx4 a[204:207], v10, s[44:47], s77 offen offset:3072 sc1
v_mfma_f32_16x16x32_bf16 v[248:251], v[60:63], a[152:155], v[248:251]
v_mfma_f32_16x16x32_bf16 v[252:255], v[60:63], a[156:159], v[252:255]
ds_read_b64_tr_b16 v[60:61], v14 offset:8192
s_waitcnt vmcnt(12)
s_waitcnt lgkmcnt(13)
v_mfma_f32_16x16x32_bf16 v[128:131], v[32:35], a[160:163], v[128:131]
ds_read_b64_tr_b16 v[62:63], v14 offset:12288
s_add_u32 s74, s74, 4096
s_add_u32 s83, s80, 14336
v_accvgpr_write_b32 a60, 0
v_mfma_f32_16x16x32_bf16 v[132:135], v[32:35], a[164:167], v[132:135]
buffer_store_dwordx4 v[104:107], v10, s[44:47], s83 offen sc1
v_mfma_f32_16x16x32_bf16 v[136:139], v[32:35], a[168:171], v[136:139]
v_subrev_u32 v16, 0x10000, v16
v_mfma_f32_16x16x32_bf16 v[140:143], v[32:35], a[172:175], v[140:143]
ds_read_b64_tr_b16 v[32:33], v2 offset:16384
v_accvgpr_write_b32 a61, 0
s_waitcnt lgkmcnt(13)
v_mfma_f32_16x16x32_bf16 v[144:147], v[36:39], a[160:163], v[144:147]
ds_read_b64_tr_b16 v[34:35], v2 offset:20480
s_add_u32 s75, s75, 4096
v_accvgpr_write_b32 a62, 0
v_mfma_f32_16x16x32_bf16 v[148:151], v[36:39], a[164:167], v[148:151]
buffer_load_dwordx4 a[144:147], v10, s[44:47], s74 offen offset:0 sc1
v_mfma_f32_16x16x32_bf16 v[152:155], v[36:39], a[168:171], v[152:155]
v_subrev_u32 v17, 0x10000, v17
v_mfma_f32_16x16x32_bf16 v[156:159], v[36:39], a[172:175], v[156:159]
ds_read_b64_tr_b16 v[36:37], v3 offset:16384
v_accvgpr_write_b32 a63, 0
s_waitcnt lgkmcnt(13)
v_mfma_f32_16x16x32_bf16 v[160:163], v[40:43], a[160:163], v[160:163]
ds_read_b64_tr_b16 v[38:39], v3 offset:20480
s_add_u32 s76, s76, 4096
v_accvgpr_write_b32 a64, 0
v_mfma_f32_16x16x32_bf16 v[164:167], v[40:43], a[164:167], v[164:167]
v_accvgpr_write_b32 a65, 0
v_mfma_f32_16x16x32_bf16 v[168:171], v[40:43], a[168:171], v[168:171]
v_subrev_u32 v18, 0x10000, v18
v_mfma_f32_16x16x32_bf16 v[172:175], v[40:43], a[172:175], v[172:175]
ds_read_b64_tr_b16 v[40:41], v8 offset:16384
v_accvgpr_write_b32 a66, 0
s_waitcnt lgkmcnt(13)
v_mfma_f32_16x16x32_bf16 v[176:179], v[44:47], a[160:163], v[176:179]
ds_read_b64_tr_b16 v[42:43], v8 offset:20480
s_add_u32 s77, s77, 4096
v_accvgpr_write_b32 a67, 0
v_mfma_f32_16x16x32_bf16 v[180:183], v[44:47], a[164:167], v[180:183]
buffer_load_dwordx4 a[148:151], v10, s[44:47], s75 offen offset:0 sc1
v_mfma_f32_16x16x32_bf16 v[184:187], v[44:47], a[168:171], v[184:187]
v_subrev_u32 v19, 0x10000, v19
v_mfma_f32_16x16x32_bf16 v[188:191], v[44:47], a[172:175], v[188:191]
ds_read_b64_tr_b16 v[44:45], v9 offset:16384
v_accvgpr_write_b32 a68, 0
s_waitcnt lgkmcnt(13)
v_mfma_f32_16x16x32_bf16 v[192:195], v[48:51], a[160:163], v[192:195]
ds_read_b64_tr_b16 v[46:47], v9 offset:20480
v_accvgpr_write_b32 a69, 0
v_mfma_f32_16x16x32_bf16 v[196:199], v[48:51], a[164:167], v[196:199]
v_accvgpr_write_b32 a70, 0
v_mfma_f32_16x16x32_bf16 v[200:203], v[48:51], a[168:171], v[200:203]
v_accvgpr_write_b32 a71, 0
v_mfma_f32_16x16x32_bf16 v[204:207], v[48:51], a[172:175], v[204:207]
ds_read_b64_tr_b16 v[48:49], v11 offset:16384
s_waitcnt lgkmcnt(13)
v_mfma_f32_16x16x32_bf16 v[208:211], v[52:55], a[160:163], v[208:211]
ds_read_b64_tr_b16 v[50:51], v11 offset:20480
v_mfma_f32_16x16x32_bf16 v[212:215], v[52:55], a[164:167], v[212:215]
buffer_load_dwordx4 a[152:155], v10, s[44:47], s76 offen offset:0 sc1
v_mfma_f32_16x16x32_bf16 v[216:219], v[52:55], a[168:171], v[216:219]
v_mfma_f32_16x16x32_bf16 v[220:223], v[52:55], a[172:175], v[220:223]
ds_read_b64_tr_b16 v[52:53], v12 offset:16384
s_waitcnt lgkmcnt(13)
v_mfma_f32_16x16x32_bf16 v[224:227], v[56:59], a[160:163], v[224:227]
ds_read_b64_tr_b16 v[54:55], v12 offset:20480
v_mfma_f32_16x16x32_bf16 v[228:231], v[56:59], a[164:167], v[228:231]
v_mfma_f32_16x16x32_bf16 v[232:235], v[56:59], a[168:171], v[232:235]
v_mfma_f32_16x16x32_bf16 v[236:239], v[56:59], a[172:175], v[236:239]
ds_read_b64_tr_b16 v[56:57], v13 offset:16384
s_waitcnt lgkmcnt(13)
v_mfma_f32_16x16x32_bf16 v[240:243], v[60:63], a[160:163], v[240:243]
ds_read_b64_tr_b16 v[58:59], v13 offset:20480
v_mfma_f32_16x16x32_bf16 v[244:247], v[60:63], a[164:167], v[244:247]
buffer_load_dwordx4 a[156:159], v10, s[44:47], s77 offen offset:0 sc1
v_mfma_f32_16x16x32_bf16 v[248:251], v[60:63], a[168:171], v[248:251]
v_mfma_f32_16x16x32_bf16 v[252:255], v[60:63], a[172:175], v[252:255]
ds_read_b64_tr_b16 v[60:61], v14 offset:16384
s_waitcnt vmcnt(10)
s_waitcnt lgkmcnt(13)
v_mfma_f32_16x16x32_bf16 v[128:131], v[32:35], a[176:179], v[128:131]
ds_read_b64_tr_b16 v[62:63], v14 offset:20480
s_add_u32 s83, s80, 15360
v_accvgpr_write_b32 a72, 0
v_mfma_f32_16x16x32_bf16 v[132:135], v[32:35], a[180:183], v[132:135]
buffer_store_dwordx4 v[120:123], v10, s[44:47], s83 offen sc1
v_mfma_f32_16x16x32_bf16 v[136:139], v[32:35], a[184:187], v[136:139]
v_subrev_u32 v20, 0x10000, v20
v_mfma_f32_16x16x32_bf16 v[140:143], v[32:35], a[188:191], v[140:143]
ds_read_b64_tr_b16 v[32:33], v2 offset:24576
v_accvgpr_write_b32 a73, 0
s_waitcnt lgkmcnt(13)
v_mfma_f32_16x16x32_bf16 v[144:147], v[36:39], a[176:179], v[144:147]
ds_read_b64_tr_b16 v[34:35], v2 offset:28672
v_accvgpr_write_b32 a74, 0
v_mfma_f32_16x16x32_bf16 v[148:151], v[36:39], a[180:183], v[148:151]
buffer_load_dwordx4 a[160:163], v10, s[44:47], s74 offen offset:1024 sc1
v_mfma_f32_16x16x32_bf16 v[152:155], v[36:39], a[184:187], v[152:155]
v_subrev_u32 v21, 0x10000, v21
v_mfma_f32_16x16x32_bf16 v[156:159], v[36:39], a[188:191], v[156:159]
ds_read_b64_tr_b16 v[36:37], v3 offset:24576
v_accvgpr_write_b32 a75, 0
s_waitcnt lgkmcnt(13)
v_mfma_f32_16x16x32_bf16 v[160:163], v[40:43], a[176:179], v[160:163]
ds_read_b64_tr_b16 v[38:39], v3 offset:28672
v_accvgpr_write_b32 a76, 0
v_mfma_f32_16x16x32_bf16 v[164:167], v[40:43], a[180:183], v[164:167]
v_accvgpr_write_b32 a77, 0
v_mfma_f32_16x16x32_bf16 v[168:171], v[40:43], a[184:187], v[168:171]
v_subrev_u32 v22, 0x10000, v22
v_mfma_f32_16x16x32_bf16 v[172:175], v[40:43], a[188:191], v[172:175]
ds_read_b64_tr_b16 v[40:41], v8 offset:24576
v_accvgpr_write_b32 a78, 0
s_waitcnt lgkmcnt(13)
v_mfma_f32_16x16x32_bf16 v[176:179], v[44:47], a[176:179], v[176:179]
ds_read_b64_tr_b16 v[42:43], v8 offset:28672
v_accvgpr_write_b32 a79, 0
v_mfma_f32_16x16x32_bf16 v[180:183], v[44:47], a[180:183], v[180:183]
buffer_load_dwordx4 a[164:167], v10, s[44:47], s75 offen offset:1024 sc1
v_mfma_f32_16x16x32_bf16 v[184:187], v[44:47], a[184:187], v[184:187]
v_subrev_u32 v23, 0x10000, v23
v_mfma_f32_16x16x32_bf16 v[188:191], v[44:47], a[188:191], v[188:191]
ds_read_b64_tr_b16 v[44:45], v9 offset:24576
v_accvgpr_write_b32 a80, 0
s_waitcnt lgkmcnt(13)
v_mfma_f32_16x16x32_bf16 v[192:195], v[48:51], a[176:179], v[192:195]
ds_read_b64_tr_b16 v[46:47], v9 offset:28672
v_accvgpr_write_b32 a81, 0
v_mfma_f32_16x16x32_bf16 v[196:199], v[48:51], a[180:183], v[196:199]
v_accvgpr_write_b32 a82, 0
v_mfma_f32_16x16x32_bf16 v[200:203], v[48:51], a[184:187], v[200:203]
v_accvgpr_write_b32 a83, 0
v_mfma_f32_16x16x32_bf16 v[204:207], v[48:51], a[188:191], v[204:207]
ds_read_b64_tr_b16 v[48:49], v11 offset:24576
s_waitcnt lgkmcnt(13)
v_mfma_f32_16x16x32_bf16 v[208:211], v[52:55], a[176:179], v[208:211]
ds_read_b64_tr_b16 v[50:51], v11 offset:28672
v_mfma_f32_16x16x32_bf16 v[212:215], v[52:55], a[180:183], v[212:215]
buffer_load_dwordx4 a[168:171], v10, s[44:47], s76 offen offset:1024 sc1
v_mfma_f32_16x16x32_bf16 v[216:219], v[52:55], a[184:187], v[216:219]
v_mfma_f32_16x16x32_bf16 v[220:223], v[52:55], a[188:191], v[220:223]
ds_read_b64_tr_b16 v[52:53], v12 offset:24576
s_waitcnt lgkmcnt(13)
v_mfma_f32_16x16x32_bf16 v[224:227], v[56:59], a[176:179], v[224:227]
ds_read_b64_tr_b16 v[54:55], v12 offset:28672
v_mfma_f32_16x16x32_bf16 v[228:231], v[56:59], a[180:183], v[228:231]
v_mfma_f32_16x16x32_bf16 v[232:235], v[56:59], a[184:187], v[232:235]
v_mfma_f32_16x16x32_bf16 v[236:239], v[56:59], a[188:191], v[236:239]
ds_read_b64_tr_b16 v[56:57], v13 offset:24576
s_waitcnt lgkmcnt(13)
v_mfma_f32_16x16x32_bf16 v[240:243], v[60:63], a[176:179], v[240:243]
ds_read_b64_tr_b16 v[58:59], v13 offset:28672
v_mfma_f32_16x16x32_bf16 v[244:247], v[60:63], a[180:183], v[244:247]
buffer_load_dwordx4 a[172:175], v10, s[44:47], s77 offen offset:1024 sc1
v_mfma_f32_16x16x32_bf16 v[248:251], v[60:63], a[184:187], v[248:251]
v_mfma_f32_16x16x32_bf16 v[252:255], v[60:63], a[188:191], v[252:255]
ds_read_b64_tr_b16 v[60:61], v14 offset:24576
s_waitcnt vmcnt(10)
s_waitcnt lgkmcnt(13)
v_mfma_f32_16x16x32_bf16 v[128:131], v[32:35], a[192:195], v[128:131]
ds_read_b64_tr_b16 v[62:63], v14 offset:28672
v_accvgpr_write_b32 a84, 0
v_mfma_f32_16x16x32_bf16 v[132:135], v[32:35], a[196:199], v[132:135]
v_accvgpr_write_b32 a85, 0
v_mfma_f32_16x16x32_bf16 v[136:139], v[32:35], a[200:203], v[136:139]
v_accvgpr_write_b32 a86, 0
v_mfma_f32_16x16x32_bf16 v[140:143], v[32:35], a[204:207], v[140:143]
ds_read_b64_tr_b16 v[32:33], v2 offset:32768
v_accvgpr_write_b32 a87, 0
s_waitcnt lgkmcnt(13)
v_mfma_f32_16x16x32_bf16 v[144:147], v[36:39], a[192:195], v[144:147]
ds_read_b64_tr_b16 v[34:35], v2 offset:36864
v_accvgpr_write_b32 a88, 0
v_mfma_f32_16x16x32_bf16 v[148:151], v[36:39], a[196:199], v[148:151]
buffer_load_dwordx4 a[176:179], v10, s[44:47], s74 offen offset:2048 sc1
v_mfma_f32_16x16x32_bf16 v[152:155], v[36:39], a[200:203], v[152:155]
v_accvgpr_write_b32 a89, 0
v_mfma_f32_16x16x32_bf16 v[156:159], v[36:39], a[204:207], v[156:159]
ds_read_b64_tr_b16 v[36:37], v3 offset:32768
v_accvgpr_write_b32 a90, 0
s_waitcnt lgkmcnt(13)
v_mfma_f32_16x16x32_bf16 v[160:163], v[40:43], a[192:195], v[160:163]
ds_read_b64_tr_b16 v[38:39], v3 offset:36864
v_accvgpr_write_b32 a91, 0
v_mfma_f32_16x16x32_bf16 v[164:167], v[40:43], a[196:199], v[164:167]
v_accvgpr_write_b32 a92, 0
v_mfma_f32_16x16x32_bf16 v[168:171], v[40:43], a[200:203], v[168:171]
v_accvgpr_write_b32 a93, 0
v_mfma_f32_16x16x32_bf16 v[172:175], v[40:43], a[204:207], v[172:175]
ds_read_b64_tr_b16 v[40:41], v8 offset:32768
v_accvgpr_write_b32 a94, 0
s_waitcnt lgkmcnt(13)
v_mfma_f32_16x16x32_bf16 v[176:179], v[44:47], a[192:195], v[176:179]
ds_read_b64_tr_b16 v[42:43], v8 offset:36864
v_accvgpr_write_b32 a95, 0
v_mfma_f32_16x16x32_bf16 v[180:183], v[44:47], a[196:199], v[180:183]
buffer_load_dwordx4 a[180:183], v10, s[44:47], s75 offen offset:2048 sc1
v_mfma_f32_16x16x32_bf16 v[184:187], v[44:47], a[200:203], v[184:187]
v_mfma_f32_16x16x32_bf16 v[188:191], v[44:47], a[204:207], v[188:191]
ds_read_b64_tr_b16 v[44:45], v9 offset:32768
s_waitcnt lgkmcnt(13)
v_mfma_f32_16x16x32_bf16 v[192:195], v[48:51], a[192:195], v[192:195]
ds_read_b64_tr_b16 v[46:47], v9 offset:36864
v_mfma_f32_16x16x32_bf16 v[196:199], v[48:51], a[196:199], v[196:199]
v_mfma_f32_16x16x32_bf16 v[200:203], v[48:51], a[200:203], v[200:203]
v_mfma_f32_16x16x32_bf16 v[204:207], v[48:51], a[204:207], v[204:207]
ds_read_b64_tr_b16 v[48:49], v11 offset:32768
s_waitcnt lgkmcnt(13)
v_mfma_f32_16x16x32_bf16 v[208:211], v[52:55], a[192:195], v[208:211]
ds_read_b64_tr_b16 v[50:51], v11 offset:36864
v_mfma_f32_16x16x32_bf16 v[212:215], v[52:55], a[196:199], v[212:215]
buffer_load_dwordx4 a[184:187], v10, s[44:47], s76 offen offset:2048 sc1
v_mfma_f32_16x16x32_bf16 v[216:219], v[52:55], a[200:203], v[216:219]
v_mfma_f32_16x16x32_bf16 v[220:223], v[52:55], a[204:207], v[220:223]
ds_read_b64_tr_b16 v[52:53], v12 offset:32768
s_waitcnt lgkmcnt(13)
v_mfma_f32_16x16x32_bf16 v[224:227], v[56:59], a[192:195], v[224:227]
ds_read_b64_tr_b16 v[54:55], v12 offset:36864
v_mfma_f32_16x16x32_bf16 v[228:231], v[56:59], a[196:199], v[228:231]
v_mfma_f32_16x16x32_bf16 v[232:235], v[56:59], a[200:203], v[232:235]
v_mfma_f32_16x16x32_bf16 v[236:239], v[56:59], a[204:207], v[236:239]
ds_read_b64_tr_b16 v[56:57], v13 offset:32768
s_waitcnt lgkmcnt(13)
v_mfma_f32_16x16x32_bf16 v[240:243], v[60:63], a[192:195], v[240:243]
ds_read_b64_tr_b16 v[58:59], v13 offset:36864
v_mfma_f32_16x16x32_bf16 v[244:247], v[60:63], a[196:199], v[244:247]
buffer_load_dwordx4 a[188:191], v10, s[44:47], s77 offen offset:2048 sc1
v_mfma_f32_16x16x32_bf16 v[248:251], v[60:63], a[200:203], v[248:251]
v_mfma_f32_16x16x32_bf16 v[252:255], v[60:63], a[204:207], v[252:255]
ds_read_b64_tr_b16 v[60:61], v14 offset:32768
s_waitcnt vmcnt(9)
s_waitcnt lgkmcnt(13)
v_mfma_f32_16x16x32_bf16 v[128:131], v[32:35], a[144:147], v[128:131]
ds_read_b64_tr_b16 v[62:63], v14 offset:36864
v_accvgpr_write_b32 a96, 0
v_mfma_f32_16x16x32_bf16 v[132:135], v[32:35], a[148:151], v[132:135]
v_accvgpr_write_b32 a97, 0
v_mfma_f32_16x16x32_bf16 v[136:139], v[32:35], a[152:155], v[136:139]
v_accvgpr_write_b32 a98, 0
v_mfma_f32_16x16x32_bf16 v[140:143], v[32:35], a[156:159], v[140:143]
ds_read_b64_tr_b16 v[32:33], v2 offset:40960
v_accvgpr_write_b32 a99, 0
s_waitcnt lgkmcnt(13)
v_mfma_f32_16x16x32_bf16 v[144:147], v[36:39], a[144:147], v[144:147]
ds_read_b64_tr_b16 v[34:35], v2 offset:45056
v_accvgpr_write_b32 a100, 0
v_mfma_f32_16x16x32_bf16 v[148:151], v[36:39], a[148:151], v[148:151]
buffer_load_dwordx4 a[192:195], v10, s[44:47], s74 offen offset:3072 sc1
v_mfma_f32_16x16x32_bf16 v[152:155], v[36:39], a[152:155], v[152:155]
v_accvgpr_write_b32 a101, 0
v_mfma_f32_16x16x32_bf16 v[156:159], v[36:39], a[156:159], v[156:159]
ds_read_b64_tr_b16 v[36:37], v3 offset:40960
v_accvgpr_write_b32 a102, 0
s_waitcnt lgkmcnt(13)
v_mfma_f32_16x16x32_bf16 v[160:163], v[40:43], a[144:147], v[160:163]
ds_read_b64_tr_b16 v[38:39], v3 offset:45056
v_accvgpr_write_b32 a103, 0
v_mfma_f32_16x16x32_bf16 v[164:167], v[40:43], a[148:151], v[164:167]
v_accvgpr_write_b32 a104, 0
v_mfma_f32_16x16x32_bf16 v[168:171], v[40:43], a[152:155], v[168:171]
v_accvgpr_write_b32 a105, 0
v_mfma_f32_16x16x32_bf16 v[172:175], v[40:43], a[156:159], v[172:175]
ds_read_b64_tr_b16 v[40:41], v8 offset:40960
v_accvgpr_write_b32 a106, 0
s_waitcnt lgkmcnt(13)
v_mfma_f32_16x16x32_bf16 v[176:179], v[44:47], a[144:147], v[176:179]
ds_read_b64_tr_b16 v[42:43], v8 offset:45056
v_accvgpr_write_b32 a107, 0
v_mfma_f32_16x16x32_bf16 v[180:183], v[44:47], a[148:151], v[180:183]
buffer_load_dwordx4 a[196:199], v10, s[44:47], s75 offen offset:3072 sc1
v_mfma_f32_16x16x32_bf16 v[184:187], v[44:47], a[152:155], v[184:187]
v_mfma_f32_16x16x32_bf16 v[188:191], v[44:47], a[156:159], v[188:191]
ds_read_b64_tr_b16 v[44:45], v9 offset:40960
s_waitcnt lgkmcnt(13)
v_mfma_f32_16x16x32_bf16 v[192:195], v[48:51], a[144:147], v[192:195]
ds_read_b64_tr_b16 v[46:47], v9 offset:45056
v_mfma_f32_16x16x32_bf16 v[196:199], v[48:51], a[148:151], v[196:199]
v_mfma_f32_16x16x32_bf16 v[200:203], v[48:51], a[152:155], v[200:203]
v_mfma_f32_16x16x32_bf16 v[204:207], v[48:51], a[156:159], v[204:207]
ds_read_b64_tr_b16 v[48:49], v11 offset:40960
s_waitcnt lgkmcnt(13)
v_mfma_f32_16x16x32_bf16 v[208:211], v[52:55], a[144:147], v[208:211]
ds_read_b64_tr_b16 v[50:51], v11 offset:45056
v_mfma_f32_16x16x32_bf16 v[212:215], v[52:55], a[148:151], v[212:215]
buffer_load_dwordx4 a[200:203], v10, s[44:47], s76 offen offset:3072 sc1
v_mfma_f32_16x16x32_bf16 v[216:219], v[52:55], a[152:155], v[216:219]
v_mfma_f32_16x16x32_bf16 v[220:223], v[52:55], a[156:159], v[220:223]
ds_read_b64_tr_b16 v[52:53], v12 offset:40960
s_waitcnt lgkmcnt(13)
v_mfma_f32_16x16x32_bf16 v[224:227], v[56:59], a[144:147], v[224:227]
ds_read_b64_tr_b16 v[54:55], v12 offset:45056
v_mfma_f32_16x16x32_bf16 v[228:231], v[56:59], a[148:151], v[228:231]
v_mfma_f32_16x16x32_bf16 v[232:235], v[56:59], a[152:155], v[232:235]
v_mfma_f32_16x16x32_bf16 v[236:239], v[56:59], a[156:159], v[236:239]
ds_read_b64_tr_b16 v[56:57], v13 offset:40960
s_waitcnt lgkmcnt(13)
v_mfma_f32_16x16x32_bf16 v[240:243], v[60:63], a[144:147], v[240:243]
ds_read_b64_tr_b16 v[58:59], v13 offset:45056
v_mfma_f32_16x16x32_bf16 v[244:247], v[60:63], a[148:151], v[244:247]
buffer_load_dwordx4 a[204:207], v10, s[44:47], s77 offen offset:3072 sc1
v_mfma_f32_16x16x32_bf16 v[248:251], v[60:63], a[152:155], v[248:251]
v_mfma_f32_16x16x32_bf16 v[252:255], v[60:63], a[156:159], v[252:255]
ds_read_b64_tr_b16 v[60:61], v14 offset:40960
s_waitcnt vmcnt(8)
s_waitcnt lgkmcnt(13)
v_mfma_f32_16x16x32_bf16 v[128:131], v[32:35], a[160:163], v[128:131]
ds_read_b64_tr_b16 v[62:63], v14 offset:45056
s_add_u32 s74, s74, 4096
v_accvgpr_write_b32 a108, 0
v_mfma_f32_16x16x32_bf16 v[132:135], v[32:35], a[164:167], v[132:135]
v_accvgpr_write_b32 a109, 0
v_mfma_f32_16x16x32_bf16 v[136:139], v[32:35], a[168:171], v[136:139]
v_accvgpr_write_b32 a110, 0
v_mfma_f32_16x16x32_bf16 v[140:143], v[32:35], a[172:175], v[140:143]
ds_read_b64_tr_b16 v[32:33], v2 offset:49152
v_accvgpr_write_b32 a111, 0
s_waitcnt lgkmcnt(13)
v_mfma_f32_16x16x32_bf16 v[144:147], v[36:39], a[160:163], v[144:147]
ds_read_b64_tr_b16 v[34:35], v2 offset:53248
s_add_u32 s75, s75, 4096
v_accvgpr_write_b32 a112, 0
v_mfma_f32_16x16x32_bf16 v[148:151], v[36:39], a[164:167], v[148:151]
buffer_load_dwordx4 a[144:147], v10, s[44:47], s74 offen offset:0 sc1
v_mfma_f32_16x16x32_bf16 v[152:155], v[36:39], a[168:171], v[152:155]
v_accvgpr_write_b32 a113, 0
v_mfma_f32_16x16x32_bf16 v[156:159], v[36:39], a[172:175], v[156:159]
ds_read_b64_tr_b16 v[36:37], v3 offset:49152
v_accvgpr_write_b32 a114, 0
s_waitcnt lgkmcnt(13)
v_mfma_f32_16x16x32_bf16 v[160:163], v[40:43], a[160:163], v[160:163]
ds_read_b64_tr_b16 v[38:39], v3 offset:53248
s_add_u32 s76, s76, 4096
v_accvgpr_write_b32 a115, 0
v_mfma_f32_16x16x32_bf16 v[164:167], v[40:43], a[164:167], v[164:167]
v_accvgpr_write_b32 a116, 0
v_mfma_f32_16x16x32_bf16 v[168:171], v[40:43], a[168:171], v[168:171]
v_accvgpr_write_b32 a117, 0
v_mfma_f32_16x16x32_bf16 v[172:175], v[40:43], a[172:175], v[172:175]
ds_read_b64_tr_b16 v[40:41], v8 offset:49152
v_accvgpr_write_b32 a118, 0
s_waitcnt lgkmcnt(13)
v_mfma_f32_16x16x32_bf16 v[176:179], v[44:47], a[160:163], v[176:179]
ds_read_b64_tr_b16 v[42:43], v8 offset:53248
s_add_u32 s77, s77, 4096
v_accvgpr_write_b32 a119, 0
v_mfma_f32_16x16x32_bf16 v[180:183], v[44:47], a[164:167], v[180:183]
buffer_load_dwordx4 a[148:151], v10, s[44:47], s75 offen offset:0 sc1
v_mfma_f32_16x16x32_bf16 v[184:187], v[44:47], a[168:171], v[184:187]
v_mfma_f32_16x16x32_bf16 v[188:191], v[44:47], a[172:175], v[188:191]
ds_read_b64_tr_b16 v[44:45], v9 offset:49152
s_waitcnt lgkmcnt(13)
v_mfma_f32_16x16x32_bf16 v[192:195], v[48:51], a[160:163], v[192:195]
ds_read_b64_tr_b16 v[46:47], v9 offset:53248
v_mfma_f32_16x16x32_bf16 v[196:199], v[48:51], a[164:167], v[196:199]
v_mfma_f32_16x16x32_bf16 v[200:203], v[48:51], a[168:171], v[200:203]
v_mfma_f32_16x16x32_bf16 v[204:207], v[48:51], a[172:175], v[204:207]
ds_read_b64_tr_b16 v[48:49], v11 offset:49152
s_waitcnt lgkmcnt(13)
v_mfma_f32_16x16x32_bf16 v[208:211], v[52:55], a[160:163], v[208:211]
ds_read_b64_tr_b16 v[50:51], v11 offset:53248
v_mfma_f32_16x16x32_bf16 v[212:215], v[52:55], a[164:167], v[212:215]
buffer_load_dwordx4 a[152:155], v10, s[44:47], s76 offen offset:0 sc1
v_mfma_f32_16x16x32_bf16 v[216:219], v[52:55], a[168:171], v[216:219]
v_mfma_f32_16x16x32_bf16 v[220:223], v[52:55], a[172:175], v[220:223]
ds_read_b64_tr_b16 v[52:53], v12 offset:49152
s_waitcnt lgkmcnt(13)
v_mfma_f32_16x16x32_bf16 v[224:227], v[56:59], a[160:163], v[224:227]
ds_read_b64_tr_b16 v[54:55], v12 offset:53248
v_mfma_f32_16x16x32_bf16 v[228:231], v[56:59], a[164:167], v[228:231]
v_mfma_f32_16x16x32_bf16 v[232:235], v[56:59], a[168:171], v[232:235]
v_mfma_f32_16x16x32_bf16 v[236:239], v[56:59], a[172:175], v[236:239]
ds_read_b64_tr_b16 v[56:57], v13 offset:49152
s_waitcnt lgkmcnt(13)
v_mfma_f32_16x16x32_bf16 v[240:243], v[60:63], a[160:163], v[240:243]
ds_read_b64_tr_b16 v[58:59], v13 offset:53248
v_mfma_f32_16x16x32_bf16 v[244:247], v[60:63], a[164:167], v[244:247]
buffer_load_dwordx4 a[156:159], v10, s[44:47], s77 offen offset:0 sc1
v_mfma_f32_16x16x32_bf16 v[248:251], v[60:63], a[168:171], v[248:251]
v_mfma_f32_16x16x32_bf16 v[252:255], v[60:63], a[172:175], v[252:255]
ds_read_b64_tr_b16 v[60:61], v14 offset:49152
s_waitcnt vmcnt(8)
s_waitcnt lgkmcnt(13)
v_mfma_f32_16x16x32_bf16 v[128:131], v[32:35], a[176:179], v[128:131]
ds_read_b64_tr_b16 v[62:63], v14 offset:53248
v_accvgpr_write_b32 a120, 0
v_mfma_f32_16x16x32_bf16 v[132:135], v[32:35], a[180:183], v[132:135]
v_accvgpr_write_b32 a121, 0
v_mfma_f32_16x16x32_bf16 v[136:139], v[32:35], a[184:187], v[136:139]
v_accvgpr_write_b32 a122, 0
v_mfma_f32_16x16x32_bf16 v[140:143], v[32:35], a[188:191], v[140:143]
ds_read_b64_tr_b16 v[32:33], v2 offset:57344
v_accvgpr_write_b32 a123, 0
s_waitcnt lgkmcnt(13)
v_mfma_f32_16x16x32_bf16 v[144:147], v[36:39], a[176:179], v[144:147]
ds_read_b64_tr_b16 v[34:35], v2 offset:61440
v_accvgpr_write_b32 a124, 0
v_mfma_f32_16x16x32_bf16 v[148:151], v[36:39], a[180:183], v[148:151]
buffer_load_dwordx4 a[160:163], v10, s[44:47], s74 offen offset:1024 sc1
v_mfma_f32_16x16x32_bf16 v[152:155], v[36:39], a[184:187], v[152:155]
v_accvgpr_write_b32 a125, 0
v_mfma_f32_16x16x32_bf16 v[156:159], v[36:39], a[188:191], v[156:159]
ds_read_b64_tr_b16 v[36:37], v3 offset:57344
v_accvgpr_write_b32 a126, 0
s_waitcnt lgkmcnt(13)
v_mfma_f32_16x16x32_bf16 v[160:163], v[40:43], a[176:179], v[160:163]
ds_read_b64_tr_b16 v[38:39], v3 offset:61440
v_accvgpr_write_b32 a127, 0
v_mfma_f32_16x16x32_bf16 v[164:167], v[40:43], a[180:183], v[164:167]
v_accvgpr_write_b32 a128, 0
v_mfma_f32_16x16x32_bf16 v[168:171], v[40:43], a[184:187], v[168:171]
v_accvgpr_write_b32 a129, 0
v_mfma_f32_16x16x32_bf16 v[172:175], v[40:43], a[188:191], v[172:175]
ds_read_b64_tr_b16 v[40:41], v8 offset:57344
v_accvgpr_write_b32 a130, 0
s_waitcnt lgkmcnt(13)
v_mfma_f32_16x16x32_bf16 v[176:179], v[44:47], a[176:179], v[176:179]
ds_read_b64_tr_b16 v[42:43], v8 offset:61440
v_accvgpr_write_b32 a131, 0
v_mfma_f32_16x16x32_bf16 v[180:183], v[44:47], a[180:183], v[180:183]
buffer_load_dwordx4 a[164:167], v10, s[44:47], s75 offen offset:1024 sc1
v_mfma_f32_16x16x32_bf16 v[184:187], v[44:47], a[184:187], v[184:187]
v_mfma_f32_16x16x32_bf16 v[188:191], v[44:47], a[188:191], v[188:191]
ds_read_b64_tr_b16 v[44:45], v9 offset:57344
s_waitcnt lgkmcnt(13)
v_mfma_f32_16x16x32_bf16 v[192:195], v[48:51], a[176:179], v[192:195]
ds_read_b64_tr_b16 v[46:47], v9 offset:61440
v_mfma_f32_16x16x32_bf16 v[196:199], v[48:51], a[180:183], v[196:199]
v_mfma_f32_16x16x32_bf16 v[200:203], v[48:51], a[184:187], v[200:203]
v_mfma_f32_16x16x32_bf16 v[204:207], v[48:51], a[188:191], v[204:207]
ds_read_b64_tr_b16 v[48:49], v11 offset:57344
s_waitcnt lgkmcnt(13)
v_mfma_f32_16x16x32_bf16 v[208:211], v[52:55], a[176:179], v[208:211]
ds_read_b64_tr_b16 v[50:51], v11 offset:61440
v_mfma_f32_16x16x32_bf16 v[212:215], v[52:55], a[180:183], v[212:215]
buffer_load_dwordx4 a[168:171], v10, s[44:47], s76 offen offset:1024 sc1
v_mfma_f32_16x16x32_bf16 v[216:219], v[52:55], a[184:187], v[216:219]
v_mfma_f32_16x16x32_bf16 v[220:223], v[52:55], a[188:191], v[220:223]
ds_read_b64_tr_b16 v[52:53], v12 offset:57344
s_waitcnt lgkmcnt(13)
v_mfma_f32_16x16x32_bf16 v[224:227], v[56:59], a[176:179], v[224:227]
ds_read_b64_tr_b16 v[54:55], v12 offset:61440
v_mfma_f32_16x16x32_bf16 v[228:231], v[56:59], a[180:183], v[228:231]
v_mfma_f32_16x16x32_bf16 v[232:235], v[56:59], a[184:187], v[232:235]
v_mfma_f32_16x16x32_bf16 v[236:239], v[56:59], a[188:191], v[236:239]
ds_read_b64_tr_b16 v[56:57], v13 offset:57344
s_waitcnt lgkmcnt(13)
v_mfma_f32_16x16x32_bf16 v[240:243], v[60:63], a[176:179], v[240:243]
ds_read_b64_tr_b16 v[58:59], v13 offset:61440
v_mfma_f32_16x16x32_bf16 v[244:247], v[60:63], a[180:183], v[244:247]
buffer_load_dwordx4 a[172:175], v10, s[44:47], s77 offen offset:1024 sc1
v_mfma_f32_16x16x32_bf16 v[248:251], v[60:63], a[184:187], v[248:251]
v_mfma_f32_16x16x32_bf16 v[252:255], v[60:63], a[188:191], v[252:255]
ds_read_b64_tr_b16 v[60:61], v14 offset:57344
ds_read_b64_tr_b16 v[62:63], v14 offset:61440
s_waitcnt vmcnt(8)
s_waitcnt lgkmcnt(14)
v_mfma_f32_16x16x32_bf16 v[128:131], v[32:35], a[192:195], v[128:131]
v_accvgpr_write_b32 a132, 0
v_mfma_f32_16x16x32_bf16 v[132:135], v[32:35], a[196:199], v[132:135]
s_waitcnt lgkmcnt(0)
s_barrier
s_lshl_b32 s70, s65, 7
s_add_u32 s70, s70, 69206016
s_cmp_lg_u32 s64, 0
s_cbranch_scc1 L_sig_5
v_mov_b32 v28, 1
v_mov_b32 v29, 0
s_mov_b64 exec, 1
buffer_atomic_add v28, v29, s[44:47], s70 offen sc1
s_mov_b64 exec, -1
L_sig_5:
v_accvgpr_write_b32 a133, 0
v_mfma_f32_16x16x32_bf16 v[136:139], v[32:35], a[200:203], v[136:139]
v_accvgpr_write_b32 a134, 0
v_mfma_f32_16x16x32_bf16 v[140:143], v[32:35], a[204:207], v[140:143]
ds_read_b64_tr_b16 v[32:33], v16 offset:0
v_accvgpr_write_b32 a135, 0
v_mfma_f32_16x16x32_bf16 v[144:147], v[36:39], a[192:195], v[144:147]
ds_read_b64_tr_b16 v[34:35], v16 offset:4096
v_accvgpr_write_b32 a136, 0
v_mfma_f32_16x16x32_bf16 v[148:151], v[36:39], a[196:199], v[148:151]
buffer_load_dwordx4 a[176:179], v10, s[44:47], s74 offen offset:2048 sc1
v_mfma_f32_16x16x32_bf16 v[152:155], v[36:39], a[200:203], v[152:155]
v_accvgpr_write_b32 a137, 0
v_mfma_f32_16x16x32_bf16 v[156:159], v[36:39], a[204:207], v[156:159]
ds_read_b64_tr_b16 v[36:37], v17 offset:0
v_accvgpr_write_b32 a138, 0
v_mfma_f32_16x16x32_bf16 v[160:163], v[40:43], a[192:195], v[160:163]
ds_read_b64_tr_b16 v[38:39], v17 offset:4096
v_accvgpr_write_b32 a139, 0
v_mfma_f32_16x16x32_bf16 v[164:167], v[40:43], a[196:199], v[164:167]
v_accvgpr_write_b32 a140, 0
v_mfma_f32_16x16x32_bf16 v[168:171], v[40:43], a[200:203], v[168:171]
v_accvgpr_write_b32 a141, 0
v_mfma_f32_16x16x32_bf16 v[172:175], v[40:43], a[204:207], v[172:175]
ds_read_b64_tr_b16 v[40:41], v18 offset:0
v_accvgpr_write_b32 a142, 0
v_mfma_f32_16x16x32_bf16 v[176:179], v[44:47], a[192:195], v[176:179]
ds_read_b64_tr_b16 v[42:43], v18 offset:4096
v_accvgpr_write_b32 a143, 0
v_mfma_f32_16x16x32_bf16 v[180:183], v[44:47], a[196:199], v[180:183]
buffer_load_dwordx4 a[180:183], v10, s[44:47], s75 offen offset:2048 sc1
v_mfma_f32_16x16x32_bf16 v[184:187], v[44:47], a[200:203], v[184:187]
v_mfma_f32_16x16x32_bf16 v[188:191], v[44:47], a[204:207], v[188:191]
ds_read_b64_tr_b16 v[44:45], v19 offset:0
v_mfma_f32_16x16x32_bf16 v[192:195], v[48:51], a[192:195], v[192:195]
ds_read_b64_tr_b16 v[46:47], v19 offset:4096
v_mfma_f32_16x16x32_bf16 v[196:199], v[48:51], a[196:199], v[196:199]
v_mfma_f32_16x16x32_bf16 v[200:203], v[48:51], a[200:203], v[200:203]
v_mfma_f32_16x16x32_bf16 v[204:207], v[48:51], a[204:207], v[204:207]
ds_read_b64_tr_b16 v[48:49], v20 offset:0
v_mfma_f32_16x16x32_bf16 v[208:211], v[52:55], a[192:195], v[208:211]
ds_read_b64_tr_b16 v[50:51], v20 offset:4096
v_mfma_f32_16x16x32_bf16 v[212:215], v[52:55], a[196:199], v[212:215]
buffer_load_dwordx4 a[184:187], v10, s[44:47], s76 offen offset:2048 sc1
v_mfma_f32_16x16x32_bf16 v[216:219], v[52:55], a[200:203], v[216:219]
v_mfma_f32_16x16x32_bf16 v[220:223], v[52:55], a[204:207], v[220:223]
ds_read_b64_tr_b16 v[52:53], v21 offset:0
v_mfma_f32_16x16x32_bf16 v[224:227], v[56:59], a[192:195], v[224:227]
ds_read_b64_tr_b16 v[54:55], v21 offset:4096
v_mfma_f32_16x16x32_bf16 v[228:231], v[56:59], a[196:199], v[228:231]
v_mfma_f32_16x16x32_bf16 v[232:235], v[56:59], a[200:203], v[232:235]
v_mfma_f32_16x16x32_bf16 v[236:239], v[56:59], a[204:207], v[236:239]
ds_read_b64_tr_b16 v[56:57], v22 offset:0
v_mfma_f32_16x16x32_bf16 v[240:243], v[60:63], a[192:195], v[240:243]
ds_read_b64_tr_b16 v[58:59], v22 offset:4096
v_mfma_f32_16x16x32_bf16 v[244:247], v[60:63], a[196:199], v[244:247]
buffer_load_dwordx4 a[188:191], v10, s[44:47], s77 offen offset:2048 sc1
v_mfma_f32_16x16x32_bf16 v[248:251], v[60:63], a[200:203], v[248:251]
v_mfma_f32_16x16x32_bf16 v[252:255], v[60:63], a[204:207], v[252:255]
ds_read_b64_tr_b16 v[60:61], v23 offset:0
s_waitcnt vmcnt(8)
s_waitcnt lgkmcnt(13)
v_mfma_f32_16x16x32_bf16 v[128:131], v[32:35], a[144:147], v[128:131]
ds_read_b64_tr_b16 v[62:63], v23 offset:4096
v_accvgpr_write_b32 a208, 0
v_mfma_f32_16x16x32_bf16 v[132:135], v[32:35], a[148:151], v[132:135]
v_accvgpr_write_b32 a209, 0
v_mfma_f32_16x16x32_bf16 v[136:139], v[32:35], a[152:155], v[136:139]
v_accvgpr_write_b32 a210, 0
v_mfma_f32_16x16x32_bf16 v[140:143], v[32:35], a[156:159], v[140:143]
ds_read_b64_tr_b16 v[32:33], v16 offset:8192
v_accvgpr_write_b32 a211, 0
s_waitcnt lgkmcnt(13)
v_mfma_f32_16x16x32_bf16 v[144:147], v[36:39], a[144:147], v[144:147]
ds_read_b64_tr_b16 v[34:35], v16 offset:12288
v_accvgpr_write_b32 a212, 0
v_mfma_f32_16x16x32_bf16 v[148:151], v[36:39], a[148:151], v[148:151]
buffer_load_dwordx4 a[192:195], v10, s[44:47], s74 offen offset:3072 sc1
v_mfma_f32_16x16x32_bf16 v[152:155], v[36:39], a[152:155], v[152:155]
v_accvgpr_write_b32 a213, 0
v_mfma_f32_16x16x32_bf16 v[156:159], v[36:39], a[156:159], v[156:159]
ds_read_b64_tr_b16 v[36:37], v17 offset:8192
v_accvgpr_write_b32 a214, 0
s_waitcnt lgkmcnt(13)
v_mfma_f32_16x16x32_bf16 v[160:163], v[40:43], a[144:147], v[160:163]
ds_read_b64_tr_b16 v[38:39], v17 offset:12288
v_accvgpr_write_b32 a215, 0
v_mfma_f32_16x16x32_bf16 v[164:167], v[40:43], a[148:151], v[164:167]
v_accvgpr_write_b32 a216, 0
v_mfma_f32_16x16x32_bf16 v[168:171], v[40:43], a[152:155], v[168:171]
v_accvgpr_write_b32 a217, 0
v_mfma_f32_16x16x32_bf16 v[172:175], v[40:43], a[156:159], v[172:175]
ds_read_b64_tr_b16 v[40:41], v18 offset:8192
v_accvgpr_write_b32 a218, 0
s_waitcnt lgkmcnt(13)
v_mfma_f32_16x16x32_bf16 v[176:179], v[44:47], a[144:147], v[176:179]
ds_read_b64_tr_b16 v[42:43], v18 offset:12288
v_accvgpr_write_b32 a219, 0
v_mfma_f32_16x16x32_bf16 v[180:183], v[44:47], a[148:151], v[180:183]
buffer_load_dwordx4 a[196:199], v10, s[44:47], s75 offen offset:3072 sc1
v_mfma_f32_16x16x32_bf16 v[184:187], v[44:47], a[152:155], v[184:187]
v_mfma_f32_16x16x32_bf16 v[188:191], v[44:47], a[156:159], v[188:191]
ds_read_b64_tr_b16 v[44:45], v19 offset:8192
s_waitcnt lgkmcnt(13)
v_mfma_f32_16x16x32_bf16 v[192:195], v[48:51], a[144:147], v[192:195]
ds_read_b64_tr_b16 v[46:47], v19 offset:12288
v_mfma_f32_16x16x32_bf16 v[196:199], v[48:51], a[148:151], v[196:199]
v_mfma_f32_16x16x32_bf16 v[200:203], v[48:51], a[152:155], v[200:203]
v_mfma_f32_16x16x32_bf16 v[204:207], v[48:51], a[156:159], v[204:207]
ds_read_b64_tr_b16 v[48:49], v20 offset:8192
s_waitcnt lgkmcnt(13)
v_mfma_f32_16x16x32_bf16 v[208:211], v[52:55], a[144:147], v[208:211]
ds_read_b64_tr_b16 v[50:51], v20 offset:12288
v_mfma_f32_16x16x32_bf16 v[212:215], v[52:55], a[148:151], v[212:215]
buffer_load_dwordx4 a[200:203], v10, s[44:47], s76 offen offset:3072 sc1
v_mfma_f32_16x16x32_bf16 v[216:219], v[52:55], a[152:155], v[216:219]
v_mfma_f32_16x16x32_bf16 v[220:223], v[52:55], a[156:159], v[220:223]
ds_read_b64_tr_b16 v[52:53], v21 offset:8192
s_waitcnt lgkmcnt(13)
v_mfma_f32_16x16x32_bf16 v[224:227], v[56:59], a[144:147], v[224:227]
ds_read_b64_tr_b16 v[54:55], v21 offset:12288
v_mfma_f32_16x16x32_bf16 v[228:231], v[56:59], a[148:151], v[228:231]
v_mfma_f32_16x16x32_bf16 v[232:235], v[56:59], a[152:155], v[232:235]
v_mfma_f32_16x16x32_bf16 v[236:239], v[56:59], a[156:159], v[236:239]
ds_read_b64_tr_b16 v[56:57], v22 offset:8192
s_waitcnt lgkmcnt(13)
v_mfma_f32_16x16x32_bf16 v[240:243], v[60:63], a[144:147], v[240:243]
ds_read_b64_tr_b16 v[58:59], v22 offset:12288
v_mfma_f32_16x16x32_bf16 v[244:247], v[60:63], a[148:151], v[244:247]
buffer_load_dwordx4 a[204:207], v10, s[44:47], s77 offen offset:3072 sc1
v_mfma_f32_16x16x32_bf16 v[248:251], v[60:63], a[152:155], v[248:251]
v_mfma_f32_16x16x32_bf16 v[252:255], v[60:63], a[156:159], v[252:255]
ds_read_b64_tr_b16 v[60:61], v23 offset:8192
s_waitcnt vmcnt(8)
s_waitcnt lgkmcnt(13)
v_mfma_f32_16x16x32_bf16 v[128:131], v[32:35], a[160:163], v[128:131]
ds_read_b64_tr_b16 v[62:63], v23 offset:12288
s_add_u32 s74, s74, 4096
v_accvgpr_write_b32 a220, 0
v_mfma_f32_16x16x32_bf16 v[132:135], v[32:35], a[164:167], v[132:135]
v_accvgpr_write_b32 a221, 0
v_mfma_f32_16x16x32_bf16 v[136:139], v[32:35], a[168:171], v[136:139]
v_accvgpr_write_b32 a222, 0
v_mfma_f32_16x16x32_bf16 v[140:143], v[32:35], a[172:175], v[140:143]
ds_read_b64_tr_b16 v[32:33], v16 offset:16384
v_accvgpr_write_b32 a223, 0
s_waitcnt lgkmcnt(13)
v_mfma_f32_16x16x32_bf16 v[144:147], v[36:39], a[160:163], v[144:147]
ds_read_b64_tr_b16 v[34:35], v16 offset:20480
s_add_u32 s75, s75, 4096
v_accvgpr_write_b32 a224, 0
v_mfma_f32_16x16x32_bf16 v[148:151], v[36:39], a[164:167], v[148:151]
buffer_load_dwordx4 a[144:147], v10, s[44:47], s74 offen offset:0 sc1
v_mfma_f32_16x16x32_bf16 v[152:155], v[36:39], a[168:171], v[152:155]
v_accvgpr_write_b32 a225, 0
v_mfma_f32_16x16x32_bf16 v[156:159], v[36:39], a[172:175], v[156:159]
ds_read_b64_tr_b16 v[36:37], v17 offset:16384
v_accvgpr_write_b32 a226, 0
s_waitcnt lgkmcnt(13)
v_mfma_f32_16x16x32_bf16 v[160:163], v[40:43], a[160:163], v[160:163]
ds_read_b64_tr_b16 v[38:39], v17 offset:20480
s_add_u32 s76, s76, 4096
v_accvgpr_write_b32 a227, 0
v_mfma_f32_16x16x32_bf16 v[164:167], v[40:43], a[164:167], v[164:167]
v_accvgpr_write_b32 a228, 0
v_mfma_f32_16x16x32_bf16 v[168:171], v[40:43], a[168:171], v[168:171]
v_accvgpr_write_b32 a229, 0
v_mfma_f32_16x16x32_bf16 v[172:175], v[40:43], a[172:175], v[172:175]
ds_read_b64_tr_b16 v[40:41], v18 offset:16384
v_accvgpr_write_b32 a230, 0
s_waitcnt lgkmcnt(13)
v_mfma_f32_16x16x32_bf16 v[176:179], v[44:47], a[160:163], v[176:179]
ds_read_b64_tr_b16 v[42:43], v18 offset:20480
s_add_u32 s77, s77, 4096
v_accvgpr_write_b32 a231, 0
v_mfma_f32_16x16x32_bf16 v[180:183], v[44:47], a[164:167], v[180:183]
buffer_load_dwordx4 a[148:151], v10, s[44:47], s75 offen offset:0 sc1
v_mfma_f32_16x16x32_bf16 v[184:187], v[44:47], a[168:171], v[184:187]
v_mfma_f32_16x16x32_bf16 v[188:191], v[44:47], a[172:175], v[188:191]
ds_read_b64_tr_b16 v[44:45], v19 offset:16384
s_waitcnt lgkmcnt(13)
v_mfma_f32_16x16x32_bf16 v[192:195], v[48:51], a[160:163], v[192:195]
ds_read_b64_tr_b16 v[46:47], v19 offset:20480
v_mfma_f32_16x16x32_bf16 v[196:199], v[48:51], a[164:167], v[196:199]
s_lshl_b32 s78, s65, 7
s_add_u32 s78, s78, 69206016
v_mfma_f32_16x16x32_bf16 v[200:203], v[48:51], a[168:171], v[200:203]
v_mfma_f32_16x16x32_bf16 v[204:207], v[48:51], a[172:175], v[204:207]
ds_read_b64_tr_b16 v[48:49], v20 offset:16384
s_waitcnt lgkmcnt(13)
v_mfma_f32_16x16x32_bf16 v[208:211], v[52:55], a[160:163], v[208:211]
ds_read_b64_tr_b16 v[50:51], v20 offset:20480
v_mfma_f32_16x16x32_bf16 v[212:215], v[52:55], a[164:167], v[212:215]
buffer_load_dwordx4 a[152:155], v10, s[44:47], s76 offen offset:0 sc1
v_mfma_f32_16x16x32_bf16 v[216:219], v[52:55], a[168:171], v[216:219]
v_mfma_f32_16x16x32_bf16 v[220:223], v[52:55], a[172:175], v[220:223]
ds_read_b64_tr_b16 v[52:53], v21 offset:16384
s_waitcnt lgkmcnt(13)
v_mfma_f32_16x16x32_bf16 v[224:227], v[56:59], a[160:163], v[224:227]
ds_read_b64_tr_b16 v[54:55], v21 offset:20480
v_mfma_f32_16x16x32_bf16 v[228:231], v[56:59], a[164:167], v[228:231]
buffer_load_dword v29, v30, s[44:47], s78 offen sc1
v_mfma_f32_16x16x32_bf16 v[232:235], v[56:59], a[168:171], v[232:235]
v_mfma_f32_16x16x32_bf16 v[236:239], v[56:59], a[172:175], v[236:239]
ds_read_b64_tr_b16 v[56:57], v22 offset:16384
s_waitcnt lgkmcnt(13)
v_mfma_f32_16x16x32_bf16 v[240:243], v[60:63], a[160:163], v[240:243]
ds_read_b64_tr_b16 v[58:59], v22 offset:20480
v_mfma_f32_16x16x32_bf16 v[244:247], v[60:63], a[164:167], v[244:247]
buffer_load_dwordx4 a[156:159], v10, s[44:47], s77 offen offset:0 sc1
v_mfma_f32_16x16x32_bf16 v[248:251], v[60:63], a[168:171], v[248:251]
v_mfma_f32_16x16x32_bf16 v[252:255], v[60:63], a[172:175], v[252:255]
ds_read_b64_tr_b16 v[60:61], v23 offset:16384
s_waitcnt vmcnt(9)
s_waitcnt lgkmcnt(13)
v_mfma_f32_16x16x32_bf16 v[128:131], v[32:35], a[176:179], v[128:131]
ds_read_b64_tr_b16 v[62:63], v23 offset:20480
v_accvgpr_write_b32 a232, 0
v_mfma_f32_16x16x32_bf16 v[132:135], v[32:35], a[180:183], v[132:135]
v_accvgpr_write_b32 a233, 0
v_mfma_f32_16x16x32_bf16 v[136:139], v[32:35], a[184:187], v[136:139]
v_accvgpr_write_b32 a234, 0
v_mfma_f32_16x16x32_bf16 v[140:143], v[32:35], a[188:191], v[140:143]
ds_read_b64_tr_b16 v[32:33], v16 offset:24576
v_accvgpr_write_b32 a235, 0
s_waitcnt lgkmcnt(13)
v_mfma_f32_16x16x32_bf16 v[144:147], v[36:39], a[176:179], v[144:147]
ds_read_b64_tr_b16 v[34:35], v16 offset:28672
v_accvgpr_write_b32 a236, 0
v_mfma_f32_16x16x32_bf16 v[148:151], v[36:39], a[180:183], v[148:151]
buffer_load_dwordx4 a[160:163], v10, s[44:47], s74 offen offset:1024 sc1
v_mfma_f32_16x16x32_bf16 v[152:155], v[36:39], a[184:187], v[152:155]
v_accvgpr_write_b32 a237, 0
v_mfma_f32_16x16x32_bf16 v[156:159], v[36:39], a[188:191], v[156:159]
ds_read_b64_tr_b16 v[36:37], v17 offset:24576
v_accvgpr_write_b32 a238, 0
s_waitcnt lgkmcnt(13)
v_mfma_f32_16x16x32_bf16 v[160:163], v[40:43], a[176:179], v[160:163]
ds_read_b64_tr_b16 v[38:39], v17 offset:28672
v_accvgpr_write_b32 a239, 0
v_mfma_f32_16x16x32_bf16 v[164:167], v[40:43], a[180:183], v[164:167]
v_mfma_f32_16x16x32_bf16 v[168:171], v[40:43], a[184:187], v[168:171]
v_mfma_f32_16x16x32_bf16 v[172:175], v[40:43], a[188:191], v[172:175]
ds_read_b64_tr_b16 v[40:41], v18 offset:24576
s_waitcnt lgkmcnt(13)
v_mfma_f32_16x16x32_bf16 v[176:179], v[44:47], a[176:179], v[176:179]
ds_read_b64_tr_b16 v[42:43], v18 offset:28672
v_mfma_f32_16x16x32_bf16 v[180:183], v[44:47], a[180:183], v[180:183]
buffer_load_dwordx4 a[164:167], v10, s[44:47], s75 offen offset:1024 sc1
v_mfma_f32_16x16x32_bf16 v[184:187], v[44:47], a[184:187], v[184:187]
v_mfma_f32_16x16x32_bf16 v[188:191], v[44:47], a[188:191], v[188:191]
ds_read_b64_tr_b16 v[44:45], v19 offset:24576
s_waitcnt lgkmcnt(13)
v_mfma_f32_16x16x32_bf16 v[192:195], v[48:51], a[176:179], v[192:195]
ds_read_b64_tr_b16 v[46:47], v19 offset:28672
v_mfma_f32_16x16x32_bf16 v[196:199], v[48:51], a[180:183], v[196:199]
v_mfma_f32_16x16x32_bf16 v[200:203], v[48:51], a[184:187], v[200:203]
v_mfma_f32_16x16x32_bf16 v[204:207], v[48:51], a[188:191], v[204:207]
ds_read_b64_tr_b16 v[48:49], v20 offset:24576
s_waitcnt lgkmcnt(13)
v_mfma_f32_16x16x32_bf16 v[208:211], v[52:55], a[176:179], v[208:211]
ds_read_b64_tr_b16 v[50:51], v20 offset:28672
v_mfma_f32_16x16x32_bf16 v[212:215], v[52:55], a[180:183], v[212:215]
buffer_load_dwordx4 a[168:171], v10, s[44:47], s76 offen offset:1024 sc1
v_mfma_f32_16x16x32_bf16 v[216:219], v[52:55], a[184:187], v[216:219]
v_mfma_f32_16x16x32_bf16 v[220:223], v[52:55], a[188:191], v[220:223]
ds_read_b64_tr_b16 v[52:53], v21 offset:24576
s_waitcnt lgkmcnt(13)
v_mfma_f32_16x16x32_bf16 v[224:227], v[56:59], a[176:179], v[224:227]
ds_read_b64_tr_b16 v[54:55], v21 offset:28672
v_mfma_f32_16x16x32_bf16 v[228:231], v[56:59], a[180:183], v[228:231]
v_mfma_f32_16x16x32_bf16 v[232:235], v[56:59], a[184:187], v[232:235]
v_mfma_f32_16x16x32_bf16 v[236:239], v[56:59], a[188:191], v[236:239]
ds_read_b64_tr_b16 v[56:57], v22 offset:24576
s_waitcnt lgkmcnt(13)
v_mfma_f32_16x16x32_bf16 v[240:243], v[60:63], a[176:179], v[240:243]
ds_read_b64_tr_b16 v[58:59], v22 offset:28672
v_mfma_f32_16x16x32_bf16 v[244:247], v[60:63], a[180:183], v[244:247]
buffer_load_dwordx4 a[172:175], v10, s[44:47], s77 offen offset:1024 sc1
v_mfma_f32_16x16x32_bf16 v[248:251], v[60:63], a[184:187], v[248:251]
v_mfma_f32_16x16x32_bf16 v[252:255], v[60:63], a[188:191], v[252:255]
ds_read_b64_tr_b16 v[60:61], v23 offset:24576
s_waitcnt vmcnt(9)
s_waitcnt lgkmcnt(13)
v_mfma_f32_16x16x32_bf16 v[128:131], v[32:35], a[192:195], v[128:131]
ds_read_b64_tr_b16 v[62:63], v23 offset:28672
v_mfma_f32_16x16x32_bf16 v[132:135], v[32:35], a[196:199], v[132:135]
v_mfma_f32_16x16x32_bf16 v[136:139], v[32:35], a[200:203], v[136:139]
v_mfma_f32_16x16x32_bf16 v[140:143], v[32:35], a[204:207], v[140:143]
ds_read_b64_tr_b16 v[32:33], v16 offset:32768
s_waitcnt lgkmcnt(13)
v_mfma_f32_16x16x32_bf16 v[144:147], v[36:39], a[192:195], v[144:147]
ds_read_b64_tr_b16 v[34:35], v16 offset:36864
v_mfma_f32_16x16x32_bf16 v[148:151], v[36:39], a[196:199], v[148:151]
buffer_load_dwordx4 a[176:179], v10, s[44:47], s74 offen offset:2048 sc1
v_mfma_f32_16x16x32_bf16 v[152:155], v[36:39], a[200:203], v[152:155]
v_mfma_f32_16x16x32_bf16 v[156:159], v[36:39], a[204:207], v[156:159]
ds_read_b64_tr_b16 v[36:37], v17 offset:32768
s_waitcnt lgkmcnt(13)
v_mfma_f32_16x16x32_bf16 v[160:163], v[40:43], a[192:195], v[160:163]
ds_read_b64_tr_b16 v[38:39], v17 offset:36864
v_mfma_f32_16x16x32_bf16 v[164:167], v[40:43], a[196:199], v[164:167]
v_mfma_f32_16x16x32_bf16 v[168:171], v[40:43], a[200:203], v[168:171]
v_mfma_f32_16x16x32_bf16 v[172:175], v[40:43], a[204:207], v[172:175]
ds_read_b64_tr_b16 v[40:41], v18 offset:32768
s_waitcnt lgkmcnt(13)
v_mfma_f32_16x16x32_bf16 v[176:179], v[44:47], a[192:195], v[176:179]
ds_read_b64_tr_b16 v[42:43], v18 offset:36864
v_mfma_f32_16x16x32_bf16 v[180:183], v[44:47], a[196:199], v[180:183]
buffer_load_dwordx4 a[180:183], v10, s[44:47], s75 offen offset:2048 sc1
v_mfma_f32_16x16x32_bf16 v[184:187], v[44:47], a[200:203], v[184:187]
v_mfma_f32_16x16x32_bf16 v[188:191], v[44:47], a[204:207], v[188:191]
ds_read_b64_tr_b16 v[44:45], v19 offset:32768
s_waitcnt lgkmcnt(13)
v_mfma_f32_16x16x32_bf16 v[192:195], v[48:51], a[192:195], v[192:195]
ds_read_b64_tr_b16 v[46:47], v19 offset:36864
v_mfma_f32_16x16x32_bf16 v[196:199], v[48:51], a[196:199], v[196:199]
v_mfma_f32_16x16x32_bf16 v[200:203], v[48:51], a[200:203], v[200:203]
v_mfma_f32_16x16x32_bf16 v[204:207], v[48:51], a[204:207], v[204:207]
ds_read_b64_tr_b16 v[48:49], v20 offset:32768
s_waitcnt lgkmcnt(13)
v_mfma_f32_16x16x32_bf16 v[208:211], v[52:55], a[192:195], v[208:211]
ds_read_b64_tr_b16 v[50:51], v20 offset:36864
v_mfma_f32_16x16x32_bf16 v[212:215], v[52:55], a[196:199], v[212:215]
buffer_load_dwordx4 a[184:187], v10, s[44:47], s76 offen offset:2048 sc1
v_mfma_f32_16x16x32_bf16 v[216:219], v[52:55], a[200:203], v[216:219]
v_mfma_f32_16x16x32_bf16 v[220:223], v[52:55], a[204:207], v[220:223]
ds_read_b64_tr_b16 v[52:53], v21 offset:32768
s_waitcnt lgkmcnt(13)
v_mfma_f32_16x16x32_bf16 v[224:227], v[56:59], a[192:195], v[224:227]
ds_read_b64_tr_b16 v[54:55], v21 offset:36864
v_mfma_f32_16x16x32_bf16 v[228:231], v[56:59], a[196:199], v[228:231]
v_mfma_f32_16x16x32_bf16 v[232:235], v[56:59], a[200:203], v[232:235]
v_mfma_f32_16x16x32_bf16 v[236:239], v[56:59], a[204:207], v[236:239]
ds_read_b64_tr_b16 v[56:57], v22 offset:32768
s_waitcnt lgkmcnt(13)
v_mfma_f32_16x16x32_bf16 v[240:243], v[60:63], a[192:195], v[240:243]
ds_read_b64_tr_b16 v[58:59], v22 offset:36864
v_mfma_f32_16x16x32_bf16 v[244:247], v[60:63], a[196:199], v[244:247]
buffer_load_dwordx4 a[188:191], v10, s[44:47], s77 offen offset:2048 sc1
v_mfma_f32_16x16x32_bf16 v[248:251], v[60:63], a[200:203], v[248:251]
v_mfma_f32_16x16x32_bf16 v[252:255], v[60:63], a[204:207], v[252:255]
ds_read_b64_tr_b16 v[60:61], v23 offset:32768
s_waitcnt vmcnt(8)
s_lshl_b32 s70, s65, 20
s_add_u32 s70, s70, 4194304
s_add_u32 s56, s42, s70
s_addc_u32 s57, s43, 0
s_and_b32 s57, s57, 0xffff
s_mov_b32 s58, 0x100000
s_mov_b32 s59, 0x20000
v_add_u32 v4, 0, v10
v_add_u32 v5, 4096, v10
v_add_u32 v6, 8192, v10
v_add_u32 v7, 12288, v10
s_lshl_b32 s83, s64, 14
s_lshl_b32 s84, s64, 14
v_readfirstlane_b32 s71, v29
s_nop 0
s_cmp_ge_u32 s71, 8
s_cbranch_scc1 L_pk_6
v_mov_b32 v29, 0
s_mov_b32 s72, 0
L_spin_7:
buffer_load_dword v28, v29, s[44:47], s78 offen sc1
s_waitcnt vmcnt(0)
v_readfirstlane_b32 s71, v28
s_add_u32 s72, s72, 1
s_cmp_ge_u32 s71, 8
s_cbranch_scc1 L_spine_8
s_sleep 2
s_cmp_lt_u32 s72, 262144
s_cbranch_scc1 L_spin_7
L_spine_8:
L_pk_6:
s_waitcnt lgkmcnt(13)
v_mfma_f32_16x16x32_bf16 v[128:131], v[32:35], a[144:147], v[128:131]
ds_read_b64_tr_b16 v[62:63], v23 offset:36864
v_mfma_f32_16x16x32_bf16 v[132:135], v[32:35], a[148:151], v[132:135]
s_add_u32 m0, s84, 0
s_nop 0
buffer_load_dwordx4 v4, s[56:59], s83 offen offset:0 sc1 lds
v_mfma_f32_16x16x32_bf16 v[136:139], v[32:35], a[152:155], v[136:139]
v_mfma_f32_16x16x32_bf16 v[140:143], v[32:35], a[156:159], v[140:143]
ds_read_b64_tr_b16 v[32:33], v16 offset:40960
s_waitcnt lgkmcnt(13)
v_mfma_f32_16x16x32_bf16 v[144:147], v[36:39], a[144:147], v[144:147]
ds_read_b64_tr_b16 v[34:35], v16 offset:45056
v_mfma_f32_16x16x32_bf16 v[148:151], v[36:39], a[148:151], v[148:151]
buffer_load_dwordx4 a[192:195], v10, s[44:47], s74 offen offset:3072 sc1
v_mfma_f32_16x16x32_bf16 v[152:155], v[36:39], a[152:155], v[152:155]
v_mfma_f32_16x16x32_bf16 v[156:159], v[36:39], a[156:159], v[156:159]
ds_read_b64_tr_b16 v[36:37], v17 offset:40960
s_waitcnt lgkmcnt(13)
v_mfma_f32_16x16x32_bf16 v[160:163], v[40:43], a[144:147], v[160:163]
ds_read_b64_tr_b16 v[38:39], v17 offset:45056
v_mfma_f32_16x16x32_bf16 v[164:167], v[40:43], a[148:151], v[164:167]
s_add_u32 m0, s84, 0
s_nop 0
buffer_load_dwordx4 v4, s[56:59], s83 offen offset:1024 sc1 lds
v_mfma_f32_16x16x32_bf16 v[168:171], v[40:43], a[152:155], v[168:171]
v_mfma_f32_16x16x32_bf16 v[172:175], v[40:43], a[156:159], v[172:175]
ds_read_b64_tr_b16 v[40:41], v18 offset:40960
s_waitcnt lgkmcnt(13)
v_mfma_f32_16x16x32_bf16 v[176:179], v[44:47], a[144:147], v[176:179]
ds_read_b64_tr_b16 v[42:43], v18 offset:45056
v_mfma_f32_16x16x32_bf16 v[180:183], v[44:47], a[148:151], v[180:183]
buffer_load_dwordx4 a[196:199], v10, s[44:47], s75 offen offset:3072 sc1
v_mfma_f32_16x16x32_bf16 v[184:187], v[44:47], a[152:155], v[184:187]
v_mfma_f32_16x16x32_bf16 v[188:191], v[44:47], a[156:159], v[188:191]
ds_read_b64_tr_b16 v[44:45], v19 offset:40960
s_waitcnt lgkmcnt(13)
v_mfma_f32_16x16x32_bf16 v[192:195], v[48:51], a[144:147], v[192:195]
ds_read_b64_tr_b16 v[46:47], v19 offset:45056
v_mfma_f32_16x16x32_bf16 v[196:199], v[48:51], a[148:151], v[196:199]
s_add_u32 m0, s84, 0
s_nop 0
buffer_load_dwordx4 v4, s[56:59], s83 offen offset:2048 sc1 lds
v_mfma_f32_16x16x32_bf16 v[200:203], v[48:51], a[152:155], v[200:203]
v_mfma_f32_16x16x32_bf16 v[204:207], v[48:51], a[156:159], v[204:207]
ds_read_b64_tr_b16 v[48:49], v20 offset:40960
s_waitcnt lgkmcnt(13)
v_mfma_f32_16x16x32_bf16 v[208:211], v[52:55], a[144:147], v[208:211]
ds_read_b64_tr_b16 v[50:51], v20 offset:45056
v_mfma_f32_16x16x32_bf16 v[212:215], v[52:55], a[148:151], v[212:215]
buffer_load_dwordx4 a[200:203], v10, s[44:47], s76 offen offset:3072 sc1
v_mfma_f32_16x16x32_bf16 v[216:219], v[52:55], a[152:155], v[216:219]
v_mfma_f32_16x16x32_bf16 v[220:223], v[52:55], a[156:159], v[220:223]
ds_read_b64_tr_b16 v[52:53], v21 offset:40960
s_waitcnt lgkmcnt(13)
v_mfma_f32_16x16x32_bf16 v[224:227], v[56:59], a[144:147], v[224:227]
ds_read_b64_tr_b16 v[54:55], v21 offset:45056
v_mfma_f32_16x16x32_bf16 v[228:231], v[56:59], a[148:151], v[228:231]
v_mfma_f32_16x16x32_bf16 v[232:235], v[56:59], a[152:155], v[232:235]
v_mfma_f32_16x16x32_bf16 v[236:239], v[56:59], a[156:159], v[236:239]
ds_read_b64_tr_b16 v[56:57], v22 offset:40960
s_waitcnt lgkmcnt(13)
v_mfma_f32_16x16x32_bf16 v[240:243], v[60:63], a[144:147], v[240:243]
ds_read_b64_tr_b16 v[58:59], v22 offset:45056
v_mfma_f32_16x16x32_bf16 v[244:247], v[60:63], a[148:151], v[244:247]
buffer_load_dwordx4 a[204:207], v10, s[44:47], s77 offen offset:3072 sc1
v_mfma_f32_16x16x32_bf16 v[248:251], v[60:63], a[152:155], v[248:251]
v_mfma_f32_16x16x32_bf16 v[252:255], v[60:63], a[156:159], v[252:255]
ds_read_b64_tr_b16 v[60:61], v23 offset:40960
s_waitcnt vmcnt(11)
s_waitcnt lgkmcnt(13)
v_mfma_f32_16x16x32_bf16 v[128:131], v[32:35], a[160:163], v[128:131]
ds_read_b64_tr_b16 v[62:63], v23 offset:45056
v_mfma_f32_16x16x32_bf16 v[132:135], v[32:35], a[164:167], v[132:135]
v_mfma_f32_16x16x32_bf16 v[136:139], v[32:35], a[168:171], v[136:139]
s_add_u32 m0, s84, 0
s_nop 0
buffer_load_dwordx4 v4, s[56:59], s83 offen offset:3072 sc1 lds
v_mfma_f32_16x16x32_bf16 v[140:143], v[32:35], a[172:175], v[140:143]
ds_read_b64_tr_b16 v[32:33], v16 offset:49152
s_waitcnt lgkmcnt(13)
v_mfma_f32_16x16x32_bf16 v[144:147], v[36:39], a[160:163], v[144:147]
ds_read_b64_tr_b16 v[34:35], v16 offset:53248
v_mfma_f32_16x16x32_bf16 v[148:151], v[36:39], a[164:167], v[148:151]
v_mfma_f32_16x16x32_bf16 v[152:155], v[36:39], a[168:171], v[152:155]
s_add_u32 m0, s84, 4096
s_nop 0
buffer_load_dwordx4 v5, s[56:59], s83 offen offset:0 sc1 lds
v_mfma_f32_16x16x32_bf16 v[156:159], v[36:39], a[172:175], v[156:159]
ds_read_b64_tr_b16 v[36:37], v17 offset:49152
s_waitcnt lgkmcnt(13)
v_mfma_f32_16x16x32_bf16 v[160:163], v[40:43], a[160:163], v[160:163]
ds_read_b64_tr_b16 v[38:39], v17 offset:53248
v_mfma_f32_16x16x32_bf16 v[164:167], v[40:43], a[164:167], v[164:167]
v_mfma_f32_16x16x32_bf16 v[168:171], v[40:43], a[168:171], v[168:171]
s_add_u32 m0, s84, 4096
s_nop 0
buffer_load_dwordx4 v5, s[56:59], s83 offen offset:1024 sc1 lds
v_mfma_f32_16x16x32_bf16 v[172:175], v[40:43], a[172:175], v[172:175]
ds_read_b64_tr_b16 v[40:41], v18 offset:49152
s_waitcnt lgkmcnt(13)
v_mfma_f32_16x16x32_bf16 v[176:179], v[44:47], a[160:163], v[176:179]
ds_read_b64_tr_b16 v[42:43], v18 offset:53248
v_mfma_f32_16x16x32_bf16 v[180:183], v[44:47], a[164:167], v[180:183]
v_mfma_f32_16x16x32_bf16 v[184:187], v[44:47], a[168:171], v[184:187]
s_add_u32 m0, s84, 4096
s_nop 0
buffer_load_dwordx4 v5, s[56:59], s83 offen offset:2048 sc1 lds
v_mfma_f32_16x16x32_bf16 v[188:191], v[44:47], a[172:175], v[188:191]
ds_read_b64_tr_b16 v[44:45], v19 offset:49152
s_waitcnt lgkmcnt(13)
v_mfma_f32_16x16x32_bf16 v[192:195], v[48:51], a[160:163], v[192:195]
ds_read_b64_tr_b16 v[46:47], v19 offset:53248
v_mfma_f32_16x16x32_bf16 v[196:199], v[48:51], a[164:167], v[196:199]
v_mfma_f32_16x16x32_bf16 v[200:203], v[48:51], a[168:171], v[200:203]
s_add_u32 m0, s84, 4096
s_nop 0
buffer_load_dwordx4 v5, s[56:59], s83 offen offset:3072 sc1 lds
v_mfma_f32_16x16x32_bf16 v[204:207], v[48:51], a[172:175], v[204:207]
ds_read_b64_tr_b16 v[48:49], v20 offset:49152
s_waitcnt lgkmcnt(13)
v_mfma_f32_16x16x32_bf16 v[208:211], v[52:55], a[160:163], v[208:211]
ds_read_b64_tr_b16 v[50:51], v20 offset:53248
v_mfma_f32_16x16x32_bf16 v[212:215], v[52:55], a[164:167], v[212:215]
v_mfma_f32_16x16x32_bf16 v[216:219], v[52:55], a[168:171], v[216:219]
s_add_u32 m0, s84, 8192
s_nop 0
buffer_load_dwordx4 v6, s[56:59], s83 offen offset:0 sc1 lds
v_mfma_f32_16x16x32_bf16 v[220:223], v[52:55], a[172:175], v[220:223]
ds_read_b64_tr_b16 v[52:53], v21 offset:49152
s_waitcnt lgkmcnt(13)
v_mfma_f32_16x16x32_bf16 v[224:227], v[56:59], a[160:163], v[224:227]
ds_read_b64_tr_b16 v[54:55], v21 offset:53248
v_mfma_f32_16x16x32_bf16 v[228:231], v[56:59], a[164:167], v[228:231]
v_mfma_f32_16x16x32_bf16 v[232:235], v[56:59], a[168:171], v[232:235]
s_add_u32 m0, s84, 8192
s_nop 0
buffer_load_dwordx4 v6, s[56:59], s83 offen offset:1024 sc1 lds
v_mfma_f32_16x16x32_bf16 v[236:239], v[56:59], a[172:175], v[236:239]
ds_read_b64_tr_b16 v[56:57], v22 offset:49152
s_waitcnt lgkmcnt(13)
v_mfma_f32_16x16x32_bf16 v[240:243], v[60:63], a[160:163], v[240:243]
ds_read_b64_tr_b16 v[58:59], v22 offset:53248
v_mfma_f32_16x16x32_bf16 v[244:247], v[60:63], a[164:167], v[244:247]
v_mfma_f32_16x16x32_bf16 v[248:251], v[60:63], a[168:171], v[248:251]
v_mfma_f32_16x16x32_bf16 v[252:255], v[60:63], a[172:175], v[252:255]
ds_read_b64_tr_b16 v[60:61], v23 offset:49152
s_waitcnt vmcnt(14)
s_waitcnt lgkmcnt(13)
v_mfma_f32_16x16x32_bf16 v[128:131], v[32:35], a[176:179], v[128:131]
ds_read_b64_tr_b16 v[62:63], v23 offset:53248
v_mfma_f32_16x16x32_bf16 v[132:135], v[32:35], a[180:183], v[132:135]
v_mfma_f32_16x16x32_bf16 v[136:139], v[32:35], a[184:187], v[136:139]
s_add_u32 m0, s84, 8192
s_nop 0
buffer_load_dwordx4 v6, s[56:59], s83 offen offset:2048 sc1 lds
v_mfma_f32_16x16x32_bf16 v[140:143], v[32:35], a[188:191], v[140:143]
ds_read_b64_tr_b16 v[32:33], v16 offset:57344
s_waitcnt lgkmcnt(13)
v_mfma_f32_16x16x32_bf16 v[144:147], v[36:39], a[176:179], v[144:147]
ds_read_b64_tr_b16 v[34:35], v16 offset:61440
v_mfma_f32_16x16x32_bf16 v[148:151], v[36:39], a[180:183], v[148:151]
v_mfma_f32_16x16x32_bf16 v[152:155], v[36:39], a[184:187], v[152:155]
s_add_u32 m0, s84, 8192
s_nop 0
buffer_load_dwordx4 v6, s[56:59], s83 offen offset:3072 sc1 lds
v_mfma_f32_16x16x32_bf16 v[156:159], v[36:39], a[188:191], v[156:159]
ds_read_b64_tr_b16 v[36:37], v17 offset:57344
s_waitcnt lgkmcnt(13)
v_mfma_f32_16x16x32_bf16 v[160:163], v[40:43], a[176:179], v[160:163]
ds_read_b64_tr_b16 v[38:39], v17 offset:61440
v_mfma_f32_16x16x32_bf16 v[164:167], v[40:43], a[180:183], v[164:167]
v_mfma_f32_16x16x32_bf16 v[168:171], v[40:43], a[184:187], v[168:171]
s_add_u32 m0, s84, 12288
s_nop 0
buffer_load_dwordx4 v7, s[56:59], s83 offen offset:0 sc1 lds
v_mfma_f32_16x16x32_bf16 v[172:175], v[40:43], a[188:191], v[172:175]
ds_read_b64_tr_b16 v[40:41], v18 offset:57344
s_waitcnt lgkmcnt(13)
v_mfma_f32_16x16x32_bf16 v[176:179], v[44:47], a[176:179], v[176:179]
ds_read_b64_tr_b16 v[42:43], v18 offset:61440
v_mfma_f32_16x16x32_bf16 v[180:183], v[44:47], a[180:183], v[180:183]
v_mfma_f32_16x16x32_bf16 v[184:187], v[44:47], a[184:187], v[184:187]
s_add_u32 m0, s84, 12288
s_nop 0
buffer_load_dwordx4 v7, s[56:59], s83 offen offset:1024 sc1 lds
v_mfma_f32_16x16x32_bf16 v[188:191], v[44:47], a[188:191], v[188:191]
ds_read_b64_tr_b16 v[44:45], v19 offset:57344
s_waitcnt lgkmcnt(13)
v_mfma_f32_16x16x32_bf16 v[192:195], v[48:51], a[176:179], v[192:195]
ds_read_b64_tr_b16 v[46:47], v19 offset:61440
v_mfma_f32_16x16x32_bf16 v[196:199], v[48:51], a[180:183], v[196:199]
v_mfma_f32_16x16x32_bf16 v[200:203], v[48:51], a[184:187], v[200:203]
s_add_u32 m0, s84, 12288
s_nop 0
buffer_load_dwordx4 v7, s[56:59], s83 offen offset:2048 sc1 lds
v_mfma_f32_16x16x32_bf16 v[204:207], v[48:51], a[188:191], v[204:207]
ds_read_b64_tr_b16 v[48:49], v20 offset:57344
s_waitcnt lgkmcnt(13)
v_mfma_f32_16x16x32_bf16 v[208:211], v[52:55], a[176:179], v[208:211]
ds_read_b64_tr_b16 v[50:51], v20 offset:61440
v_mfma_f32_16x16x32_bf16 v[212:215], v[52:55], a[180:183], v[212:215]
v_mfma_f32_16x16x32_bf16 v[216:219], v[52:55], a[184:187], v[216:219]
s_add_u32 m0, s84, 12288
s_nop 0
buffer_load_dwordx4 v7, s[56:59], s83 offen offset:3072 sc1 lds
v_mfma_f32_16x16x32_bf16 v[220:223], v[52:55], a[188:191], v[220:223]
ds_read_b64_tr_b16 v[52:53], v21 offset:57344
s_waitcnt lgkmcnt(13)
v_mfma_f32_16x16x32_bf16 v[224:227], v[56:59], a[176:179], v[224:227]
ds_read_b64_tr_b16 v[54:55], v21 offset:61440
v_mfma_f32_16x16x32_bf16 v[228:231], v[56:59], a[180:183], v[228:231]
v_mfma_f32_16x16x32_bf16 v[232:235], v[56:59], a[184:187], v[232:235]
v_mfma_f32_16x16x32_bf16 v[236:239], v[56:59], a[188:191], v[236:239]
ds_read_b64_tr_b16 v[56:57], v22 offset:57344
s_waitcnt lgkmcnt(13)
v_mfma_f32_16x16x32_bf16 v[240:243], v[60:63], a[176:179], v[240:243]
ds_read_b64_tr_b16 v[58:59], v22 offset:61440
v_mfma_f32_16x16x32_bf16 v[244:247], v[60:63], a[180:183], v[244:247]
v_mfma_f32_16x16x32_bf16 v[248:251], v[60:63], a[184:187], v[248:251]
v_mfma_f32_16x16x32_bf16 v[252:255], v[60:63], a[188:191], v[252:255]
ds_read_b64_tr_b16 v[60:61], v23 offset:57344
s_waitcnt vmcnt(13)
s_waitcnt lgkmcnt(13)
v_mfma_f32_16x16x32_bf16 v[128:131], v[32:35], a[192:195], v[128:131]
ds_read_b64_tr_b16 v[62:63], v23 offset:61440
v_mfma_f32_16x16x32_bf16 v[132:135], v[32:35], a[196:199], v[132:135]
v_mfma_f32_16x16x32_bf16 v[136:139], v[32:35], a[200:203], v[136:139]
v_mfma_f32_16x16x32_bf16 v[140:143], v[32:35], a[204:207], v[140:143]
s_waitcnt lgkmcnt(12)
v_mfma_f32_16x16x32_bf16 v[144:147], v[36:39], a[192:195], v[144:147]
v_mfma_f32_16x16x32_bf16 v[148:151], v[36:39], a[196:199], v[148:151]
v_mfma_f32_16x16x32_bf16 v[152:155], v[36:39], a[200:203], v[152:155]
v_mfma_f32_16x16x32_bf16 v[156:159], v[36:39], a[204:207], v[156:159]
s_waitcnt lgkmcnt(10)
v_mfma_f32_16x16x32_bf16 v[160:163], v[40:43], a[192:195], v[160:163]
v_mfma_f32_16x16x32_bf16 v[164:167], v[40:43], a[196:199], v[164:167]
v_mfma_f32_16x16x32_bf16 v[168:171], v[40:43], a[200:203], v[168:171]
v_mfma_f32_16x16x32_bf16 v[172:175], v[40:43], a[204:207], v[172:175]
s_waitcnt lgkmcnt(8)
v_mfma_f32_16x16x32_bf16 v[176:179], v[44:47], a[192:195], v[176:179]
v_mfma_f32_16x16x32_bf16 v[180:183], v[44:47], a[196:199], v[180:183]
v_mfma_f32_16x16x32_bf16 v[184:187], v[44:47], a[200:203], v[184:187]
v_mfma_f32_16x16x32_bf16 v[188:191], v[44:47], a[204:207], v[188:191]
s_waitcnt lgkmcnt(6)
v_mfma_f32_16x16x32_bf16 v[192:195], v[48:51], a[192:195], v[192:195]
v_mfma_f32_16x16x32_bf16 v[196:199], v[48:51], a[196:199], v[196:199]
v_mfma_f32_16x16x32_bf16 v[200:203], v[48:51], a[200:203], v[200:203]
v_mfma_f32_16x16x32_bf16 v[204:207], v[48:51], a[204:207], v[204:207]
s_waitcnt lgkmcnt(4)
v_mfma_f32_16x16x32_bf16 v[208:211], v[52:55], a[192:195], v[208:211]
v_mfma_f32_16x16x32_bf16 v[212:215], v[52:55], a[196:199], v[212:215]
v_mfma_f32_16x16x32_bf16 v[216:219], v[52:55], a[200:203], v[216:219]
v_mfma_f32_16x16x32_bf16 v[220:223], v[52:55], a[204:207], v[220:223]
s_waitcnt lgkmcnt(2)
v_mfma_f32_16x16x32_bf16 v[224:227], v[56:59], a[192:195], v[224:227]
v_mfma_f32_16x16x32_bf16 v[228:231], v[56:59], a[196:199], v[228:231]
v_mfma_f32_16x16x32_bf16 v[232:235], v[56:59], a[200:203], v[232:235]
v_mfma_f32_16x16x32_bf16 v[236:239], v[56:59], a[204:207], v[236:239]
s_waitcnt lgkmcnt(0)
v_mfma_f32_16x16x32_bf16 v[240:243], v[60:63], a[192:195], v[240:243]
v_mfma_f32_16x16x32_bf16 v[244:247], v[60:63], a[196:199], v[244:247]
v_mfma_f32_16x16x32_bf16 v[248:251], v[60:63], a[200:203], v[248:251]
v_mfma_f32_16x16x32_bf16 v[252:255], v[60:63], a[204:207], v[252:255]
s_nop 3
v_cvt_pk_bf16_f32 v128, v128, v129
v_cvt_pk_bf16_f32 v129, v130, v131
v_cvt_pk_bf16_f32 v130, v144, v145
v_cvt_pk_bf16_f32 v131, v146, v147
v_cvt_pk_bf16_f32 v132, v132, v133
v_cvt_pk_bf16_f32 v133, v134, v135
v_cvt_pk_bf16_f32 v134, v148, v149
v_cvt_pk_bf16_f32 v135, v150, v151
v_cvt_pk_bf16_f32 v136, v136, v137
v_cvt_pk_bf16_f32 v137, v138, v139
v_cvt_pk_bf16_f32 v138, v152, v153
v_cvt_pk_bf16_f32 v139, v154, v155
v_cvt_pk_bf16_f32 v140, v140, v141
v_cvt_pk_bf16_f32 v141, v142, v143
v_cvt_pk_bf16_f32 v142, v156, v157
v_cvt_pk_bf16_f32 v143, v158, v159
v_cvt_pk_bf16_f32 v160, v160, v161
v_cvt_pk_bf16_f32 v161, v162, v163
v_cvt_pk_bf16_f32 v162, v176, v177
v_cvt_pk_bf16_f32 v163, v178, v179
v_cvt_pk_bf16_f32 v164, v164, v165
v_cvt_pk_bf16_f32 v165, v166, v167
v_cvt_pk_bf16_f32 v166, v180, v181
v_cvt_pk_bf16_f32 v167, v182, v183
v_cvt_pk_bf16_f32 v168, v168, v169
v_cvt_pk_bf16_f32 v169, v170, v171
v_cvt_pk_bf16_f32 v170, v184, v185
v_cvt_pk_bf16_f32 v171, v186, v187
v_cvt_pk_bf16_f32 v172, v172, v173
v_cvt_pk_bf16_f32 v173, v174, v175
v_cvt_pk_bf16_f32 v174, v188, v189
v_cvt_pk_bf16_f32 v175, v190, v191
v_cvt_pk_bf16_f32 v192, v192, v193
v_cvt_pk_bf16_f32 v193, v194, v195
v_cvt_pk_bf16_f32 v194, v208, v209
v_cvt_pk_bf16_f32 v195, v210, v211
v_cvt_pk_bf16_f32 v196, v196, v197
v_cvt_pk_bf16_f32 v197, v198, v199
v_cvt_pk_bf16_f32 v198, v212, v213
v_cvt_pk_bf16_f32 v199, v214, v215
v_cvt_pk_bf16_f32 v200, v200, v201
v_cvt_pk_bf16_f32 v201, v202, v203
v_cvt_pk_bf16_f32 v202, v216, v217
v_cvt_pk_bf16_f32 v203, v218, v219
v_cvt_pk_bf16_f32 v204, v204, v205
v_cvt_pk_bf16_f32 v205, v206, v207
v_cvt_pk_bf16_f32 v206, v220, v221
v_cvt_pk_bf16_f32 v207, v222, v223
v_cvt_pk_bf16_f32 v224, v224, v225
v_cvt_pk_bf16_f32 v225, v226, v227
v_cvt_pk_bf16_f32 v226, v240, v241
v_cvt_pk_bf16_f32 v227, v242, v243
v_cvt_pk_bf16_f32 v228, v228, v229
v_cvt_pk_bf16_f32 v229, v230, v231
v_cvt_pk_bf16_f32 v230, v244, v245
v_cvt_pk_bf16_f32 v231, v246, v247
v_cvt_pk_bf16_f32 v232, v232, v233
v_cvt_pk_bf16_f32 v233, v234, v235
v_cvt_pk_bf16_f32 v234, v248, v249
v_cvt_pk_bf16_f32 v235, v250, v251
v_cvt_pk_bf16_f32 v236, v236, v237
v_cvt_pk_bf16_f32 v237, v238, v239
v_cvt_pk_bf16_f32 v238, v252, v253
v_cvt_pk_bf16_f32 v239, v254, v255
s_mov_b32 s8, s26
s_and_b32 s9, s27, 0xffff
s_mov_b32 s10, 0x500000
s_mov_b32 s11, 0x20000
s_mov_b32 s52, s30
s_and_b32 s53, s31, 0xffff
s_mov_b32 s54, 0x500
s_mov_b32 s55, 0x20000
s_mul_i32 s14, s67, 1310720
s_lshr_b32 s15, s69, 3
s_mul_i32 s15, s15, 40960
s_add_u32 s14, s14, s15
s_mul_i32 s15, s64, 10240
s_add_u32 s14, s14, s15
s_cmp_eq_u32 s66, 0
s_cselect_b32 s14, 536870912, s14
s_and_b32 s70, s69, 7
s_lshr_b32 s71, s70, 1
s_mul_i32 s71, s71, 56
s_and_b32 s70, s70, 1
s_lshl_b32 s70, s70, 5
s_add_u32 s71, s71, s70
s_lshr_b32 s70, s69, 3
s_add_u32 s70, s70, s71
s_sub_u32 s70, s70, 8
s_lshl_b32 s70, s70, 2
s_add_u32 s70, s70, s64
s_cmp_lt_u32 s70, 270
s_cselect_b32 s71, 0, 270
s_cselect_b32 s48, s32, s34
s_cselect_b32 s49, s33, s35
s_cmp_lt_u32 s70, 540
s_cselect_b32 s71, s71, 540
s_cselect_b32 s48, s48, s36
s_cselect_b32 s49, s49, s37
s_and_b32 s49, s49, 0xffff
s_mov_b32 s50, 2211840
s_mov_b32 s51, 0x20000
s_sub_u32 s70, s70, s71
s_lshl_b32 s15, s70, 13
s_min_u32 s15, s15, 536870912
s_cmp_eq_u32 s66, 0
s_cselect_b32 s15, 536870912, s15
v_mov_b32 v2, v10
v_add_u32 v3, 0x10000, v10
s_add_u32 s83, s83, 0x10000
s_xor_b32 s84, s84, 0x10000
v_mov_b32 v16, 0x3f803f80
v_accvgpr_write_b32 a240, v16
v_accvgpr_write_b32 a241, v16
v_accvgpr_write_b32 a242, v16
v_accvgpr_write_b32 a243, v16
v_and_b32 v16, 15, v1
v_lshrrev_b32 v17, 4, v1
v_lshlrev_b32 v17, 2, v17
v_mov_b32 v18, 0xff800000
v_add_u32 v19, 0, v17
v_cmp_le_u32 vcc, v19, v16
s_nop 1
v_cndmask_b32_e64 v212, v18, 0, vcc
v_add_u32 v19, 1, v17
v_cmp_le_u32 vcc, v19, v16
s_nop 1
v_cndmask_b32_e64 v213, v18, 0, vcc
v_add_u32 v19, 2, v17
v_cmp_le_u32 vcc, v19, v16
s_nop 1
v_cndmask_b32_e64 v214, v18, 0, vcc
v_add_u32 v19, 3, v17
v_cmp_le_u32 vcc, v19, v16
s_nop 1
v_cndmask_b32_e64 v215, v18, 0, vcc
v_mov_b32 v184, 0
v_mov_b32 v185, 0
v_mov_b32 v186, 0
v_mov_b32 v187, 0
v_mov_b32 v188, 0
v_mov_b32 v189, 0
v_mov_b32 v190, 0
v_mov_b32 v191, 0
v_mov_b32 v208, 0
v_mov_b32 v209, 0
v_mov_b32 v210, 0
v_mov_b32 v211, 0
s_waitcnt vmcnt(0)
s_barrier
ds_read_b128 a[144:147], v2 offset:0
ds_read_b128 a[160:163], v2 offset:4096
ds_read_b128 a[148:151], v2 offset:1024
ds_read_b128 a[164:167], v2 offset:5120
ds_read_b128 a[152:155], v2 offset:2048
ds_read_b128 a[168:171], v2 offset:6144
ds_read_b128 a[156:159], v2 offset:3072
ds_read_b128 a[172:175], v2 offset:7168
buffer_load_dwordx4 v[220:223], v10, s[52:55], 0 offen
buffer_load_dwordx4 v[220:223], v10, s[52:55], 0 offen offset:1024
s_add_u32 s73, s14, 0
buffer_load_dwordx4 v[220:223], v10, s[8:11], s73 offen offset:0
buffer_load_dwordx4 v[220:223], v10, s[8:11], s73 offen offset:1024
s_waitcnt lgkmcnt(7)
v_mfma_f32_16x16x32_bf16 v[144:147], a[144:147], v[128:131], 0
s_waitcnt lgkmcnt(6)
v_mfma_f32_16x16x32_bf16 v[148:151], a[160:163], v[128:131], 0
s_waitcnt lgkmcnt(5)
v_mfma_f32_16x16x32_bf16 v[144:147], a[148:151], v[160:163], v[144:147]
s_waitcnt lgkmcnt(4)
v_mfma_f32_16x16x32_bf16 v[148:151], a[164:167], v[160:163], v[148:151]
s_waitcnt lgkmcnt(3)
v_mfma_f32_16x16x32_bf16 v[144:147], a[152:155], v[192:195], v[144:147]
s_waitcnt lgkmcnt(2)
v_mfma_f32_16x16x32_bf16 v[148:151], a[168:171], v[192:195], v[148:151]
s_waitcnt lgkmcnt(1)
v_mfma_f32_16x16x32_bf16 v[144:147], a[156:159], v[224:227], v[144:147]
s_waitcnt lgkmcnt(0)
v_mfma_f32_16x16x32_bf16 v[148:151], a[172:175], v[224:227], v[148:151]
v_mfma_f32_16x16x32_bf16 v[152:155], a[144:147], v[132:135], 0
v_mfma_f32_16x16x32_bf16 v[156:159], a[160:163], v[132:135], 0
v_mfma_f32_16x16x32_bf16 v[152:155], a[148:151], v[164:167], v[152:155]
v_mfma_f32_16x16x32_bf16 v[156:159], a[164:167], v[164:167], v[156:159]
v_mfma_f32_16x16x32_bf16 v[152:155], a[152:155], v[196:199], v[152:155]
v_mfma_f32_16x16x32_bf16 v[156:159], a[168:171], v[196:199], v[156:159]
v_mfma_f32_16x16x32_bf16 v[152:155], a[156:159], v[228:231], v[152:155]
v_mfma_f32_16x16x32_bf16 v[156:159], a[172:175], v[228:231], v[156:159]
v_max3_f32 v16, v144, v145, v146
v_max3_f32 v16, v16, v147, v148
v_max3_f32 v16, v16, v149, v150
v_max_f32 v16, v16, v151
s_nop 2
v_max3_f32 v18, v152, v153, v154
v_max3_f32 v18, v18, v155, v156
v_max3_f32 v18, v18, v157, v158
v_max_f32 v18, v18, v159
v_mov_b32 v17, v16
v_mov_b32 v19, v18
s_nop 0
v_permlane16_swap_b32 v16, v17
v_permlane16_swap_b32 v18, v19
v_max_f32 v16, v16, v17
v_max_f32 v18, v18, v19
v_mov_b32 v17, v16
v_mov_b32 v19, v18
s_nop 0
v_permlane32_swap_b32 v16, v17
v_permlane32_swap_b32 v18, v19
v_max_f32 v16, v16, v17
v_max_f32 v18, v18, v19
v_sub_f32 v240, 0, v16
v_sub_f32 v241, 0, v16
v_sub_f32 v242, 0, v16
v_sub_f32 v243, 0, v16
v_sub_f32 v244, 0, v18
v_sub_f32 v245, 0, v18
v_sub_f32 v246, 0, v18
v_sub_f32 v247, 0, v18
buffer_load_dwordx4 v[220:223], v10, s[8:11], s73 offen offset:2048
buffer_load_dwordx4 v[220:223], v10, s[8:11], s73 offen offset:3072
s_add_u32 s73, s14, 4096
buffer_load_dwordx4 v[220:223], v10, s[8:11], s73 offen offset:0
buffer_load_dwordx4 v[220:223], v10, s[8:11], s73 offen offset:1024
buffer_load_dwordx4 v[220:223], v10, s[8:11], s73 offen offset:2048
buffer_load_dwordx4 v[220:223], v10, s[8:11], s73 offen offset:3072
s_add_u32 s73, s14, 8192
buffer_load_dwordx4 v[220:223], v10, s[8:11], s73 offen offset:0
buffer_load_dwordx4 v[220:223], v10, s[8:11], s73 offen offset:1024
v_mfma_f32_16x16x32_bf16 v[144:147], a[144:147], v[136:139], 0
v_mfma_f32_16x16x32_bf16 v[148:151], a[160:163], v[136:139], 0
v_mfma_f32_16x16x32_bf16 v[144:147], a[148:151], v[168:171], v[144:147]
v_mfma_f32_16x16x32_bf16 v[148:151], a[164:167], v[168:171], v[148:151]
v_mfma_f32_16x16x32_bf16 v[144:147], a[152:155], v[200:203], v[144:147]
v_mfma_f32_16x16x32_bf16 v[148:151], a[168:171], v[200:203], v[148:151]
v_mfma_f32_16x16x32_bf16 v[144:147], a[156:159], v[232:235], v[144:147]
v_mfma_f32_16x16x32_bf16 v[148:151], a[172:175], v[232:235], v[148:151]
v_mfma_f32_16x16x32_bf16 v[152:155], a[144:147], v[140:143], 0
v_mfma_f32_16x16x32_bf16 v[156:159], a[160:163], v[140:143], 0
v_mfma_f32_16x16x32_bf16 v[152:155], a[148:151], v[172:175], v[152:155]
v_mfma_f32_16x16x32_bf16 v[156:159], a[164:167], v[172:175], v[156:159]
v_mfma_f32_16x16x32_bf16 v[152:155], a[152:155], v[204:207], v[152:155]
v_mfma_f32_16x16x32_bf16 v[156:159], a[168:171], v[204:207], v[156:159]
v_mfma_f32_16x16x32_bf16 v[152:155], a[156:159], v[236:239], v[152:155]
v_mfma_f32_16x16x32_bf16 v[156:159], a[172:175], v[236:239], v[156:159]
v_max3_f32 v16, v144, v145, v146
v_max3_f32 v16, v16, v147, v148
v_max3_f32 v16, v16, v149, v150
v_max_f32 v16, v16, v151
s_nop 2
v_max3_f32 v18, v152, v153, v154
v_max3_f32 v18, v18, v155, v156
v_max3_f32 v18, v18, v157, v158
v_max_f32 v18, v18, v159
v_mov_b32 v17, v16
v_mov_b32 v19, v18
s_nop 0
v_permlane16_swap_b32 v16, v17
v_permlane16_swap_b32 v18, v19
v_max_f32 v16, v16, v17
v_max_f32 v18, v18, v19
v_mov_b32 v17, v16
v_mov_b32 v19, v18
s_nop 0
v_permlane32_swap_b32 v16, v17
v_permlane32_swap_b32 v18, v19
v_max_f32 v16, v16, v17
v_max_f32 v18, v18, v19
v_sub_f32 v248, 0, v16
v_sub_f32 v249, 0, v16
v_sub_f32 v250, 0, v16
v_sub_f32 v251, 0, v16
v_sub_f32 v252, 0, v18
v_sub_f32 v253, 0, v18
v_sub_f32 v254, 0, v18
v_sub_f32 v255, 0, v18
s_add_u32 s72, s15, 0
buffer_load_dwordx4 v[220:223], v10, s[48:51], s72 offen offset:0
buffer_load_dwordx4 v[220:223], v10, s[48:51], s72 offen offset:1024
buffer_load_dwordx4 v[220:223], v10, s[48:51], s72 offen offset:2048
buffer_load_dwordx4 v[220:223], v10, s[48:51], s72 offen offset:3072
s_add_u32 s72, s15, 4096
buffer_load_dwordx4 v[220:223], v10, s[48:51], s72 offen offset:0
buffer_load_dwordx4 v[220:223], v10, s[48:51], s72 offen offset:1024
buffer_load_dwordx4 v[220:223], v10, s[48:51], s72 offen offset:2048
buffer_load_dwordx4 v[220:223], v10, s[48:51], s72 offen offset:3072
v_mov_b32 v152, 0xff800000
v_mov_b32 v153, 0xff800000
v_mov_b32 v154, 0xff800000
v_mov_b32 v155, 0xff800000
v_mov_b32 v156, 0xff800000
v_mov_b32 v157, 0xff800000
v_mov_b32 v158, 0xff800000
v_mov_b32 v159, 0xff800000
s_mov_b32 s82, 0
s_sub_u32 s85, 15, s66
s_mov_b32 s81, 0
s_cmp_ge_u32 s82, s66
s_cbranch_scc1 L_joint_done
L_joint:
v_mfma_f32_16x16x32_bf16 v[144:147], a[144:147], v[128:131], v[240:243]
v_exp_f32 v152, v152
v_mfma_f32_16x16x32_bf16 v[148:151], a[160:163], v[128:131], v[240:243]
ds_read_b128 a[176:179], v2 offset:8192
v_mfma_f32_16x16x32_bf16 v[144:147], a[148:151], v[160:163], v[144:147]
v_exp_f32 v153, v153
v_mfma_f32_16x16x32_bf16 v[148:151], a[164:167], v[160:163], v[148:151]
ds_read_b128 a[180:183], v2 offset:9216
s_add_u32 m0, s84, 0
v_cvt_pk_bf16_f32 v188, v152, v153
s_waitcnt lgkmcnt(4)
v_mfma_f32_16x16x32_bf16 v[144:147], a[152:155], v[192:195], v[144:147]
v_exp_f32 v154, v154
v_mfma_f32_16x16x32_bf16 v[148:151], a[168:171], v[192:195], v[148:151]
ds_read_b128 a[184:187], v2 offset:10240
buffer_load_dwordx4 v4, s[56:59], s83 offen offset:0 sc1 lds
s_waitcnt lgkmcnt(3)
v_mfma_f32_16x16x32_bf16 v[144:147], a[156:159], v[224:227], v[144:147]
v_exp_f32 v155, v155
v_mfma_f32_16x16x32_bf16 v[148:151], a[172:175], v[224:227], v[148:151]
ds_read_b128 a[188:191], v2 offset:11264
v_cvt_pk_bf16_f32 v189, v154, v155
v_mfma_f32_16x16x32_bf16 a[8:11], a[208:211], v[184:187], a[8:11]
v_exp_f32 v156, v156
v_mfma_f32_16x16x32_bf16 a[24:27], a[212:215], v[184:187], a[24:27]
ds_read_b128 a[192:195], v2 offset:12288
v_mfma_f32_16x16x32_bf16 a[40:43], a[216:219], v[184:187], a[40:43]
v_exp_f32 v157, v157
v_mfma_f32_16x16x32_bf16 a[56:59], a[220:223], v[184:187], a[56:59]
ds_read_b128 a[196:199], v2 offset:13312
v_cvt_pk_bf16_f32 v190, v156, v157
v_mfma_f32_16x16x32_bf16 a[72:75], a[224:227], v[184:187], a[72:75]
v_exp_f32 v158, v158
v_mfma_f32_16x16x32_bf16 a[88:91], a[228:231], v[184:187], a[88:91]
ds_read_b128 a[200:203], v2 offset:14336
v_mfma_f32_16x16x32_bf16 a[104:107], a[232:235], v[184:187], a[104:107]
v_exp_f32 v159, v159
v_mfma_f32_16x16x32_bf16 a[120:123], a[236:239], v[184:187], a[120:123]
ds_read_b128 a[204:207], v2 offset:15360
v_cvt_pk_bf16_f32 v191, v158, v159
v_mfma_f32_16x16x32_bf16 a[136:139], a[240:243], v[184:187], a[136:139]
buffer_load_dwordx4 v4, s[56:59], s83 offen offset:1024 sc1 lds
v_mfma_f32_16x16x32_bf16 v[152:155], a[144:147], v[132:135], v[244:247]
v_exp_f32 v144, v144
v_mfma_f32_16x16x32_bf16 v[156:159], a[160:163], v[132:135], v[244:247]
v_mfma_f32_16x16x32_bf16 v[152:155], a[148:151], v[164:167], v[152:155]
v_exp_f32 v145, v145
v_mfma_f32_16x16x32_bf16 v[156:159], a[164:167], v[164:167], v[156:159]
v_cvt_pk_bf16_f32 v184, v144, v145
v_mfma_f32_16x16x32_bf16 v[152:155], a[152:155], v[196:199], v[152:155]
v_exp_f32 v146, v146
v_mfma_f32_16x16x32_bf16 v[156:159], a[168:171], v[196:199], v[156:159]
buffer_load_dwordx4 v4, s[56:59], s83 offen offset:2048 sc1 lds
v_mfma_f32_16x16x32_bf16 v[152:155], a[156:159], v[228:231], v[152:155]
v_exp_f32 v147, v147
v_mfma_f32_16x16x32_bf16 v[156:159], a[172:175], v[228:231], v[156:159]
v_cvt_pk_bf16_f32 v185, v146, v147
v_mfma_f32_16x16x32_bf16 a[12:15], a[208:211], v[188:191], a[12:15]
v_exp_f32 v148, v148
v_mfma_f32_16x16x32_bf16 a[28:31], a[212:215], v[188:191], a[28:31]
v_mfma_f32_16x16x32_bf16 a[44:47], a[216:219], v[188:191], a[44:47]
v_exp_f32 v149, v149
v_mfma_f32_16x16x32_bf16 a[60:63], a[220:223], v[188:191], a[60:63]
v_cvt_pk_bf16_f32 v186, v148, v149
v_mfma_f32_16x16x32_bf16 a[76:79], a[224:227], v[188:191], a[76:79]
v_exp_f32 v150, v150
v_mfma_f32_16x16x32_bf16 a[92:95], a[228:231], v[188:191], a[92:95]
v_mfma_f32_16x16x32_bf16 a[108:111], a[232:235], v[188:191], a[108:111]
v_exp_f32 v151, v151
v_mfma_f32_16x16x32_bf16 a[124:127], a[236:239], v[188:191], a[124:127]
v_cvt_pk_bf16_f32 v187, v150, v151
v_mfma_f32_16x16x32_bf16 a[140:143], a[240:243], v[188:191], a[140:143]
buffer_load_dwordx4 v4, s[56:59], s83 offen offset:3072 sc1 lds
s_waitcnt lgkmcnt(0)
v_mfma_f32_16x16x32_bf16 v[144:147], a[144:147], v[136:139], v[248:251]
v_exp_f32 v152, v152
v_mfma_f32_16x16x32_bf16 v[148:151], a[160:163], v[136:139], v[248:251]
v_mfma_f32_16x16x32_bf16 v[144:147], a[148:151], v[168:171], v[144:147]
v_exp_f32 v153, v153
v_mfma_f32_16x16x32_bf16 v[148:151], a[164:167], v[168:171], v[148:151]
s_add_u32 m0, s84, 4096
v_cvt_pk_bf16_f32 v188, v152, v153
v_mfma_f32_16x16x32_bf16 v[144:147], a[152:155], v[200:203], v[144:147]
v_exp_f32 v154, v154
v_mfma_f32_16x16x32_bf16 v[148:151], a[168:171], v[200:203], v[148:151]
buffer_load_dwordx4 v5, s[56:59], s83 offen offset:0 sc1 lds
v_mfma_f32_16x16x32_bf16 v[144:147], a[156:159], v[232:235], v[144:147]
v_exp_f32 v155, v155
v_mfma_f32_16x16x32_bf16 v[148:151], a[172:175], v[232:235], v[148:151]
v_cvt_pk_bf16_f32 v189, v154, v155
v_mfma_f32_16x16x32_bf16 a[0:3], a[176:179], v[184:187], a[0:3]
v_exp_f32 v156, v156
v_mfma_f32_16x16x32_bf16 a[16:19], a[180:183], v[184:187], a[16:19]
v_mfma_f32_16x16x32_bf16 a[32:35], a[184:187], v[184:187], a[32:35]
v_exp_f32 v157, v157
v_mfma_f32_16x16x32_bf16 a[48:51], a[188:191], v[184:187], a[48:51]
v_cvt_pk_bf16_f32 v190, v156, v157
v_mfma_f32_16x16x32_bf16 a[64:67], a[192:195], v[184:187], a[64:67]
v_exp_f32 v158, v158
v_mfma_f32_16x16x32_bf16 a[80:83], a[196:199], v[184:187], a[80:83]
v_mfma_f32_16x16x32_bf16 a[96:99], a[200:203], v[184:187], a[96:99]
v_exp_f32 v159, v159
v_mfma_f32_16x16x32_bf16 a[112:115], a[204:207], v[184:187], a[112:115]
v_cvt_pk_bf16_f32 v191, v158, v159
v_mfma_f32_16x16x32_bf16 a[128:131], a[240:243], v[184:187], a[128:131]
buffer_load_dwordx4 v5, s[56:59], s83 offen offset:1024 sc1 lds
v_mfma_f32_16x16x32_bf16 v[152:155], a[144:147], v[140:143], v[252:255]
v_exp_f32 v144, v144
v_mfma_f32_16x16x32_bf16 v[156:159], a[160:163], v[140:143], v[252:255]
ds_read_b128 a[144:147], v2 offset:16384
v_mfma_f32_16x16x32_bf16 v[152:155], a[148:151], v[172:175], v[152:155]
v_exp_f32 v145, v145
v_mfma_f32_16x16x32_bf16 v[156:159], a[164:167], v[172:175], v[156:159]
ds_read_b128 a[160:163], v2 offset:20480
v_cvt_pk_bf16_f32 v184, v144, v145
v_mfma_f32_16x16x32_bf16 v[152:155], a[152:155], v[204:207], v[152:155]
v_exp_f32 v146, v146
v_mfma_f32_16x16x32_bf16 v[156:159], a[168:171], v[204:207], v[156:159]
ds_read_b128 a[148:151], v2 offset:17408
buffer_load_dwordx4 v5, s[56:59], s83 offen offset:2048 sc1 lds
v_mfma_f32_16x16x32_bf16 v[152:155], a[156:159], v[236:239], v[152:155]
v_exp_f32 v147, v147
v_mfma_f32_16x16x32_bf16 v[156:159], a[172:175], v[236:239], v[156:159]
ds_read_b128 a[164:167], v2 offset:21504
v_cvt_pk_bf16_f32 v185, v146, v147
v_mfma_f32_16x16x32_bf16 a[4:7], a[176:179], v[188:191], a[4:7]
v_exp_f32 v148, v148
v_mfma_f32_16x16x32_bf16 a[20:23], a[180:183], v[188:191], a[20:23]
ds_read_b128 a[152:155], v2 offset:18432
v_mfma_f32_16x16x32_bf16 a[36:39], a[184:187], v[188:191], a[36:39]
v_exp_f32 v149, v149
v_mfma_f32_16x16x32_bf16 a[52:55], a[188:191], v[188:191], a[52:55]
ds_read_b128 a[168:171], v2 offset:22528
v_cvt_pk_bf16_f32 v186, v148, v149
v_mfma_f32_16x16x32_bf16 a[68:71], a[192:195], v[188:191], a[68:71]
v_exp_f32 v150, v150
v_mfma_f32_16x16x32_bf16 a[84:87], a[196:199], v[188:191], a[84:87]
ds_read_b128 a[156:159], v2 offset:19456
v_mfma_f32_16x16x32_bf16 a[100:103], a[200:203], v[188:191], a[100:103]
v_exp_f32 v151, v151
v_mfma_f32_16x16x32_bf16 a[116:119], a[204:207], v[188:191], a[116:119]
ds_read_b128 a[172:175], v2 offset:23552
v_cvt_pk_bf16_f32 v187, v150, v151
v_mfma_f32_16x16x32_bf16 a[132:135], a[240:243], v[188:191], a[132:135]
buffer_load_dwordx4 v5, s[56:59], s83 offen offset:3072 sc1 lds
s_waitcnt lgkmcnt(4)
v_mfma_f32_16x16x32_bf16 v[144:147], a[144:147], v[128:131], v[240:243]
v_exp_f32 v152, v152
v_mfma_f32_16x16x32_bf16 v[148:151], a[160:163], v[128:131], v[240:243]
ds_read_b128 a[208:211], v2 offset:24576
v_mfma_f32_16x16x32_bf16 v[144:147], a[148:151], v[160:163], v[144:147]
v_exp_f32 v153, v153
v_mfma_f32_16x16x32_bf16 v[148:151], a[164:167], v[160:163], v[148:151]
ds_read_b128 a[212:215], v2 offset:25600
s_add_u32 m0, s84, 8192
v_cvt_pk_bf16_f32 v188, v152, v153
s_waitcnt lgkmcnt(4)
v_mfma_f32_16x16x32_bf16 v[144:147], a[152:155], v[192:195], v[144:147]
v_exp_f32 v154, v154
v_mfma_f32_16x16x32_bf16 v[148:151], a[168:171], v[192:195], v[148:151]
ds_read_b128 a[216:219], v2 offset:26624
buffer_load_dwordx4 v6, s[56:59], s83 offen offset:0 sc1 lds
s_waitcnt lgkmcnt(3)
v_mfma_f32_16x16x32_bf16 v[144:147], a[156:159], v[224:227], v[144:147]
v_exp_f32 v155, v155
v_mfma_f32_16x16x32_bf16 v[148:151], a[172:175], v[224:227], v[148:151]
ds_read_b128 a[220:223], v2 offset:27648
v_cvt_pk_bf16_f32 v189, v154, v155
v_mfma_f32_16x16x32_bf16 a[8:11], a[176:179], v[184:187], a[8:11]
v_exp_f32 v156, v156
v_mfma_f32_16x16x32_bf16 a[24:27], a[180:183], v[184:187], a[24:27]
ds_read_b128 a[224:227], v2 offset:28672
v_mfma_f32_16x16x32_bf16 a[40:43], a[184:187], v[184:187], a[40:43]
v_exp_f32 v157, v157
v_mfma_f32_16x16x32_bf16 a[56:59], a[188:191], v[184:187], a[56:59]
ds_read_b128 a[228:231], v2 offset:29696
v_cvt_pk_bf16_f32 v190, v156, v157
v_mfma_f32_16x16x32_bf16 a[72:75], a[192:195], v[184:187], a[72:75]
v_exp_f32 v158, v158
v_mfma_f32_16x16x32_bf16 a[88:91], a[196:199], v[184:187], a[88:91]
ds_read_b128 a[232:235], v2 offset:30720
v_mfma_f32_16x16x32_bf16 a[104:107], a[200:203], v[184:187], a[104:107]
v_exp_f32 v159, v159
v_mfma_f32_16x16x32_bf16 a[120:123], a[204:207], v[184:187], a[120:123]
ds_read_b128 a[236:239], v2 offset:31744
v_cvt_pk_bf16_f32 v191, v158, v159
v_mfma_f32_16x16x32_bf16 a[136:139], a[240:243], v[184:187], a[136:139]
buffer_load_dwordx4 v6, s[56:59], s83 offen offset:1024 sc1 lds
v_mfma_f32_16x16x32_bf16 v[152:155], a[144:147], v[132:135], v[244:247]
v_exp_f32 v144, v144
v_mfma_f32_16x16x32_bf16 v[156:159], a[160:163], v[132:135], v[244:247]
v_mfma_f32_16x16x32_bf16 v[152:155], a[148:151], v[164:167], v[152:155]
v_exp_f32 v145, v145
v_mfma_f32_16x16x32_bf16 v[156:159], a[164:167], v[164:167], v[156:159]
v_cvt_pk_bf16_f32 v184, v144, v145
v_mfma_f32_16x16x32_bf16 v[152:155], a[152:155], v[196:199], v[152:155]
v_exp_f32 v146, v146
v_mfma_f32_16x16x32_bf16 v[156:159], a[168:171], v[196:199], v[156:159]
buffer_load_dwordx4 v6, s[56:59], s83 offen offset:2048 sc1 lds
v_mfma_f32_16x16x32_bf16 v[152:155], a[156:159], v[228:231], v[152:155]
v_exp_f32 v147, v147
v_mfma_f32_16x16x32_bf16 v[156:159], a[172:175], v[228:231], v[156:159]
v_cvt_pk_bf16_f32 v185, v146, v147
v_mfma_f32_16x16x32_bf16 a[12:15], a[176:179], v[188:191], a[12:15]
v_exp_f32 v148, v148
v_mfma_f32_16x16x32_bf16 a[28:31], a[180:183], v[188:191], a[28:31]
v_mfma_f32_16x16x32_bf16 a[44:47], a[184:187], v[188:191], a[44:47]
v_exp_f32 v149, v149
v_mfma_f32_16x16x32_bf16 a[60:63], a[188:191], v[188:191], a[60:63]
v_cvt_pk_bf16_f32 v186, v148, v149
v_mfma_f32_16x16x32_bf16 a[76:79], a[192:195], v[188:191], a[76:79]
v_exp_f32 v150, v150
v_mfma_f32_16x16x32_bf16 a[92:95], a[196:199], v[188:191], a[92:95]
v_mfma_f32_16x16x32_bf16 a[108:111], a[200:203], v[188:191], a[108:111]
v_exp_f32 v151, v151
v_mfma_f32_16x16x32_bf16 a[124:127], a[204:207], v[188:191], a[124:127]
v_cvt_pk_bf16_f32 v187, v150, v151
v_mfma_f32_16x16x32_bf16 a[140:143], a[240:243], v[188:191], a[140:143]
buffer_load_dwordx4 v6, s[56:59], s83 offen offset:3072 sc1 lds
s_waitcnt lgkmcnt(0)
v_mfma_f32_16x16x32_bf16 v[144:147], a[144:147], v[136:139], v[248:251]
v_exp_f32 v152, v152
v_mfma_f32_16x16x32_bf16 v[148:151], a[160:163], v[136:139], v[248:251]
v_mfma_f32_16x16x32_bf16 v[144:147], a[148:151], v[168:171], v[144:147]
v_exp_f32 v153, v153
v_mfma_f32_16x16x32_bf16 v[148:151], a[164:167], v[168:171], v[148:151]
v_cvt_pk_bf16_f32 v188, v152, v153
v_mfma_f32_16x16x32_bf16 v[144:147], a[152:155], v[200:203], v[144:147]
v_exp_f32 v154, v154
v_mfma_f32_16x16x32_bf16 v[148:151], a[168:171], v[200:203], v[148:151]
v_mfma_f32_16x16x32_bf16 v[144:147], a[156:159], v[232:235], v[144:147]
v_exp_f32 v155, v155
v_mfma_f32_16x16x32_bf16 v[148:151], a[172:175], v[232:235], v[148:151]
v_cvt_pk_bf16_f32 v189, v154, v155
v_mfma_f32_16x16x32_bf16 a[0:3], a[208:211], v[184:187], a[0:3]
v_exp_f32 v156, v156
v_mfma_f32_16x16x32_bf16 a[16:19], a[212:215], v[184:187], a[16:19]
v_mfma_f32_16x16x32_bf16 a[32:35], a[216:219], v[184:187], a[32:35]
v_exp_f32 v157, v157
v_mfma_f32_16x16x32_bf16 a[48:51], a[220:223], v[184:187], a[48:51]
v_cvt_pk_bf16_f32 v190, v156, v157
v_mfma_f32_16x16x32_bf16 a[64:67], a[224:227], v[184:187], a[64:67]
v_exp_f32 v158, v158
v_mfma_f32_16x16x32_bf16 a[80:83], a[228:231], v[184:187], a[80:83]
v_mfma_f32_16x16x32_bf16 a[96:99], a[232:235], v[184:187], a[96:99]
v_exp_f32 v159, v159
v_mfma_f32_16x16x32_bf16 a[112:115], a[236:239], v[184:187], a[112:115]
s_add_u32 m0, s84, 12288
v_cvt_pk_bf16_f32 v191, v158, v159
v_mfma_f32_16x16x32_bf16 a[128:131], a[240:243], v[184:187], a[128:131]
buffer_load_dwordx4 v7, s[56:59], s83 offen offset:0 sc1 lds
v_mfma_f32_16x16x32_bf16 v[152:155], a[144:147], v[140:143], v[252:255]
v_exp_f32 v144, v144
v_mfma_f32_16x16x32_bf16 v[156:159], a[160:163], v[140:143], v[252:255]
ds_read_b128 a[144:147], v2 offset:32768
v_mfma_f32_16x16x32_bf16 v[152:155], a[148:151], v[172:175], v[152:155]
v_exp_f32 v145, v145
v_mfma_f32_16x16x32_bf16 v[156:159], a[164:167], v[172:175], v[156:159]
ds_read_b128 a[160:163], v2 offset:36864
v_cvt_pk_bf16_f32 v184, v144, v145
v_mfma_f32_16x16x32_bf16 v[152:155], a[152:155], v[204:207], v[152:155]
v_exp_f32 v146, v146
v_mfma_f32_16x16x32_bf16 v[156:159], a[168:171], v[204:207], v[156:159]
ds_read_b128 a[148:151], v2 offset:33792
v_mfma_f32_16x16x32_bf16 v[152:155], a[156:159], v[236:239], v[152:155]
v_exp_f32 v147, v147
v_mfma_f32_16x16x32_bf16 v[156:159], a[172:175], v[236:239], v[156:159]
ds_read_b128 a[164:167], v2 offset:37888
v_cvt_pk_bf16_f32 v185, v146, v147
v_mfma_f32_16x16x32_bf16 a[4:7], a[208:211], v[188:191], a[4:7]
v_exp_f32 v148, v148
v_mfma_f32_16x16x32_bf16 a[20:23], a[212:215], v[188:191], a[20:23]
ds_read_b128 a[152:155], v2 offset:34816
v_mfma_f32_16x16x32_bf16 a[36:39], a[216:219], v[188:191], a[36:39]
v_exp_f32 v149, v149
v_mfma_f32_16x16x32_bf16 a[52:55], a[220:223], v[188:191], a[52:55]
ds_read_b128 a[168:171], v2 offset:38912
v_cvt_pk_bf16_f32 v186, v148, v149
v_mfma_f32_16x16x32_bf16 a[68:71], a[224:227], v[188:191], a[68:71]
v_exp_f32 v150, v150
v_mfma_f32_16x16x32_bf16 a[84:87], a[228:231], v[188:191], a[84:87]
ds_read_b128 a[156:159], v2 offset:35840
v_mfma_f32_16x16x32_bf16 a[100:103], a[232:235], v[188:191], a[100:103]
v_exp_f32 v151, v151
v_mfma_f32_16x16x32_bf16 a[116:119], a[236:239], v[188:191], a[116:119]
ds_read_b128 a[172:175], v2 offset:39936
v_cvt_pk_bf16_f32 v187, v150, v151
v_mfma_f32_16x16x32_bf16 a[132:135], a[240:243], v[188:191], a[132:135]
buffer_load_dwordx4 v7, s[56:59], s83 offen offset:1024 sc1 lds
s_waitcnt lgkmcnt(4)
v_mfma_f32_16x16x32_bf16 v[144:147], a[144:147], v[128:131], v[240:243]
v_exp_f32 v152, v152
v_mfma_f32_16x16x32_bf16 v[148:151], a[160:163], v[128:131], v[240:243]
ds_read_b128 a[176:179], v2 offset:40960
v_mfma_f32_16x16x32_bf16 v[144:147], a[148:151], v[160:163], v[144:147]
v_exp_f32 v153, v153
v_mfma_f32_16x16x32_bf16 v[148:151], a[164:167], v[160:163], v[148:151]
ds_read_b128 a[180:183], v2 offset:41984
v_cvt_pk_bf16_f32 v188, v152, v153
s_waitcnt lgkmcnt(4)
v_mfma_f32_16x16x32_bf16 v[144:147], a[152:155], v[192:195], v[144:147]
v_exp_f32 v154, v154
v_mfma_f32_16x16x32_bf16 v[148:151], a[168:171], v[192:195], v[148:151]
ds_read_b128 a[184:187], v2 offset:43008
s_waitcnt lgkmcnt(3)
v_mfma_f32_16x16x32_bf16 v[144:147], a[156:159], v[224:227], v[144:147]
v_exp_f32 v155, v155
v_mfma_f32_16x16x32_bf16 v[148:151], a[172:175], v[224:227], v[148:151]
ds_read_b128 a[188:191], v2 offset:44032
v_cvt_pk_bf16_f32 v189, v154, v155
v_mfma_f32_16x16x32_bf16 a[8:11], a[208:211], v[184:187], a[8:11]
v_exp_f32 v156, v156
v_mfma_f32_16x16x32_bf16 a[24:27], a[212:215], v[184:187], a[24:27]
ds_read_b128 a[192:195], v2 offset:45056
v_mfma_f32_16x16x32_bf16 a[40:43], a[216:219], v[184:187], a[40:43]
v_exp_f32 v157, v157
v_mfma_f32_16x16x32_bf16 a[56:59], a[220:223], v[184:187], a[56:59]
ds_read_b128 a[196:199], v2 offset:46080
v_cvt_pk_bf16_f32 v190, v156, v157
v_mfma_f32_16x16x32_bf16 a[72:75], a[224:227], v[184:187], a[72:75]
v_exp_f32 v158, v158
v_mfma_f32_16x16x32_bf16 a[88:91], a[228:231], v[184:187], a[88:91]
ds_read_b128 a[200:203], v2 offset:47104
v_mfma_f32_16x16x32_bf16 a[104:107], a[232:235], v[184:187], a[104:107]
v_exp_f32 v159, v159
v_mfma_f32_16x16x32_bf16 a[120:123], a[236:239], v[184:187], a[120:123]
ds_read_b128 a[204:207], v2 offset:48128
v_cvt_pk_bf16_f32 v191, v158, v159
v_mfma_f32_16x16x32_bf16 a[136:139], a[240:243], v[184:187], a[136:139]
buffer_load_dwordx4 v7, s[56:59], s83 offen offset:2048 sc1 lds
v_mfma_f32_16x16x32_bf16 v[152:155], a[144:147], v[132:135], v[244:247]
v_exp_f32 v144, v144
v_mfma_f32_16x16x32_bf16 v[156:159], a[160:163], v[132:135], v[244:247]
v_mfma_f32_16x16x32_bf16 v[152:155], a[148:151], v[164:167], v[152:155]
v_exp_f32 v145, v145
v_mfma_f32_16x16x32_bf16 v[156:159], a[164:167], v[164:167], v[156:159]
v_cvt_pk_bf16_f32 v184, v144, v145
v_mfma_f32_16x16x32_bf16 v[152:155], a[152:155], v[196:199], v[152:155]
v_exp_f32 v146, v146
v_mfma_f32_16x16x32_bf16 v[156:159], a[168:171], v[196:199], v[156:159]
v_mfma_f32_16x16x32_bf16 v[152:155], a[156:159], v[228:231], v[152:155]
v_exp_f32 v147, v147
v_mfma_f32_16x16x32_bf16 v[156:159], a[172:175], v[228:231], v[156:159]
v_cvt_pk_bf16_f32 v185, v146, v147
v_mfma_f32_16x16x32_bf16 a[12:15], a[208:211], v[188:191], a[12:15]
v_exp_f32 v148, v148
v_mfma_f32_16x16x32_bf16 a[28:31], a[212:215], v[188:191], a[28:31]
v_mfma_f32_16x16x32_bf16 a[44:47], a[216:219], v[188:191], a[44:47]
v_exp_f32 v149, v149
v_mfma_f32_16x16x32_bf16 a[60:63], a[220:223], v[188:191], a[60:63]
v_cvt_pk_bf16_f32 v186, v148, v149
v_mfma_f32_16x16x32_bf16 a[76:79], a[224:227], v[188:191], a[76:79]
v_exp_f32 v150, v150
v_mfma_f32_16x16x32_bf16 a[92:95], a[228:231], v[188:191], a[92:95]
v_mfma_f32_16x16x32_bf16 a[108:111], a[232:235], v[188:191], a[108:111]
v_exp_f32 v151, v151
v_mfma_f32_16x16x32_bf16 a[124:127], a[236:239], v[188:191], a[124:127]
v_cvt_pk_bf16_f32 v187, v150, v151
v_mfma_f32_16x16x32_bf16 a[140:143], a[240:243], v[188:191], a[140:143]
buffer_load_dwordx4 v7, s[56:59], s83 offen offset:3072 sc1 lds
s_waitcnt lgkmcnt(0)
v_mfma_f32_16x16x32_bf16 v[144:147], a[144:147], v[136:139], v[248:251]
v_exp_f32 v152, v152
v_mfma_f32_16x16x32_bf16 v[148:151], a[160:163], v[136:139], v[248:251]
v_mfma_f32_16x16x32_bf16 v[144:147], a[148:151], v[168:171], v[144:147]
v_exp_f32 v153, v153
v_mfma_f32_16x16x32_bf16 v[148:151], a[164:167], v[168:171], v[148:151]
v_cvt_pk_bf16_f32 v188, v152, v153
v_mfma_f32_16x16x32_bf16 v[144:147], a[152:155], v[200:203], v[144:147]
v_exp_f32 v154, v154
v_mfma_f32_16x16x32_bf16 v[148:151], a[168:171], v[200:203], v[148:151]
v_mfma_f32_16x16x32_bf16 v[144:147], a[156:159], v[232:235], v[144:147]
v_exp_f32 v155, v155
v_mfma_f32_16x16x32_bf16 v[148:151], a[172:175], v[232:235], v[148:151]
v_cvt_pk_bf16_f32 v189, v154, v155
v_mfma_f32_16x16x32_bf16 a[0:3], a[176:179], v[184:187], a[0:3]
v_exp_f32 v156, v156
v_mfma_f32_16x16x32_bf16 a[16:19], a[180:183], v[184:187], a[16:19]
v_mfma_f32_16x16x32_bf16 a[32:35], a[184:187], v[184:187], a[32:35]
v_exp_f32 v157, v157
v_mfma_f32_16x16x32_bf16 a[48:51], a[188:191], v[184:187], a[48:51]
v_cvt_pk_bf16_f32 v190, v156, v157
v_mfma_f32_16x16x32_bf16 a[64:67], a[192:195], v[184:187], a[64:67]
v_exp_f32 v158, v158
v_mfma_f32_16x16x32_bf16 a[80:83], a[196:199], v[184:187], a[80:83]
v_mfma_f32_16x16x32_bf16 a[96:99], a[200:203], v[184:187], a[96:99]
v_exp_f32 v159, v159
v_mfma_f32_16x16x32_bf16 a[112:115], a[204:207], v[184:187], a[112:115]
v_cvt_pk_bf16_f32 v191, v158, v159
v_mfma_f32_16x16x32_bf16 a[128:131], a[240:243], v[184:187], a[128:131]
v_mfma_f32_16x16x32_bf16 v[152:155], a[144:147], v[140:143], v[252:255]
v_exp_f32 v144, v144
v_mfma_f32_16x16x32_bf16 v[156:159], a[160:163], v[140:143], v[252:255]
ds_read_b128 a[144:147], v2 offset:49152
v_mfma_f32_16x16x32_bf16 v[152:155], a[148:151], v[172:175], v[152:155]
v_exp_f32 v145, v145
v_mfma_f32_16x16x32_bf16 v[156:159], a[164:167], v[172:175], v[156:159]
ds_read_b128 a[160:163], v2 offset:53248
v_cvt_pk_bf16_f32 v184, v144, v145
v_mfma_f32_16x16x32_bf16 v[152:155], a[152:155], v[204:207], v[152:155]
v_exp_f32 v146, v146
v_mfma_f32_16x16x32_bf16 v[156:159], a[168:171], v[204:207], v[156:159]
ds_read_b128 a[148:151], v2 offset:50176
v_mfma_f32_16x16x32_bf16 v[152:155], a[156:159], v[236:239], v[152:155]
v_exp_f32 v147, v147
v_mfma_f32_16x16x32_bf16 v[156:159], a[172:175], v[236:239], v[156:159]
ds_read_b128 a[164:167], v2 offset:54272
v_cvt_pk_bf16_f32 v185, v146, v147
v_mfma_f32_16x16x32_bf16 a[4:7], a[176:179], v[188:191], a[4:7]
v_exp_f32 v148, v148
v_mfma_f32_16x16x32_bf16 a[20:23], a[180:183], v[188:191], a[20:23]
ds_read_b128 a[152:155], v2 offset:51200
v_mfma_f32_16x16x32_bf16 a[36:39], a[184:187], v[188:191], a[36:39]
v_exp_f32 v149, v149
v_mfma_f32_16x16x32_bf16 a[52:55], a[188:191], v[188:191], a[52:55]
ds_read_b128 a[168:171], v2 offset:55296
v_cvt_pk_bf16_f32 v186, v148, v149
v_mfma_f32_16x16x32_bf16 a[68:71], a[192:195], v[188:191], a[68:71]
v_exp_f32 v150, v150
v_mfma_f32_16x16x32_bf16 a[84:87], a[196:199], v[188:191], a[84:87]
ds_read_b128 a[156:159], v2 offset:52224
v_mfma_f32_16x16x32_bf16 a[100:103], a[200:203], v[188:191], a[100:103]
v_exp_f32 v151, v151
v_mfma_f32_16x16x32_bf16 a[116:119], a[204:207], v[188:191], a[116:119]
ds_read_b128 a[172:175], v2 offset:56320
v_cvt_pk_bf16_f32 v187, v150, v151
v_mfma_f32_16x16x32_bf16 a[132:135], a[240:243], v[188:191], a[132:135]
s_waitcnt lgkmcnt(4)
v_mfma_f32_16x16x32_bf16 v[144:147], a[144:147], v[128:131], v[240:243]
v_exp_f32 v152, v152
v_mfma_f32_16x16x32_bf16 v[148:151], a[160:163], v[128:131], v[240:243]
ds_read_b128 a[208:211], v2 offset:57344
v_mfma_f32_16x16x32_bf16 v[144:147], a[148:151], v[160:163], v[144:147]
v_exp_f32 v153, v153
v_mfma_f32_16x16x32_bf16 v[148:151], a[164:167], v[160:163], v[148:151]
ds_read_b128 a[212:215], v2 offset:58368
v_cvt_pk_bf16_f32 v188, v152, v153
s_waitcnt lgkmcnt(4)
v_mfma_f32_16x16x32_bf16 v[144:147], a[152:155], v[192:195], v[144:147]
v_exp_f32 v154, v154
v_mfma_f32_16x16x32_bf16 v[148:151], a[168:171], v[192:195], v[148:151]
ds_read_b128 a[216:219], v2 offset:59392
s_waitcnt lgkmcnt(3)
v_mfma_f32_16x16x32_bf16 v[144:147], a[156:159], v[224:227], v[144:147]
v_exp_f32 v155, v155
v_mfma_f32_16x16x32_bf16 v[148:151], a[172:175], v[224:227], v[148:151]
ds_read_b128 a[220:223], v2 offset:60416
v_cvt_pk_bf16_f32 v189, v154, v155
v_mfma_f32_16x16x32_bf16 a[8:11], a[176:179], v[184:187], a[8:11]
v_exp_f32 v156, v156
v_mfma_f32_16x16x32_bf16 a[24:27], a[180:183], v[184:187], a[24:27]
ds_read_b128 a[224:227], v2 offset:61440
v_mfma_f32_16x16x32_bf16 a[40:43], a[184:187], v[184:187], a[40:43]
v_exp_f32 v157, v157
v_mfma_f32_16x16x32_bf16 a[56:59], a[188:191], v[184:187], a[56:59]
ds_read_b128 a[228:231], v2 offset:62464
v_cvt_pk_bf16_f32 v190, v156, v157
v_mfma_f32_16x16x32_bf16 a[72:75], a[192:195], v[184:187], a[72:75]
v_exp_f32 v158, v158
v_mfma_f32_16x16x32_bf16 a[88:91], a[196:199], v[184:187], a[88:91]
ds_read_b128 a[232:235], v2 offset:63488
v_mfma_f32_16x16x32_bf16 a[104:107], a[200:203], v[184:187], a[104:107]
v_exp_f32 v159, v159
v_mfma_f32_16x16x32_bf16 a[120:123], a[204:207], v[184:187], a[120:123]
ds_read_b128 a[236:239], v2 offset:64512
v_cvt_pk_bf16_f32 v191, v158, v159
v_mfma_f32_16x16x32_bf16 a[136:139], a[240:243], v[184:187], a[136:139]
v_mfma_f32_16x16x32_bf16 v[152:155], a[144:147], v[132:135], v[244:247]
v_exp_f32 v144, v144
v_mfma_f32_16x16x32_bf16 v[156:159], a[160:163], v[132:135], v[244:247]
v_mfma_f32_16x16x32_bf16 v[152:155], a[148:151], v[164:167], v[152:155]
v_exp_f32 v145, v145
v_mfma_f32_16x16x32_bf16 v[156:159], a[164:167], v[164:167], v[156:159]
v_cvt_pk_bf16_f32 v184, v144, v145
v_mfma_f32_16x16x32_bf16 v[152:155], a[152:155], v[196:199], v[152:155]
v_exp_f32 v146, v146
v_mfma_f32_16x16x32_bf16 v[156:159], a[168:171], v[196:199], v[156:159]
v_mfma_f32_16x16x32_bf16 v[152:155], a[156:159], v[228:231], v[152:155]
v_exp_f32 v147, v147
v_mfma_f32_16x16x32_bf16 v[156:159], a[172:175], v[228:231], v[156:159]
v_cvt_pk_bf16_f32 v185, v146, v147
v_mfma_f32_16x16x32_bf16 a[12:15], a[176:179], v[188:191], a[12:15]
v_exp_f32 v148, v148
v_mfma_f32_16x16x32_bf16 a[28:31], a[180:183], v[188:191], a[28:31]
v_mfma_f32_16x16x32_bf16 a[44:47], a[184:187], v[188:191], a[44:47]
v_exp_f32 v149, v149
v_mfma_f32_16x16x32_bf16 a[60:63], a[188:191], v[188:191], a[60:63]
v_cvt_pk_bf16_f32 v186, v148, v149
v_mfma_f32_16x16x32_bf16 a[76:79], a[192:195], v[188:191], a[76:79]
v_exp_f32 v150, v150
v_mfma_f32_16x16x32_bf16 a[92:95], a[196:199], v[188:191], a[92:95]
v_mfma_f32_16x16x32_bf16 a[108:111], a[200:203], v[188:191], a[108:111]
v_exp_f32 v151, v151
v_mfma_f32_16x16x32_bf16 a[124:127], a[204:207], v[188:191], a[124:127]
v_cvt_pk_bf16_f32 v187, v150, v151
v_mfma_f32_16x16x32_bf16 a[140:143], a[240:243], v[188:191], a[140:143]
s_waitcnt lgkmcnt(0)
v_mfma_f32_16x16x32_bf16 v[144:147], a[144:147], v[136:139], v[248:251]
v_exp_f32 v152, v152
v_mfma_f32_16x16x32_bf16 v[148:151], a[160:163], v[136:139], v[248:251]
v_mfma_f32_16x16x32_bf16 v[144:147], a[148:151], v[168:171], v[144:147]
v_exp_f32 v153, v153
v_mfma_f32_16x16x32_bf16 v[148:151], a[164:167], v[168:171], v[148:151]
v_cvt_pk_bf16_f32 v188, v152, v153
v_mfma_f32_16x16x32_bf16 v[144:147], a[152:155], v[200:203], v[144:147]
v_exp_f32 v154, v154
v_mfma_f32_16x16x32_bf16 v[148:151], a[168:171], v[200:203], v[148:151]
v_mfma_f32_16x16x32_bf16 v[144:147], a[156:159], v[232:235], v[144:147]
v_exp_f32 v155, v155
v_mfma_f32_16x16x32_bf16 v[148:151], a[172:175], v[232:235], v[148:151]
v_cvt_pk_bf16_f32 v189, v154, v155
v_mfma_f32_16x16x32_bf16 a[0:3], a[208:211], v[184:187], a[0:3]
v_exp_f32 v156, v156
v_mfma_f32_16x16x32_bf16 a[16:19], a[212:215], v[184:187], a[16:19]
v_mfma_f32_16x16x32_bf16 a[32:35], a[216:219], v[184:187], a[32:35]
v_exp_f32 v157, v157
v_mfma_f32_16x16x32_bf16 a[48:51], a[220:223], v[184:187], a[48:51]
v_cvt_pk_bf16_f32 v190, v156, v157
v_mfma_f32_16x16x32_bf16 a[64:67], a[224:227], v[184:187], a[64:67]
v_exp_f32 v158, v158
v_mfma_f32_16x16x32_bf16 a[80:83], a[228:231], v[184:187], a[80:83]
v_mfma_f32_16x16x32_bf16 a[96:99], a[232:235], v[184:187], a[96:99]
v_exp_f32 v159, v159
v_mfma_f32_16x16x32_bf16 a[112:115], a[236:239], v[184:187], a[112:115]
v_cvt_pk_bf16_f32 v191, v158, v159
v_mfma_f32_16x16x32_bf16 a[128:131], a[240:243], v[184:187], a[128:131]
v_mfma_f32_16x16x32_bf16 v[152:155], a[144:147], v[140:143], v[252:255]
v_exp_f32 v144, v144
v_mfma_f32_16x16x32_bf16 v[156:159], a[160:163], v[140:143], v[252:255]
v_exp_f32 v145, v145
v_mfma_f32_16x16x32_bf16 v[152:155], a[148:151], v[172:175], v[152:155]
v_exp_f32 v146, v146
v_mfma_f32_16x16x32_bf16 v[156:159], a[164:167], v[172:175], v[156:159]
v_exp_f32 v147, v147
v_mfma_f32_16x16x32_bf16 v[152:155], a[152:155], v[204:207], v[152:155]
v_exp_f32 v148, v148
v_mfma_f32_16x16x32_bf16 v[156:159], a[168:171], v[204:207], v[156:159]
s_waitcnt vmcnt(0) lgkmcnt(0)
s_barrier
ds_read_b128 a[144:147], v3 offset:0
v_cvt_pk_bf16_f32 v184, v144, v145
v_mfma_f32_16x16x32_bf16 v[152:155], a[156:159], v[236:239], v[152:155]
v_exp_f32 v149, v149
v_mfma_f32_16x16x32_bf16 v[156:159], a[172:175], v[236:239], v[156:159]
ds_read_b128 a[160:163], v3 offset:4096
v_cvt_pk_bf16_f32 v185, v146, v147
v_mfma_f32_16x16x32_bf16 a[4:7], a[208:211], v[188:191], a[4:7]
v_exp_f32 v150, v150
v_mfma_f32_16x16x32_bf16 a[20:23], a[212:215], v[188:191], a[20:23]
ds_read_b128 a[148:151], v3 offset:1024
v_cvt_pk_bf16_f32 v186, v148, v149
v_mfma_f32_16x16x32_bf16 a[36:39], a[216:219], v[188:191], a[36:39]
v_exp_f32 v151, v151
v_mfma_f32_16x16x32_bf16 a[52:55], a[220:223], v[188:191], a[52:55]
ds_read_b128 a[164:167], v3 offset:5120
v_cvt_pk_bf16_f32 v187, v150, v151
v_mfma_f32_16x16x32_bf16 a[68:71], a[224:227], v[188:191], a[68:71]
ds_read_b128 a[152:155], v3 offset:2048
v_xor_b32 v2, 0x10000, v2
v_mfma_f32_16x16x32_bf16 a[84:87], a[228:231], v[188:191], a[84:87]
ds_read_b128 a[168:171], v3 offset:6144
s_add_u32 s83, s83, 0x10000
s_xor_b32 s84, s84, 0x10000
v_mfma_f32_16x16x32_bf16 a[100:103], a[232:235], v[188:191], a[100:103]
ds_read_b128 a[156:159], v3 offset:3072
s_add_u32 s82, s82, 1
v_mfma_f32_16x16x32_bf16 a[116:119], a[236:239], v[188:191], a[116:119]
ds_read_b128 a[172:175], v3 offset:7168
v_mfma_f32_16x16x32_bf16 a[132:135], a[240:243], v[188:191], a[132:135]
v_xor_b32 v3, 0x10000, v3
s_waitcnt lgkmcnt(4)
s_cmp_lt_u32 s82, s66
s_cbranch_scc1 L_joint
L_joint_done:
s_cmp_lg_u32 s64, 0
s_cbranch_scc1 L_sd_1
v_mfma_f32_16x16x32_bf16 v[144:147], a[144:147], v[128:131], v[240:243]
v_exp_f32 v152, v152
v_mfma_f32_16x16x32_bf16 v[148:151], a[160:163], v[128:131], v[240:243]
ds_read_b128 a[176:179], v2 offset:8192
v_mfma_f32_16x16x32_bf16 v[144:147], a[148:151], v[160:163], v[144:147]
v_exp_f32 v153, v153
v_mfma_f32_16x16x32_bf16 v[148:151], a[164:167], v[160:163], v[148:151]
ds_read_b128 a[180:183], v2 offset:9216
s_add_u32 m0, s84, 0
v_cvt_pk_bf16_f32 v188, v152, v153
s_waitcnt lgkmcnt(4)
v_mfma_f32_16x16x32_bf16 v[144:147], a[152:155], v[192:195], v[144:147]
v_exp_f32 v154, v154
v_mfma_f32_16x16x32_bf16 v[148:151], a[168:171], v[192:195], v[148:151]
ds_read_b128 a[184:187], v2 offset:10240
buffer_load_dwordx4 v4, s[56:59], s83 offen offset:0 sc1 lds
s_waitcnt lgkmcnt(3)
v_mfma_f32_16x16x32_bf16 v[144:147], a[156:159], v[224:227], v[144:147]
v_exp_f32 v155, v155
v_mfma_f32_16x16x32_bf16 v[148:151], a[172:175], v[224:227], v[148:151]
ds_read_b128 a[188:191], v2 offset:11264
v_cvt_pk_bf16_f32 v189, v154, v155
v_mfma_f32_16x16x32_bf16 a[8:11], a[208:211], v[184:187], a[8:11]
v_exp_f32 v156, v156
v_mfma_f32_16x16x32_bf16 a[24:27], a[212:215], v[184:187], a[24:27]
ds_read_b128 a[192:195], v2 offset:12288
v_mfma_f32_16x16x32_bf16 a[40:43], a[216:219], v[184:187], a[40:43]
v_exp_f32 v157, v157
v_mfma_f32_16x16x32_bf16 a[56:59], a[220:223], v[184:187], a[56:59]
ds_read_b128 a[196:199], v2 offset:13312
v_cvt_pk_bf16_f32 v190, v156, v157
v_mfma_f32_16x16x32_bf16 a[72:75], a[224:227], v[184:187], a[72:75]
v_exp_f32 v158, v158
v_mfma_f32_16x16x32_bf16 a[88:91], a[228:231], v[184:187], a[88:91]
ds_read_b128 a[200:203], v2 offset:14336
v_mfma_f32_16x16x32_bf16 a[104:107], a[232:235], v[184:187], a[104:107]
v_exp_f32 v159, v159
v_mfma_f32_16x16x32_bf16 a[120:123], a[236:239], v[184:187], a[120:123]
ds_read_b128 a[204:207], v2 offset:15360
v_cvt_pk_bf16_f32 v191, v158, v159
v_mfma_f32_16x16x32_bf16 a[136:139], a[240:243], v[184:187], a[136:139]
buffer_load_dwordx4 v4, s[56:59], s83 offen offset:1024 sc1 lds
v_add_f32 v216, v244, v212
v_add_f32 v217, v245, v213
v_add_f32 v218, v246, v214
v_add_f32 v219, v247, v215
s_nop 1
v_mfma_f32_16x16x32_bf16 v[152:155], a[144:147], v[132:135], v[216:219]
v_exp_f32 v144, v144
v_mfma_f32_16x16x32_bf16 v[152:155], a[148:151], v[164:167], v[152:155]
buffer_load_dwordx4 v4, s[56:59], s83 offen offset:2048 sc1 lds
v_mfma_f32_16x16x32_bf16 v[152:155], a[152:155], v[196:199], v[152:155]
v_exp_f32 v145, v145
v_mfma_f32_16x16x32_bf16 v[152:155], a[156:159], v[228:231], v[152:155]
v_cvt_pk_bf16_f32 v184, v144, v145
v_mfma_f32_16x16x32_bf16 a[12:15], a[208:211], v[188:191], a[12:15]
v_exp_f32 v146, v146
v_mfma_f32_16x16x32_bf16 a[28:31], a[212:215], v[188:191], a[28:31]
buffer_load_dwordx4 v4, s[56:59], s83 offen offset:3072 sc1 lds
v_mfma_f32_16x16x32_bf16 a[44:47], a[216:219], v[188:191], a[44:47]
v_exp_f32 v147, v147
v_mfma_f32_16x16x32_bf16 a[60:63], a[220:223], v[188:191], a[60:63]
v_cvt_pk_bf16_f32 v185, v146, v147
v_mfma_f32_16x16x32_bf16 a[76:79], a[224:227], v[188:191], a[76:79]
v_exp_f32 v148, v148
v_mfma_f32_16x16x32_bf16 a[92:95], a[228:231], v[188:191], a[92:95]
v_mfma_f32_16x16x32_bf16 a[108:111], a[232:235], v[188:191], a[108:111]
v_exp_f32 v149, v149
v_mfma_f32_16x16x32_bf16 a[124:127], a[236:239], v[188:191], a[124:127]
v_cvt_pk_bf16_f32 v186, v148, v149
v_mfma_f32_16x16x32_bf16 a[140:143], a[240:243], v[188:191], a[140:143]
v_exp_f32 v150, v150
s_waitcnt lgkmcnt(0)
v_exp_f32 v151, v151
s_nop 0
v_cvt_pk_bf16_f32 v187, v150, v151
v_mfma_f32_16x16x32_bf16 v[144:147], a[144:147], v[136:139], v[248:251]
v_exp_f32 v152, v152
v_mfma_f32_16x16x32_bf16 v[148:151], a[160:163], v[136:139], v[248:251]
v_mfma_f32_16x16x32_bf16 v[144:147], a[148:151], v[168:171], v[144:147]
v_exp_f32 v153, v153
v_mfma_f32_16x16x32_bf16 v[148:151], a[164:167], v[168:171], v[148:151]
s_add_u32 m0, s84, 4096
v_cvt_pk_bf16_f32 v188, v152, v153
v_mfma_f32_16x16x32_bf16 v[144:147], a[152:155], v[200:203], v[144:147]
v_exp_f32 v154, v154
v_mfma_f32_16x16x32_bf16 v[148:151], a[168:171], v[200:203], v[148:151]
buffer_load_dwordx4 v5, s[56:59], s83 offen offset:0 sc1 lds
v_mfma_f32_16x16x32_bf16 v[144:147], a[156:159], v[232:235], v[144:147]
v_exp_f32 v155, v155
v_mfma_f32_16x16x32_bf16 v[148:151], a[172:175], v[232:235], v[148:151]
v_cvt_pk_bf16_f32 v189, v154, v155
v_mfma_f32_16x16x32_bf16 a[0:3], a[176:179], v[184:187], a[0:3]
v_mov_b32 v190, 0
v_mfma_f32_16x16x32_bf16 a[16:19], a[180:183], v[184:187], a[16:19]
v_mov_b32 v191, 0
v_mfma_f32_16x16x32_bf16 a[32:35], a[184:187], v[184:187], a[32:35]
v_mfma_f32_16x16x32_bf16 a[48:51], a[188:191], v[184:187], a[48:51]
v_mfma_f32_16x16x32_bf16 a[64:67], a[192:195], v[184:187], a[64:67]
v_mfma_f32_16x16x32_bf16 a[80:83], a[196:199], v[184:187], a[80:83]
v_mfma_f32_16x16x32_bf16 a[96:99], a[200:203], v[184:187], a[96:99]
v_mfma_f32_16x16x32_bf16 a[112:115], a[204:207], v[184:187], a[112:115]
v_mfma_f32_16x16x32_bf16 a[128:131], a[240:243], v[184:187], a[128:131]
buffer_load_dwordx4 v5, s[56:59], s83 offen offset:1024 sc1 lds
v_mfma_f32_16x16x32_bf16 v[152:155], a[144:147], v[140:143], v[252:255]
v_exp_f32 v144, v144
v_mfma_f32_16x16x32_bf16 v[156:159], a[160:163], v[140:143], v[252:255]
ds_read_b128 a[144:147], v2 offset:16384
v_mfma_f32_16x16x32_bf16 v[152:155], a[148:151], v[172:175], v[152:155]
v_exp_f32 v145, v145
v_mfma_f32_16x16x32_bf16 v[156:159], a[164:167], v[172:175], v[156:159]
ds_read_b128 a[160:163], v2 offset:20480
v_cvt_pk_bf16_f32 v184, v144, v145
v_mfma_f32_16x16x32_bf16 v[152:155], a[152:155], v[204:207], v[152:155]
v_exp_f32 v146, v146
v_mfma_f32_16x16x32_bf16 v[156:159], a[168:171], v[204:207], v[156:159]
ds_read_b128 a[148:151], v2 offset:17408
buffer_load_dwordx4 v5, s[56:59], s83 offen offset:2048 sc1 lds
v_mfma_f32_16x16x32_bf16 v[152:155], a[156:159], v[236:239], v[152:155]
v_exp_f32 v147, v147
v_mfma_f32_16x16x32_bf16 v[156:159], a[172:175], v[236:239], v[156:159]
ds_read_b128 a[164:167], v2 offset:21504
v_cvt_pk_bf16_f32 v185, v146, v147
v_mfma_f32_16x16x32_bf16 a[4:7], a[176:179], v[188:191], a[4:7]
v_exp_f32 v148, v148
v_mfma_f32_16x16x32_bf16 a[20:23], a[180:183], v[188:191], a[20:23]
ds_read_b128 a[152:155], v2 offset:18432
v_mfma_f32_16x16x32_bf16 a[36:39], a[184:187], v[188:191], a[36:39]
v_exp_f32 v149, v149
v_mfma_f32_16x16x32_bf16 a[52:55], a[188:191], v[188:191], a[52:55]
ds_read_b128 a[168:171], v2 offset:22528
v_cvt_pk_bf16_f32 v186, v148, v149
v_mfma_f32_16x16x32_bf16 a[68:71], a[192:195], v[188:191], a[68:71]
v_exp_f32 v150, v150
v_mfma_f32_16x16x32_bf16 a[84:87], a[196:199], v[188:191], a[84:87]
ds_read_b128 a[156:159], v2 offset:19456
v_mfma_f32_16x16x32_bf16 a[100:103], a[200:203], v[188:191], a[100:103]
v_exp_f32 v151, v151
v_mfma_f32_16x16x32_bf16 a[116:119], a[204:207], v[188:191], a[116:119]
ds_read_b128 a[172:175], v2 offset:23552
v_cvt_pk_bf16_f32 v187, v150, v151
v_mfma_f32_16x16x32_bf16 a[132:135], a[240:243], v[188:191], a[132:135]
buffer_load_dwordx4 v5, s[56:59], s83 offen offset:3072 sc1 lds
s_waitcnt lgkmcnt(4)
v_mfma_f32_16x16x32_bf16 v[144:147], a[144:147], v[128:131], v[240:243]
v_exp_f32 v152, v152
v_mfma_f32_16x16x32_bf16 v[148:151], a[160:163], v[128:131], v[240:243]
ds_read_b128 a[208:211], v2 offset:24576
v_mfma_f32_16x16x32_bf16 v[144:147], a[148:151], v[160:163], v[144:147]
v_exp_f32 v153, v153
v_mfma_f32_16x16x32_bf16 v[148:151], a[164:167], v[160:163], v[148:151]
ds_read_b128 a[212:215], v2 offset:25600
s_add_u32 m0, s84, 8192
v_cvt_pk_bf16_f32 v188, v152, v153
s_waitcnt lgkmcnt(4)
v_mfma_f32_16x16x32_bf16 v[144:147], a[152:155], v[192:195], v[144:147]
v_exp_f32 v154, v154
v_mfma_f32_16x16x32_bf16 v[148:151], a[168:171], v[192:195], v[148:151]
ds_read_b128 a[216:219], v2 offset:26624
buffer_load_dwordx4 v6, s[56:59], s83 offen offset:0 sc1 lds
s_waitcnt lgkmcnt(3)
v_mfma_f32_16x16x32_bf16 v[144:147], a[156:159], v[224:227], v[144:147]
v_exp_f32 v155, v155
v_mfma_f32_16x16x32_bf16 v[148:151], a[172:175], v[224:227], v[148:151]
ds_read_b128 a[220:223], v2 offset:27648
v_cvt_pk_bf16_f32 v189, v154, v155
v_mfma_f32_16x16x32_bf16 a[8:11], a[176:179], v[184:187], a[8:11]
v_exp_f32 v156, v156
v_mfma_f32_16x16x32_bf16 a[24:27], a[180:183], v[184:187], a[24:27]
ds_read_b128 a[224:227], v2 offset:28672
v_mfma_f32_16x16x32_bf16 a[40:43], a[184:187], v[184:187], a[40:43]
v_exp_f32 v157, v157
v_mfma_f32_16x16x32_bf16 a[56:59], a[188:191], v[184:187], a[56:59]
ds_read_b128 a[228:231], v2 offset:29696
v_cvt_pk_bf16_f32 v190, v156, v157
v_mfma_f32_16x16x32_bf16 a[72:75], a[192:195], v[184:187], a[72:75]
v_exp_f32 v158, v158
v_mfma_f32_16x16x32_bf16 a[88:91], a[196:199], v[184:187], a[88:91]
ds_read_b128 a[232:235], v2 offset:30720
v_mfma_f32_16x16x32_bf16 a[104:107], a[200:203], v[184:187], a[104:107]
v_exp_f32 v159, v159
v_mfma_f32_16x16x32_bf16 a[120:123], a[204:207], v[184:187], a[120:123]
ds_read_b128 a[236:239], v2 offset:31744
v_cvt_pk_bf16_f32 v191, v158, v159
v_mfma_f32_16x16x32_bf16 a[136:139], a[240:243], v[184:187], a[136:139]
buffer_load_dwordx4 v6, s[56:59], s83 offen offset:1024 sc1 lds
v_mfma_f32_16x16x32_bf16 v[152:155], a[144:147], v[136:139], v[248:251]
v_exp_f32 v144, v144
v_mfma_f32_16x16x32_bf16 v[156:159], a[160:163], v[136:139], v[248:251]
v_mfma_f32_16x16x32_bf16 v[152:155], a[148:151], v[168:171], v[152:155]
v_exp_f32 v145, v145
v_mfma_f32_16x16x32_bf16 v[156:159], a[164:167], v[168:171], v[156:159]
v_cvt_pk_bf16_f32 v184, v144, v145
v_mfma_f32_16x16x32_bf16 v[152:155], a[152:155], v[200:203], v[152:155]
v_exp_f32 v146, v146
v_mfma_f32_16x16x32_bf16 v[156:159], a[168:171], v[200:203], v[156:159]
buffer_load_dwordx4 v6, s[56:59], s83 offen offset:2048 sc1 lds
v_mfma_f32_16x16x32_bf16 v[152:155], a[156:159], v[232:235], v[152:155]
v_exp_f32 v147, v147
v_mfma_f32_16x16x32_bf16 v[156:159], a[172:175], v[232:235], v[156:159]
v_cvt_pk_bf16_f32 v185, v146, v147
v_mfma_f32_16x16x32_bf16 a[12:15], a[176:179], v[188:191], a[12:15]
v_exp_f32 v148, v148
v_mfma_f32_16x16x32_bf16 a[28:31], a[180:183], v[188:191], a[28:31]
v_mfma_f32_16x16x32_bf16 a[44:47], a[184:187], v[188:191], a[44:47]
v_exp_f32 v149, v149
v_mfma_f32_16x16x32_bf16 a[60:63], a[188:191], v[188:191], a[60:63]
v_cvt_pk_bf16_f32 v186, v148, v149
v_mfma_f32_16x16x32_bf16 a[76:79], a[192:195], v[188:191], a[76:79]
v_exp_f32 v150, v150
v_mfma_f32_16x16x32_bf16 a[92:95], a[196:199], v[188:191], a[92:95]
v_mfma_f32_16x16x32_bf16 a[108:111], a[200:203], v[188:191], a[108:111]
v_exp_f32 v151, v151
v_mfma_f32_16x16x32_bf16 a[124:127], a[204:207], v[188:191], a[124:127]
v_cvt_pk_bf16_f32 v187, v150, v151
v_mfma_f32_16x16x32_bf16 a[140:143], a[240:243], v[188:191], a[140:143]
buffer_load_dwordx4 v6, s[56:59], s83 offen offset:3072 sc1 lds
s_waitcnt lgkmcnt(0)
v_mfma_f32_16x16x32_bf16 v[144:147], a[144:147], v[140:143], v[252:255]
v_exp_f32 v152, v152
v_mfma_f32_16x16x32_bf16 v[148:151], a[160:163], v[140:143], v[252:255]
ds_read_b128 a[144:147], v2 offset:32768
v_mfma_f32_16x16x32_bf16 v[144:147], a[148:151], v[172:175], v[144:147]
v_exp_f32 v153, v153
v_mfma_f32_16x16x32_bf16 v[148:151], a[164:167], v[172:175], v[148:151]
ds_read_b128 a[160:163], v2 offset:36864
s_add_u32 m0, s84, 12288
v_cvt_pk_bf16_f32 v188, v152, v153
v_mfma_f32_16x16x32_bf16 v[144:147], a[152:155], v[204:207], v[144:147]
v_exp_f32 v154, v154
v_mfma_f32_16x16x32_bf16 v[148:151], a[168:171], v[204:207], v[148:151]
ds_read_b128 a[148:151], v2 offset:33792
buffer_load_dwordx4 v7, s[56:59], s83 offen offset:0 sc1 lds
v_mfma_f32_16x16x32_bf16 v[144:147], a[156:159], v[236:239], v[144:147]
v_exp_f32 v155, v155
v_mfma_f32_16x16x32_bf16 v[148:151], a[172:175], v[236:239], v[148:151]
ds_read_b128 a[164:167], v2 offset:37888
v_cvt_pk_bf16_f32 v189, v154, v155
v_mfma_f32_16x16x32_bf16 a[0:3], a[208:211], v[184:187], a[0:3]
v_exp_f32 v156, v156
v_mfma_f32_16x16x32_bf16 a[16:19], a[212:215], v[184:187], a[16:19]
ds_read_b128 a[152:155], v2 offset:34816
v_mfma_f32_16x16x32_bf16 a[32:35], a[216:219], v[184:187], a[32:35]
v_exp_f32 v157, v157
v_mfma_f32_16x16x32_bf16 a[48:51], a[220:223], v[184:187], a[48:51]
ds_read_b128 a[168:171], v2 offset:38912
v_cvt_pk_bf16_f32 v190, v156, v157
v_mfma_f32_16x16x32_bf16 a[64:67], a[224:227], v[184:187], a[64:67]
v_exp_f32 v158, v158
v_mfma_f32_16x16x32_bf16 a[80:83], a[228:231], v[184:187], a[80:83]
ds_read_b128 a[156:159], v2 offset:35840
v_mfma_f32_16x16x32_bf16 a[96:99], a[232:235], v[184:187], a[96:99]
v_exp_f32 v159, v159
v_mfma_f32_16x16x32_bf16 a[112:115], a[236:239], v[184:187], a[112:115]
ds_read_b128 a[172:175], v2 offset:39936
v_cvt_pk_bf16_f32 v191, v158, v159
v_mfma_f32_16x16x32_bf16 a[128:131], a[240:243], v[184:187], a[128:131]
buffer_load_dwordx4 v7, s[56:59], s83 offen offset:1024 sc1 lds
s_waitcnt lgkmcnt(4)
v_mfma_f32_16x16x32_bf16 v[152:155], a[144:147], v[128:131], v[240:243]
v_exp_f32 v144, v144
v_mfma_f32_16x16x32_bf16 v[156:159], a[160:163], v[128:131], v[240:243]
ds_read_b128 a[176:179], v2 offset:40960
v_mfma_f32_16x16x32_bf16 v[152:155], a[148:151], v[160:163], v[152:155]
v_exp_f32 v145, v145
v_mfma_f32_16x16x32_bf16 v[156:159], a[164:167], v[160:163], v[156:159]
ds_read_b128 a[180:183], v2 offset:41984
v_cvt_pk_bf16_f32 v184, v144, v145
s_waitcnt lgkmcnt(4)
v_mfma_f32_16x16x32_bf16 v[152:155], a[152:155], v[192:195], v[152:155]
v_exp_f32 v146, v146
v_mfma_f32_16x16x32_bf16 v[156:159], a[168:171], v[192:195], v[156:159]
ds_read_b128 a[184:187], v2 offset:43008
buffer_load_dwordx4 v7, s[56:59], s83 offen offset:2048 sc1 lds
s_waitcnt lgkmcnt(3)
v_mfma_f32_16x16x32_bf16 v[152:155], a[156:159], v[224:227], v[152:155]
v_exp_f32 v147, v147
v_mfma_f32_16x16x32_bf16 v[156:159], a[172:175], v[224:227], v[156:159]
ds_read_b128 a[188:191], v2 offset:44032
v_cvt_pk_bf16_f32 v185, v146, v147
v_mfma_f32_16x16x32_bf16 a[8:11], a[208:211], v[188:191], a[8:11]
v_exp_f32 v148, v148
v_mfma_f32_16x16x32_bf16 a[24:27], a[212:215], v[188:191], a[24:27]
ds_read_b128 a[192:195], v2 offset:45056
v_mfma_f32_16x16x32_bf16 a[40:43], a[216:219], v[188:191], a[40:43]
v_exp_f32 v149, v149
v_mfma_f32_16x16x32_bf16 a[56:59], a[220:223], v[188:191], a[56:59]
ds_read_b128 a[196:199], v2 offset:46080
v_cvt_pk_bf16_f32 v186, v148, v149
v_mfma_f32_16x16x32_bf16 a[72:75], a[224:227], v[188:191], a[72:75]
v_exp_f32 v150, v150
v_mfma_f32_16x16x32_bf16 a[88:91], a[228:231], v[188:191], a[88:91]
ds_read_b128 a[200:203], v2 offset:47104
v_mfma_f32_16x16x32_bf16 a[104:107], a[232:235], v[188:191], a[104:107]
v_exp_f32 v151, v151
v_mfma_f32_16x16x32_bf16 a[120:123], a[236:239], v[188:191], a[120:123]
ds_read_b128 a[204:207], v2 offset:48128
v_cvt_pk_bf16_f32 v187, v150, v151
v_mfma_f32_16x16x32_bf16 a[136:139], a[240:243], v[188:191], a[136:139]
buffer_load_dwordx4 v7, s[56:59], s83 offen offset:3072 sc1 lds
v_mfma_f32_16x16x32_bf16 v[144:147], a[144:147], v[136:139], v[248:251]
v_exp_f32 v152, v152
v_mfma_f32_16x16x32_bf16 v[148:151], a[160:163], v[136:139], v[248:251]
v_mfma_f32_16x16x32_bf16 v[144:147], a[148:151], v[168:171], v[144:147]
v_exp_f32 v153, v153
v_mfma_f32_16x16x32_bf16 v[148:151], a[164:167], v[168:171], v[148:151]
v_cvt_pk_bf16_f32 v188, v152, v153
v_mfma_f32_16x16x32_bf16 v[144:147], a[152:155], v[200:203], v[144:147]
v_exp_f32 v154, v154
v_mfma_f32_16x16x32_bf16 v[148:151], a[168:171], v[200:203], v[148:151]
v_mfma_f32_16x16x32_bf16 v[144:147], a[156:159], v[232:235], v[144:147]
v_exp_f32 v155, v155
v_mfma_f32_16x16x32_bf16 v[148:151], a[172:175], v[232:235], v[148:151]
v_cvt_pk_bf16_f32 v189, v154, v155
v_mfma_f32_16x16x32_bf16 a[12:15], a[208:211], v[184:187], a[12:15]
v_exp_f32 v156, v156
v_mfma_f32_16x16x32_bf16 a[28:31], a[212:215], v[184:187], a[28:31]
v_mfma_f32_16x16x32_bf16 a[44:47], a[216:219], v[184:187], a[44:47]
v_exp_f32 v157, v157
v_mfma_f32_16x16x32_bf16 a[60:63], a[220:223], v[184:187], a[60:63]
v_cvt_pk_bf16_f32 v190, v156, v157
v_mfma_f32_16x16x32_bf16 a[76:79], a[224:227], v[184:187], a[76:79]
v_exp_f32 v158, v158
v_mfma_f32_16x16x32_bf16 a[92:95], a[228:231], v[184:187], a[92:95]
v_mfma_f32_16x16x32_bf16 a[108:111], a[232:235], v[184:187], a[108:111]
v_exp_f32 v159, v159
v_mfma_f32_16x16x32_bf16 a[124:127], a[236:239], v[184:187], a[124:127]
v_cvt_pk_bf16_f32 v191, v158, v159
v_mfma_f32_16x16x32_bf16 a[140:143], a[240:243], v[184:187], a[140:143]
s_waitcnt lgkmcnt(0)
v_mfma_f32_16x16x32_bf16 v[152:155], a[144:147], v[140:143], v[252:255]
v_exp_f32 v144, v144
v_mfma_f32_16x16x32_bf16 v[156:159], a[160:163], v[140:143], v[252:255]
ds_read_b128 a[144:147], v2 offset:49152
v_mfma_f32_16x16x32_bf16 v[152:155], a[148:151], v[172:175], v[152:155]
v_exp_f32 v145, v145
v_mfma_f32_16x16x32_bf16 v[156:159], a[164:167], v[172:175], v[156:159]
ds_read_b128 a[160:163], v2 offset:53248
v_cvt_pk_bf16_f32 v184, v144, v145
v_mfma_f32_16x16x32_bf16 v[152:155], a[152:155], v[204:207], v[152:155]
v_exp_f32 v146, v146
v_mfma_f32_16x16x32_bf16 v[156:159], a[168:171], v[204:207], v[156:159]
ds_read_b128 a[148:151], v2 offset:50176
v_mfma_f32_16x16x32_bf16 v[152:155], a[156:159], v[236:239], v[152:155]
v_exp_f32 v147, v147
v_mfma_f32_16x16x32_bf16 v[156:159], a[172:175], v[236:239], v[156:159]
ds_read_b128 a[164:167], v2 offset:54272
v_cvt_pk_bf16_f32 v185, v146, v147
v_mfma_f32_16x16x32_bf16 a[0:3], a[176:179], v[188:191], a[0:3]
v_exp_f32 v148, v148
v_mfma_f32_16x16x32_bf16 a[16:19], a[180:183], v[188:191], a[16:19]
ds_read_b128 a[152:155], v2 offset:51200
v_mfma_f32_16x16x32_bf16 a[32:35], a[184:187], v[188:191], a[32:35]
v_exp_f32 v149, v149
v_mfma_f32_16x16x32_bf16 a[48:51], a[188:191], v[188:191], a[48:51]
ds_read_b128 a[168:171], v2 offset:55296
v_cvt_pk_bf16_f32 v186, v148, v149
v_mfma_f32_16x16x32_bf16 a[64:67], a[192:195], v[188:191], a[64:67]
v_exp_f32 v150, v150
v_mfma_f32_16x16x32_bf16 a[80:83], a[196:199], v[188:191], a[80:83]
ds_read_b128 a[156:159], v2 offset:52224
v_mfma_f32_16x16x32_bf16 a[96:99], a[200:203], v[188:191], a[96:99]
v_exp_f32 v151, v151
v_mfma_f32_16x16x32_bf16 a[112:115], a[204:207], v[188:191], a[112:115]
ds_read_b128 a[172:175], v2 offset:56320
v_cvt_pk_bf16_f32 v187, v150, v151
v_mfma_f32_16x16x32_bf16 a[128:131], a[240:243], v[188:191], a[128:131]
s_waitcnt lgkmcnt(4)
v_add_f32 v216, v240, v212
v_add_f32 v217, v241, v213
v_add_f32 v218, v242, v214
v_add_f32 v219, v243, v215
v_mfma_f32_16x16x32_bf16 v[144:147], a[144:147], v[128:131], v[240:243]
v_exp_f32 v152, v152
v_mfma_f32_16x16x32_bf16 v[148:151], a[160:163], v[128:131], v[216:219]
ds_read_b128 a[208:211], v2 offset:57344
v_mfma_f32_16x16x32_bf16 v[144:147], a[148:151], v[160:163], v[144:147]
v_exp_f32 v153, v153
v_mfma_f32_16x16x32_bf16 v[148:151], a[164:167], v[160:163], v[148:151]
ds_read_b128 a[212:215], v2 offset:58368
v_cvt_pk_bf16_f32 v188, v152, v153
s_waitcnt lgkmcnt(4)
v_mfma_f32_16x16x32_bf16 v[144:147], a[152:155], v[192:195], v[144:147]
v_exp_f32 v154, v154
v_mfma_f32_16x16x32_bf16 v[148:151], a[168:171], v[192:195], v[148:151]
ds_read_b128 a[216:219], v2 offset:59392
s_waitcnt lgkmcnt(3)
v_mfma_f32_16x16x32_bf16 v[144:147], a[156:159], v[224:227], v[144:147]
v_exp_f32 v155, v155
v_mfma_f32_16x16x32_bf16 v[148:151], a[172:175], v[224:227], v[148:151]
ds_read_b128 a[220:223], v2 offset:60416
v_cvt_pk_bf16_f32 v189, v154, v155
v_mfma_f32_16x16x32_bf16 a[8:11], a[176:179], v[184:187], a[8:11]
v_exp_f32 v156, v156
v_mfma_f32_16x16x32_bf16 a[24:27], a[180:183], v[184:187], a[24:27]
ds_read_b128 a[224:227], v2 offset:61440
v_mfma_f32_16x16x32_bf16 a[40:43], a[184:187], v[184:187], a[40:43]
v_exp_f32 v157, v157
v_mfma_f32_16x16x32_bf16 a[56:59], a[188:191], v[184:187], a[56:59]
ds_read_b128 a[228:231], v2 offset:62464
v_cvt_pk_bf16_f32 v190, v156, v157
v_mfma_f32_16x16x32_bf16 a[72:75], a[192:195], v[184:187], a[72:75]
v_exp_f32 v158, v158
v_mfma_f32_16x16x32_bf16 a[88:91], a[196:199], v[184:187], a[88:91]
ds_read_b128 a[232:235], v2 offset:63488
v_mfma_f32_16x16x32_bf16 a[104:107], a[200:203], v[184:187], a[104:107]
v_exp_f32 v159, v159
v_mfma_f32_16x16x32_bf16 a[120:123], a[204:207], v[184:187], a[120:123]
ds_read_b128 a[236:239], v2 offset:64512
v_cvt_pk_bf16_f32 v191, v158, v159
v_mfma_f32_16x16x32_bf16 a[136:139], a[240:243], v[184:187], a[136:139]
v_mfma_f32_16x16x32_bf16 v[176:179], a[144:147], v[136:139], v[248:251]
v_exp_f32 v144, v144
v_mfma_f32_16x16x32_bf16 v[180:183], a[160:163], v[136:139], v[248:251]
v_mfma_f32_16x16x32_bf16 v[176:179], a[148:151], v[168:171], v[176:179]
v_exp_f32 v145, v145
v_mfma_f32_16x16x32_bf16 v[180:183], a[164:167], v[168:171], v[180:183]
v_cvt_pk_bf16_f32 v208, v144, v145
v_mfma_f32_16x16x32_bf16 v[176:179], a[152:155], v[200:203], v[176:179]
v_exp_f32 v146, v146
v_mfma_f32_16x16x32_bf16 v[180:183], a[168:171], v[200:203], v[180:183]
v_mfma_f32_16x16x32_bf16 v[176:179], a[156:159], v[232:235], v[176:179]
v_exp_f32 v147, v147
v_mfma_f32_16x16x32_bf16 v[180:183], a[172:175], v[232:235], v[180:183]
v_cvt_pk_bf16_f32 v209, v146, v147
v_mfma_f32_16x16x32_bf16 a[12:15], a[176:179], v[188:191], a[12:15]
v_exp_f32 v148, v148
v_mfma_f32_16x16x32_bf16 a[28:31], a[180:183], v[188:191], a[28:31]
v_mfma_f32_16x16x32_bf16 a[44:47], a[184:187], v[188:191], a[44:47]
v_exp_f32 v149, v149
v_mfma_f32_16x16x32_bf16 a[60:63], a[188:191], v[188:191], a[60:63]
v_cvt_pk_bf16_f32 v210, v148, v149
v_mfma_f32_16x16x32_bf16 a[76:79], a[192:195], v[188:191], a[76:79]
v_exp_f32 v150, v150
v_mfma_f32_16x16x32_bf16 a[92:95], a[196:199], v[188:191], a[92:95]
v_mfma_f32_16x16x32_bf16 a[108:111], a[200:203], v[188:191], a[108:111]
v_exp_f32 v151, v151
v_mfma_f32_16x16x32_bf16 a[124:127], a[204:207], v[188:191], a[124:127]
v_cvt_pk_bf16_f32 v211, v150, v151
v_mfma_f32_16x16x32_bf16 a[140:143], a[240:243], v[188:191], a[140:143]
s_waitcnt lgkmcnt(0)
v_mfma_f32_16x16x32_bf16 v[152:155], a[144:147], v[140:143], v[252:255]
v_exp_f32 v176, v176
v_mfma_f32_16x16x32_bf16 v[156:159], a[160:163], v[140:143], v[252:255]
v_exp_f32 v177, v177
v_mfma_f32_16x16x32_bf16 v[152:155], a[148:151], v[172:175], v[152:155]
v_exp_f32 v178, v178
v_mfma_f32_16x16x32_bf16 v[156:159], a[164:167], v[172:175], v[156:159]
v_exp_f32 v179, v179
v_mfma_f32_16x16x32_bf16 v[152:155], a[152:155], v[204:207], v[152:155]
v_exp_f32 v180, v180
v_mfma_f32_16x16x32_bf16 v[156:159], a[168:171], v[204:207], v[156:159]
s_waitcnt vmcnt(0) lgkmcnt(0)
s_barrier
ds_read_b128 a[144:147], v3 offset:0
v_cvt_pk_bf16_f32 v184, v176, v177
v_mfma_f32_16x16x32_bf16 v[152:155], a[156:159], v[236:239], v[152:155]
v_exp_f32 v181, v181
v_mfma_f32_16x16x32_bf16 v[156:159], a[172:175], v[236:239], v[156:159]
ds_read_b128 a[160:163], v3 offset:4096
v_cvt_pk_bf16_f32 v185, v178, v179
v_mfma_f32_16x16x32_bf16 a[0:3], a[208:211], v[208:211], a[0:3]
v_exp_f32 v182, v182
v_mfma_f32_16x16x32_bf16 a[16:19], a[212:215], v[208:211], a[16:19]
ds_read_b128 a[148:151], v3 offset:1024
v_cvt_pk_bf16_f32 v186, v180, v181
v_mfma_f32_16x16x32_bf16 a[32:35], a[216:219], v[208:211], a[32:35]
v_exp_f32 v183, v183
v_mfma_f32_16x16x32_bf16 a[48:51], a[220:223], v[208:211], a[48:51]
ds_read_b128 a[164:167], v3 offset:5120
v_cvt_pk_bf16_f32 v187, v182, v183
v_mfma_f32_16x16x32_bf16 a[64:67], a[224:227], v[208:211], a[64:67]
ds_read_b128 a[152:155], v3 offset:2048
v_xor_b32 v2, 0x10000, v2
v_mfma_f32_16x16x32_bf16 a[80:83], a[228:231], v[208:211], a[80:83]
ds_read_b128 a[168:171], v3 offset:6144
s_add_u32 s83, s83, 0x10000
s_xor_b32 s84, s84, 0x10000
v_mfma_f32_16x16x32_bf16 a[96:99], a[232:235], v[208:211], a[96:99]
ds_read_b128 a[156:159], v3 offset:3072
s_add_u32 s82, s82, 1
v_mfma_f32_16x16x32_bf16 a[112:115], a[236:239], v[208:211], a[112:115]
ds_read_b128 a[172:175], v3 offset:7168
v_mfma_f32_16x16x32_bf16 a[128:131], a[240:243], v[208:211], a[128:131]
v_xor_b32 v3, 0x10000, v3
s_waitcnt lgkmcnt(4)
s_branch L_sd_done
L_sd_1:
s_cmp_lg_u32 s64, 1
s_cbranch_scc1 L_sd_2
v_mfma_f32_16x16x32_bf16 v[144:147], a[144:147], v[128:131], v[240:243]
v_exp_f32 v152, v152
v_mfma_f32_16x16x32_bf16 v[148:151], a[160:163], v[128:131], v[240:243]
ds_read_b128 a[176:179], v2 offset:8192
v_mfma_f32_16x16x32_bf16 v[144:147], a[148:151], v[160:163], v[144:147]
v_exp_f32 v153, v153
v_mfma_f32_16x16x32_bf16 v[148:151], a[164:167], v[160:163], v[148:151]
ds_read_b128 a[180:183], v2 offset:9216
s_add_u32 m0, s84, 0
v_cvt_pk_bf16_f32 v188, v152, v153
s_waitcnt lgkmcnt(4)
v_mfma_f32_16x16x32_bf16 v[144:147], a[152:155], v[192:195], v[144:147]
v_exp_f32 v154, v154
v_mfma_f32_16x16x32_bf16 v[148:151], a[168:171], v[192:195], v[148:151]
ds_read_b128 a[184:187], v2 offset:10240
buffer_load_dwordx4 v4, s[56:59], s83 offen offset:0 sc1 lds
s_waitcnt lgkmcnt(3)
v_mfma_f32_16x16x32_bf16 v[144:147], a[156:159], v[224:227], v[144:147]
v_exp_f32 v155, v155
v_mfma_f32_16x16x32_bf16 v[148:151], a[172:175], v[224:227], v[148:151]
ds_read_b128 a[188:191], v2 offset:11264
v_cvt_pk_bf16_f32 v189, v154, v155
v_mfma_f32_16x16x32_bf16 a[8:11], a[208:211], v[184:187], a[8:11]
v_exp_f32 v156, v156
v_mfma_f32_16x16x32_bf16 a[24:27], a[212:215], v[184:187], a[24:27]
ds_read_b128 a[192:195], v2 offset:12288
v_mfma_f32_16x16x32_bf16 a[40:43], a[216:219], v[184:187], a[40:43]
v_exp_f32 v157, v157
v_mfma_f32_16x16x32_bf16 a[56:59], a[220:223], v[184:187], a[56:59]
ds_read_b128 a[196:199], v2 offset:13312
v_cvt_pk_bf16_f32 v190, v156, v157
v_mfma_f32_16x16x32_bf16 a[72:75], a[224:227], v[184:187], a[72:75]
v_exp_f32 v158, v158
v_mfma_f32_16x16x32_bf16 a[88:91], a[228:231], v[184:187], a[88:91]
ds_read_b128 a[200:203], v2 offset:14336
v_mfma_f32_16x16x32_bf16 a[104:107], a[232:235], v[184:187], a[104:107]
v_exp_f32 v159, v159
v_mfma_f32_16x16x32_bf16 a[120:123], a[236:239], v[184:187], a[120:123]
ds_read_b128 a[204:207], v2 offset:15360
v_cvt_pk_bf16_f32 v191, v158, v159
v_mfma_f32_16x16x32_bf16 a[136:139], a[240:243], v[184:187], a[136:139]
buffer_load_dwordx4 v4, s[56:59], s83 offen offset:1024 sc1 lds
v_add_f32 v216, v244, v212
v_add_f32 v217, v245, v213
v_add_f32 v218, v246, v214
v_add_f32 v219, v247, v215
v_mfma_f32_16x16x32_bf16 v[152:155], a[144:147], v[132:135], v[244:247]
v_exp_f32 v144, v144
v_mfma_f32_16x16x32_bf16 v[156:159], a[160:163], v[132:135], v[216:219]
v_mfma_f32_16x16x32_bf16 v[152:155], a[148:151], v[164:167], v[152:155]
v_exp_f32 v145, v145
v_mfma_f32_16x16x32_bf16 v[156:159], a[164:167], v[164:167], v[156:159]
v_cvt_pk_bf16_f32 v184, v144, v145
v_mfma_f32_16x16x32_bf16 v[152:155], a[152:155], v[196:199], v[152:155]
v_exp_f32 v146, v146
v_mfma_f32_16x16x32_bf16 v[156:159], a[168:171], v[196:199], v[156:159]
buffer_load_dwordx4 v4, s[56:59], s83 offen offset:2048 sc1 lds
v_mfma_f32_16x16x32_bf16 v[152:155], a[156:159], v[228:231], v[152:155]
v_exp_f32 v147, v147
v_mfma_f32_16x16x32_bf16 v[156:159], a[172:175], v[228:231], v[156:159]
v_cvt_pk_bf16_f32 v185, v146, v147
v_mfma_f32_16x16x32_bf16 a[12:15], a[208:211], v[188:191], a[12:15]
v_exp_f32 v148, v148
v_mfma_f32_16x16x32_bf16 a[28:31], a[212:215], v[188:191], a[28:31]
v_mfma_f32_16x16x32_bf16 a[44:47], a[216:219], v[188:191], a[44:47]
v_exp_f32 v149, v149
v_mfma_f32_16x16x32_bf16 a[60:63], a[220:223], v[188:191], a[60:63]
v_cvt_pk_bf16_f32 v186, v148, v149
v_mfma_f32_16x16x32_bf16 a[76:79], a[224:227], v[188:191], a[76:79]
v_exp_f32 v150, v150
v_mfma_f32_16x16x32_bf16 a[92:95], a[228:231], v[188:191], a[92:95]
v_mfma_f32_16x16x32_bf16 a[108:111], a[232:235], v[188:191], a[108:111]
v_exp_f32 v151, v151
v_mfma_f32_16x16x32_bf16 a[124:127], a[236:239], v[188:191], a[124:127]
v_cvt_pk_bf16_f32 v187, v150, v151
v_mfma_f32_16x16x32_bf16 a[140:143], a[240:243], v[188:191], a[140:143]
buffer_load_dwordx4 v4, s[56:59], s83 offen offset:3072 sc1 lds
s_waitcnt lgkmcnt(0)
v_mfma_f32_16x16x32_bf16 v[144:147], a[144:147], v[136:139], v[248:251]
v_exp_f32 v152, v152
v_mfma_f32_16x16x32_bf16 v[148:151], a[160:163], v[136:139], v[248:251]
v_mfma_f32_16x16x32_bf16 v[144:147], a[148:151], v[168:171], v[144:147]
v_exp_f32 v153, v153
v_mfma_f32_16x16x32_bf16 v[148:151], a[164:167], v[168:171], v[148:151]
s_add_u32 m0, s84, 4096
v_cvt_pk_bf16_f32 v188, v152, v153
v_mfma_f32_16x16x32_bf16 v[144:147], a[152:155], v[200:203], v[144:147]
v_exp_f32 v154, v154
v_mfma_f32_16x16x32_bf16 v[148:151], a[168:171], v[200:203], v[148:151]
buffer_load_dwordx4 v5, s[56:59], s83 offen offset:0 sc1 lds
v_mfma_f32_16x16x32_bf16 v[144:147], a[156:159], v[232:235], v[144:147]
v_exp_f32 v155, v155
v_mfma_f32_16x16x32_bf16 v[148:151], a[172:175], v[232:235], v[148:151]
v_cvt_pk_bf16_f32 v189, v154, v155
v_mfma_f32_16x16x32_bf16 a[0:3], a[176:179], v[184:187], a[0:3]
v_exp_f32 v156, v156
v_mfma_f32_16x16x32_bf16 a[16:19], a[180:183], v[184:187], a[16:19]
v_mfma_f32_16x16x32_bf16 a[32:35], a[184:187], v[184:187], a[32:35]
v_exp_f32 v157, v157
v_mfma_f32_16x16x32_bf16 a[48:51], a[188:191], v[184:187], a[48:51]
v_cvt_pk_bf16_f32 v190, v156, v157
v_mfma_f32_16x16x32_bf16 a[64:67], a[192:195], v[184:187], a[64:67]
v_exp_f32 v158, v158
v_mfma_f32_16x16x32_bf16 a[80:83], a[196:199], v[184:187], a[80:83]
v_mfma_f32_16x16x32_bf16 a[96:99], a[200:203], v[184:187], a[96:99]
v_exp_f32 v159, v159
v_mfma_f32_16x16x32_bf16 a[112:115], a[204:207], v[184:187], a[112:115]
v_cvt_pk_bf16_f32 v191, v158, v159
v_mfma_f32_16x16x32_bf16 a[128:131], a[240:243], v[184:187], a[128:131]
buffer_load_dwordx4 v5, s[56:59], s83 offen offset:1024 sc1 lds
v_mfma_f32_16x16x32_bf16 v[152:155], a[144:147], v[140:143], v[252:255]
v_exp_f32 v144, v144
v_mfma_f32_16x16x32_bf16 v[156:159], a[160:163], v[140:143], v[252:255]
ds_read_b128 a[144:147], v2 offset:16384
v_mfma_f32_16x16x32_bf16 v[152:155], a[148:151], v[172:175], v[152:155]
v_exp_f32 v145, v145
v_mfma_f32_16x16x32_bf16 v[156:159], a[164:167], v[172:175], v[156:159]
ds_read_b128 a[160:163], v2 offset:20480
v_cvt_pk_bf16_f32 v184, v144, v145
v_mfma_f32_16x16x32_bf16 v[152:155], a[152:155], v[204:207], v[152:155]
v_exp_f32 v146, v146
v_mfma_f32_16x16x32_bf16 v[156:159], a[168:171], v[204:207], v[156:159]
ds_read_b128 a[148:151], v2 offset:17408
buffer_load_dwordx4 v5, s[56:59], s83 offen offset:2048 sc1 lds
v_mfma_f32_16x16x32_bf16 v[152:155], a[156:159], v[236:239], v[152:155]
v_exp_f32 v147, v147
v_mfma_f32_16x16x32_bf16 v[156:159], a[172:175], v[236:239], v[156:159]
ds_read_b128 a[164:167], v2 offset:21504
v_cvt_pk_bf16_f32 v185, v146, v147
v_mfma_f32_16x16x32_bf16 a[4:7], a[176:179], v[188:191], a[4:7]
v_exp_f32 v148, v148
v_mfma_f32_16x16x32_bf16 a[20:23], a[180:183], v[188:191], a[20:23]
ds_read_b128 a[152:155], v2 offset:18432
v_mfma_f32_16x16x32_bf16 a[36:39], a[184:187], v[188:191], a[36:39]
v_exp_f32 v149, v149
v_mfma_f32_16x16x32_bf16 a[52:55], a[188:191], v[188:191], a[52:55]
ds_read_b128 a[168:171], v2 offset:22528
v_cvt_pk_bf16_f32 v186, v148, v149
v_mfma_f32_16x16x32_bf16 a[68:71], a[192:195], v[188:191], a[68:71]
v_exp_f32 v150, v150
v_mfma_f32_16x16x32_bf16 a[84:87], a[196:199], v[188:191], a[84:87]
ds_read_b128 a[156:159], v2 offset:19456
v_mfma_f32_16x16x32_bf16 a[100:103], a[200:203], v[188:191], a[100:103]
v_exp_f32 v151, v151
v_mfma_f32_16x16x32_bf16 a[116:119], a[204:207], v[188:191], a[116:119]
ds_read_b128 a[172:175], v2 offset:23552
v_cvt_pk_bf16_f32 v187, v150, v151
v_mfma_f32_16x16x32_bf16 a[132:135], a[240:243], v[188:191], a[132:135]
buffer_load_dwordx4 v5, s[56:59], s83 offen offset:3072 sc1 lds
s_waitcnt lgkmcnt(4)
v_mfma_f32_16x16x32_bf16 v[144:147], a[144:147], v[128:131], v[240:243]
v_exp_f32 v152, v152
v_mfma_f32_16x16x32_bf16 v[148:151], a[160:163], v[128:131], v[240:243]
ds_read_b128 a[208:211], v2 offset:24576
v_mfma_f32_16x16x32_bf16 v[144:147], a[148:151], v[160:163], v[144:147]
v_exp_f32 v153, v153
v_mfma_f32_16x16x32_bf16 v[148:151], a[164:167], v[160:163], v[148:151]
ds_read_b128 a[212:215], v2 offset:25600
s_add_u32 m0, s84, 8192
v_cvt_pk_bf16_f32 v188, v152, v153
s_waitcnt lgkmcnt(4)
v_mfma_f32_16x16x32_bf16 v[144:147], a[152:155], v[192:195], v[144:147]
v_exp_f32 v154, v154
v_mfma_f32_16x16x32_bf16 v[148:151], a[168:171], v[192:195], v[148:151]
ds_read_b128 a[216:219], v2 offset:26624
buffer_load_dwordx4 v6, s[56:59], s83 offen offset:0 sc1 lds
s_waitcnt lgkmcnt(3)
v_mfma_f32_16x16x32_bf16 v[144:147], a[156:159], v[224:227], v[144:147]
v_exp_f32 v155, v155
v_mfma_f32_16x16x32_bf16 v[148:151], a[172:175], v[224:227], v[148:151]
ds_read_b128 a[220:223], v2 offset:27648
v_cvt_pk_bf16_f32 v189, v154, v155
v_mfma_f32_16x16x32_bf16 a[8:11], a[176:179], v[184:187], a[8:11]
v_exp_f32 v156, v156
v_mfma_f32_16x16x32_bf16 a[24:27], a[180:183], v[184:187], a[24:27]
ds_read_b128 a[224:227], v2 offset:28672
v_mfma_f32_16x16x32_bf16 a[40:43], a[184:187], v[184:187], a[40:43]
v_exp_f32 v157, v157
v_mfma_f32_16x16x32_bf16 a[56:59], a[188:191], v[184:187], a[56:59]
ds_read_b128 a[228:231], v2 offset:29696
v_cvt_pk_bf16_f32 v190, v156, v157
v_mfma_f32_16x16x32_bf16 a[72:75], a[192:195], v[184:187], a[72:75]
v_exp_f32 v158, v158
v_mfma_f32_16x16x32_bf16 a[88:91], a[196:199], v[184:187], a[88:91]
ds_read_b128 a[232:235], v2 offset:30720
v_mfma_f32_16x16x32_bf16 a[104:107], a[200:203], v[184:187], a[104:107]
v_exp_f32 v159, v159
v_mfma_f32_16x16x32_bf16 a[120:123], a[204:207], v[184:187], a[120:123]
ds_read_b128 a[236:239], v2 offset:31744
v_cvt_pk_bf16_f32 v191, v158, v159
v_mfma_f32_16x16x32_bf16 a[136:139], a[240:243], v[184:187], a[136:139]
buffer_load_dwordx4 v6, s[56:59], s83 offen offset:1024 sc1 lds
v_mfma_f32_16x16x32_bf16 v[152:155], a[144:147], v[136:139], v[248:251]
v_exp_f32 v144, v144
v_mfma_f32_16x16x32_bf16 v[156:159], a[160:163], v[136:139], v[248:251]
v_mfma_f32_16x16x32_bf16 v[152:155], a[148:151], v[168:171], v[152:155]
v_exp_f32 v145, v145
v_mfma_f32_16x16x32_bf16 v[156:159], a[164:167], v[168:171], v[156:159]
v_cvt_pk_bf16_f32 v184, v144, v145
v_mfma_f32_16x16x32_bf16 v[152:155], a[152:155], v[200:203], v[152:155]
v_exp_f32 v146, v146
v_mfma_f32_16x16x32_bf16 v[156:159], a[168:171], v[200:203], v[156:159]
buffer_load_dwordx4 v6, s[56:59], s83 offen offset:2048 sc1 lds
v_mfma_f32_16x16x32_bf16 v[152:155], a[156:159], v[232:235], v[152:155]
v_exp_f32 v147, v147
v_mfma_f32_16x16x32_bf16 v[156:159], a[172:175], v[232:235], v[156:159]
v_cvt_pk_bf16_f32 v185, v146, v147
v_mfma_f32_16x16x32_bf16 a[12:15], a[176:179], v[188:191], a[12:15]
v_exp_f32 v148, v148
v_mfma_f32_16x16x32_bf16 a[28:31], a[180:183], v[188:191], a[28:31]
v_mfma_f32_16x16x32_bf16 a[44:47], a[184:187], v[188:191], a[44:47]
v_exp_f32 v149, v149
v_mfma_f32_16x16x32_bf16 a[60:63], a[188:191], v[188:191], a[60:63]
v_cvt_pk_bf16_f32 v186, v148, v149
v_mfma_f32_16x16x32_bf16 a[76:79], a[192:195], v[188:191], a[76:79]
v_exp_f32 v150, v150
v_mfma_f32_16x16x32_bf16 a[92:95], a[196:199], v[188:191], a[92:95]
v_mfma_f32_16x16x32_bf16 a[108:111], a[200:203], v[188:191], a[108:111]
v_exp_f32 v151, v151
v_mfma_f32_16x16x32_bf16 a[124:127], a[204:207], v[188:191], a[124:127]
v_cvt_pk_bf16_f32 v187, v150, v151
v_mfma_f32_16x16x32_bf16 a[140:143], a[240:243], v[188:191], a[140:143]
buffer_load_dwordx4 v6, s[56:59], s83 offen offset:3072 sc1 lds
s_waitcnt lgkmcnt(0)
v_mfma_f32_16x16x32_bf16 v[144:147], a[144:147], v[140:143], v[252:255]
v_exp_f32 v152, v152
v_mfma_f32_16x16x32_bf16 v[148:151], a[160:163], v[140:143], v[252:255]
ds_read_b128 a[144:147], v2 offset:32768
v_mfma_f32_16x16x32_bf16 v[144:147], a[148:151], v[172:175], v[144:147]
v_exp_f32 v153, v153
v_mfma_f32_16x16x32_bf16 v[148:151], a[164:167], v[172:175], v[148:151]
ds_read_b128 a[160:163], v2 offset:36864
s_add_u32 m0, s84, 12288
v_cvt_pk_bf16_f32 v188, v152, v153
v_mfma_f32_16x16x32_bf16 v[144:147], a[152:155], v[204:207], v[144:147]
v_exp_f32 v154, v154
v_mfma_f32_16x16x32_bf16 v[148:151], a[168:171], v[204:207], v[148:151]
ds_read_b128 a[148:151], v2 offset:33792
buffer_load_dwordx4 v7, s[56:59], s83 offen offset:0 sc1 lds
v_mfma_f32_16x16x32_bf16 v[144:147], a[156:159], v[236:239], v[144:147]
v_exp_f32 v155, v155
v_mfma_f32_16x16x32_bf16 v[148:151], a[172:175], v[236:239], v[148:151]
ds_read_b128 a[164:167], v2 offset:37888
v_cvt_pk_bf16_f32 v189, v154, v155
v_mfma_f32_16x16x32_bf16 a[0:3], a[208:211], v[184:187], a[0:3]
v_exp_f32 v156, v156
v_mfma_f32_16x16x32_bf16 a[16:19], a[212:215], v[184:187], a[16:19]
ds_read_b128 a[152:155], v2 offset:34816
v_mfma_f32_16x16x32_bf16 a[32:35], a[216:219], v[184:187], a[32:35]
v_exp_f32 v157, v157
v_mfma_f32_16x16x32_bf16 a[48:51], a[220:223], v[184:187], a[48:51]
ds_read_b128 a[168:171], v2 offset:38912
v_cvt_pk_bf16_f32 v190, v156, v157
v_mfma_f32_16x16x32_bf16 a[64:67], a[224:227], v[184:187], a[64:67]
v_exp_f32 v158, v158
v_mfma_f32_16x16x32_bf16 a[80:83], a[228:231], v[184:187], a[80:83]
ds_read_b128 a[156:159], v2 offset:35840
v_mfma_f32_16x16x32_bf16 a[96:99], a[232:235], v[184:187], a[96:99]
v_exp_f32 v159, v159
v_mfma_f32_16x16x32_bf16 a[112:115], a[236:239], v[184:187], a[112:115]
ds_read_b128 a[172:175], v2 offset:39936
v_cvt_pk_bf16_f32 v191, v158, v159
v_mfma_f32_16x16x32_bf16 a[128:131], a[240:243], v[184:187], a[128:131]
buffer_load_dwordx4 v7, s[56:59], s83 offen offset:1024 sc1 lds
s_waitcnt lgkmcnt(4)
v_mfma_f32_16x16x32_bf16 v[152:155], a[144:147], v[128:131], v[240:243]
v_exp_f32 v144, v144
v_mfma_f32_16x16x32_bf16 v[156:159], a[160:163], v[128:131], v[240:243]
ds_read_b128 a[176:179], v2 offset:40960
v_mfma_f32_16x16x32_bf16 v[152:155], a[148:151], v[160:163], v[152:155]
v_exp_f32 v145, v145
v_mfma_f32_16x16x32_bf16 v[156:159], a[164:167], v[160:163], v[156:159]
ds_read_b128 a[180:183], v2 offset:41984
v_cvt_pk_bf16_f32 v184, v144, v145
s_waitcnt lgkmcnt(4)
v_mfma_f32_16x16x32_bf16 v[152:155], a[152:155], v[192:195], v[152:155]
v_exp_f32 v146, v146
v_mfma_f32_16x16x32_bf16 v[156:159], a[168:171], v[192:195], v[156:159]
ds_read_b128 a[184:187], v2 offset:43008
buffer_load_dwordx4 v7, s[56:59], s83 offen offset:2048 sc1 lds
s_waitcnt lgkmcnt(3)
v_mfma_f32_16x16x32_bf16 v[152:155], a[156:159], v[224:227], v[152:155]
v_exp_f32 v147, v147
v_mfma_f32_16x16x32_bf16 v[156:159], a[172:175], v[224:227], v[156:159]
ds_read_b128 a[188:191], v2 offset:44032
v_cvt_pk_bf16_f32 v185, v146, v147
v_mfma_f32_16x16x32_bf16 a[8:11], a[208:211], v[188:191], a[8:11]
v_exp_f32 v148, v148
v_mfma_f32_16x16x32_bf16 a[24:27], a[212:215], v[188:191], a[24:27]
ds_read_b128 a[192:195], v2 offset:45056
v_mfma_f32_16x16x32_bf16 a[40:43], a[216:219], v[188:191], a[40:43]
v_exp_f32 v149, v149
v_mfma_f32_16x16x32_bf16 a[56:59], a[220:223], v[188:191], a[56:59]
ds_read_b128 a[196:199], v2 offset:46080
v_cvt_pk_bf16_f32 v186, v148, v149
v_mfma_f32_16x16x32_bf16 a[72:75], a[224:227], v[188:191], a[72:75]
v_exp_f32 v150, v150
v_mfma_f32_16x16x32_bf16 a[88:91], a[228:231], v[188:191], a[88:91]
ds_read_b128 a[200:203], v2 offset:47104
v_mfma_f32_16x16x32_bf16 a[104:107], a[232:235], v[188:191], a[104:107]
v_exp_f32 v151, v151
v_mfma_f32_16x16x32_bf16 a[120:123], a[236:239], v[188:191], a[120:123]
ds_read_b128 a[204:207], v2 offset:48128
v_cvt_pk_bf16_f32 v187, v150, v151
v_mfma_f32_16x16x32_bf16 a[136:139], a[240:243], v[188:191], a[136:139]
buffer_load_dwordx4 v7, s[56:59], s83 offen offset:3072 sc1 lds
v_mfma_f32_16x16x32_bf16 v[144:147], a[144:147], v[136:139], v[248:251]
v_exp_f32 v152, v152
v_mfma_f32_16x16x32_bf16 v[148:151], a[160:163], v[136:139], v[248:251]
v_mfma_f32_16x16x32_bf16 v[144:147], a[148:151], v[168:171], v[144:147]
v_exp_f32 v153, v153
v_mfma_f32_16x16x32_bf16 v[148:151], a[164:167], v[168:171], v[148:151]
v_cvt_pk_bf16_f32 v188, v152, v153
v_mfma_f32_16x16x32_bf16 v[144:147], a[152:155], v[200:203], v[144:147]
v_exp_f32 v154, v154
v_mfma_f32_16x16x32_bf16 v[148:151], a[168:171], v[200:203], v[148:151]
v_mfma_f32_16x16x32_bf16 v[144:147], a[156:159], v[232:235], v[144:147]
v_exp_f32 v155, v155
v_mfma_f32_16x16x32_bf16 v[148:151], a[172:175], v[232:235], v[148:151]
v_cvt_pk_bf16_f32 v189, v154, v155
v_mfma_f32_16x16x32_bf16 a[12:15], a[208:211], v[184:187], a[12:15]
v_exp_f32 v156, v156
v_mfma_f32_16x16x32_bf16 a[28:31], a[212:215], v[184:187], a[28:31]
v_mfma_f32_16x16x32_bf16 a[44:47], a[216:219], v[184:187], a[44:47]
v_exp_f32 v157, v157
v_mfma_f32_16x16x32_bf16 a[60:63], a[220:223], v[184:187], a[60:63]
v_cvt_pk_bf16_f32 v190, v156, v157
v_mfma_f32_16x16x32_bf16 a[76:79], a[224:227], v[184:187], a[76:79]
v_exp_f32 v158, v158
v_mfma_f32_16x16x32_bf16 a[92:95], a[228:231], v[184:187], a[92:95]
v_mfma_f32_16x16x32_bf16 a[108:111], a[232:235], v[184:187], a[108:111]
v_exp_f32 v159, v159
v_mfma_f32_16x16x32_bf16 a[124:127], a[236:239], v[184:187], a[124:127]
v_cvt_pk_bf16_f32 v191, v158, v159
v_mfma_f32_16x16x32_bf16 a[140:143], a[240:243], v[184:187], a[140:143]
s_waitcnt lgkmcnt(0)
v_mfma_f32_16x16x32_bf16 v[152:155], a[144:147], v[140:143], v[252:255]
v_exp_f32 v144, v144
v_mfma_f32_16x16x32_bf16 v[156:159], a[160:163], v[140:143], v[252:255]
ds_read_b128 a[144:147], v2 offset:49152
v_mfma_f32_16x16x32_bf16 v[152:155], a[148:151], v[172:175], v[152:155]
v_exp_f32 v145, v145
v_mfma_f32_16x16x32_bf16 v[156:159], a[164:167], v[172:175], v[156:159]
ds_read_b128 a[160:163], v2 offset:53248
v_cvt_pk_bf16_f32 v184, v144, v145
v_mfma_f32_16x16x32_bf16 v[152:155], a[152:155], v[204:207], v[152:155]
v_exp_f32 v146, v146
v_mfma_f32_16x16x32_bf16 v[156:159], a[168:171], v[204:207], v[156:159]
ds_read_b128 a[148:151], v2 offset:50176
v_mfma_f32_16x16x32_bf16 v[152:155], a[156:159], v[236:239], v[152:155]
v_exp_f32 v147, v147
v_mfma_f32_16x16x32_bf16 v[156:159], a[172:175], v[236:239], v[156:159]
ds_read_b128 a[164:167], v2 offset:54272
v_cvt_pk_bf16_f32 v185, v146, v147
v_mfma_f32_16x16x32_bf16 a[0:3], a[176:179], v[188:191], a[0:3]
v_exp_f32 v148, v148
v_mfma_f32_16x16x32_bf16 a[16:19], a[180:183], v[188:191], a[16:19]
ds_read_b128 a[152:155], v2 offset:51200
v_mfma_f32_16x16x32_bf16 a[32:35], a[184:187], v[188:191], a[32:35]
v_exp_f32 v149, v149
v_mfma_f32_16x16x32_bf16 a[48:51], a[188:191], v[188:191], a[48:51]
ds_read_b128 a[168:171], v2 offset:55296
v_cvt_pk_bf16_f32 v186, v148, v149
v_mfma_f32_16x16x32_bf16 a[64:67], a[192:195], v[188:191], a[64:67]
v_exp_f32 v150, v150
v_mfma_f32_16x16x32_bf16 a[80:83], a[196:199], v[188:191], a[80:83]
ds_read_b128 a[156:159], v2 offset:52224
v_mfma_f32_16x16x32_bf16 a[96:99], a[200:203], v[188:191], a[96:99]
v_exp_f32 v151, v151
v_mfma_f32_16x16x32_bf16 a[112:115], a[204:207], v[188:191], a[112:115]
ds_read_b128 a[172:175], v2 offset:56320
v_cvt_pk_bf16_f32 v187, v150, v151
v_mfma_f32_16x16x32_bf16 a[128:131], a[240:243], v[188:191], a[128:131]
s_waitcnt lgkmcnt(4)
v_add_f32 v216, v240, v212
v_add_f32 v217, v241, v213
v_add_f32 v218, v242, v214
v_add_f32 v219, v243, v215
s_nop 1
v_mfma_f32_16x16x32_bf16 v[144:147], a[144:147], v[128:131], v[216:219]
v_exp_f32 v152, v152
v_mfma_f32_16x16x32_bf16 v[144:147], a[148:151], v[160:163], v[144:147]
ds_read_b128 a[208:211], v2 offset:57344
s_waitcnt lgkmcnt(4)
v_mfma_f32_16x16x32_bf16 v[144:147], a[152:155], v[192:195], v[144:147]
v_exp_f32 v153, v153
s_waitcnt lgkmcnt(2)
v_mfma_f32_16x16x32_bf16 v[144:147], a[156:159], v[224:227], v[144:147]
ds_read_b128 a[212:215], v2 offset:58368
v_cvt_pk_bf16_f32 v188, v152, v153
v_mfma_f32_16x16x32_bf16 a[8:11], a[176:179], v[184:187], a[8:11]
v_exp_f32 v154, v154
v_mfma_f32_16x16x32_bf16 a[24:27], a[180:183], v[184:187], a[24:27]
ds_read_b128 a[216:219], v2 offset:59392
v_mfma_f32_16x16x32_bf16 a[40:43], a[184:187], v[184:187], a[40:43]
v_exp_f32 v155, v155
v_mfma_f32_16x16x32_bf16 a[56:59], a[188:191], v[184:187], a[56:59]
ds_read_b128 a[220:223], v2 offset:60416
v_cvt_pk_bf16_f32 v189, v154, v155
v_mfma_f32_16x16x32_bf16 a[72:75], a[192:195], v[184:187], a[72:75]
v_exp_f32 v156, v156
v_mfma_f32_16x16x32_bf16 a[88:91], a[196:199], v[184:187], a[88:91]
ds_read_b128 a[224:227], v2 offset:61440
v_mfma_f32_16x16x32_bf16 a[104:107], a[200:203], v[184:187], a[104:107]
v_exp_f32 v157, v157
v_mfma_f32_16x16x32_bf16 a[120:123], a[204:207], v[184:187], a[120:123]
ds_read_b128 a[228:231], v2 offset:62464
v_cvt_pk_bf16_f32 v190, v156, v157
v_mfma_f32_16x16x32_bf16 a[136:139], a[240:243], v[184:187], a[136:139]
v_exp_f32 v158, v158
ds_read_b128 a[232:235], v2 offset:63488
ds_read_b128 a[236:239], v2 offset:64512
v_exp_f32 v159, v159
s_nop 0
v_cvt_pk_bf16_f32 v191, v158, v159
v_mfma_f32_16x16x32_bf16 v[176:179], a[144:147], v[136:139], v[248:251]
v_exp_f32 v144, v144
v_mfma_f32_16x16x32_bf16 v[180:183], a[160:163], v[136:139], v[248:251]
v_mfma_f32_16x16x32_bf16 v[176:179], a[148:151], v[168:171], v[176:179]
v_exp_f32 v145, v145
v_mfma_f32_16x16x32_bf16 v[180:183], a[164:167], v[168:171], v[180:183]
v_cvt_pk_bf16_f32 v208, v144, v145
v_mfma_f32_16x16x32_bf16 v[176:179], a[152:155], v[200:203], v[176:179]
v_exp_f32 v146, v146
v_mfma_f32_16x16x32_bf16 v[180:183], a[168:171], v[200:203], v[180:183]
s_waitcnt lgkmcnt(8)
v_mfma_f32_16x16x32_bf16 v[176:179], a[156:159], v[232:235], v[176:179]
v_exp_f32 v147, v147
v_mfma_f32_16x16x32_bf16 v[180:183], a[172:175], v[232:235], v[180:183]
v_cvt_pk_bf16_f32 v209, v146, v147
v_mfma_f32_16x16x32_bf16 a[12:15], a[176:179], v[188:191], a[12:15]
v_mov_b32 v210, 0
v_mfma_f32_16x16x32_bf16 a[28:31], a[180:183], v[188:191], a[28:31]
v_mov_b32 v211, 0
v_mfma_f32_16x16x32_bf16 a[44:47], a[184:187], v[188:191], a[44:47]
v_mfma_f32_16x16x32_bf16 a[60:63], a[188:191], v[188:191], a[60:63]
v_mfma_f32_16x16x32_bf16 a[76:79], a[192:195], v[188:191], a[76:79]
v_mfma_f32_16x16x32_bf16 a[92:95], a[196:199], v[188:191], a[92:95]
v_mfma_f32_16x16x32_bf16 a[108:111], a[200:203], v[188:191], a[108:111]
v_mfma_f32_16x16x32_bf16 a[124:127], a[204:207], v[188:191], a[124:127]
v_mfma_f32_16x16x32_bf16 a[140:143], a[240:243], v[188:191], a[140:143]
s_waitcnt lgkmcnt(0)
v_mfma_f32_16x16x32_bf16 v[152:155], a[144:147], v[140:143], v[252:255]
v_exp_f32 v176, v176
v_mfma_f32_16x16x32_bf16 v[156:159], a[160:163], v[140:143], v[252:255]
v_exp_f32 v177, v177
v_mfma_f32_16x16x32_bf16 v[152:155], a[148:151], v[172:175], v[152:155]
v_exp_f32 v178, v178
v_mfma_f32_16x16x32_bf16 v[156:159], a[164:167], v[172:175], v[156:159]
v_exp_f32 v179, v179
v_mfma_f32_16x16x32_bf16 v[152:155], a[152:155], v[204:207], v[152:155]
v_exp_f32 v180, v180
v_mfma_f32_16x16x32_bf16 v[156:159], a[168:171], v[204:207], v[156:159]
s_waitcnt vmcnt(0) lgkmcnt(0)
s_barrier
ds_read_b128 a[144:147], v3 offset:0
v_cvt_pk_bf16_f32 v184, v176, v177
v_mfma_f32_16x16x32_bf16 v[152:155], a[156:159], v[236:239], v[152:155]
v_exp_f32 v181, v181
v_mfma_f32_16x16x32_bf16 v[156:159], a[172:175], v[236:239], v[156:159]
ds_read_b128 a[160:163], v3 offset:4096
v_cvt_pk_bf16_f32 v185, v178, v179
v_mfma_f32_16x16x32_bf16 a[0:3], a[208:211], v[208:211], a[0:3]
v_exp_f32 v182, v182
v_mfma_f32_16x16x32_bf16 a[16:19], a[212:215], v[208:211], a[16:19]
ds_read_b128 a[148:151], v3 offset:1024
v_cvt_pk_bf16_f32 v186, v180, v181
v_mfma_f32_16x16x32_bf16 a[32:35], a[216:219], v[208:211], a[32:35]
v_exp_f32 v183, v183
v_mfma_f32_16x16x32_bf16 a[48:51], a[220:223], v[208:211], a[48:51]
ds_read_b128 a[164:167], v3 offset:5120
v_cvt_pk_bf16_f32 v187, v182, v183
v_mfma_f32_16x16x32_bf16 a[64:67], a[224:227], v[208:211], a[64:67]
ds_read_b128 a[152:155], v3 offset:2048
v_xor_b32 v2, 0x10000, v2
v_mfma_f32_16x16x32_bf16 a[80:83], a[228:231], v[208:211], a[80:83]
ds_read_b128 a[168:171], v3 offset:6144
s_add_u32 s83, s83, 0x10000
s_xor_b32 s84, s84, 0x10000
v_mfma_f32_16x16x32_bf16 a[96:99], a[232:235], v[208:211], a[96:99]
ds_read_b128 a[156:159], v3 offset:3072
s_add_u32 s82, s82, 1
v_mfma_f32_16x16x32_bf16 a[112:115], a[236:239], v[208:211], a[112:115]
ds_read_b128 a[172:175], v3 offset:7168
v_mfma_f32_16x16x32_bf16 a[128:131], a[240:243], v[208:211], a[128:131]
v_xor_b32 v3, 0x10000, v3
s_waitcnt lgkmcnt(4)
s_branch L_sd_done
L_sd_2:
s_cmp_lg_u32 s64, 2
s_cbranch_scc1 L_sd_3
v_mfma_f32_16x16x32_bf16 v[144:147], a[144:147], v[128:131], v[240:243]
v_exp_f32 v152, v152
v_mfma_f32_16x16x32_bf16 v[148:151], a[160:163], v[128:131], v[240:243]
ds_read_b128 a[176:179], v2 offset:8192
v_mfma_f32_16x16x32_bf16 v[144:147], a[148:151], v[160:163], v[144:147]
v_exp_f32 v153, v153
v_mfma_f32_16x16x32_bf16 v[148:151], a[164:167], v[160:163], v[148:151]
ds_read_b128 a[180:183], v2 offset:9216
s_add_u32 m0, s84, 0
v_cvt_pk_bf16_f32 v188, v152, v153
s_waitcnt lgkmcnt(4)
v_mfma_f32_16x16x32_bf16 v[144:147], a[152:155], v[192:195], v[144:147]
v_exp_f32 v154, v154
v_mfma_f32_16x16x32_bf16 v[148:151], a[168:171], v[192:195], v[148:151]
ds_read_b128 a[184:187], v2 offset:10240
buffer_load_dwordx4 v4, s[56:59], s83 offen offset:0 sc1 lds
s_waitcnt lgkmcnt(3)
v_mfma_f32_16x16x32_bf16 v[144:147], a[156:159], v[224:227], v[144:147]
v_exp_f32 v155, v155
v_mfma_f32_16x16x32_bf16 v[148:151], a[172:175], v[224:227], v[148:151]
ds_read_b128 a[188:191], v2 offset:11264
v_cvt_pk_bf16_f32 v189, v154, v155
v_mfma_f32_16x16x32_bf16 a[8:11], a[208:211], v[184:187], a[8:11]
v_exp_f32 v156, v156
v_mfma_f32_16x16x32_bf16 a[24:27], a[212:215], v[184:187], a[24:27]
ds_read_b128 a[192:195], v2 offset:12288
v_mfma_f32_16x16x32_bf16 a[40:43], a[216:219], v[184:187], a[40:43]
v_exp_f32 v157, v157
v_mfma_f32_16x16x32_bf16 a[56:59], a[220:223], v[184:187], a[56:59]
ds_read_b128 a[196:199], v2 offset:13312
v_cvt_pk_bf16_f32 v190, v156, v157
v_mfma_f32_16x16x32_bf16 a[72:75], a[224:227], v[184:187], a[72:75]
v_exp_f32 v158, v158
v_mfma_f32_16x16x32_bf16 a[88:91], a[228:231], v[184:187], a[88:91]
ds_read_b128 a[200:203], v2 offset:14336
v_mfma_f32_16x16x32_bf16 a[104:107], a[232:235], v[184:187], a[104:107]
v_exp_f32 v159, v159
v_mfma_f32_16x16x32_bf16 a[120:123], a[236:239], v[184:187], a[120:123]
ds_read_b128 a[204:207], v2 offset:15360
v_cvt_pk_bf16_f32 v191, v158, v159
v_mfma_f32_16x16x32_bf16 a[136:139], a[240:243], v[184:187], a[136:139]
buffer_load_dwordx4 v4, s[56:59], s83 offen offset:1024 sc1 lds
v_mfma_f32_16x16x32_bf16 v[152:155], a[144:147], v[132:135], v[244:247]
v_exp_f32 v144, v144
v_mfma_f32_16x16x32_bf16 v[156:159], a[160:163], v[132:135], v[244:247]
v_mfma_f32_16x16x32_bf16 v[152:155], a[148:151], v[164:167], v[152:155]
v_exp_f32 v145, v145
v_mfma_f32_16x16x32_bf16 v[156:159], a[164:167], v[164:167], v[156:159]
v_cvt_pk_bf16_f32 v184, v144, v145
v_mfma_f32_16x16x32_bf16 v[152:155], a[152:155], v[196:199], v[152:155]
v_exp_f32 v146, v146
v_mfma_f32_16x16x32_bf16 v[156:159], a[168:171], v[196:199], v[156:159]
buffer_load_dwordx4 v4, s[56:59], s83 offen offset:2048 sc1 lds
v_mfma_f32_16x16x32_bf16 v[152:155], a[156:159], v[228:231], v[152:155]
v_exp_f32 v147, v147
v_mfma_f32_16x16x32_bf16 v[156:159], a[172:175], v[228:231], v[156:159]
v_cvt_pk_bf16_f32 v185, v146, v147
v_mfma_f32_16x16x32_bf16 a[12:15], a[208:211], v[188:191], a[12:15]
v_exp_f32 v148, v148
v_mfma_f32_16x16x32_bf16 a[28:31], a[212:215], v[188:191], a[28:31]
v_mfma_f32_16x16x32_bf16 a[44:47], a[216:219], v[188:191], a[44:47]
v_exp_f32 v149, v149
v_mfma_f32_16x16x32_bf16 a[60:63], a[220:223], v[188:191], a[60:63]
v_cvt_pk_bf16_f32 v186, v148, v149
v_mfma_f32_16x16x32_bf16 a[76:79], a[224:227], v[188:191], a[76:79]
v_exp_f32 v150, v150
v_mfma_f32_16x16x32_bf16 a[92:95], a[228:231], v[188:191], a[92:95]
v_mfma_f32_16x16x32_bf16 a[108:111], a[232:235], v[188:191], a[108:111]
v_exp_f32 v151, v151
v_mfma_f32_16x16x32_bf16 a[124:127], a[236:239], v[188:191], a[124:127]
v_cvt_pk_bf16_f32 v187, v150, v151
v_mfma_f32_16x16x32_bf16 a[140:143], a[240:243], v[188:191], a[140:143]
buffer_load_dwordx4 v4, s[56:59], s83 offen offset:3072 sc1 lds
s_waitcnt lgkmcnt(0)
v_mfma_f32_16x16x32_bf16 v[144:147], a[144:147], v[136:139], v[248:251]
v_exp_f32 v152, v152
v_mfma_f32_16x16x32_bf16 v[148:151], a[160:163], v[136:139], v[248:251]
v_mfma_f32_16x16x32_bf16 v[144:147], a[148:151], v[168:171], v[144:147]
v_exp_f32 v153, v153
v_mfma_f32_16x16x32_bf16 v[148:151], a[164:167], v[168:171], v[148:151]
s_add_u32 m0, s84, 4096
v_cvt_pk_bf16_f32 v188, v152, v153
v_mfma_f32_16x16x32_bf16 v[144:147], a[152:155], v[200:203], v[144:147]
v_exp_f32 v154, v154
v_mfma_f32_16x16x32_bf16 v[148:151], a[168:171], v[200:203], v[148:151]
buffer_load_dwordx4 v5, s[56:59], s83 offen offset:0 sc1 lds
v_mfma_f32_16x16x32_bf16 v[144:147], a[156:159], v[232:235], v[144:147]
v_exp_f32 v155, v155
v_mfma_f32_16x16x32_bf16 v[148:151], a[172:175], v[232:235], v[148:151]
v_cvt_pk_bf16_f32 v189, v154, v155
v_mfma_f32_16x16x32_bf16 a[0:3], a[176:179], v[184:187], a[0:3]
v_exp_f32 v156, v156
v_mfma_f32_16x16x32_bf16 a[16:19], a[180:183], v[184:187], a[16:19]
v_mfma_f32_16x16x32_bf16 a[32:35], a[184:187], v[184:187], a[32:35]
v_exp_f32 v157, v157
v_mfma_f32_16x16x32_bf16 a[48:51], a[188:191], v[184:187], a[48:51]
v_cvt_pk_bf16_f32 v190, v156, v157
v_mfma_f32_16x16x32_bf16 a[64:67], a[192:195], v[184:187], a[64:67]
v_exp_f32 v158, v158
v_mfma_f32_16x16x32_bf16 a[80:83], a[196:199], v[184:187], a[80:83]
v_mfma_f32_16x16x32_bf16 a[96:99], a[200:203], v[184:187], a[96:99]
v_exp_f32 v159, v159
v_mfma_f32_16x16x32_bf16 a[112:115], a[204:207], v[184:187], a[112:115]
v_cvt_pk_bf16_f32 v191, v158, v159
v_mfma_f32_16x16x32_bf16 a[128:131], a[240:243], v[184:187], a[128:131]
buffer_load_dwordx4 v5, s[56:59], s83 offen offset:1024 sc1 lds
v_mfma_f32_16x16x32_bf16 v[152:155], a[144:147], v[140:143], v[252:255]
v_exp_f32 v144, v144
v_mfma_f32_16x16x32_bf16 v[156:159], a[160:163], v[140:143], v[252:255]
ds_read_b128 a[144:147], v2 offset:16384
v_mfma_f32_16x16x32_bf16 v[152:155], a[148:151], v[172:175], v[152:155]
v_exp_f32 v145, v145
v_mfma_f32_16x16x32_bf16 v[156:159], a[164:167], v[172:175], v[156:159]
ds_read_b128 a[160:163], v2 offset:20480
v_cvt_pk_bf16_f32 v184, v144, v145
v_mfma_f32_16x16x32_bf16 v[152:155], a[152:155], v[204:207], v[152:155]
v_exp_f32 v146, v146
v_mfma_f32_16x16x32_bf16 v[156:159], a[168:171], v[204:207], v[156:159]
ds_read_b128 a[148:151], v2 offset:17408
buffer_load_dwordx4 v5, s[56:59], s83 offen offset:2048 sc1 lds
v_mfma_f32_16x16x32_bf16 v[152:155], a[156:159], v[236:239], v[152:155]
v_exp_f32 v147, v147
v_mfma_f32_16x16x32_bf16 v[156:159], a[172:175], v[236:239], v[156:159]
ds_read_b128 a[164:167], v2 offset:21504
v_cvt_pk_bf16_f32 v185, v146, v147
v_mfma_f32_16x16x32_bf16 a[4:7], a[176:179], v[188:191], a[4:7]
v_exp_f32 v148, v148
v_mfma_f32_16x16x32_bf16 a[20:23], a[180:183], v[188:191], a[20:23]
ds_read_b128 a[152:155], v2 offset:18432
v_mfma_f32_16x16x32_bf16 a[36:39], a[184:187], v[188:191], a[36:39]
v_exp_f32 v149, v149
v_mfma_f32_16x16x32_bf16 a[52:55], a[188:191], v[188:191], a[52:55]
ds_read_b128 a[168:171], v2 offset:22528
v_cvt_pk_bf16_f32 v186, v148, v149
v_mfma_f32_16x16x32_bf16 a[68:71], a[192:195], v[188:191], a[68:71]
v_exp_f32 v150, v150
v_mfma_f32_16x16x32_bf16 a[84:87], a[196:199], v[188:191], a[84:87]
ds_read_b128 a[156:159], v2 offset:19456
v_mfma_f32_16x16x32_bf16 a[100:103], a[200:203], v[188:191], a[100:103]
v_exp_f32 v151, v151
v_mfma_f32_16x16x32_bf16 a[116:119], a[204:207], v[188:191], a[116:119]
ds_read_b128 a[172:175], v2 offset:23552
v_cvt_pk_bf16_f32 v187, v150, v151
v_mfma_f32_16x16x32_bf16 a[132:135], a[240:243], v[188:191], a[132:135]
buffer_load_dwordx4 v5, s[56:59], s83 offen offset:3072 sc1 lds
s_waitcnt lgkmcnt(4)
v_mfma_f32_16x16x32_bf16 v[144:147], a[144:147], v[128:131], v[240:243]
v_exp_f32 v152, v152
v_mfma_f32_16x16x32_bf16 v[148:151], a[160:163], v[128:131], v[240:243]
ds_read_b128 a[208:211], v2 offset:24576
v_mfma_f32_16x16x32_bf16 v[144:147], a[148:151], v[160:163], v[144:147]
v_exp_f32 v153, v153
v_mfma_f32_16x16x32_bf16 v[148:151], a[164:167], v[160:163], v[148:151]
ds_read_b128 a[212:215], v2 offset:25600
s_add_u32 m0, s84, 8192
v_cvt_pk_bf16_f32 v188, v152, v153
s_waitcnt lgkmcnt(4)
v_mfma_f32_16x16x32_bf16 v[144:147], a[152:155], v[192:195], v[144:147]
v_exp_f32 v154, v154
v_mfma_f32_16x16x32_bf16 v[148:151], a[168:171], v[192:195], v[148:151]
ds_read_b128 a[216:219], v2 offset:26624
buffer_load_dwordx4 v6, s[56:59], s83 offen offset:0 sc1 lds
s_waitcnt lgkmcnt(3)
v_mfma_f32_16x16x32_bf16 v[144:147], a[156:159], v[224:227], v[144:147]
v_exp_f32 v155, v155
v_mfma_f32_16x16x32_bf16 v[148:151], a[172:175], v[224:227], v[148:151]
ds_read_b128 a[220:223], v2 offset:27648
v_cvt_pk_bf16_f32 v189, v154, v155
v_mfma_f32_16x16x32_bf16 a[8:11], a[176:179], v[184:187], a[8:11]
v_exp_f32 v156, v156
v_mfma_f32_16x16x32_bf16 a[24:27], a[180:183], v[184:187], a[24:27]
ds_read_b128 a[224:227], v2 offset:28672
v_mfma_f32_16x16x32_bf16 a[40:43], a[184:187], v[184:187], a[40:43]
v_exp_f32 v157, v157
v_mfma_f32_16x16x32_bf16 a[56:59], a[188:191], v[184:187], a[56:59]
ds_read_b128 a[228:231], v2 offset:29696
v_cvt_pk_bf16_f32 v190, v156, v157
v_mfma_f32_16x16x32_bf16 a[72:75], a[192:195], v[184:187], a[72:75]
v_exp_f32 v158, v158
v_mfma_f32_16x16x32_bf16 a[88:91], a[196:199], v[184:187], a[88:91]
ds_read_b128 a[232:235], v2 offset:30720
v_mfma_f32_16x16x32_bf16 a[104:107], a[200:203], v[184:187], a[104:107]
v_exp_f32 v159, v159
v_mfma_f32_16x16x32_bf16 a[120:123], a[204:207], v[184:187], a[120:123]
ds_read_b128 a[236:239], v2 offset:31744
v_cvt_pk_bf16_f32 v191, v158, v159
v_mfma_f32_16x16x32_bf16 a[136:139], a[240:243], v[184:187], a[136:139]
buffer_load_dwordx4 v6, s[56:59], s83 offen offset:1024 sc1 lds
v_add_f32 v216, v244, v212
v_add_f32 v217, v245, v213
v_add_f32 v218, v246, v214
v_add_f32 v219, v247, v215
s_nop 1
v_mfma_f32_16x16x32_bf16 v[152:155], a[144:147], v[132:135], v[216:219]
v_exp_f32 v144, v144
v_mfma_f32_16x16x32_bf16 v[152:155], a[148:151], v[164:167], v[152:155]
buffer_load_dwordx4 v6, s[56:59], s83 offen offset:2048 sc1 lds
v_mfma_f32_16x16x32_bf16 v[152:155], a[152:155], v[196:199], v[152:155]
v_exp_f32 v145, v145
v_mfma_f32_16x16x32_bf16 v[152:155], a[156:159], v[228:231], v[152:155]
v_cvt_pk_bf16_f32 v184, v144, v145
v_mfma_f32_16x16x32_bf16 a[12:15], a[176:179], v[188:191], a[12:15]
v_exp_f32 v146, v146
v_mfma_f32_16x16x32_bf16 a[28:31], a[180:183], v[188:191], a[28:31]
buffer_load_dwordx4 v6, s[56:59], s83 offen offset:3072 sc1 lds
v_mfma_f32_16x16x32_bf16 a[44:47], a[184:187], v[188:191], a[44:47]
v_exp_f32 v147, v147
v_mfma_f32_16x16x32_bf16 a[60:63], a[188:191], v[188:191], a[60:63]
v_cvt_pk_bf16_f32 v185, v146, v147
v_mfma_f32_16x16x32_bf16 a[76:79], a[192:195], v[188:191], a[76:79]
v_exp_f32 v148, v148
v_mfma_f32_16x16x32_bf16 a[92:95], a[196:199], v[188:191], a[92:95]
v_mfma_f32_16x16x32_bf16 a[108:111], a[200:203], v[188:191], a[108:111]
v_exp_f32 v149, v149
v_mfma_f32_16x16x32_bf16 a[124:127], a[204:207], v[188:191], a[124:127]
v_cvt_pk_bf16_f32 v186, v148, v149
v_mfma_f32_16x16x32_bf16 a[140:143], a[240:243], v[188:191], a[140:143]
v_exp_f32 v150, v150
s_waitcnt lgkmcnt(0)
v_exp_f32 v151, v151
s_nop 0
v_cvt_pk_bf16_f32 v187, v150, v151
v_mfma_f32_16x16x32_bf16 v[144:147], a[144:147], v[136:139], v[248:251]
v_exp_f32 v152, v152
v_mfma_f32_16x16x32_bf16 v[148:151], a[160:163], v[136:139], v[248:251]
v_mfma_f32_16x16x32_bf16 v[144:147], a[148:151], v[168:171], v[144:147]
v_exp_f32 v153, v153
v_mfma_f32_16x16x32_bf16 v[148:151], a[164:167], v[168:171], v[148:151]
s_add_u32 m0, s84, 12288
v_cvt_pk_bf16_f32 v188, v152, v153
v_mfma_f32_16x16x32_bf16 v[144:147], a[152:155], v[200:203], v[144:147]
v_exp_f32 v154, v154
v_mfma_f32_16x16x32_bf16 v[148:151], a[168:171], v[200:203], v[148:151]
buffer_load_dwordx4 v7, s[56:59], s83 offen offset:0 sc1 lds
v_mfma_f32_16x16x32_bf16 v[144:147], a[156:159], v[232:235], v[144:147]
v_exp_f32 v155, v155
v_mfma_f32_16x16x32_bf16 v[148:151], a[172:175], v[232:235], v[148:151]
v_cvt_pk_bf16_f32 v189, v154, v155
v_mfma_f32_16x16x32_bf16 a[0:3], a[208:211], v[184:187], a[0:3]
v_mov_b32 v190, 0
v_mfma_f32_16x16x32_bf16 a[16:19], a[212:215], v[184:187], a[16:19]
v_mov_b32 v191, 0
v_mfma_f32_16x16x32_bf16 a[32:35], a[216:219], v[184:187], a[32:35]
v_mfma_f32_16x16x32_bf16 a[48:51], a[220:223], v[184:187], a[48:51]
v_mfma_f32_16x16x32_bf16 a[64:67], a[224:227], v[184:187], a[64:67]
v_mfma_f32_16x16x32_bf16 a[80:83], a[228:231], v[184:187], a[80:83]
v_mfma_f32_16x16x32_bf16 a[96:99], a[232:235], v[184:187], a[96:99]
v_mfma_f32_16x16x32_bf16 a[112:115], a[236:239], v[184:187], a[112:115]
v_mfma_f32_16x16x32_bf16 a[128:131], a[240:243], v[184:187], a[128:131]
buffer_load_dwordx4 v7, s[56:59], s83 offen offset:1024 sc1 lds
v_mfma_f32_16x16x32_bf16 v[152:155], a[144:147], v[140:143], v[252:255]
v_exp_f32 v144, v144
v_mfma_f32_16x16x32_bf16 v[156:159], a[160:163], v[140:143], v[252:255]
ds_read_b128 a[144:147], v2 offset:32768
v_mfma_f32_16x16x32_bf16 v[152:155], a[148:151], v[172:175], v[152:155]
v_exp_f32 v145, v145
v_mfma_f32_16x16x32_bf16 v[156:159], a[164:167], v[172:175], v[156:159]
ds_read_b128 a[160:163], v2 offset:36864
v_cvt_pk_bf16_f32 v184, v144, v145
v_mfma_f32_16x16x32_bf16 v[152:155], a[152:155], v[204:207], v[152:155]
v_exp_f32 v146, v146
v_mfma_f32_16x16x32_bf16 v[156:159], a[168:171], v[204:207], v[156:159]
ds_read_b128 a[148:151], v2 offset:33792
buffer_load_dwordx4 v7, s[56:59], s83 offen offset:2048 sc1 lds
v_mfma_f32_16x16x32_bf16 v[152:155], a[156:159], v[236:239], v[152:155]
v_exp_f32 v147, v147
v_mfma_f32_16x16x32_bf16 v[156:159], a[172:175], v[236:239], v[156:159]
ds_read_b128 a[164:167], v2 offset:37888
v_cvt_pk_bf16_f32 v185, v146, v147
v_mfma_f32_16x16x32_bf16 a[4:7], a[208:211], v[188:191], a[4:7]
v_exp_f32 v148, v148
v_mfma_f32_16x16x32_bf16 a[20:23], a[212:215], v[188:191], a[20:23]
ds_read_b128 a[152:155], v2 offset:34816
v_mfma_f32_16x16x32_bf16 a[36:39], a[216:219], v[188:191], a[36:39]
v_exp_f32 v149, v149
v_mfma_f32_16x16x32_bf16 a[52:55], a[220:223], v[188:191], a[52:55]
ds_read_b128 a[168:171], v2 offset:38912
v_cvt_pk_bf16_f32 v186, v148, v149
v_mfma_f32_16x16x32_bf16 a[68:71], a[224:227], v[188:191], a[68:71]
v_exp_f32 v150, v150
v_mfma_f32_16x16x32_bf16 a[84:87], a[228:231], v[188:191], a[84:87]
ds_read_b128 a[156:159], v2 offset:35840
v_mfma_f32_16x16x32_bf16 a[100:103], a[232:235], v[188:191], a[100:103]
v_exp_f32 v151, v151
v_mfma_f32_16x16x32_bf16 a[116:119], a[236:239], v[188:191], a[116:119]
ds_read_b128 a[172:175], v2 offset:39936
v_cvt_pk_bf16_f32 v187, v150, v151
v_mfma_f32_16x16x32_bf16 a[132:135], a[240:243], v[188:191], a[132:135]
buffer_load_dwordx4 v7, s[56:59], s83 offen offset:3072 sc1 lds
s_waitcnt lgkmcnt(4)
v_add_f32 v216, v240, v212
v_add_f32 v217, v241, v213
v_add_f32 v218, v242, v214
v_add_f32 v219, v243, v215
v_mfma_f32_16x16x32_bf16 v[144:147], a[144:147], v[128:131], v[240:243]
v_exp_f32 v152, v152
v_mfma_f32_16x16x32_bf16 v[148:151], a[160:163], v[128:131], v[216:219]
ds_read_b128 a[176:179], v2 offset:40960
v_mfma_f32_16x16x32_bf16 v[144:147], a[148:151], v[160:163], v[144:147]
v_exp_f32 v153, v153
v_mfma_f32_16x16x32_bf16 v[148:151], a[164:167], v[160:163], v[148:151]
ds_read_b128 a[180:183], v2 offset:41984
v_cvt_pk_bf16_f32 v188, v152, v153
s_waitcnt lgkmcnt(4)
v_mfma_f32_16x16x32_bf16 v[144:147], a[152:155], v[192:195], v[144:147]
v_exp_f32 v154, v154
v_mfma_f32_16x16x32_bf16 v[148:151], a[168:171], v[192:195], v[148:151]
ds_read_b128 a[184:187], v2 offset:43008
s_waitcnt lgkmcnt(3)
v_mfma_f32_16x16x32_bf16 v[144:147], a[156:159], v[224:227], v[144:147]
v_exp_f32 v155, v155
v_mfma_f32_16x16x32_bf16 v[148:151], a[172:175], v[224:227], v[148:151]
ds_read_b128 a[188:191], v2 offset:44032
v_cvt_pk_bf16_f32 v189, v154, v155
v_mfma_f32_16x16x32_bf16 a[8:11], a[208:211], v[184:187], a[8:11]
v_exp_f32 v156, v156
v_mfma_f32_16x16x32_bf16 a[24:27], a[212:215], v[184:187], a[24:27]
ds_read_b128 a[192:195], v2 offset:45056
v_mfma_f32_16x16x32_bf16 a[40:43], a[216:219], v[184:187], a[40:43]
v_exp_f32 v157, v157
v_mfma_f32_16x16x32_bf16 a[56:59], a[220:223], v[184:187], a[56:59]
ds_read_b128 a[196:199], v2 offset:46080
v_cvt_pk_bf16_f32 v190, v156, v157
v_mfma_f32_16x16x32_bf16 a[72:75], a[224:227], v[184:187], a[72:75]
v_exp_f32 v158, v158
v_mfma_f32_16x16x32_bf16 a[88:91], a[228:231], v[184:187], a[88:91]
ds_read_b128 a[200:203], v2 offset:47104
v_mfma_f32_16x16x32_bf16 a[104:107], a[232:235], v[184:187], a[104:107]
v_exp_f32 v159, v159
v_mfma_f32_16x16x32_bf16 a[120:123], a[236:239], v[184:187], a[120:123]
ds_read_b128 a[204:207], v2 offset:48128
v_cvt_pk_bf16_f32 v191, v158, v159
v_mfma_f32_16x16x32_bf16 a[136:139], a[240:243], v[184:187], a[136:139]
v_mfma_f32_16x16x32_bf16 v[152:155], a[144:147], v[136:139], v[248:251]
v_exp_f32 v144, v144
v_mfma_f32_16x16x32_bf16 v[156:159], a[160:163], v[136:139], v[248:251]
v_mfma_f32_16x16x32_bf16 v[152:155], a[148:151], v[168:171], v[152:155]
v_exp_f32 v145, v145
v_mfma_f32_16x16x32_bf16 v[156:159], a[164:167], v[168:171], v[156:159]
v_cvt_pk_bf16_f32 v184, v144, v145
v_mfma_f32_16x16x32_bf16 v[152:155], a[152:155], v[200:203], v[152:155]
v_exp_f32 v146, v146
v_mfma_f32_16x16x32_bf16 v[156:159], a[168:171], v[200:203], v[156:159]
v_mfma_f32_16x16x32_bf16 v[152:155], a[156:159], v[232:235], v[152:155]
v_exp_f32 v147, v147
v_mfma_f32_16x16x32_bf16 v[156:159], a[172:175], v[232:235], v[156:159]
v_cvt_pk_bf16_f32 v185, v146, v147
v_mfma_f32_16x16x32_bf16 a[12:15], a[208:211], v[188:191], a[12:15]
v_exp_f32 v148, v148
v_mfma_f32_16x16x32_bf16 a[28:31], a[212:215], v[188:191], a[28:31]
v_mfma_f32_16x16x32_bf16 a[44:47], a[216:219], v[188:191], a[44:47]
v_exp_f32 v149, v149
v_mfma_f32_16x16x32_bf16 a[60:63], a[220:223], v[188:191], a[60:63]
v_cvt_pk_bf16_f32 v186, v148, v149
v_mfma_f32_16x16x32_bf16 a[76:79], a[224:227], v[188:191], a[76:79]
v_exp_f32 v150, v150
v_mfma_f32_16x16x32_bf16 a[92:95], a[228:231], v[188:191], a[92:95]
v_mfma_f32_16x16x32_bf16 a[108:111], a[232:235], v[188:191], a[108:111]
v_exp_f32 v151, v151
v_mfma_f32_16x16x32_bf16 a[124:127], a[236:239], v[188:191], a[124:127]
v_cvt_pk_bf16_f32 v187, v150, v151
v_mfma_f32_16x16x32_bf16 a[140:143], a[240:243], v[188:191], a[140:143]
s_waitcnt lgkmcnt(0)
v_mfma_f32_16x16x32_bf16 v[144:147], a[144:147], v[140:143], v[252:255]
v_exp_f32 v152, v152
v_mfma_f32_16x16x32_bf16 v[148:151], a[160:163], v[140:143], v[252:255]
ds_read_b128 a[144:147], v2 offset:49152
v_mfma_f32_16x16x32_bf16 v[144:147], a[148:151], v[172:175], v[144:147]
v_exp_f32 v153, v153
v_mfma_f32_16x16x32_bf16 v[148:151], a[164:167], v[172:175], v[148:151]
ds_read_b128 a[160:163], v2 offset:53248
v_cvt_pk_bf16_f32 v188, v152, v153
v_mfma_f32_16x16x32_bf16 v[144:147], a[152:155], v[204:207], v[144:147]
v_exp_f32 v154, v154
v_mfma_f32_16x16x32_bf16 v[148:151], a[168:171], v[204:207], v[148:151]
ds_read_b128 a[148:151], v2 offset:50176
v_mfma_f32_16x16x32_bf16 v[144:147], a[156:159], v[236:239], v[144:147]
v_exp_f32 v155, v155
v_mfma_f32_16x16x32_bf16 v[148:151], a[172:175], v[236:239], v[148:151]
ds_read_b128 a[164:167], v2 offset:54272
v_cvt_pk_bf16_f32 v189, v154, v155
v_mfma_f32_16x16x32_bf16 a[0:3], a[176:179], v[184:187], a[0:3]
v_exp_f32 v156, v156
v_mfma_f32_16x16x32_bf16 a[16:19], a[180:183], v[184:187], a[16:19]
ds_read_b128 a[152:155], v2 offset:51200
v_mfma_f32_16x16x32_bf16 a[32:35], a[184:187], v[184:187], a[32:35]
v_exp_f32 v157, v157
v_mfma_f32_16x16x32_bf16 a[48:51], a[188:191], v[184:187], a[48:51]
ds_read_b128 a[168:171], v2 offset:55296
v_cvt_pk_bf16_f32 v190, v156, v157
v_mfma_f32_16x16x32_bf16 a[64:67], a[192:195], v[184:187], a[64:67]
v_exp_f32 v158, v158
v_mfma_f32_16x16x32_bf16 a[80:83], a[196:199], v[184:187], a[80:83]
ds_read_b128 a[156:159], v2 offset:52224
v_mfma_f32_16x16x32_bf16 a[96:99], a[200:203], v[184:187], a[96:99]
v_exp_f32 v159, v159
v_mfma_f32_16x16x32_bf16 a[112:115], a[204:207], v[184:187], a[112:115]
ds_read_b128 a[172:175], v2 offset:56320
v_cvt_pk_bf16_f32 v191, v158, v159
v_mfma_f32_16x16x32_bf16 a[128:131], a[240:243], v[184:187], a[128:131]
s_waitcnt lgkmcnt(4)
v_mfma_f32_16x16x32_bf16 v[176:179], a[144:147], v[136:139], v[248:251]
v_exp_f32 v144, v144
v_mfma_f32_16x16x32_bf16 v[180:183], a[160:163], v[136:139], v[248:251]
ds_read_b128 a[208:211], v2 offset:57344
v_mfma_f32_16x16x32_bf16 v[176:179], a[148:151], v[168:171], v[176:179]
v_exp_f32 v145, v145
v_mfma_f32_16x16x32_bf16 v[180:183], a[164:167], v[168:171], v[180:183]
ds_read_b128 a[212:215], v2 offset:58368
v_cvt_pk_bf16_f32 v208, v144, v145
s_waitcnt lgkmcnt(4)
v_mfma_f32_16x16x32_bf16 v[176:179], a[152:155], v[200:203], v[176:179]
v_exp_f32 v146, v146
v_mfma_f32_16x16x32_bf16 v[180:183], a[168:171], v[200:203], v[180:183]
ds_read_b128 a[216:219], v2 offset:59392
s_waitcnt lgkmcnt(3)
v_mfma_f32_16x16x32_bf16 v[176:179], a[156:159], v[232:235], v[176:179]
v_exp_f32 v147, v147
v_mfma_f32_16x16x32_bf16 v[180:183], a[172:175], v[232:235], v[180:183]
ds_read_b128 a[220:223], v2 offset:60416
v_cvt_pk_bf16_f32 v209, v146, v147
v_mfma_f32_16x16x32_bf16 a[8:11], a[176:179], v[188:191], a[8:11]
v_exp_f32 v148, v148
v_mfma_f32_16x16x32_bf16 a[24:27], a[180:183], v[188:191], a[24:27]
ds_read_b128 a[224:227], v2 offset:61440
v_mfma_f32_16x16x32_bf16 a[40:43], a[184:187], v[188:191], a[40:43]
v_exp_f32 v149, v149
v_mfma_f32_16x16x32_bf16 a[56:59], a[188:191], v[188:191], a[56:59]
ds_read_b128 a[228:231], v2 offset:62464
v_cvt_pk_bf16_f32 v210, v148, v149
v_mfma_f32_16x16x32_bf16 a[72:75], a[192:195], v[188:191], a[72:75]
v_exp_f32 v150, v150
v_mfma_f32_16x16x32_bf16 a[88:91], a[196:199], v[188:191], a[88:91]
ds_read_b128 a[232:235], v2 offset:63488
v_mfma_f32_16x16x32_bf16 a[104:107], a[200:203], v[188:191], a[104:107]
v_exp_f32 v151, v151
v_mfma_f32_16x16x32_bf16 a[120:123], a[204:207], v[188:191], a[120:123]
ds_read_b128 a[236:239], v2 offset:64512
v_cvt_pk_bf16_f32 v211, v150, v151
v_mfma_f32_16x16x32_bf16 a[136:139], a[240:243], v[188:191], a[136:139]
v_mfma_f32_16x16x32_bf16 v[152:155], a[144:147], v[140:143], v[252:255]
v_exp_f32 v176, v176
v_mfma_f32_16x16x32_bf16 v[156:159], a[160:163], v[140:143], v[252:255]
v_exp_f32 v177, v177
v_mfma_f32_16x16x32_bf16 v[152:155], a[148:151], v[172:175], v[152:155]
v_exp_f32 v178, v178
v_mfma_f32_16x16x32_bf16 v[156:159], a[164:167], v[172:175], v[156:159]
v_exp_f32 v179, v179
v_mfma_f32_16x16x32_bf16 v[152:155], a[152:155], v[204:207], v[152:155]
v_exp_f32 v180, v180
v_mfma_f32_16x16x32_bf16 v[156:159], a[168:171], v[204:207], v[156:159]
s_waitcnt vmcnt(0) lgkmcnt(0)
s_barrier
ds_read_b128 a[144:147], v3 offset:0
v_cvt_pk_bf16_f32 v184, v176, v177
v_mfma_f32_16x16x32_bf16 v[152:155], a[156:159], v[236:239], v[152:155]
v_exp_f32 v181, v181
v_mfma_f32_16x16x32_bf16 v[156:159], a[172:175], v[236:239], v[156:159]
ds_read_b128 a[160:163], v3 offset:4096
v_cvt_pk_bf16_f32 v185, v178, v179
v_mfma_f32_16x16x32_bf16 a[12:15], a[176:179], v[208:211], a[12:15]
v_exp_f32 v182, v182
v_mfma_f32_16x16x32_bf16 a[28:31], a[180:183], v[208:211], a[28:31]
ds_read_b128 a[148:151], v3 offset:1024
v_cvt_pk_bf16_f32 v186, v180, v181
v_mfma_f32_16x16x32_bf16 a[44:47], a[184:187], v[208:211], a[44:47]
v_exp_f32 v183, v183
v_mfma_f32_16x16x32_bf16 a[60:63], a[188:191], v[208:211], a[60:63]
ds_read_b128 a[164:167], v3 offset:5120
v_cvt_pk_bf16_f32 v187, v182, v183
v_mfma_f32_16x16x32_bf16 a[76:79], a[192:195], v[208:211], a[76:79]
ds_read_b128 a[152:155], v3 offset:2048
v_xor_b32 v2, 0x10000, v2
v_mfma_f32_16x16x32_bf16 a[92:95], a[196:199], v[208:211], a[92:95]
ds_read_b128 a[168:171], v3 offset:6144
s_add_u32 s83, s83, 0x10000
s_xor_b32 s84, s84, 0x10000
v_mfma_f32_16x16x32_bf16 a[108:111], a[200:203], v[208:211], a[108:111]
ds_read_b128 a[156:159], v3 offset:3072
s_add_u32 s82, s82, 1
v_mfma_f32_16x16x32_bf16 a[124:127], a[204:207], v[208:211], a[124:127]
ds_read_b128 a[172:175], v3 offset:7168
v_mfma_f32_16x16x32_bf16 a[140:143], a[240:243], v[208:211], a[140:143]
v_xor_b32 v3, 0x10000, v3
s_waitcnt lgkmcnt(4)
s_branch L_sd_done
L_sd_3:
v_mfma_f32_16x16x32_bf16 v[144:147], a[144:147], v[128:131], v[240:243]
v_exp_f32 v152, v152
v_mfma_f32_16x16x32_bf16 v[148:151], a[160:163], v[128:131], v[240:243]
ds_read_b128 a[176:179], v2 offset:8192
v_mfma_f32_16x16x32_bf16 v[144:147], a[148:151], v[160:163], v[144:147]
v_exp_f32 v153, v153
v_mfma_f32_16x16x32_bf16 v[148:151], a[164:167], v[160:163], v[148:151]
ds_read_b128 a[180:183], v2 offset:9216
s_add_u32 m0, s84, 0
v_cvt_pk_bf16_f32 v188, v152, v153
s_waitcnt lgkmcnt(4)
v_mfma_f32_16x16x32_bf16 v[144:147], a[152:155], v[192:195], v[144:147]
v_exp_f32 v154, v154
v_mfma_f32_16x16x32_bf16 v[148:151], a[168:171], v[192:195], v[148:151]
ds_read_b128 a[184:187], v2 offset:10240
buffer_load_dwordx4 v4, s[56:59], s83 offen offset:0 sc1 lds
s_waitcnt lgkmcnt(3)
v_mfma_f32_16x16x32_bf16 v[144:147], a[156:159], v[224:227], v[144:147]
v_exp_f32 v155, v155
v_mfma_f32_16x16x32_bf16 v[148:151], a[172:175], v[224:227], v[148:151]
ds_read_b128 a[188:191], v2 offset:11264
v_cvt_pk_bf16_f32 v189, v154, v155
v_mfma_f32_16x16x32_bf16 a[8:11], a[208:211], v[184:187], a[8:11]
v_exp_f32 v156, v156
v_mfma_f32_16x16x32_bf16 a[24:27], a[212:215], v[184:187], a[24:27]
ds_read_b128 a[192:195], v2 offset:12288
v_mfma_f32_16x16x32_bf16 a[40:43], a[216:219], v[184:187], a[40:43]
v_exp_f32 v157, v157
v_mfma_f32_16x16x32_bf16 a[56:59], a[220:223], v[184:187], a[56:59]
ds_read_b128 a[196:199], v2 offset:13312
v_cvt_pk_bf16_f32 v190, v156, v157
v_mfma_f32_16x16x32_bf16 a[72:75], a[224:227], v[184:187], a[72:75]
v_exp_f32 v158, v158
v_mfma_f32_16x16x32_bf16 a[88:91], a[228:231], v[184:187], a[88:91]
ds_read_b128 a[200:203], v2 offset:14336
v_mfma_f32_16x16x32_bf16 a[104:107], a[232:235], v[184:187], a[104:107]
v_exp_f32 v159, v159
v_mfma_f32_16x16x32_bf16 a[120:123], a[236:239], v[184:187], a[120:123]
ds_read_b128 a[204:207], v2 offset:15360
v_cvt_pk_bf16_f32 v191, v158, v159
v_mfma_f32_16x16x32_bf16 a[136:139], a[240:243], v[184:187], a[136:139]
buffer_load_dwordx4 v4, s[56:59], s83 offen offset:1024 sc1 lds
v_mfma_f32_16x16x32_bf16 v[152:155], a[144:147], v[132:135], v[244:247]
v_exp_f32 v144, v144
v_mfma_f32_16x16x32_bf16 v[156:159], a[160:163], v[132:135], v[244:247]
v_mfma_f32_16x16x32_bf16 v[152:155], a[148:151], v[164:167], v[152:155]
v_exp_f32 v145, v145
v_mfma_f32_16x16x32_bf16 v[156:159], a[164:167], v[164:167], v[156:159]
v_cvt_pk_bf16_f32 v184, v144, v145
v_mfma_f32_16x16x32_bf16 v[152:155], a[152:155], v[196:199], v[152:155]
v_exp_f32 v146, v146
v_mfma_f32_16x16x32_bf16 v[156:159], a[168:171], v[196:199], v[156:159]
buffer_load_dwordx4 v4, s[56:59], s83 offen offset:2048 sc1 lds
v_mfma_f32_16x16x32_bf16 v[152:155], a[156:159], v[228:231], v[152:155]
v_exp_f32 v147, v147
v_mfma_f32_16x16x32_bf16 v[156:159], a[172:175], v[228:231], v[156:159]
v_cvt_pk_bf16_f32 v185, v146, v147
v_mfma_f32_16x16x32_bf16 a[12:15], a[208:211], v[188:191], a[12:15]
v_exp_f32 v148, v148
v_mfma_f32_16x16x32_bf16 a[28:31], a[212:215], v[188:191], a[28:31]
v_mfma_f32_16x16x32_bf16 a[44:47], a[216:219], v[188:191], a[44:47]
v_exp_f32 v149, v149
v_mfma_f32_16x16x32_bf16 a[60:63], a[220:223], v[188:191], a[60:63]
v_cvt_pk_bf16_f32 v186, v148, v149
v_mfma_f32_16x16x32_bf16 a[76:79], a[224:227], v[188:191], a[76:79]
v_exp_f32 v150, v150
v_mfma_f32_16x16x32_bf16 a[92:95], a[228:231], v[188:191], a[92:95]
v_mfma_f32_16x16x32_bf16 a[108:111], a[232:235], v[188:191], a[108:111]
v_exp_f32 v151, v151
v_mfma_f32_16x16x32_bf16 a[124:127], a[236:239], v[188:191], a[124:127]
v_cvt_pk_bf16_f32 v187, v150, v151
v_mfma_f32_16x16x32_bf16 a[140:143], a[240:243], v[188:191], a[140:143]
buffer_load_dwordx4 v4, s[56:59], s83 offen offset:3072 sc1 lds
s_waitcnt lgkmcnt(0)
v_mfma_f32_16x16x32_bf16 v[144:147], a[144:147], v[136:139], v[248:251]
v_exp_f32 v152, v152
v_mfma_f32_16x16x32_bf16 v[148:151], a[160:163], v[136:139], v[248:251]
v_mfma_f32_16x16x32_bf16 v[144:147], a[148:151], v[168:171], v[144:147]
v_exp_f32 v153, v153
v_mfma_f32_16x16x32_bf16 v[148:151], a[164:167], v[168:171], v[148:151]
s_add_u32 m0, s84, 4096
v_cvt_pk_bf16_f32 v188, v152, v153
v_mfma_f32_16x16x32_bf16 v[144:147], a[152:155], v[200:203], v[144:147]
v_exp_f32 v154, v154
v_mfma_f32_16x16x32_bf16 v[148:151], a[168:171], v[200:203], v[148:151]
buffer_load_dwordx4 v5, s[56:59], s83 offen offset:0 sc1 lds
v_mfma_f32_16x16x32_bf16 v[144:147], a[156:159], v[232:235], v[144:147]
v_exp_f32 v155, v155
v_mfma_f32_16x16x32_bf16 v[148:151], a[172:175], v[232:235], v[148:151]
v_cvt_pk_bf16_f32 v189, v154, v155
v_mfma_f32_16x16x32_bf16 a[0:3], a[176:179], v[184:187], a[0:3]
v_exp_f32 v156, v156
v_mfma_f32_16x16x32_bf16 a[16:19], a[180:183], v[184:187], a[16:19]
v_mfma_f32_16x16x32_bf16 a[32:35], a[184:187], v[184:187], a[32:35]
v_exp_f32 v157, v157
v_mfma_f32_16x16x32_bf16 a[48:51], a[188:191], v[184:187], a[48:51]
v_cvt_pk_bf16_f32 v190, v156, v157
v_mfma_f32_16x16x32_bf16 a[64:67], a[192:195], v[184:187], a[64:67]
v_exp_f32 v158, v158
v_mfma_f32_16x16x32_bf16 a[80:83], a[196:199], v[184:187], a[80:83]
v_mfma_f32_16x16x32_bf16 a[96:99], a[200:203], v[184:187], a[96:99]
v_exp_f32 v159, v159
v_mfma_f32_16x16x32_bf16 a[112:115], a[204:207], v[184:187], a[112:115]
v_cvt_pk_bf16_f32 v191, v158, v159
v_mfma_f32_16x16x32_bf16 a[128:131], a[240:243], v[184:187], a[128:131]
buffer_load_dwordx4 v5, s[56:59], s83 offen offset:1024 sc1 lds
v_mfma_f32_16x16x32_bf16 v[152:155], a[144:147], v[140:143], v[252:255]
v_exp_f32 v144, v144
v_mfma_f32_16x16x32_bf16 v[156:159], a[160:163], v[140:143], v[252:255]
ds_read_b128 a[144:147], v2 offset:16384
v_mfma_f32_16x16x32_bf16 v[152:155], a[148:151], v[172:175], v[152:155]
v_exp_f32 v145, v145
v_mfma_f32_16x16x32_bf16 v[156:159], a[164:167], v[172:175], v[156:159]
ds_read_b128 a[160:163], v2 offset:20480
v_cvt_pk_bf16_f32 v184, v144, v145
v_mfma_f32_16x16x32_bf16 v[152:155], a[152:155], v[204:207], v[152:155]
v_exp_f32 v146, v146
v_mfma_f32_16x16x32_bf16 v[156:159], a[168:171], v[204:207], v[156:159]
ds_read_b128 a[148:151], v2 offset:17408
buffer_load_dwordx4 v5, s[56:59], s83 offen offset:2048 sc1 lds
v_mfma_f32_16x16x32_bf16 v[152:155], a[156:159], v[236:239], v[152:155]
v_exp_f32 v147, v147
v_mfma_f32_16x16x32_bf16 v[156:159], a[172:175], v[236:239], v[156:159]
ds_read_b128 a[164:167], v2 offset:21504
v_cvt_pk_bf16_f32 v185, v146, v147
v_mfma_f32_16x16x32_bf16 a[4:7], a[176:179], v[188:191], a[4:7]
v_exp_f32 v148, v148
v_mfma_f32_16x16x32_bf16 a[20:23], a[180:183], v[188:191], a[20:23]
ds_read_b128 a[152:155], v2 offset:18432
v_mfma_f32_16x16x32_bf16 a[36:39], a[184:187], v[188:191], a[36:39]
v_exp_f32 v149, v149
v_mfma_f32_16x16x32_bf16 a[52:55], a[188:191], v[188:191], a[52:55]
ds_read_b128 a[168:171], v2 offset:22528
v_cvt_pk_bf16_f32 v186, v148, v149
v_mfma_f32_16x16x32_bf16 a[68:71], a[192:195], v[188:191], a[68:71]
v_exp_f32 v150, v150
v_mfma_f32_16x16x32_bf16 a[84:87], a[196:199], v[188:191], a[84:87]
ds_read_b128 a[156:159], v2 offset:19456
v_mfma_f32_16x16x32_bf16 a[100:103], a[200:203], v[188:191], a[100:103]
v_exp_f32 v151, v151
v_mfma_f32_16x16x32_bf16 a[116:119], a[204:207], v[188:191], a[116:119]
ds_read_b128 a[172:175], v2 offset:23552
v_cvt_pk_bf16_f32 v187, v150, v151
v_mfma_f32_16x16x32_bf16 a[132:135], a[240:243], v[188:191], a[132:135]
buffer_load_dwordx4 v5, s[56:59], s83 offen offset:3072 sc1 lds
s_waitcnt lgkmcnt(4)
v_mfma_f32_16x16x32_bf16 v[144:147], a[144:147], v[128:131], v[240:243]
v_exp_f32 v152, v152
v_mfma_f32_16x16x32_bf16 v[148:151], a[160:163], v[128:131], v[240:243]
ds_read_b128 a[208:211], v2 offset:24576
v_mfma_f32_16x16x32_bf16 v[144:147], a[148:151], v[160:163], v[144:147]
v_exp_f32 v153, v153
v_mfma_f32_16x16x32_bf16 v[148:151], a[164:167], v[160:163], v[148:151]
ds_read_b128 a[212:215], v2 offset:25600
s_add_u32 m0, s84, 8192
v_cvt_pk_bf16_f32 v188, v152, v153
s_waitcnt lgkmcnt(4)
v_mfma_f32_16x16x32_bf16 v[144:147], a[152:155], v[192:195], v[144:147]
v_exp_f32 v154, v154
v_mfma_f32_16x16x32_bf16 v[148:151], a[168:171], v[192:195], v[148:151]
ds_read_b128 a[216:219], v2 offset:26624
buffer_load_dwordx4 v6, s[56:59], s83 offen offset:0 sc1 lds
s_waitcnt lgkmcnt(3)
v_mfma_f32_16x16x32_bf16 v[144:147], a[156:159], v[224:227], v[144:147]
v_exp_f32 v155, v155
v_mfma_f32_16x16x32_bf16 v[148:151], a[172:175], v[224:227], v[148:151]
ds_read_b128 a[220:223], v2 offset:27648
v_cvt_pk_bf16_f32 v189, v154, v155
v_mfma_f32_16x16x32_bf16 a[8:11], a[176:179], v[184:187], a[8:11]
v_exp_f32 v156, v156
v_mfma_f32_16x16x32_bf16 a[24:27], a[180:183], v[184:187], a[24:27]
ds_read_b128 a[224:227], v2 offset:28672
v_mfma_f32_16x16x32_bf16 a[40:43], a[184:187], v[184:187], a[40:43]
v_exp_f32 v157, v157
v_mfma_f32_16x16x32_bf16 a[56:59], a[188:191], v[184:187], a[56:59]
ds_read_b128 a[228:231], v2 offset:29696
v_cvt_pk_bf16_f32 v190, v156, v157
v_mfma_f32_16x16x32_bf16 a[72:75], a[192:195], v[184:187], a[72:75]
v_exp_f32 v158, v158
v_mfma_f32_16x16x32_bf16 a[88:91], a[196:199], v[184:187], a[88:91]
ds_read_b128 a[232:235], v2 offset:30720
v_mfma_f32_16x16x32_bf16 a[104:107], a[200:203], v[184:187], a[104:107]
v_exp_f32 v159, v159
v_mfma_f32_16x16x32_bf16 a[120:123], a[204:207], v[184:187], a[120:123]
ds_read_b128 a[236:239], v2 offset:31744
v_cvt_pk_bf16_f32 v191, v158, v159
v_mfma_f32_16x16x32_bf16 a[136:139], a[240:243], v[184:187], a[136:139]
buffer_load_dwordx4 v6, s[56:59], s83 offen offset:1024 sc1 lds
v_add_f32 v216, v244, v212
v_add_f32 v217, v245, v213
v_add_f32 v218, v246, v214
v_add_f32 v219, v247, v215
v_mfma_f32_16x16x32_bf16 v[152:155], a[144:147], v[132:135], v[244:247]
v_exp_f32 v144, v144
v_mfma_f32_16x16x32_bf16 v[156:159], a[160:163], v[132:135], v[216:219]
v_mfma_f32_16x16x32_bf16 v[152:155], a[148:151], v[164:167], v[152:155]
v_exp_f32 v145, v145
v_mfma_f32_16x16x32_bf16 v[156:159], a[164:167], v[164:167], v[156:159]
v_cvt_pk_bf16_f32 v184, v144, v145
v_mfma_f32_16x16x32_bf16 v[152:155], a[152:155], v[196:199], v[152:155]
v_exp_f32 v146, v146
v_mfma_f32_16x16x32_bf16 v[156:159], a[168:171], v[196:199], v[156:159]
buffer_load_dwordx4 v6, s[56:59], s83 offen offset:2048 sc1 lds
v_mfma_f32_16x16x32_bf16 v[152:155], a[156:159], v[228:231], v[152:155]
v_exp_f32 v147, v147
v_mfma_f32_16x16x32_bf16 v[156:159], a[172:175], v[228:231], v[156:159]
v_cvt_pk_bf16_f32 v185, v146, v147
v_mfma_f32_16x16x32_bf16 a[12:15], a[176:179], v[188:191], a[12:15]
v_exp_f32 v148, v148
v_mfma_f32_16x16x32_bf16 a[28:31], a[180:183], v[188:191], a[28:31]
v_mfma_f32_16x16x32_bf16 a[44:47], a[184:187], v[188:191], a[44:47]
v_exp_f32 v149, v149
v_mfma_f32_16x16x32_bf16 a[60:63], a[188:191], v[188:191], a[60:63]
v_cvt_pk_bf16_f32 v186, v148, v149
v_mfma_f32_16x16x32_bf16 a[76:79], a[192:195], v[188:191], a[76:79]
v_exp_f32 v150, v150
v_mfma_f32_16x16x32_bf16 a[92:95], a[196:199], v[188:191], a[92:95]
v_mfma_f32_16x16x32_bf16 a[108:111], a[200:203], v[188:191], a[108:111]
v_exp_f32 v151, v151
v_mfma_f32_16x16x32_bf16 a[124:127], a[204:207], v[188:191], a[124:127]
v_cvt_pk_bf16_f32 v187, v150, v151
v_mfma_f32_16x16x32_bf16 a[140:143], a[240:243], v[188:191], a[140:143]
buffer_load_dwordx4 v6, s[56:59], s83 offen offset:3072 sc1 lds
s_waitcnt lgkmcnt(0)
v_mfma_f32_16x16x32_bf16 v[144:147], a[144:147], v[136:139], v[248:251]
v_exp_f32 v152, v152
v_mfma_f32_16x16x32_bf16 v[148:151], a[160:163], v[136:139], v[248:251]
v_mfma_f32_16x16x32_bf16 v[144:147], a[148:151], v[168:171], v[144:147]
v_exp_f32 v153, v153
v_mfma_f32_16x16x32_bf16 v[148:151], a[164:167], v[168:171], v[148:151]
s_add_u32 m0, s84, 12288
v_cvt_pk_bf16_f32 v188, v152, v153
v_mfma_f32_16x16x32_bf16 v[144:147], a[152:155], v[200:203], v[144:147]
v_exp_f32 v154, v154
v_mfma_f32_16x16x32_bf16 v[148:151], a[168:171], v[200:203], v[148:151]
buffer_load_dwordx4 v7, s[56:59], s83 offen offset:0 sc1 lds
v_mfma_f32_16x16x32_bf16 v[144:147], a[156:159], v[232:235], v[144:147]
v_exp_f32 v155, v155
v_mfma_f32_16x16x32_bf16 v[148:151], a[172:175], v[232:235], v[148:151]
v_cvt_pk_bf16_f32 v189, v154, v155
v_mfma_f32_16x16x32_bf16 a[0:3], a[208:211], v[184:187], a[0:3]
v_exp_f32 v156, v156
v_mfma_f32_16x16x32_bf16 a[16:19], a[212:215], v[184:187], a[16:19]
v_mfma_f32_16x16x32_bf16 a[32:35], a[216:219], v[184:187], a[32:35]
v_exp_f32 v157, v157
v_mfma_f32_16x16x32_bf16 a[48:51], a[220:223], v[184:187], a[48:51]
v_cvt_pk_bf16_f32 v190, v156, v157
v_mfma_f32_16x16x32_bf16 a[64:67], a[224:227], v[184:187], a[64:67]
v_exp_f32 v158, v158
v_mfma_f32_16x16x32_bf16 a[80:83], a[228:231], v[184:187], a[80:83]
v_mfma_f32_16x16x32_bf16 a[96:99], a[232:235], v[184:187], a[96:99]
v_exp_f32 v159, v159
v_mfma_f32_16x16x32_bf16 a[112:115], a[236:239], v[184:187], a[112:115]
v_cvt_pk_bf16_f32 v191, v158, v159
v_mfma_f32_16x16x32_bf16 a[128:131], a[240:243], v[184:187], a[128:131]
buffer_load_dwordx4 v7, s[56:59], s83 offen offset:1024 sc1 lds
v_mfma_f32_16x16x32_bf16 v[152:155], a[144:147], v[140:143], v[252:255]
v_exp_f32 v144, v144
v_mfma_f32_16x16x32_bf16 v[156:159], a[160:163], v[140:143], v[252:255]
ds_read_b128 a[144:147], v2 offset:32768
v_mfma_f32_16x16x32_bf16 v[152:155], a[148:151], v[172:175], v[152:155]
v_exp_f32 v145, v145
v_mfma_f32_16x16x32_bf16 v[156:159], a[164:167], v[172:175], v[156:159]
ds_read_b128 a[160:163], v2 offset:36864
v_cvt_pk_bf16_f32 v184, v144, v145
v_mfma_f32_16x16x32_bf16 v[152:155], a[152:155], v[204:207], v[152:155]
v_exp_f32 v146, v146
v_mfma_f32_16x16x32_bf16 v[156:159], a[168:171], v[204:207], v[156:159]
ds_read_b128 a[148:151], v2 offset:33792
buffer_load_dwordx4 v7, s[56:59], s83 offen offset:2048 sc1 lds
v_mfma_f32_16x16x32_bf16 v[152:155], a[156:159], v[236:239], v[152:155]
v_exp_f32 v147, v147
v_mfma_f32_16x16x32_bf16 v[156:159], a[172:175], v[236:239], v[156:159]
ds_read_b128 a[164:167], v2 offset:37888
v_cvt_pk_bf16_f32 v185, v146, v147
v_mfma_f32_16x16x32_bf16 a[4:7], a[208:211], v[188:191], a[4:7]
v_exp_f32 v148, v148
v_mfma_f32_16x16x32_bf16 a[20:23], a[212:215], v[188:191], a[20:23]
ds_read_b128 a[152:155], v2 offset:34816
v_mfma_f32_16x16x32_bf16 a[36:39], a[216:219], v[188:191], a[36:39]
v_exp_f32 v149, v149
v_mfma_f32_16x16x32_bf16 a[52:55], a[220:223], v[188:191], a[52:55]
ds_read_b128 a[168:171], v2 offset:38912
v_cvt_pk_bf16_f32 v186, v148, v149
v_mfma_f32_16x16x32_bf16 a[68:71], a[224:227], v[188:191], a[68:71]
v_exp_f32 v150, v150
v_mfma_f32_16x16x32_bf16 a[84:87], a[228:231], v[188:191], a[84:87]
ds_read_b128 a[156:159], v2 offset:35840
v_mfma_f32_16x16x32_bf16 a[100:103], a[232:235], v[188:191], a[100:103]
v_exp_f32 v151, v151
v_mfma_f32_16x16x32_bf16 a[116:119], a[236:239], v[188:191], a[116:119]
ds_read_b128 a[172:175], v2 offset:39936
v_cvt_pk_bf16_f32 v187, v150, v151
v_mfma_f32_16x16x32_bf16 a[132:135], a[240:243], v[188:191], a[132:135]
buffer_load_dwordx4 v7, s[56:59], s83 offen offset:3072 sc1 lds
s_waitcnt lgkmcnt(4)
v_add_f32 v216, v240, v212
v_add_f32 v217, v241, v213
v_add_f32 v218, v242, v214
v_add_f32 v219, v243, v215
s_nop 1
v_mfma_f32_16x16x32_bf16 v[144:147], a[144:147], v[128:131], v[216:219]
v_exp_f32 v152, v152
v_mfma_f32_16x16x32_bf16 v[144:147], a[148:151], v[160:163], v[144:147]
ds_read_b128 a[176:179], v2 offset:40960
s_waitcnt lgkmcnt(4)
v_mfma_f32_16x16x32_bf16 v[144:147], a[152:155], v[192:195], v[144:147]
v_exp_f32 v153, v153
s_waitcnt lgkmcnt(2)
v_mfma_f32_16x16x32_bf16 v[144:147], a[156:159], v[224:227], v[144:147]
ds_read_b128 a[180:183], v2 offset:41984
v_cvt_pk_bf16_f32 v188, v152, v153
v_mfma_f32_16x16x32_bf16 a[8:11], a[208:211], v[184:187], a[8:11]
v_exp_f32 v154, v154
v_mfma_f32_16x16x32_bf16 a[24:27], a[212:215], v[184:187], a[24:27]
ds_read_b128 a[184:187], v2 offset:43008
v_mfma_f32_16x16x32_bf16 a[40:43], a[216:219], v[184:187], a[40:43]
v_exp_f32 v155, v155
v_mfma_f32_16x16x32_bf16 a[56:59], a[220:223], v[184:187], a[56:59]
ds_read_b128 a[188:191], v2 offset:44032
v_cvt_pk_bf16_f32 v189, v154, v155
v_mfma_f32_16x16x32_bf16 a[72:75], a[224:227], v[184:187], a[72:75]
v_exp_f32 v156, v156
v_mfma_f32_16x16x32_bf16 a[88:91], a[228:231], v[184:187], a[88:91]
ds_read_b128 a[192:195], v2 offset:45056
v_mfma_f32_16x16x32_bf16 a[104:107], a[232:235], v[184:187], a[104:107]
v_exp_f32 v157, v157
v_mfma_f32_16x16x32_bf16 a[120:123], a[236:239], v[184:187], a[120:123]
ds_read_b128 a[196:199], v2 offset:46080
v_cvt_pk_bf16_f32 v190, v156, v157
v_mfma_f32_16x16x32_bf16 a[136:139], a[240:243], v[184:187], a[136:139]
v_exp_f32 v158, v158
ds_read_b128 a[200:203], v2 offset:47104
ds_read_b128 a[204:207], v2 offset:48128
v_exp_f32 v159, v159
s_nop 0
v_cvt_pk_bf16_f32 v191, v158, v159
v_mfma_f32_16x16x32_bf16 v[152:155], a[144:147], v[136:139], v[248:251]
v_exp_f32 v144, v144
v_mfma_f32_16x16x32_bf16 v[156:159], a[160:163], v[136:139], v[248:251]
v_mfma_f32_16x16x32_bf16 v[152:155], a[148:151], v[168:171], v[152:155]
v_exp_f32 v145, v145
v_mfma_f32_16x16x32_bf16 v[156:159], a[164:167], v[168:171], v[156:159]
v_cvt_pk_bf16_f32 v184, v144, v145
v_mfma_f32_16x16x32_bf16 v[152:155], a[152:155], v[200:203], v[152:155]
v_exp_f32 v146, v146
v_mfma_f32_16x16x32_bf16 v[156:159], a[168:171], v[200:203], v[156:159]
s_waitcnt lgkmcnt(8)
v_mfma_f32_16x16x32_bf16 v[152:155], a[156:159], v[232:235], v[152:155]
v_exp_f32 v147, v147
v_mfma_f32_16x16x32_bf16 v[156:159], a[172:175], v[232:235], v[156:159]
v_cvt_pk_bf16_f32 v185, v146, v147
v_mfma_f32_16x16x32_bf16 a[12:15], a[208:211], v[188:191], a[12:15]
v_mov_b32 v186, 0
v_mfma_f32_16x16x32_bf16 a[28:31], a[212:215], v[188:191], a[28:31]
v_mov_b32 v187, 0
v_mfma_f32_16x16x32_bf16 a[44:47], a[216:219], v[188:191], a[44:47]
v_mfma_f32_16x16x32_bf16 a[60:63], a[220:223], v[188:191], a[60:63]
v_mfma_f32_16x16x32_bf16 a[76:79], a[224:227], v[188:191], a[76:79]
v_mfma_f32_16x16x32_bf16 a[92:95], a[228:231], v[188:191], a[92:95]
v_mfma_f32_16x16x32_bf16 a[108:111], a[232:235], v[188:191], a[108:111]
v_mfma_f32_16x16x32_bf16 a[124:127], a[236:239], v[188:191], a[124:127]
v_mfma_f32_16x16x32_bf16 a[140:143], a[240:243], v[188:191], a[140:143]
s_waitcnt lgkmcnt(0)
v_mfma_f32_16x16x32_bf16 v[144:147], a[144:147], v[140:143], v[252:255]
v_exp_f32 v152, v152
v_mfma_f32_16x16x32_bf16 v[148:151], a[160:163], v[140:143], v[252:255]
ds_read_b128 a[144:147], v2 offset:49152
v_mfma_f32_16x16x32_bf16 v[144:147], a[148:151], v[172:175], v[144:147]
v_exp_f32 v153, v153
v_mfma_f32_16x16x32_bf16 v[148:151], a[164:167], v[172:175], v[148:151]
ds_read_b128 a[160:163], v2 offset:53248
v_cvt_pk_bf16_f32 v188, v152, v153
v_mfma_f32_16x16x32_bf16 v[144:147], a[152:155], v[204:207], v[144:147]
v_exp_f32 v154, v154
v_mfma_f32_16x16x32_bf16 v[148:151], a[168:171], v[204:207], v[148:151]
ds_read_b128 a[148:151], v2 offset:50176
v_mfma_f32_16x16x32_bf16 v[144:147], a[156:159], v[236:239], v[144:147]
v_exp_f32 v155, v155
v_mfma_f32_16x16x32_bf16 v[148:151], a[172:175], v[236:239], v[148:151]
ds_read_b128 a[164:167], v2 offset:54272
v_cvt_pk_bf16_f32 v189, v154, v155
v_mfma_f32_16x16x32_bf16 a[0:3], a[176:179], v[184:187], a[0:3]
v_exp_f32 v156, v156
v_mfma_f32_16x16x32_bf16 a[16:19], a[180:183], v[184:187], a[16:19]
ds_read_b128 a[152:155], v2 offset:51200
v_mfma_f32_16x16x32_bf16 a[32:35], a[184:187], v[184:187], a[32:35]
v_exp_f32 v157, v157
v_mfma_f32_16x16x32_bf16 a[48:51], a[188:191], v[184:187], a[48:51]
ds_read_b128 a[168:171], v2 offset:55296
v_cvt_pk_bf16_f32 v190, v156, v157
v_mfma_f32_16x16x32_bf16 a[64:67], a[192:195], v[184:187], a[64:67]
v_exp_f32 v158, v158
v_mfma_f32_16x16x32_bf16 a[80:83], a[196:199], v[184:187], a[80:83]
ds_read_b128 a[156:159], v2 offset:52224
v_mfma_f32_16x16x32_bf16 a[96:99], a[200:203], v[184:187], a[96:99]
v_exp_f32 v159, v159
v_mfma_f32_16x16x32_bf16 a[112:115], a[204:207], v[184:187], a[112:115]
ds_read_b128 a[172:175], v2 offset:56320
v_cvt_pk_bf16_f32 v191, v158, v159
v_mfma_f32_16x16x32_bf16 a[128:131], a[240:243], v[184:187], a[128:131]
s_waitcnt lgkmcnt(4)
v_mfma_f32_16x16x32_bf16 v[176:179], a[144:147], v[136:139], v[248:251]
v_exp_f32 v144, v144
v_mfma_f32_16x16x32_bf16 v[180:183], a[160:163], v[136:139], v[248:251]
ds_read_b128 a[208:211], v2 offset:57344
v_mfma_f32_16x16x32_bf16 v[176:179], a[148:151], v[168:171], v[176:179]
v_exp_f32 v145, v145
v_mfma_f32_16x16x32_bf16 v[180:183], a[164:167], v[168:171], v[180:183]
ds_read_b128 a[212:215], v2 offset:58368
v_cvt_pk_bf16_f32 v208, v144, v145
s_waitcnt lgkmcnt(4)
v_mfma_f32_16x16x32_bf16 v[176:179], a[152:155], v[200:203], v[176:179]
v_exp_f32 v146, v146
v_mfma_f32_16x16x32_bf16 v[180:183], a[168:171], v[200:203], v[180:183]
ds_read_b128 a[216:219], v2 offset:59392
s_waitcnt lgkmcnt(3)
v_mfma_f32_16x16x32_bf16 v[176:179], a[156:159], v[232:235], v[176:179]
v_exp_f32 v147, v147
v_mfma_f32_16x16x32_bf16 v[180:183], a[172:175], v[232:235], v[180:183]
ds_read_b128 a[220:223], v2 offset:60416
v_cvt_pk_bf16_f32 v209, v146, v147
v_mfma_f32_16x16x32_bf16 a[8:11], a[176:179], v[188:191], a[8:11]
v_exp_f32 v148, v148
v_mfma_f32_16x16x32_bf16 a[24:27], a[180:183], v[188:191], a[24:27]
ds_read_b128 a[224:227], v2 offset:61440
v_mfma_f32_16x16x32_bf16 a[40:43], a[184:187], v[188:191], a[40:43]
v_exp_f32 v149, v149
v_mfma_f32_16x16x32_bf16 a[56:59], a[188:191], v[188:191], a[56:59]
ds_read_b128 a[228:231], v2 offset:62464
v_cvt_pk_bf16_f32 v210, v148, v149
v_mfma_f32_16x16x32_bf16 a[72:75], a[192:195], v[188:191], a[72:75]
v_exp_f32 v150, v150
v_mfma_f32_16x16x32_bf16 a[88:91], a[196:199], v[188:191], a[88:91]
ds_read_b128 a[232:235], v2 offset:63488
v_mfma_f32_16x16x32_bf16 a[104:107], a[200:203], v[188:191], a[104:107]
v_exp_f32 v151, v151
v_mfma_f32_16x16x32_bf16 a[120:123], a[204:207], v[188:191], a[120:123]
ds_read_b128 a[236:239], v2 offset:64512
v_cvt_pk_bf16_f32 v211, v150, v151
v_mfma_f32_16x16x32_bf16 a[136:139], a[240:243], v[188:191], a[136:139]
v_mfma_f32_16x16x32_bf16 v[152:155], a[144:147], v[140:143], v[252:255]
v_exp_f32 v176, v176
v_mfma_f32_16x16x32_bf16 v[156:159], a[160:163], v[140:143], v[252:255]
v_exp_f32 v177, v177
v_mfma_f32_16x16x32_bf16 v[152:155], a[148:151], v[172:175], v[152:155]
v_exp_f32 v178, v178
v_mfma_f32_16x16x32_bf16 v[156:159], a[164:167], v[172:175], v[156:159]
v_exp_f32 v179, v179
v_mfma_f32_16x16x32_bf16 v[152:155], a[152:155], v[204:207], v[152:155]
v_exp_f32 v180, v180
v_mfma_f32_16x16x32_bf16 v[156:159], a[168:171], v[204:207], v[156:159]
s_waitcnt vmcnt(0) lgkmcnt(0)
s_barrier
ds_read_b128 a[144:147], v3 offset:0
v_cvt_pk_bf16_f32 v184, v176, v177
v_mfma_f32_16x16x32_bf16 v[152:155], a[156:159], v[236:239], v[152:155]
v_exp_f32 v181, v181
v_mfma_f32_16x16x32_bf16 v[156:159], a[172:175], v[236:239], v[156:159]
ds_read_b128 a[160:163], v3 offset:4096
v_cvt_pk_bf16_f32 v185, v178, v179
v_mfma_f32_16x16x32_bf16 a[12:15], a[176:179], v[208:211], a[12:15]
v_exp_f32 v182, v182
v_mfma_f32_16x16x32_bf16 a[28:31], a[180:183], v[208:211], a[28:31]
ds_read_b128 a[148:151], v3 offset:1024
v_cvt_pk_bf16_f32 v186, v180, v181
v_mfma_f32_16x16x32_bf16 a[44:47], a[184:187], v[208:211], a[44:47]
v_exp_f32 v183, v183
v_mfma_f32_16x16x32_bf16 a[60:63], a[188:191], v[208:211], a[60:63]
ds_read_b128 a[164:167], v3 offset:5120
v_cvt_pk_bf16_f32 v187, v182, v183
v_mfma_f32_16x16x32_bf16 a[76:79], a[192:195], v[208:211], a[76:79]
ds_read_b128 a[152:155], v3 offset:2048
v_xor_b32 v2, 0x10000, v2
v_mfma_f32_16x16x32_bf16 a[92:95], a[196:199], v[208:211], a[92:95]
ds_read_b128 a[168:171], v3 offset:6144
s_add_u32 s83, s83, 0x10000
s_xor_b32 s84, s84, 0x10000
v_mfma_f32_16x16x32_bf16 a[108:111], a[200:203], v[208:211], a[108:111]
ds_read_b128 a[156:159], v3 offset:3072
s_add_u32 s82, s82, 1
v_mfma_f32_16x16x32_bf16 a[124:127], a[204:207], v[208:211], a[124:127]
ds_read_b128 a[172:175], v3 offset:7168
v_mfma_f32_16x16x32_bf16 a[140:143], a[240:243], v[208:211], a[140:143]
v_xor_b32 v3, 0x10000, v3
s_waitcnt lgkmcnt(4)
L_sd_done:
s_lshl_b32 s70, s92, 17
s_lshl_b32 s71, s65, 12
s_add_u32 s70, s70, s71
s_add_u32 s72, s70, 37748736
s_lshl_b32 s70, s93, 17
s_lshl_b32 s71, s65, 12
s_add_u32 s70, s70, s71
s_add_u32 s73, s70, 37748736
v_accvgpr_read_b32 v24, a128
v_mov_b32 v16, 0x2b800000
v_mov_b32 v17, 0x67800000
v_cmp_ge_f32 vcc, v24, v16
v_cmp_le_f32 s[14:15], v24, v17
s_nop 0
s_and_b64 vcc, vcc, s[14:15]
s_cmp_eq_u64 vcc, exec
s_cbranch_scc0 L_slow_0
L_slow_ret_0:
v_accvgpr_read_b32 v25, a132
v_mov_b32 v16, 0x2b800000
v_mov_b32 v17, 0x67800000
v_cmp_ge_f32 vcc, v25, v16
v_cmp_le_f32 s[14:15], v25, v17
s_nop 0
s_and_b64 vcc, vcc, s[14:15]
s_cmp_eq_u64 vcc, exec
s_cbranch_scc0 L_slow_1
L_slow_ret_1:
v_accvgpr_read_b32 v24, a128
v_accvgpr_read_b32 v25, a132
v_rcp_f32 v26, v24
v_rcp_f32 v27, v25
v_accvgpr_read_b32 v16, a0
v_accvgpr_read_b32 v17, a1
v_accvgpr_read_b32 v18, a2
v_accvgpr_read_b32 v19, a3
v_accvgpr_read_b32 v20, a16
v_accvgpr_read_b32 v21, a17
v_accvgpr_read_b32 v22, a18
v_accvgpr_read_b32 v23, a19
v_mul_f32 v16, v16, v26
v_mul_f32 v17, v17, v26
v_mul_f32 v18, v18, v26
v_mul_f32 v19, v19, v26
v_mul_f32 v20, v20, v26
v_mul_f32 v21, v21, v26
v_mul_f32 v22, v22, v26
v_mul_f32 v23, v23, v26
v_cvt_pk_bf16_f32 v64, v16, v17
v_cvt_pk_bf16_f32 v65, v18, v19
v_cvt_pk_bf16_f32 v66, v20, v21
v_cvt_pk_bf16_f32 v67, v22, v23
buffer_store_dwordx4 v[64:67], v10, s[44:47], s72 offen offset:0 sc1
v_accvgpr_read_b32 v16, a32
v_accvgpr_read_b32 v17, a33
v_accvgpr_read_b32 v18, a34
v_accvgpr_read_b32 v19, a35
v_accvgpr_read_b32 v20, a48
v_accvgpr_read_b32 v21, a49
v_accvgpr_read_b32 v22, a50
v_accvgpr_read_b32 v23, a51
v_mul_f32 v16, v16, v26
v_mul_f32 v17, v17, v26
v_mul_f32 v18, v18, v26
v_mul_f32 v19, v19, v26
v_mul_f32 v20, v20, v26
v_mul_f32 v21, v21, v26
v_mul_f32 v22, v22, v26
v_mul_f32 v23, v23, v26
v_cvt_pk_bf16_f32 v68, v16, v17
v_cvt_pk_bf16_f32 v69, v18, v19
v_cvt_pk_bf16_f32 v70, v20, v21
v_cvt_pk_bf16_f32 v71, v22, v23
buffer_store_dwordx4 v[68:71], v10, s[44:47], s72 offen offset:1024 sc1
v_accvgpr_read_b32 v16, a64
v_accvgpr_read_b32 v17, a65
v_accvgpr_read_b32 v18, a66
v_accvgpr_read_b32 v19, a67
v_accvgpr_read_b32 v20, a80
v_accvgpr_read_b32 v21, a81
v_accvgpr_read_b32 v22, a82
v_accvgpr_read_b32 v23, a83
v_mul_f32 v16, v16, v26
v_mul_f32 v17, v17, v26
v_mul_f32 v18, v18, v26
v_mul_f32 v19, v19, v26
v_mul_f32 v20, v20, v26
v_mul_f32 v21, v21, v26
v_mul_f32 v22, v22, v26
v_mul_f32 v23, v23, v26
v_cvt_pk_bf16_f32 v72, v16, v17
v_cvt_pk_bf16_f32 v73, v18, v19
v_cvt_pk_bf16_f32 v74, v20, v21
v_cvt_pk_bf16_f32 v75, v22, v23
buffer_store_dwordx4 v[72:75], v10, s[44:47], s72 offen offset:2048 sc1
v_accvgpr_read_b32 v16, a96
v_accvgpr_read_b32 v17, a97
v_accvgpr_read_b32 v18, a98
v_accvgpr_read_b32 v19, a99
v_accvgpr_read_b32 v20, a112
v_accvgpr_read_b32 v21, a113
v_accvgpr_read_b32 v22, a114
v_accvgpr_read_b32 v23, a115
v_mul_f32 v16, v16, v26
v_mul_f32 v17, v17, v26
v_mul_f32 v18, v18, v26
v_mul_f32 v19, v19, v26
v_mul_f32 v20, v20, v26
v_mul_f32 v21, v21, v26
v_mul_f32 v22, v22, v26
v_mul_f32 v23, v23, v26
v_cvt_pk_bf16_f32 v76, v16, v17
v_cvt_pk_bf16_f32 v77, v18, v19
v_cvt_pk_bf16_f32 v78, v20, v21
v_cvt_pk_bf16_f32 v79, v22, v23
buffer_store_dwordx4 v[76:79], v10, s[44:47], s72 offen offset:3072 sc1
v_accvgpr_read_b32 v16, a4
v_accvgpr_read_b32 v17, a5
v_accvgpr_read_b32 v18, a6
v_accvgpr_read_b32 v19, a7
v_accvgpr_read_b32 v20, a20
v_accvgpr_read_b32 v21, a21
v_accvgpr_read_b32 v22, a22
v_accvgpr_read_b32 v23, a23
v_mul_f32 v16, v16, v27
v_mul_f32 v17, v17, v27
v_mul_f32 v18, v18, v27
v_mul_f32 v19, v19, v27
v_mul_f32 v20, v20, v27
v_mul_f32 v21, v21, v27
v_mul_f32 v22, v22, v27
v_mul_f32 v23, v23, v27
v_cvt_pk_bf16_f32 v80, v16, v17
v_cvt_pk_bf16_f32 v81, v18, v19
v_cvt_pk_bf16_f32 v82, v20, v21
v_cvt_pk_bf16_f32 v83, v22, v23
buffer_store_dwordx4 v[80:83], v10, s[44:47], s73 offen offset:0 sc1
v_accvgpr_read_b32 v16, a36
v_accvgpr_read_b32 v17, a37
v_accvgpr_read_b32 v18, a38
v_accvgpr_read_b32 v19, a39
v_accvgpr_read_b32 v20, a52
v_accvgpr_read_b32 v21, a53
v_accvgpr_read_b32 v22, a54
v_accvgpr_read_b32 v23, a55
v_mul_f32 v16, v16, v27
v_mul_f32 v17, v17, v27
v_mul_f32 v18, v18, v27
v_mul_f32 v19, v19, v27
v_mul_f32 v20, v20, v27
v_mul_f32 v21, v21, v27
v_mul_f32 v22, v22, v27
v_mul_f32 v23, v23, v27
v_cvt_pk_bf16_f32 v84, v16, v17
v_cvt_pk_bf16_f32 v85, v18, v19
v_cvt_pk_bf16_f32 v86, v20, v21
v_cvt_pk_bf16_f32 v87, v22, v23
buffer_store_dwordx4 v[84:87], v10, s[44:47], s73 offen offset:1024 sc1
v_accvgpr_read_b32 v16, a68
v_accvgpr_read_b32 v17, a69
v_accvgpr_read_b32 v18, a70
v_accvgpr_read_b32 v19, a71
v_accvgpr_read_b32 v20, a84
v_accvgpr_read_b32 v21, a85
v_accvgpr_read_b32 v22, a86
v_accvgpr_read_b32 v23, a87
v_mul_f32 v16, v16, v27
v_mul_f32 v17, v17, v27
v_mul_f32 v18, v18, v27
v_mul_f32 v19, v19, v27
v_mul_f32 v20, v20, v27
v_mul_f32 v21, v21, v27
v_mul_f32 v22, v22, v27
v_mul_f32 v23, v23, v27
v_cvt_pk_bf16_f32 v88, v16, v17
v_cvt_pk_bf16_f32 v89, v18, v19
v_cvt_pk_bf16_f32 v90, v20, v21
v_cvt_pk_bf16_f32 v91, v22, v23
buffer_store_dwordx4 v[88:91], v10, s[44:47], s73 offen offset:2048 sc1
v_accvgpr_read_b32 v16, a100
v_accvgpr_read_b32 v17, a101
v_accvgpr_read_b32 v18, a102
v_accvgpr_read_b32 v19, a103
v_accvgpr_read_b32 v20, a116
v_accvgpr_read_b32 v21, a117
v_accvgpr_read_b32 v22, a118
v_accvgpr_read_b32 v23, a119
v_mul_f32 v16, v16, v27
v_mul_f32 v17, v17, v27
v_mul_f32 v18, v18, v27
v_mul_f32 v19, v19, v27
v_mul_f32 v20, v20, v27
v_mul_f32 v21, v21, v27
v_mul_f32 v22, v22, v27
v_mul_f32 v23, v23, v27
v_cvt_pk_bf16_f32 v92, v16, v17
v_cvt_pk_bf16_f32 v93, v18, v19
v_cvt_pk_bf16_f32 v94, v20, v21
v_cvt_pk_bf16_f32 v95, v22, v23
buffer_store_dwordx4 v[92:95], v10, s[44:47], s73 offen offset:3072 sc1
s_mov_b32 s81, 1
s_lshl_b32 s78, s67, 3
s_add_u32 s78, s78, s66
s_lshl_b32 s78, s78, 2
s_add_u32 s78, s78, s64
s_lshl_b32 s78, s78, 5
s_add_u32 s78, s78, 69210112
s_cmp_ge_u32 s82, s85
s_cbranch_scc1 L_solo_done
L_solo:
v_mfma_f32_16x16x32_bf16 v[144:147], a[144:147], v[136:139], v[248:251]
v_exp_f32 v152, v152
v_mfma_f32_16x16x32_bf16 v[148:151], a[160:163], v[136:139], v[248:251]
ds_read_b128 a[176:179], v2 offset:8192
s_add_u32 m0, s84, 0
s_nop 0
buffer_load_dwordx4 v4, s[56:59], s83 offen offset:0 sc1 lds
v_mfma_f32_16x16x32_bf16 v[144:147], a[148:151], v[168:171], v[144:147]
v_exp_f32 v153, v153
v_mfma_f32_16x16x32_bf16 v[148:151], a[164:167], v[168:171], v[148:151]
ds_read_b128 a[180:183], v2 offset:9216
v_cvt_pk_bf16_f32 v188, v152, v153
s_waitcnt lgkmcnt(4)
v_mfma_f32_16x16x32_bf16 v[144:147], a[152:155], v[200:203], v[144:147]
v_exp_f32 v154, v154
v_mfma_f32_16x16x32_bf16 v[148:151], a[168:171], v[200:203], v[148:151]
ds_read_b128 a[184:187], v2 offset:10240
buffer_load_dwordx4 v4, s[56:59], s83 offen offset:1024 sc1 lds
s_waitcnt lgkmcnt(3)
v_mfma_f32_16x16x32_bf16 v[144:147], a[156:159], v[232:235], v[144:147]
v_exp_f32 v155, v155
v_mfma_f32_16x16x32_bf16 v[148:151], a[172:175], v[232:235], v[148:151]
ds_read_b128 a[188:191], v2 offset:11264
v_cvt_pk_bf16_f32 v189, v154, v155
v_mfma_f32_16x16x32_bf16 a[8:11], a[208:211], v[184:187], a[8:11]
v_exp_f32 v156, v156
v_mfma_f32_16x16x32_bf16 a[24:27], a[212:215], v[184:187], a[24:27]
ds_read_b128 a[192:195], v2 offset:12288
buffer_load_dwordx4 v4, s[56:59], s83 offen offset:2048 sc1 lds
v_mfma_f32_16x16x32_bf16 a[40:43], a[216:219], v[184:187], a[40:43]
v_exp_f32 v157, v157
v_mfma_f32_16x16x32_bf16 a[56:59], a[220:223], v[184:187], a[56:59]
ds_read_b128 a[196:199], v2 offset:13312
v_cvt_pk_bf16_f32 v190, v156, v157
v_mfma_f32_16x16x32_bf16 a[72:75], a[224:227], v[184:187], a[72:75]
v_exp_f32 v158, v158
v_mfma_f32_16x16x32_bf16 a[88:91], a[228:231], v[184:187], a[88:91]
ds_read_b128 a[200:203], v2 offset:14336
buffer_load_dwordx4 v4, s[56:59], s83 offen offset:3072 sc1 lds
v_mfma_f32_16x16x32_bf16 a[104:107], a[232:235], v[184:187], a[104:107]
v_exp_f32 v159, v159
v_mfma_f32_16x16x32_bf16 a[120:123], a[236:239], v[184:187], a[120:123]
ds_read_b128 a[204:207], v2 offset:15360
v_cvt_pk_bf16_f32 v191, v158, v159
v_mfma_f32_16x16x32_bf16 a[136:139], a[240:243], v[184:187], a[136:139]
v_mfma_f32_16x16x32_bf16 v[152:155], a[144:147], v[140:143], v[252:255]
v_exp_f32 v144, v144
v_mfma_f32_16x16x32_bf16 v[156:159], a[160:163], v[140:143], v[252:255]
ds_read_b128 a[144:147], v2 offset:16384
v_mfma_f32_16x16x32_bf16 v[152:155], a[148:151], v[172:175], v[152:155]
v_exp_f32 v145, v145
v_mfma_f32_16x16x32_bf16 v[156:159], a[164:167], v[172:175], v[156:159]
ds_read_b128 a[160:163], v2 offset:20480
s_add_u32 m0, s84, 4096
v_cvt_pk_bf16_f32 v184, v144, v145
v_mfma_f32_16x16x32_bf16 v[152:155], a[152:155], v[204:207], v[152:155]
v_exp_f32 v146, v146
v_mfma_f32_16x16x32_bf16 v[156:159], a[168:171], v[204:207], v[156:159]
ds_read_b128 a[148:151], v2 offset:17408
buffer_load_dwordx4 v5, s[56:59], s83 offen offset:0 sc1 lds
v_mfma_f32_16x16x32_bf16 v[152:155], a[156:159], v[236:239], v[152:155]
v_exp_f32 v147, v147
v_mfma_f32_16x16x32_bf16 v[156:159], a[172:175], v[236:239], v[156:159]
ds_read_b128 a[164:167], v2 offset:21504
v_cvt_pk_bf16_f32 v185, v146, v147
v_mfma_f32_16x16x32_bf16 a[12:15], a[208:211], v[188:191], a[12:15]
v_exp_f32 v148, v148
v_mfma_f32_16x16x32_bf16 a[28:31], a[212:215], v[188:191], a[28:31]
ds_read_b128 a[152:155], v2 offset:18432
v_mfma_f32_16x16x32_bf16 a[44:47], a[216:219], v[188:191], a[44:47]
v_exp_f32 v149, v149
v_mfma_f32_16x16x32_bf16 a[60:63], a[220:223], v[188:191], a[60:63]
ds_read_b128 a[168:171], v2 offset:22528
v_cvt_pk_bf16_f32 v186, v148, v149
v_mfma_f32_16x16x32_bf16 a[76:79], a[224:227], v[188:191], a[76:79]
v_exp_f32 v150, v150
v_mfma_f32_16x16x32_bf16 a[92:95], a[228:231], v[188:191], a[92:95]
ds_read_b128 a[156:159], v2 offset:19456
buffer_load_dwordx4 v5, s[56:59], s83 offen offset:1024 sc1 lds
v_mfma_f32_16x16x32_bf16 a[108:111], a[232:235], v[188:191], a[108:111]
v_exp_f32 v151, v151
v_mfma_f32_16x16x32_bf16 a[124:127], a[236:239], v[188:191], a[124:127]
ds_read_b128 a[172:175], v2 offset:23552
v_cvt_pk_bf16_f32 v187, v150, v151
v_mfma_f32_16x16x32_bf16 a[140:143], a[240:243], v[188:191], a[140:143]
buffer_load_dwordx4 v5, s[56:59], s83 offen offset:2048 sc1 lds
s_waitcnt lgkmcnt(4)
v_mfma_f32_16x16x32_bf16 v[144:147], a[144:147], v[136:139], v[248:251]
v_exp_f32 v152, v152
v_mfma_f32_16x16x32_bf16 v[148:151], a[160:163], v[136:139], v[248:251]
ds_read_b128 a[208:211], v2 offset:24576
v_mfma_f32_16x16x32_bf16 v[144:147], a[148:151], v[168:171], v[144:147]
v_exp_f32 v153, v153
v_mfma_f32_16x16x32_bf16 v[148:151], a[164:167], v[168:171], v[148:151]
ds_read_b128 a[212:215], v2 offset:25600
v_cvt_pk_bf16_f32 v188, v152, v153
s_waitcnt lgkmcnt(4)
v_mfma_f32_16x16x32_bf16 v[144:147], a[152:155], v[200:203], v[144:147]
v_exp_f32 v154, v154
v_mfma_f32_16x16x32_bf16 v[148:151], a[168:171], v[200:203], v[148:151]
ds_read_b128 a[216:219], v2 offset:26624
buffer_load_dwordx4 v5, s[56:59], s83 offen offset:3072 sc1 lds
s_waitcnt lgkmcnt(3)
v_mfma_f32_16x16x32_bf16 v[144:147], a[156:159], v[232:235], v[144:147]
v_exp_f32 v155, v155
v_mfma_f32_16x16x32_bf16 v[148:151], a[172:175], v[232:235], v[148:151]
ds_read_b128 a[220:223], v2 offset:27648
v_cvt_pk_bf16_f32 v189, v154, v155
v_mfma_f32_16x16x32_bf16 a[8:11], a[176:179], v[184:187], a[8:11]
v_exp_f32 v156, v156
v_mfma_f32_16x16x32_bf16 a[24:27], a[180:183], v[184:187], a[24:27]
ds_read_b128 a[224:227], v2 offset:28672
v_mfma_f32_16x16x32_bf16 a[40:43], a[184:187], v[184:187], a[40:43]
v_exp_f32 v157, v157
v_mfma_f32_16x16x32_bf16 a[56:59], a[188:191], v[184:187], a[56:59]
ds_read_b128 a[228:231], v2 offset:29696
s_add_u32 m0, s84, 8192
v_cvt_pk_bf16_f32 v190, v156, v157
v_mfma_f32_16x16x32_bf16 a[72:75], a[192:195], v[184:187], a[72:75]
v_exp_f32 v158, v158
v_mfma_f32_16x16x32_bf16 a[88:91], a[196:199], v[184:187], a[88:91]
ds_read_b128 a[232:235], v2 offset:30720
buffer_load_dwordx4 v6, s[56:59], s83 offen offset:0 sc1 lds
v_mfma_f32_16x16x32_bf16 a[104:107], a[200:203], v[184:187], a[104:107]
v_exp_f32 v159, v159
v_mfma_f32_16x16x32_bf16 a[120:123], a[204:207], v[184:187], a[120:123]
ds_read_b128 a[236:239], v2 offset:31744
v_cvt_pk_bf16_f32 v191, v158, v159
v_mfma_f32_16x16x32_bf16 a[136:139], a[240:243], v[184:187], a[136:139]
buffer_load_dwordx4 v6, s[56:59], s83 offen offset:1024 sc1 lds
v_mfma_f32_16x16x32_bf16 v[152:155], a[144:147], v[140:143], v[252:255]
v_exp_f32 v144, v144
v_mfma_f32_16x16x32_bf16 v[156:159], a[160:163], v[140:143], v[252:255]
ds_read_b128 a[144:147], v2 offset:32768
v_mfma_f32_16x16x32_bf16 v[152:155], a[148:151], v[172:175], v[152:155]
v_exp_f32 v145, v145
v_mfma_f32_16x16x32_bf16 v[156:159], a[164:167], v[172:175], v[156:159]
ds_read_b128 a[160:163], v2 offset:36864
v_cvt_pk_bf16_f32 v184, v144, v145
v_mfma_f32_16x16x32_bf16 v[152:155], a[152:155], v[204:207], v[152:155]
v_exp_f32 v146, v146
v_mfma_f32_16x16x32_bf16 v[156:159], a[168:171], v[204:207], v[156:159]
ds_read_b128 a[148:151], v2 offset:33792
buffer_load_dwordx4 v6, s[56:59], s83 offen offset:2048 sc1 lds
v_mfma_f32_16x16x32_bf16 v[152:155], a[156:159], v[236:239], v[152:155]
v_exp_f32 v147, v147
v_mfma_f32_16x16x32_bf16 v[156:159], a[172:175], v[236:239], v[156:159]
ds_read_b128 a[164:167], v2 offset:37888
v_cvt_pk_bf16_f32 v185, v146, v147
v_mfma_f32_16x16x32_bf16 a[12:15], a[176:179], v[188:191], a[12:15]
v_exp_f32 v148, v148
v_mfma_f32_16x16x32_bf16 a[28:31], a[180:183], v[188:191], a[28:31]
ds_read_b128 a[152:155], v2 offset:34816
v_mfma_f32_16x16x32_bf16 a[44:47], a[184:187], v[188:191], a[44:47]
v_exp_f32 v149, v149
v_mfma_f32_16x16x32_bf16 a[60:63], a[188:191], v[188:191], a[60:63]
ds_read_b128 a[168:171], v2 offset:38912
v_cvt_pk_bf16_f32 v186, v148, v149
v_mfma_f32_16x16x32_bf16 a[76:79], a[192:195], v[188:191], a[76:79]
v_exp_f32 v150, v150
v_mfma_f32_16x16x32_bf16 a[92:95], a[196:199], v[188:191], a[92:95]
ds_read_b128 a[156:159], v2 offset:35840
buffer_load_dwordx4 v6, s[56:59], s83 offen offset:3072 sc1 lds
v_mfma_f32_16x16x32_bf16 a[108:111], a[200:203], v[188:191], a[108:111]
v_exp_f32 v151, v151
v_mfma_f32_16x16x32_bf16 a[124:127], a[204:207], v[188:191], a[124:127]
ds_read_b128 a[172:175], v2 offset:39936
s_add_u32 m0, s84, 12288
v_cvt_pk_bf16_f32 v187, v150, v151
v_mfma_f32_16x16x32_bf16 a[140:143], a[240:243], v[188:191], a[140:143]
buffer_load_dwordx4 v7, s[56:59], s83 offen offset:0 sc1 lds
s_waitcnt lgkmcnt(4)
v_mfma_f32_16x16x32_bf16 v[144:147], a[144:147], v[136:139], v[248:251]
v_exp_f32 v152, v152
v_mfma_f32_16x16x32_bf16 v[148:151], a[160:163], v[136:139], v[248:251]
ds_read_b128 a[176:179], v2 offset:40960
v_mfma_f32_16x16x32_bf16 v[144:147], a[148:151], v[168:171], v[144:147]
v_exp_f32 v153, v153
v_mfma_f32_16x16x32_bf16 v[148:151], a[164:167], v[168:171], v[148:151]
ds_read_b128 a[180:183], v2 offset:41984
v_cvt_pk_bf16_f32 v188, v152, v153
s_waitcnt lgkmcnt(4)
v_mfma_f32_16x16x32_bf16 v[144:147], a[152:155], v[200:203], v[144:147]
v_exp_f32 v154, v154
v_mfma_f32_16x16x32_bf16 v[148:151], a[168:171], v[200:203], v[148:151]
ds_read_b128 a[184:187], v2 offset:43008
buffer_load_dwordx4 v7, s[56:59], s83 offen offset:1024 sc1 lds
s_waitcnt lgkmcnt(3)
v_mfma_f32_16x16x32_bf16 v[144:147], a[156:159], v[232:235], v[144:147]
v_exp_f32 v155, v155
v_mfma_f32_16x16x32_bf16 v[148:151], a[172:175], v[232:235], v[148:151]
ds_read_b128 a[188:191], v2 offset:44032
v_cvt_pk_bf16_f32 v189, v154, v155
v_mfma_f32_16x16x32_bf16 a[8:11], a[208:211], v[184:187], a[8:11]
v_exp_f32 v156, v156
v_mfma_f32_16x16x32_bf16 a[24:27], a[212:215], v[184:187], a[24:27]
ds_read_b128 a[192:195], v2 offset:45056
v_mfma_f32_16x16x32_bf16 a[40:43], a[216:219], v[184:187], a[40:43]
v_exp_f32 v157, v157
v_mfma_f32_16x16x32_bf16 a[56:59], a[220:223], v[184:187], a[56:59]
ds_read_b128 a[196:199], v2 offset:46080
v_cvt_pk_bf16_f32 v190, v156, v157
v_mfma_f32_16x16x32_bf16 a[72:75], a[224:227], v[184:187], a[72:75]
v_exp_f32 v158, v158
v_mfma_f32_16x16x32_bf16 a[88:91], a[228:231], v[184:187], a[88:91]
ds_read_b128 a[200:203], v2 offset:47104
buffer_load_dwordx4 v7, s[56:59], s83 offen offset:2048 sc1 lds
v_mfma_f32_16x16x32_bf16 a[104:107], a[232:235], v[184:187], a[104:107]
v_exp_f32 v159, v159
v_mfma_f32_16x16x32_bf16 a[120:123], a[236:239], v[184:187], a[120:123]
ds_read_b128 a[204:207], v2 offset:48128
v_cvt_pk_bf16_f32 v191, v158, v159
v_mfma_f32_16x16x32_bf16 a[136:139], a[240:243], v[184:187], a[136:139]
buffer_load_dwordx4 v7, s[56:59], s83 offen offset:3072 sc1 lds
v_mfma_f32_16x16x32_bf16 v[152:155], a[144:147], v[140:143], v[252:255]
v_exp_f32 v144, v144
v_mfma_f32_16x16x32_bf16 v[156:159], a[160:163], v[140:143], v[252:255]
ds_read_b128 a[144:147], v2 offset:49152
v_mfma_f32_16x16x32_bf16 v[152:155], a[148:151], v[172:175], v[152:155]
v_exp_f32 v145, v145
v_mfma_f32_16x16x32_bf16 v[156:159], a[164:167], v[172:175], v[156:159]
ds_read_b128 a[160:163], v2 offset:53248
v_cvt_pk_bf16_f32 v184, v144, v145
v_mfma_f32_16x16x32_bf16 v[152:155], a[152:155], v[204:207], v[152:155]
v_exp_f32 v146, v146
v_mfma_f32_16x16x32_bf16 v[156:159], a[168:171], v[204:207], v[156:159]
ds_read_b128 a[148:151], v2 offset:50176
v_mfma_f32_16x16x32_bf16 v[152:155], a[156:159], v[236:239], v[152:155]
v_exp_f32 v147, v147
v_mfma_f32_16x16x32_bf16 v[156:159], a[172:175], v[236:239], v[156:159]
ds_read_b128 a[164:167], v2 offset:54272
v_cvt_pk_bf16_f32 v185, v146, v147
v_mfma_f32_16x16x32_bf16 a[12:15], a[208:211], v[188:191], a[12:15]
v_exp_f32 v148, v148
v_mfma_f32_16x16x32_bf16 a[28:31], a[212:215], v[188:191], a[28:31]
ds_read_b128 a[152:155], v2 offset:51200
v_mfma_f32_16x16x32_bf16 a[44:47], a[216:219], v[188:191], a[44:47]
v_exp_f32 v149, v149
v_mfma_f32_16x16x32_bf16 a[60:63], a[220:223], v[188:191], a[60:63]
ds_read_b128 a[168:171], v2 offset:55296
v_cvt_pk_bf16_f32 v186, v148, v149
v_mfma_f32_16x16x32_bf16 a[76:79], a[224:227], v[188:191], a[76:79]
v_exp_f32 v150, v150
v_mfma_f32_16x16x32_bf16 a[92:95], a[228:231], v[188:191], a[92:95]
ds_read_b128 a[156:159], v2 offset:52224
v_mfma_f32_16x16x32_bf16 a[108:111], a[232:235], v[188:191], a[108:111]
v_exp_f32 v151, v151
v_mfma_f32_16x16x32_bf16 a[124:127], a[236:239], v[188:191], a[124:127]
ds_read_b128 a[172:175], v2 offset:56320
v_cvt_pk_bf16_f32 v187, v150, v151
v_mfma_f32_16x16x32_bf16 a[140:143], a[240:243], v[188:191], a[140:143]
s_waitcnt lgkmcnt(4)
v_mfma_f32_16x16x32_bf16 v[144:147], a[144:147], v[136:139], v[248:251]
v_exp_f32 v152, v152
v_mfma_f32_16x16x32_bf16 v[148:151], a[160:163], v[136:139], v[248:251]
ds_read_b128 a[208:211], v2 offset:57344
v_mfma_f32_16x16x32_bf16 v[144:147], a[148:151], v[168:171], v[144:147]
v_exp_f32 v153, v153
v_mfma_f32_16x16x32_bf16 v[148:151], a[164:167], v[168:171], v[148:151]
ds_read_b128 a[212:215], v2 offset:58368
v_cvt_pk_bf16_f32 v188, v152, v153
s_waitcnt lgkmcnt(4)
v_mfma_f32_16x16x32_bf16 v[144:147], a[152:155], v[200:203], v[144:147]
v_exp_f32 v154, v154
v_mfma_f32_16x16x32_bf16 v[148:151], a[168:171], v[200:203], v[148:151]
ds_read_b128 a[216:219], v2 offset:59392
s_waitcnt lgkmcnt(3)
v_mfma_f32_16x16x32_bf16 v[144:147], a[156:159], v[232:235], v[144:147]
v_exp_f32 v155, v155
v_mfma_f32_16x16x32_bf16 v[148:151], a[172:175], v[232:235], v[148:151]
ds_read_b128 a[220:223], v2 offset:60416
v_cvt_pk_bf16_f32 v189, v154, v155
v_mfma_f32_16x16x32_bf16 a[8:11], a[176:179], v[184:187], a[8:11]
v_exp_f32 v156, v156
v_mfma_f32_16x16x32_bf16 a[24:27], a[180:183], v[184:187], a[24:27]
ds_read_b128 a[224:227], v2 offset:61440
v_mfma_f32_16x16x32_bf16 a[40:43], a[184:187], v[184:187], a[40:43]
v_exp_f32 v157, v157
v_mfma_f32_16x16x32_bf16 a[56:59], a[188:191], v[184:187], a[56:59]
ds_read_b128 a[228:231], v2 offset:62464
v_cvt_pk_bf16_f32 v190, v156, v157
v_mfma_f32_16x16x32_bf16 a[72:75], a[192:195], v[184:187], a[72:75]
v_exp_f32 v158, v158
v_mfma_f32_16x16x32_bf16 a[88:91], a[196:199], v[184:187], a[88:91]
ds_read_b128 a[232:235], v2 offset:63488
v_mfma_f32_16x16x32_bf16 a[104:107], a[200:203], v[184:187], a[104:107]
v_exp_f32 v159, v159
v_mfma_f32_16x16x32_bf16 a[120:123], a[204:207], v[184:187], a[120:123]
ds_read_b128 a[236:239], v2 offset:64512
v_cvt_pk_bf16_f32 v191, v158, v159
v_mfma_f32_16x16x32_bf16 a[136:139], a[240:243], v[184:187], a[136:139]
v_mfma_f32_16x16x32_bf16 v[152:155], a[144:147], v[140:143], v[252:255]
v_exp_f32 v144, v144
v_mfma_f32_16x16x32_bf16 v[156:159], a[160:163], v[140:143], v[252:255]
v_exp_f32 v145, v145
v_mfma_f32_16x16x32_bf16 v[152:155], a[148:151], v[172:175], v[152:155]
v_exp_f32 v146, v146
v_mfma_f32_16x16x32_bf16 v[156:159], a[164:167], v[172:175], v[156:159]
v_exp_f32 v147, v147
v_mfma_f32_16x16x32_bf16 v[152:155], a[152:155], v[204:207], v[152:155]
v_exp_f32 v148, v148
v_mfma_f32_16x16x32_bf16 v[156:159], a[168:171], v[204:207], v[156:159]
s_waitcnt vmcnt(0) lgkmcnt(0)
s_barrier
s_cmp_eq_u32 s81, 0
s_cbranch_scc1 L_sgs_9
v_mov_b32 v16, 1
s_mov_b64 exec, 1
buffer_atomic_add v16, v30, s[44:47], s78 offen sc1
s_mov_b64 exec, -1
s_mov_b32 s81, 0
L_sgs_9:
ds_read_b128 a[144:147], v3 offset:0
v_cvt_pk_bf16_f32 v184, v144, v145
v_mfma_f32_16x16x32_bf16 v[152:155], a[156:159], v[236:239], v[152:155]
v_exp_f32 v149, v149
v_mfma_f32_16x16x32_bf16 v[156:159], a[172:175], v[236:239], v[156:159]
ds_read_b128 a[160:163], v3 offset:4096
v_cvt_pk_bf16_f32 v185, v146, v147
v_mfma_f32_16x16x32_bf16 a[12:15], a[176:179], v[188:191], a[12:15]
v_exp_f32 v150, v150
v_mfma_f32_16x16x32_bf16 a[28:31], a[180:183], v[188:191], a[28:31]
ds_read_b128 a[148:151], v3 offset:1024
v_cvt_pk_bf16_f32 v186, v148, v149
v_mfma_f32_16x16x32_bf16 a[44:47], a[184:187], v[188:191], a[44:47]
v_exp_f32 v151, v151
v_mfma_f32_16x16x32_bf16 a[60:63], a[188:191], v[188:191], a[60:63]
ds_read_b128 a[164:167], v3 offset:5120
v_cvt_pk_bf16_f32 v187, v150, v151
v_mfma_f32_16x16x32_bf16 a[76:79], a[192:195], v[188:191], a[76:79]
ds_read_b128 a[152:155], v3 offset:2048
v_xor_b32 v2, 0x10000, v2
v_mfma_f32_16x16x32_bf16 a[92:95], a[196:199], v[188:191], a[92:95]
ds_read_b128 a[168:171], v3 offset:6144
s_add_u32 s83, s83, 0x10000
s_xor_b32 s84, s84, 0x10000
v_mfma_f32_16x16x32_bf16 a[108:111], a[200:203], v[188:191], a[108:111]
ds_read_b128 a[156:159], v3 offset:3072
s_add_u32 s82, s82, 1
v_mfma_f32_16x16x32_bf16 a[124:127], a[204:207], v[188:191], a[124:127]
ds_read_b128 a[172:175], v3 offset:7168
v_mfma_f32_16x16x32_bf16 a[140:143], a[240:243], v[188:191], a[140:143]
v_xor_b32 v3, 0x10000, v3
s_waitcnt lgkmcnt(4)
s_cmp_lt_u32 s82, s85
s_cbranch_scc1 L_solo
L_solo_done:
v_add_u32 v16, 0, v1
v_mul_u32_u24 v17, 6554, v16
v_lshrrev_b32 v17, 16, v17
v_mul_u32_u24 v18, 10, v17
v_sub_u32 v18, v16, v18
v_mul_u32_u24 v17, 1280, v17
v_lshl_add_u32 v17, v18, 4, v17
v_mov_b32 v11, v17
v_add_u32 v16, 64, v1
v_mul_u32_u24 v17, 6554, v16
v_lshrrev_b32 v17, 16, v17
v_mul_u32_u24 v18, 10, v17
v_sub_u32 v18, v16, v18
v_mul_u32_u24 v17, 1280, v17
v_lshl_add_u32 v17, v18, 4, v17
v_subrev_u32 v12, 1024, v17
v_add_u32 v16, 128, v1
v_mul_u32_u24 v17, 6554, v16
v_lshrrev_b32 v17, 16, v17
v_mul_u32_u24 v18, 10, v17
v_sub_u32 v18, v16, v18
v_mul_u32_u24 v17, 1280, v17
v_lshl_add_u32 v17, v18, 4, v17
v_subrev_u32 v13, 2048, v17
v_add_u32 v16, 192, v1
v_mul_u32_u24 v17, 6554, v16
v_lshrrev_b32 v17, 16, v17
v_mul_u32_u24 v18, 10, v17
v_sub_u32 v18, v16, v18
v_mul_u32_u24 v17, 1280, v17
v_lshl_add_u32 v17, v18, 4, v17
v_subrev_u32 v14, 3072, v17
v_add_u32 v16, 256, v1
v_mul_u32_u24 v17, 6554, v16
v_lshrrev_b32 v17, 16, v17
v_mul_u32_u24 v18, 10, v17
v_sub_u32 v18, v16, v18
v_mul_u32_u24 v17, 1280, v17
v_lshl_add_u32 v17, v18, 4, v17
v_mov_b32 v8, v17
s_lshl_b32 s70, s67, 10
s_lshl_b32 s71, s64, 5
s_add_u32 s70, s70, s71
s_mul_i32 s86, s70, 1280
s_mul_i32 s70, s68, 160
s_add_u32 s86, s86, s70
s_bitcmp1_b32 s84, 16
s_cselect_b32 s90, 16, 28
s_add_u32 s87, s90, s64
s_cmp_lg_u32 s64, 0
s_cbranch_scc1 L_ld_1
v_mfma_f32_16x16x32_bf16 v[144:147], a[144:147], v[136:139], v[248:251]
v_exp_f32 v152, v152
v_mfma_f32_16x16x32_bf16 v[148:151], a[160:163], v[136:139], v[248:251]
ds_read_b128 a[176:179], v2 offset:8192
s_add_u32 s89, s68, 0
s_and_b32 s89, s89, 7
s_mul_i32 s89, s89, 163840
s_add_u32 s89, s89, s86
s_add_u32 s88, s87, 0
s_and_b32 s88, s88, 31
s_mul_i32 s88, s88, 5120
s_add_u32 m0, s88, 0
s_nop 0
buffer_load_dwordx4 v11, s[8:11], s89 offen offset:0 lds
v_mfma_f32_16x16x32_bf16 v[144:147], a[148:151], v[168:171], v[144:147]
v_exp_f32 v153, v153
v_mfma_f32_16x16x32_bf16 v[148:151], a[164:167], v[168:171], v[148:151]
ds_read_b128 a[180:183], v2 offset:9216
v_cvt_pk_bf16_f32 v188, v152, v153
s_waitcnt lgkmcnt(4)
v_mfma_f32_16x16x32_bf16 v[144:147], a[152:155], v[200:203], v[144:147]
v_exp_f32 v154, v154
v_mfma_f32_16x16x32_bf16 v[148:151], a[168:171], v[200:203], v[148:151]
ds_read_b128 a[184:187], v2 offset:10240
buffer_load_dwordx4 v12, s[8:11], s89 offen offset:1024 lds
s_waitcnt lgkmcnt(3)
v_mfma_f32_16x16x32_bf16 v[144:147], a[156:159], v[232:235], v[144:147]
v_exp_f32 v155, v155
v_mfma_f32_16x16x32_bf16 v[148:151], a[172:175], v[232:235], v[148:151]
ds_read_b128 a[188:191], v2 offset:11264
v_cvt_pk_bf16_f32 v189, v154, v155
v_mfma_f32_16x16x32_bf16 a[8:11], a[208:211], v[184:187], a[8:11]
v_exp_f32 v156, v156
v_mfma_f32_16x16x32_bf16 a[24:27], a[212:215], v[184:187], a[24:27]
ds_read_b128 a[192:195], v2 offset:12288
buffer_load_dwordx4 v13, s[8:11], s89 offen offset:2048 lds
v_mfma_f32_16x16x32_bf16 a[40:43], a[216:219], v[184:187], a[40:43]
v_exp_f32 v157, v157
v_mfma_f32_16x16x32_bf16 a[56:59], a[220:223], v[184:187], a[56:59]
ds_read_b128 a[196:199], v2 offset:13312
v_cvt_pk_bf16_f32 v190, v156, v157
v_mfma_f32_16x16x32_bf16 a[72:75], a[224:227], v[184:187], a[72:75]
v_exp_f32 v158, v158
v_mfma_f32_16x16x32_bf16 a[88:91], a[228:231], v[184:187], a[88:91]
ds_read_b128 a[200:203], v2 offset:14336
buffer_load_dwordx4 v14, s[8:11], s89 offen offset:3072 lds
v_mfma_f32_16x16x32_bf16 a[104:107], a[232:235], v[184:187], a[104:107]
v_exp_f32 v159, v159
v_mfma_f32_16x16x32_bf16 a[120:123], a[236:239], v[184:187], a[120:123]
ds_read_b128 a[204:207], v2 offset:15360
v_cvt_pk_bf16_f32 v191, v158, v159
v_mfma_f32_16x16x32_bf16 a[136:139], a[240:243], v[184:187], a[136:139]
v_add_f32 v216, v252, v212
v_add_f32 v217, v253, v213
v_add_f32 v218, v254, v214
v_add_f32 v219, v255, v215
s_nop 1
v_mfma_f32_16x16x32_bf16 v[152:155], a[144:147], v[140:143], v[216:219]
v_exp_f32 v144, v144
v_mfma_f32_16x16x32_bf16 v[152:155], a[148:151], v[172:175], v[152:155]
ds_read_b128 a[144:147], v2 offset:16384
s_add_u32 m0, s88, 4096
s_nop 0
buffer_load_dwordx4 v8, s[8:11], s89 offen offset:0 lds
v_mfma_f32_16x16x32_bf16 v[152:155], a[152:155], v[204:207], v[152:155]
v_exp_f32 v145, v145
v_mfma_f32_16x16x32_bf16 v[152:155], a[156:159], v[236:239], v[152:155]
ds_read_b128 a[160:163], v2 offset:20480
s_add_u32 s89, s68, 1
s_and_b32 s89, s89, 7
s_mul_i32 s89, s89, 163840
s_add_u32 s89, s89, s86
s_add_u32 s88, s87, 4
s_and_b32 s88, s88, 31
s_mul_i32 s88, s88, 5120
s_add_u32 m0, s88, 0
v_cvt_pk_bf16_f32 v184, v144, v145
v_mfma_f32_16x16x32_bf16 a[12:15], a[208:211], v[188:191], a[12:15]
v_exp_f32 v146, v146
v_mfma_f32_16x16x32_bf16 a[28:31], a[212:215], v[188:191], a[28:31]
ds_read_b128 a[148:151], v2 offset:17408
buffer_load_dwordx4 v11, s[8:11], s89 offen offset:0 lds
v_mfma_f32_16x16x32_bf16 a[44:47], a[216:219], v[188:191], a[44:47]
v_exp_f32 v147, v147
v_mfma_f32_16x16x32_bf16 a[60:63], a[220:223], v[188:191], a[60:63]
ds_read_b128 a[164:167], v2 offset:21504
v_cvt_pk_bf16_f32 v185, v146, v147
v_mfma_f32_16x16x32_bf16 a[76:79], a[224:227], v[188:191], a[76:79]
v_exp_f32 v148, v148
v_mfma_f32_16x16x32_bf16 a[92:95], a[228:231], v[188:191], a[92:95]
ds_read_b128 a[152:155], v2 offset:18432
buffer_load_dwordx4 v12, s[8:11], s89 offen offset:1024 lds
v_mfma_f32_16x16x32_bf16 a[108:111], a[232:235], v[188:191], a[108:111]
buffer_load_dwordx4 v13, s[8:11], s89 offen offset:2048 lds
v_exp_f32 v149, v149
v_mfma_f32_16x16x32_bf16 a[124:127], a[236:239], v[188:191], a[124:127]
ds_read_b128 a[168:171], v2 offset:22528
v_cvt_pk_bf16_f32 v186, v148, v149
v_mfma_f32_16x16x32_bf16 a[140:143], a[240:243], v[188:191], a[140:143]
v_exp_f32 v150, v150
s_waitcnt lgkmcnt(6)
ds_read_b128 a[156:159], v2 offset:19456
ds_read_b128 a[172:175], v2 offset:23552
v_exp_f32 v151, v151
s_nop 0
v_cvt_pk_bf16_f32 v187, v150, v151
s_waitcnt lgkmcnt(7)
v_mfma_f32_16x16x32_bf16 v[144:147], a[144:147], v[136:139], v[248:251]
v_exp_f32 v152, v152
s_waitcnt lgkmcnt(6)
v_mfma_f32_16x16x32_bf16 v[148:151], a[160:163], v[136:139], v[248:251]
ds_read_b128 a[144:147], v2 offset:32768
buffer_load_dwordx4 v14, s[8:11], s89 offen offset:3072 lds
s_waitcnt lgkmcnt(6)
v_mfma_f32_16x16x32_bf16 v[144:147], a[148:151], v[168:171], v[144:147]
v_exp_f32 v153, v153
s_waitcnt lgkmcnt(5)
v_mfma_f32_16x16x32_bf16 v[148:151], a[164:167], v[168:171], v[148:151]
ds_read_b128 a[160:163], v2 offset:36864
s_add_u32 m0, s88, 4096
v_cvt_pk_bf16_f32 v188, v152, v153
s_waitcnt lgkmcnt(4)
v_mfma_f32_16x16x32_bf16 v[144:147], a[152:155], v[200:203], v[144:147]
v_exp_f32 v154, v154
v_mfma_f32_16x16x32_bf16 v[148:151], a[168:171], v[200:203], v[148:151]
ds_read_b128 a[148:151], v2 offset:33792
buffer_load_dwordx4 v8, s[8:11], s89 offen offset:0 lds
s_waitcnt lgkmcnt(3)
v_mfma_f32_16x16x32_bf16 v[144:147], a[156:159], v[232:235], v[144:147]
v_exp_f32 v155, v155
v_mfma_f32_16x16x32_bf16 v[148:151], a[172:175], v[232:235], v[148:151]
ds_read_b128 a[164:167], v2 offset:37888
v_cvt_pk_bf16_f32 v189, v154, v155
v_mfma_f32_16x16x32_bf16 a[8:11], a[176:179], v[184:187], a[8:11]
s_add_u32 s89, s68, 2
s_and_b32 s89, s89, 7
s_mul_i32 s89, s89, 163840
s_add_u32 s89, s89, s86
s_add_u32 s88, s87, 8
s_and_b32 s88, s88, 31
s_mul_i32 s88, s88, 5120
s_add_u32 m0, s88, 0
v_mov_b32 v190, 0
v_mfma_f32_16x16x32_bf16 a[24:27], a[180:183], v[184:187], a[24:27]
ds_read_b128 a[152:155], v2 offset:34816
buffer_load_dwordx4 v11, s[8:11], s89 offen offset:0 lds
v_mov_b32 v191, 0
v_mfma_f32_16x16x32_bf16 a[40:43], a[184:187], v[184:187], a[40:43]
v_mfma_f32_16x16x32_bf16 a[56:59], a[188:191], v[184:187], a[56:59]
ds_read_b128 a[168:171], v2 offset:38912
v_mfma_f32_16x16x32_bf16 a[72:75], a[192:195], v[184:187], a[72:75]
v_mfma_f32_16x16x32_bf16 a[88:91], a[196:199], v[184:187], a[88:91]
ds_read_b128 a[156:159], v2 offset:35840
buffer_load_dwordx4 v12, s[8:11], s89 offen offset:1024 lds
v_mfma_f32_16x16x32_bf16 a[104:107], a[200:203], v[184:187], a[104:107]
v_mfma_f32_16x16x32_bf16 a[120:123], a[204:207], v[184:187], a[120:123]
ds_read_b128 a[172:175], v2 offset:39936
v_mfma_f32_16x16x32_bf16 a[136:139], a[240:243], v[184:187], a[136:139]
s_waitcnt lgkmcnt(4)
ds_read_b128 a[208:211], v2 offset:24576
ds_read_b128 a[212:215], v2 offset:25600
ds_read_b128 a[216:219], v2 offset:26624
ds_read_b128 a[220:223], v2 offset:27648
ds_read_b128 a[224:227], v2 offset:28672
ds_read_b128 a[228:231], v2 offset:29696
ds_read_b128 a[232:235], v2 offset:30720
ds_read_b128 a[236:239], v2 offset:31744
s_cmp_eq_u32 s81, 0
s_cbranch_scc1 L_lsg_10
s_waitcnt vmcnt(12)
v_mov_b32 v16, 1
s_mov_b64 exec, 1
buffer_atomic_add v16, v30, s[44:47], s78 offen sc1
s_mov_b64 exec, -1
s_mov_b32 s81, 0
L_lsg_10:
v_mfma_f32_16x16x32_bf16 v[152:155], a[144:147], v[136:139], v[248:251]
v_exp_f32 v144, v144
v_mfma_f32_16x16x32_bf16 v[156:159], a[160:163], v[136:139], v[248:251]
ds_read_b128 a[144:147], v2 offset:49152
buffer_load_dwordx4 v13, s[8:11], s89 offen offset:2048 lds
v_mfma_f32_16x16x32_bf16 v[152:155], a[148:151], v[168:171], v[152:155]
v_exp_f32 v145, v145
v_mfma_f32_16x16x32_bf16 v[156:159], a[164:167], v[168:171], v[156:159]
ds_read_b128 a[160:163], v2 offset:53248
v_cvt_pk_bf16_f32 v184, v144, v145
s_waitcnt lgkmcnt(12)
v_mfma_f32_16x16x32_bf16 v[152:155], a[152:155], v[200:203], v[152:155]
v_exp_f32 v146, v146
v_mfma_f32_16x16x32_bf16 v[156:159], a[168:171], v[200:203], v[156:159]
ds_read_b128 a[148:151], v2 offset:50176
buffer_load_dwordx4 v14, s[8:11], s89 offen offset:3072 lds
s_waitcnt lgkmcnt(11)
v_mfma_f32_16x16x32_bf16 v[152:155], a[156:159], v[232:235], v[152:155]
v_exp_f32 v147, v147
v_mfma_f32_16x16x32_bf16 v[156:159], a[172:175], v[232:235], v[156:159]
ds_read_b128 a[164:167], v2 offset:54272
s_add_u32 m0, s88, 4096
v_cvt_pk_bf16_f32 v185, v146, v147
v_mfma_f32_16x16x32_bf16 a[12:15], a[176:179], v[188:191], a[12:15]
v_exp_f32 v148, v148
v_mfma_f32_16x16x32_bf16 a[28:31], a[180:183], v[188:191], a[28:31]
ds_read_b128 a[152:155], v2 offset:51200
buffer_load_dwordx4 v8, s[8:11], s89 offen offset:0 lds
v_mfma_f32_16x16x32_bf16 a[44:47], a[184:187], v[188:191], a[44:47]
v_exp_f32 v149, v149
v_mfma_f32_16x16x32_bf16 a[60:63], a[188:191], v[188:191], a[60:63]
ds_read_b128 a[168:171], v2 offset:55296
s_add_u32 s89, s68, 3
s_and_b32 s89, s89, 7
s_mul_i32 s89, s89, 163840
s_add_u32 s89, s89, s86
s_add_u32 s88, s87, 12
s_and_b32 s88, s88, 31
s_mul_i32 s88, s88, 5120
s_add_u32 m0, s88, 0
v_cvt_pk_bf16_f32 v186, v148, v149
v_mfma_f32_16x16x32_bf16 a[76:79], a[192:195], v[188:191], a[76:79]
v_exp_f32 v150, v150
v_mfma_f32_16x16x32_bf16 a[92:95], a[196:199], v[188:191], a[92:95]
ds_read_b128 a[156:159], v2 offset:52224
buffer_load_dwordx4 v11, s[8:11], s89 offen offset:0 lds
v_mfma_f32_16x16x32_bf16 a[108:111], a[200:203], v[188:191], a[108:111]
v_exp_f32 v151, v151
v_mfma_f32_16x16x32_bf16 a[124:127], a[204:207], v[188:191], a[124:127]
ds_read_b128 a[172:175], v2 offset:56320
v_cvt_pk_bf16_f32 v187, v150, v151
v_mfma_f32_16x16x32_bf16 a[140:143], a[240:243], v[188:191], a[140:143]
s_waitcnt lgkmcnt(4)
ds_read_b128 a[176:179], v2 offset:40960
ds_read_b128 a[180:183], v2 offset:41984
ds_read_b128 a[184:187], v2 offset:43008
ds_read_b128 a[188:191], v2 offset:44032
ds_read_b128 a[192:195], v2 offset:45056
ds_read_b128 a[196:199], v2 offset:46080
ds_read_b128 a[200:203], v2 offset:47104
ds_read_b128 a[204:207], v2 offset:48128
buffer_load_dword v29, v30, s[44:47], s78 offen sc1
v_add_f32 v216, v248, v212
v_add_f32 v217, v249, v213
v_add_f32 v218, v250, v214
v_add_f32 v219, v251, v215
v_mfma_f32_16x16x32_bf16 v[144:147], a[144:147], v[136:139], v[248:251]
v_exp_f32 v152, v152
v_mfma_f32_16x16x32_bf16 v[148:151], a[160:163], v[136:139], v[216:219]
buffer_load_dwordx4 v12, s[8:11], s89 offen offset:1024 lds
v_mfma_f32_16x16x32_bf16 v[144:147], a[148:151], v[168:171], v[144:147]
v_exp_f32 v153, v153
v_mfma_f32_16x16x32_bf16 v[148:151], a[164:167], v[168:171], v[148:151]
v_cvt_pk_bf16_f32 v188, v152, v153
s_waitcnt lgkmcnt(10)
v_mfma_f32_16x16x32_bf16 v[144:147], a[152:155], v[200:203], v[144:147]
v_exp_f32 v154, v154
v_mfma_f32_16x16x32_bf16 v[148:151], a[168:171], v[200:203], v[148:151]
buffer_load_dwordx4 v13, s[8:11], s89 offen offset:2048 lds
s_waitcnt lgkmcnt(8)
v_mfma_f32_16x16x32_bf16 v[144:147], a[156:159], v[232:235], v[144:147]
v_exp_f32 v155, v155
v_mfma_f32_16x16x32_bf16 v[148:151], a[172:175], v[232:235], v[148:151]
v_cvt_pk_bf16_f32 v189, v154, v155
v_mfma_f32_16x16x32_bf16 a[8:11], a[208:211], v[184:187], a[8:11]
v_exp_f32 v156, v156
v_mfma_f32_16x16x32_bf16 a[24:27], a[212:215], v[184:187], a[24:27]
ds_read_b128 a[208:211], v2 offset:57344
buffer_load_dwordx4 v14, s[8:11], s89 offen offset:3072 lds
v_mfma_f32_16x16x32_bf16 a[40:43], a[216:219], v[184:187], a[40:43]
v_exp_f32 v157, v157
v_mfma_f32_16x16x32_bf16 a[56:59], a[220:223], v[184:187], a[56:59]
ds_read_b128 a[212:215], v2 offset:58368
s_add_u32 m0, s88, 4096
v_cvt_pk_bf16_f32 v190, v156, v157
v_mfma_f32_16x16x32_bf16 a[72:75], a[224:227], v[184:187], a[72:75]
v_exp_f32 v158, v158
v_mfma_f32_16x16x32_bf16 a[88:91], a[228:231], v[184:187], a[88:91]
ds_read_b128 a[216:219], v2 offset:59392
buffer_load_dwordx4 v8, s[8:11], s89 offen offset:0 lds
v_mfma_f32_16x16x32_bf16 a[104:107], a[232:235], v[184:187], a[104:107]
v_exp_f32 v159, v159
v_mfma_f32_16x16x32_bf16 a[120:123], a[236:239], v[184:187], a[120:123]
ds_read_b128 a[220:223], v2 offset:60416
v_cvt_pk_bf16_f32 v191, v158, v159
v_mfma_f32_16x16x32_bf16 a[136:139], a[240:243], v[184:187], a[136:139]
ds_read_b128 a[224:227], v2 offset:61440
ds_read_b128 a[228:231], v2 offset:62464
ds_read_b128 a[232:235], v2 offset:63488
ds_read_b128 a[236:239], v2 offset:64512
s_waitcnt lgkmcnt(15)
v_mfma_f32_16x16x32_bf16 a[8:11], a[176:179], v[188:191], a[8:11]
v_exp_f32 v144, v144
s_waitcnt lgkmcnt(14)
v_mfma_f32_16x16x32_bf16 a[24:27], a[180:183], v[188:191], a[24:27]
s_waitcnt lgkmcnt(13)
v_mfma_f32_16x16x32_bf16 a[40:43], a[184:187], v[188:191], a[40:43]
v_exp_f32 v145, v145
s_waitcnt lgkmcnt(12)
v_mfma_f32_16x16x32_bf16 a[56:59], a[188:191], v[188:191], a[56:59]
v_cvt_pk_bf16_f32 v184, v144, v145
s_waitcnt lgkmcnt(11)
v_mfma_f32_16x16x32_bf16 a[72:75], a[192:195], v[188:191], a[72:75]
v_exp_f32 v146, v146
s_waitcnt lgkmcnt(10)
v_mfma_f32_16x16x32_bf16 a[88:91], a[196:199], v[188:191], a[88:91]
s_waitcnt lgkmcnt(9)
v_mfma_f32_16x16x32_bf16 a[104:107], a[200:203], v[188:191], a[104:107]
v_exp_f32 v147, v147
s_waitcnt lgkmcnt(8)
v_mfma_f32_16x16x32_bf16 a[120:123], a[204:207], v[188:191], a[120:123]
v_cvt_pk_bf16_f32 v185, v146, v147
v_mfma_f32_16x16x32_bf16 a[136:139], a[240:243], v[188:191], a[136:139]
v_exp_f32 v148, v148
v_exp_f32 v149, v149
v_exp_f32 v150, v150
v_exp_f32 v151, v151
v_cvt_pk_bf16_f32 v186, v148, v149
v_cvt_pk_bf16_f32 v187, v150, v151
s_waitcnt lgkmcnt(7)
s_nop 0
v_mfma_f32_16x16x32_bf16 a[8:11], a[208:211], v[184:187], a[8:11]
s_waitcnt lgkmcnt(6)
v_mfma_f32_16x16x32_bf16 a[24:27], a[212:215], v[184:187], a[24:27]
s_waitcnt lgkmcnt(5)
v_mfma_f32_16x16x32_bf16 a[40:43], a[216:219], v[184:187], a[40:43]
s_waitcnt lgkmcnt(4)
v_mfma_f32_16x16x32_bf16 a[56:59], a[220:223], v[184:187], a[56:59]
s_waitcnt lgkmcnt(3)
v_mfma_f32_16x16x32_bf16 a[72:75], a[224:227], v[184:187], a[72:75]
s_waitcnt lgkmcnt(2)
v_mfma_f32_16x16x32_bf16 a[88:91], a[228:231], v[184:187], a[88:91]
s_waitcnt lgkmcnt(1)
v_mfma_f32_16x16x32_bf16 a[104:107], a[232:235], v[184:187], a[104:107]
s_waitcnt lgkmcnt(0)
v_mfma_f32_16x16x32_bf16 a[120:123], a[236:239], v[184:187], a[120:123]
v_mfma_f32_16x16x32_bf16 a[136:139], a[240:243], v[184:187], a[136:139]
s_branch L_ld_done
L_ld_1:
s_cmp_lg_u32 s64, 1
s_cbranch_scc1 L_ld_2
v_mfma_f32_16x16x32_bf16 v[144:147], a[144:147], v[136:139], v[248:251]
v_exp_f32 v152, v152
v_mfma_f32_16x16x32_bf16 v[148:151], a[160:163], v[136:139], v[248:251]
ds_read_b128 a[176:179], v2 offset:8192
s_add_u32 s89, s68, 0
s_and_b32 s89, s89, 7
s_mul_i32 s89, s89, 163840
s_add_u32 s89, s89, s86
s_add_u32 s88, s87, 0
s_and_b32 s88, s88, 31
s_mul_i32 s88, s88, 5120
s_add_u32 m0, s88, 0
s_nop 0
buffer_load_dwordx4 v11, s[8:11], s89 offen offset:0 lds
v_mfma_f32_16x16x32_bf16 v[144:147], a[148:151], v[168:171], v[144:147]
v_exp_f32 v153, v153
v_mfma_f32_16x16x32_bf16 v[148:151], a[164:167], v[168:171], v[148:151]
ds_read_b128 a[180:183], v2 offset:9216
v_cvt_pk_bf16_f32 v188, v152, v153
s_waitcnt lgkmcnt(4)
v_mfma_f32_16x16x32_bf16 v[144:147], a[152:155], v[200:203], v[144:147]
v_exp_f32 v154, v154
v_mfma_f32_16x16x32_bf16 v[148:151], a[168:171], v[200:203], v[148:151]
ds_read_b128 a[184:187], v2 offset:10240
buffer_load_dwordx4 v12, s[8:11], s89 offen offset:1024 lds
s_waitcnt lgkmcnt(3)
v_mfma_f32_16x16x32_bf16 v[144:147], a[156:159], v[232:235], v[144:147]
v_exp_f32 v155, v155
v_mfma_f32_16x16x32_bf16 v[148:151], a[172:175], v[232:235], v[148:151]
ds_read_b128 a[188:191], v2 offset:11264
v_cvt_pk_bf16_f32 v189, v154, v155
v_mfma_f32_16x16x32_bf16 a[8:11], a[208:211], v[184:187], a[8:11]
v_exp_f32 v156, v156
v_mfma_f32_16x16x32_bf16 a[24:27], a[212:215], v[184:187], a[24:27]
ds_read_b128 a[192:195], v2 offset:12288
buffer_load_dwordx4 v13, s[8:11], s89 offen offset:2048 lds
v_mfma_f32_16x16x32_bf16 a[40:43], a[216:219], v[184:187], a[40:43]
v_exp_f32 v157, v157
v_mfma_f32_16x16x32_bf16 a[56:59], a[220:223], v[184:187], a[56:59]
ds_read_b128 a[196:199], v2 offset:13312
v_cvt_pk_bf16_f32 v190, v156, v157
v_mfma_f32_16x16x32_bf16 a[72:75], a[224:227], v[184:187], a[72:75]
v_exp_f32 v158, v158
v_mfma_f32_16x16x32_bf16 a[88:91], a[228:231], v[184:187], a[88:91]
ds_read_b128 a[200:203], v2 offset:14336
buffer_load_dwordx4 v14, s[8:11], s89 offen offset:3072 lds
v_mfma_f32_16x16x32_bf16 a[104:107], a[232:235], v[184:187], a[104:107]
v_exp_f32 v159, v159
v_mfma_f32_16x16x32_bf16 a[120:123], a[236:239], v[184:187], a[120:123]
ds_read_b128 a[204:207], v2 offset:15360
v_cvt_pk_bf16_f32 v191, v158, v159
v_mfma_f32_16x16x32_bf16 a[136:139], a[240:243], v[184:187], a[136:139]
v_add_f32 v216, v252, v212
v_add_f32 v217, v253, v213
v_add_f32 v218, v254, v214
v_add_f32 v219, v255, v215
v_mfma_f32_16x16x32_bf16 v[152:155], a[144:147], v[140:143], v[252:255]
v_exp_f32 v144, v144
v_mfma_f32_16x16x32_bf16 v[156:159], a[160:163], v[140:143], v[216:219]
ds_read_b128 a[144:147], v2 offset:16384
s_add_u32 m0, s88, 4096
s_nop 0
buffer_load_dwordx4 v8, s[8:11], s89 offen offset:0 lds
v_mfma_f32_16x16x32_bf16 v[152:155], a[148:151], v[172:175], v[152:155]
v_exp_f32 v145, v145
v_mfma_f32_16x16x32_bf16 v[156:159], a[164:167], v[172:175], v[156:159]
ds_read_b128 a[160:163], v2 offset:20480
s_add_u32 s89, s68, 1
s_and_b32 s89, s89, 7
s_mul_i32 s89, s89, 163840
s_add_u32 s89, s89, s86
s_add_u32 s88, s87, 4
s_and_b32 s88, s88, 31
s_mul_i32 s88, s88, 5120
s_add_u32 m0, s88, 0
v_cvt_pk_bf16_f32 v184, v144, v145
v_mfma_f32_16x16x32_bf16 v[152:155], a[152:155], v[204:207], v[152:155]
v_exp_f32 v146, v146
v_mfma_f32_16x16x32_bf16 v[156:159], a[168:171], v[204:207], v[156:159]
ds_read_b128 a[148:151], v2 offset:17408
buffer_load_dwordx4 v11, s[8:11], s89 offen offset:0 lds
v_mfma_f32_16x16x32_bf16 v[152:155], a[156:159], v[236:239], v[152:155]
v_exp_f32 v147, v147
v_mfma_f32_16x16x32_bf16 v[156:159], a[172:175], v[236:239], v[156:159]
ds_read_b128 a[164:167], v2 offset:21504
v_cvt_pk_bf16_f32 v185, v146, v147
v_mfma_f32_16x16x32_bf16 a[12:15], a[208:211], v[188:191], a[12:15]
v_exp_f32 v148, v148
v_mfma_f32_16x16x32_bf16 a[28:31], a[212:215], v[188:191], a[28:31]
ds_read_b128 a[152:155], v2 offset:18432
buffer_load_dwordx4 v12, s[8:11], s89 offen offset:1024 lds
v_mfma_f32_16x16x32_bf16 a[44:47], a[216:219], v[188:191], a[44:47]
v_exp_f32 v149, v149
v_mfma_f32_16x16x32_bf16 a[60:63], a[220:223], v[188:191], a[60:63]
ds_read_b128 a[168:171], v2 offset:22528
v_cvt_pk_bf16_f32 v186, v148, v149
v_mfma_f32_16x16x32_bf16 a[76:79], a[224:227], v[188:191], a[76:79]
v_exp_f32 v150, v150
v_mfma_f32_16x16x32_bf16 a[92:95], a[228:231], v[188:191], a[92:95]
ds_read_b128 a[156:159], v2 offset:19456
buffer_load_dwordx4 v13, s[8:11], s89 offen offset:2048 lds
v_mfma_f32_16x16x32_bf16 a[108:111], a[232:235], v[188:191], a[108:111]
v_exp_f32 v151, v151
v_mfma_f32_16x16x32_bf16 a[124:127], a[236:239], v[188:191], a[124:127]
ds_read_b128 a[172:175], v2 offset:23552
v_cvt_pk_bf16_f32 v187, v150, v151
v_mfma_f32_16x16x32_bf16 a[140:143], a[240:243], v[188:191], a[140:143]
s_waitcnt lgkmcnt(4)
v_mfma_f32_16x16x32_bf16 v[144:147], a[144:147], v[136:139], v[248:251]
v_exp_f32 v152, v152
v_mfma_f32_16x16x32_bf16 v[148:151], a[160:163], v[136:139], v[248:251]
ds_read_b128 a[144:147], v2 offset:32768
buffer_load_dwordx4 v14, s[8:11], s89 offen offset:3072 lds
v_mfma_f32_16x16x32_bf16 v[144:147], a[148:151], v[168:171], v[144:147]
v_exp_f32 v153, v153
v_mfma_f32_16x16x32_bf16 v[148:151], a[164:167], v[168:171], v[148:151]
ds_read_b128 a[160:163], v2 offset:36864
s_add_u32 m0, s88, 4096
v_cvt_pk_bf16_f32 v188, v152, v153
s_waitcnt lgkmcnt(4)
v_mfma_f32_16x16x32_bf16 v[144:147], a[152:155], v[200:203], v[144:147]
v_exp_f32 v154, v154
v_mfma_f32_16x16x32_bf16 v[148:151], a[168:171], v[200:203], v[148:151]
ds_read_b128 a[148:151], v2 offset:33792
buffer_load_dwordx4 v8, s[8:11], s89 offen offset:0 lds
s_waitcnt lgkmcnt(3)
v_mfma_f32_16x16x32_bf16 v[144:147], a[156:159], v[232:235], v[144:147]
v_exp_f32 v155, v155
v_mfma_f32_16x16x32_bf16 v[148:151], a[172:175], v[232:235], v[148:151]
ds_read_b128 a[164:167], v2 offset:37888
s_add_u32 s89, s68, 2
s_and_b32 s89, s89, 7
s_mul_i32 s89, s89, 163840
s_add_u32 s89, s89, s86
s_add_u32 s88, s87, 8
s_and_b32 s88, s88, 31
s_mul_i32 s88, s88, 5120
s_add_u32 m0, s88, 0
v_cvt_pk_bf16_f32 v189, v154, v155
v_mfma_f32_16x16x32_bf16 a[8:11], a[176:179], v[184:187], a[8:11]
v_exp_f32 v156, v156
v_mfma_f32_16x16x32_bf16 a[24:27], a[180:183], v[184:187], a[24:27]
ds_read_b128 a[152:155], v2 offset:34816
buffer_load_dwordx4 v11, s[8:11], s89 offen offset:0 lds
v_mfma_f32_16x16x32_bf16 a[40:43], a[184:187], v[184:187], a[40:43]
v_exp_f32 v157, v157
v_mfma_f32_16x16x32_bf16 a[56:59], a[188:191], v[184:187], a[56:59]
ds_read_b128 a[168:171], v2 offset:38912
v_cvt_pk_bf16_f32 v190, v156, v157
v_mfma_f32_16x16x32_bf16 a[72:75], a[192:195], v[184:187], a[72:75]
v_exp_f32 v158, v158
v_mfma_f32_16x16x32_bf16 a[88:91], a[196:199], v[184:187], a[88:91]
ds_read_b128 a[156:159], v2 offset:35840
buffer_load_dwordx4 v12, s[8:11], s89 offen offset:1024 lds
v_mfma_f32_16x16x32_bf16 a[104:107], a[200:203], v[184:187], a[104:107]
v_exp_f32 v159, v159
v_mfma_f32_16x16x32_bf16 a[120:123], a[204:207], v[184:187], a[120:123]
ds_read_b128 a[172:175], v2 offset:39936
v_cvt_pk_bf16_f32 v191, v158, v159
v_mfma_f32_16x16x32_bf16 a[136:139], a[240:243], v[184:187], a[136:139]
s_waitcnt lgkmcnt(4)
ds_read_b128 a[208:211], v2 offset:24576
ds_read_b128 a[212:215], v2 offset:25600
ds_read_b128 a[216:219], v2 offset:26624
ds_read_b128 a[220:223], v2 offset:27648
ds_read_b128 a[224:227], v2 offset:28672
ds_read_b128 a[228:231], v2 offset:29696
ds_read_b128 a[232:235], v2 offset:30720
ds_read_b128 a[236:239], v2 offset:31744
s_cmp_eq_u32 s81, 0
s_cbranch_scc1 L_lsg_11
s_waitcnt vmcnt(12)
v_mov_b32 v16, 1
s_mov_b64 exec, 1
buffer_atomic_add v16, v30, s[44:47], s78 offen sc1
s_mov_b64 exec, -1
s_mov_b32 s81, 0
L_lsg_11:
v_mfma_f32_16x16x32_bf16 v[152:155], a[144:147], v[136:139], v[248:251]
v_exp_f32 v144, v144
v_mfma_f32_16x16x32_bf16 v[156:159], a[160:163], v[136:139], v[248:251]
ds_read_b128 a[144:147], v2 offset:49152
buffer_load_dwordx4 v13, s[8:11], s89 offen offset:2048 lds
v_mfma_f32_16x16x32_bf16 v[152:155], a[148:151], v[168:171], v[152:155]
v_exp_f32 v145, v145
v_mfma_f32_16x16x32_bf16 v[156:159], a[164:167], v[168:171], v[156:159]
ds_read_b128 a[160:163], v2 offset:53248
v_cvt_pk_bf16_f32 v184, v144, v145
s_waitcnt lgkmcnt(12)
v_mfma_f32_16x16x32_bf16 v[152:155], a[152:155], v[200:203], v[152:155]
v_exp_f32 v146, v146
v_mfma_f32_16x16x32_bf16 v[156:159], a[168:171], v[200:203], v[156:159]
ds_read_b128 a[148:151], v2 offset:50176
buffer_load_dwordx4 v14, s[8:11], s89 offen offset:3072 lds
s_waitcnt lgkmcnt(11)
v_mfma_f32_16x16x32_bf16 v[152:155], a[156:159], v[232:235], v[152:155]
v_exp_f32 v147, v147
v_mfma_f32_16x16x32_bf16 v[156:159], a[172:175], v[232:235], v[156:159]
ds_read_b128 a[164:167], v2 offset:54272
s_add_u32 m0, s88, 4096
v_cvt_pk_bf16_f32 v185, v146, v147
v_mfma_f32_16x16x32_bf16 a[12:15], a[176:179], v[188:191], a[12:15]
v_exp_f32 v148, v148
v_mfma_f32_16x16x32_bf16 a[28:31], a[180:183], v[188:191], a[28:31]
ds_read_b128 a[152:155], v2 offset:51200
buffer_load_dwordx4 v8, s[8:11], s89 offen offset:0 lds
v_mfma_f32_16x16x32_bf16 a[44:47], a[184:187], v[188:191], a[44:47]
v_exp_f32 v149, v149
v_mfma_f32_16x16x32_bf16 a[60:63], a[188:191], v[188:191], a[60:63]
ds_read_b128 a[168:171], v2 offset:55296
s_add_u32 s89, s68, 3
s_and_b32 s89, s89, 7
s_mul_i32 s89, s89, 163840
s_add_u32 s89, s89, s86
s_add_u32 s88, s87, 12
s_and_b32 s88, s88, 31
s_mul_i32 s88, s88, 5120
s_add_u32 m0, s88, 0
v_cvt_pk_bf16_f32 v186, v148, v149
v_mfma_f32_16x16x32_bf16 a[76:79], a[192:195], v[188:191], a[76:79]
v_exp_f32 v150, v150
v_mfma_f32_16x16x32_bf16 a[92:95], a[196:199], v[188:191], a[92:95]
ds_read_b128 a[156:159], v2 offset:52224
buffer_load_dwordx4 v11, s[8:11], s89 offen offset:0 lds
v_mfma_f32_16x16x32_bf16 a[108:111], a[200:203], v[188:191], a[108:111]
v_exp_f32 v151, v151
v_mfma_f32_16x16x32_bf16 a[124:127], a[204:207], v[188:191], a[124:127]
ds_read_b128 a[172:175], v2 offset:56320
v_cvt_pk_bf16_f32 v187, v150, v151
v_mfma_f32_16x16x32_bf16 a[140:143], a[240:243], v[188:191], a[140:143]
s_waitcnt lgkmcnt(4)
ds_read_b128 a[176:179], v2 offset:40960
ds_read_b128 a[180:183], v2 offset:41984
ds_read_b128 a[184:187], v2 offset:43008
ds_read_b128 a[188:191], v2 offset:44032
ds_read_b128 a[192:195], v2 offset:45056
ds_read_b128 a[196:199], v2 offset:46080
ds_read_b128 a[200:203], v2 offset:47104
ds_read_b128 a[204:207], v2 offset:48128
buffer_load_dword v29, v30, s[44:47], s78 offen sc1
v_add_f32 v216, v248, v212
v_add_f32 v217, v249, v213
v_add_f32 v218, v250, v214
v_add_f32 v219, v251, v215
s_nop 1
v_mfma_f32_16x16x32_bf16 v[144:147], a[144:147], v[136:139], v[216:219]
v_exp_f32 v152, v152
v_mfma_f32_16x16x32_bf16 v[144:147], a[148:151], v[168:171], v[144:147]
buffer_load_dwordx4 v12, s[8:11], s89 offen offset:1024 lds
s_waitcnt lgkmcnt(11)
v_mfma_f32_16x16x32_bf16 v[144:147], a[152:155], v[200:203], v[144:147]
v_exp_f32 v153, v153
s_waitcnt lgkmcnt(9)
v_mfma_f32_16x16x32_bf16 v[144:147], a[156:159], v[232:235], v[144:147]
v_cvt_pk_bf16_f32 v188, v152, v153
v_mfma_f32_16x16x32_bf16 a[8:11], a[208:211], v[184:187], a[8:11]
v_exp_f32 v154, v154
v_mfma_f32_16x16x32_bf16 a[24:27], a[212:215], v[184:187], a[24:27]
ds_read_b128 a[208:211], v2 offset:57344
buffer_load_dwordx4 v13, s[8:11], s89 offen offset:2048 lds
v_mfma_f32_16x16x32_bf16 a[40:43], a[216:219], v[184:187], a[40:43]
v_exp_f32 v155, v155
v_mfma_f32_16x16x32_bf16 a[56:59], a[220:223], v[184:187], a[56:59]
ds_read_b128 a[212:215], v2 offset:58368
v_cvt_pk_bf16_f32 v189, v154, v155
v_mfma_f32_16x16x32_bf16 a[72:75], a[224:227], v[184:187], a[72:75]
v_exp_f32 v156, v156
v_mfma_f32_16x16x32_bf16 a[88:91], a[228:231], v[184:187], a[88:91]
ds_read_b128 a[216:219], v2 offset:59392
buffer_load_dwordx4 v14, s[8:11], s89 offen offset:3072 lds
v_mfma_f32_16x16x32_bf16 a[104:107], a[232:235], v[184:187], a[104:107]
s_add_u32 m0, s88, 4096
s_nop 0
buffer_load_dwordx4 v8, s[8:11], s89 offen offset:0 lds
v_exp_f32 v157, v157
v_mfma_f32_16x16x32_bf16 a[120:123], a[236:239], v[184:187], a[120:123]
ds_read_b128 a[220:223], v2 offset:60416
v_cvt_pk_bf16_f32 v190, v156, v157
v_mfma_f32_16x16x32_bf16 a[136:139], a[240:243], v[184:187], a[136:139]
v_exp_f32 v158, v158
ds_read_b128 a[224:227], v2 offset:61440
ds_read_b128 a[228:231], v2 offset:62464
ds_read_b128 a[232:235], v2 offset:63488
ds_read_b128 a[236:239], v2 offset:64512
v_exp_f32 v159, v159
s_nop 0
v_cvt_pk_bf16_f32 v191, v158, v159
s_waitcnt lgkmcnt(15)
s_nop 0
v_mfma_f32_16x16x32_bf16 a[8:11], a[176:179], v[188:191], a[8:11]
v_exp_f32 v144, v144
s_waitcnt lgkmcnt(14)
v_mfma_f32_16x16x32_bf16 a[24:27], a[180:183], v[188:191], a[24:27]
s_waitcnt lgkmcnt(13)
v_mfma_f32_16x16x32_bf16 a[40:43], a[184:187], v[188:191], a[40:43]
v_exp_f32 v145, v145
s_waitcnt lgkmcnt(12)
v_mfma_f32_16x16x32_bf16 a[56:59], a[188:191], v[188:191], a[56:59]
v_cvt_pk_bf16_f32 v184, v144, v145
s_waitcnt lgkmcnt(11)
v_mfma_f32_16x16x32_bf16 a[72:75], a[192:195], v[188:191], a[72:75]
v_exp_f32 v146, v146
s_waitcnt lgkmcnt(10)
v_mfma_f32_16x16x32_bf16 a[88:91], a[196:199], v[188:191], a[88:91]
s_waitcnt lgkmcnt(9)
v_mfma_f32_16x16x32_bf16 a[104:107], a[200:203], v[188:191], a[104:107]
v_exp_f32 v147, v147
s_waitcnt lgkmcnt(8)
v_mfma_f32_16x16x32_bf16 a[120:123], a[204:207], v[188:191], a[120:123]
v_cvt_pk_bf16_f32 v185, v146, v147
v_mfma_f32_16x16x32_bf16 a[136:139], a[240:243], v[188:191], a[136:139]
v_mov_b32 v186, 0
v_mov_b32 v187, 0
s_waitcnt lgkmcnt(7)
s_nop 0
v_mfma_f32_16x16x32_bf16 a[8:11], a[208:211], v[184:187], a[8:11]
s_waitcnt lgkmcnt(6)
v_mfma_f32_16x16x32_bf16 a[24:27], a[212:215], v[184:187], a[24:27]
s_waitcnt lgkmcnt(5)
v_mfma_f32_16x16x32_bf16 a[40:43], a[216:219], v[184:187], a[40:43]
s_waitcnt lgkmcnt(4)
v_mfma_f32_16x16x32_bf16 a[56:59], a[220:223], v[184:187], a[56:59]
s_waitcnt lgkmcnt(3)
v_mfma_f32_16x16x32_bf16 a[72:75], a[224:227], v[184:187], a[72:75]
s_waitcnt lgkmcnt(2)
v_mfma_f32_16x16x32_bf16 a[88:91], a[228:231], v[184:187], a[88:91]
s_waitcnt lgkmcnt(1)
v_mfma_f32_16x16x32_bf16 a[104:107], a[232:235], v[184:187], a[104:107]
s_waitcnt lgkmcnt(0)
v_mfma_f32_16x16x32_bf16 a[120:123], a[236:239], v[184:187], a[120:123]
v_mfma_f32_16x16x32_bf16 a[136:139], a[240:243], v[184:187], a[136:139]
s_branch L_ld_done
L_ld_2:
s_cmp_lg_u32 s64, 2
s_cbranch_scc1 L_ld_3
v_mfma_f32_16x16x32_bf16 v[144:147], a[144:147], v[136:139], v[248:251]
v_exp_f32 v152, v152
v_mfma_f32_16x16x32_bf16 v[148:151], a[160:163], v[136:139], v[248:251]
ds_read_b128 a[176:179], v2 offset:8192
s_add_u32 s89, s68, 0
s_and_b32 s89, s89, 7
s_mul_i32 s89, s89, 163840
s_add_u32 s89, s89, s86
s_add_u32 s88, s87, 0
s_and_b32 s88, s88, 31
s_mul_i32 s88, s88, 5120
s_add_u32 m0, s88, 0
s_nop 0
buffer_load_dwordx4 v11, s[8:11], s89 offen offset:0 lds
v_mfma_f32_16x16x32_bf16 v[144:147], a[148:151], v[168:171], v[144:147]
v_exp_f32 v153, v153
v_mfma_f32_16x16x32_bf16 v[148:151], a[164:167], v[168:171], v[148:151]
ds_read_b128 a[180:183], v2 offset:9216
v_cvt_pk_bf16_f32 v188, v152, v153
s_waitcnt lgkmcnt(4)
v_mfma_f32_16x16x32_bf16 v[144:147], a[152:155], v[200:203], v[144:147]
v_exp_f32 v154, v154
v_mfma_f32_16x16x32_bf16 v[148:151], a[168:171], v[200:203], v[148:151]
ds_read_b128 a[184:187], v2 offset:10240
buffer_load_dwordx4 v12, s[8:11], s89 offen offset:1024 lds
s_waitcnt lgkmcnt(3)
v_mfma_f32_16x16x32_bf16 v[144:147], a[156:159], v[232:235], v[144:147]
v_exp_f32 v155, v155
v_mfma_f32_16x16x32_bf16 v[148:151], a[172:175], v[232:235], v[148:151]
ds_read_b128 a[188:191], v2 offset:11264
v_cvt_pk_bf16_f32 v189, v154, v155
v_mfma_f32_16x16x32_bf16 a[8:11], a[208:211], v[184:187], a[8:11]
v_exp_f32 v156, v156
v_mfma_f32_16x16x32_bf16 a[24:27], a[212:215], v[184:187], a[24:27]
ds_read_b128 a[192:195], v2 offset:12288
buffer_load_dwordx4 v13, s[8:11], s89 offen offset:2048 lds
v_mfma_f32_16x16x32_bf16 a[40:43], a[216:219], v[184:187], a[40:43]
v_exp_f32 v157, v157
v_mfma_f32_16x16x32_bf16 a[56:59], a[220:223], v[184:187], a[56:59]
ds_read_b128 a[196:199], v2 offset:13312
v_cvt_pk_bf16_f32 v190, v156, v157
v_mfma_f32_16x16x32_bf16 a[72:75], a[224:227], v[184:187], a[72:75]
v_exp_f32 v158, v158
v_mfma_f32_16x16x32_bf16 a[88:91], a[228:231], v[184:187], a[88:91]
ds_read_b128 a[200:203], v2 offset:14336
buffer_load_dwordx4 v14, s[8:11], s89 offen offset:3072 lds
v_mfma_f32_16x16x32_bf16 a[104:107], a[232:235], v[184:187], a[104:107]
v_exp_f32 v159, v159
v_mfma_f32_16x16x32_bf16 a[120:123], a[236:239], v[184:187], a[120:123]
ds_read_b128 a[204:207], v2 offset:15360
v_cvt_pk_bf16_f32 v191, v158, v159
v_mfma_f32_16x16x32_bf16 a[136:139], a[240:243], v[184:187], a[136:139]
v_mfma_f32_16x16x32_bf16 v[152:155], a[144:147], v[140:143], v[252:255]
v_exp_f32 v144, v144
v_mfma_f32_16x16x32_bf16 v[156:159], a[160:163], v[140:143], v[252:255]
ds_read_b128 a[144:147], v2 offset:16384
s_add_u32 m0, s88, 4096
s_nop 0
buffer_load_dwordx4 v8, s[8:11], s89 offen offset:0 lds
v_mfma_f32_16x16x32_bf16 v[152:155], a[148:151], v[172:175], v[152:155]
v_exp_f32 v145, v145
v_mfma_f32_16x16x32_bf16 v[156:159], a[164:167], v[172:175], v[156:159]
ds_read_b128 a[160:163], v2 offset:20480
s_add_u32 s89, s68, 1
s_and_b32 s89, s89, 7
s_mul_i32 s89, s89, 163840
s_add_u32 s89, s89, s86
s_add_u32 s88, s87, 4
s_and_b32 s88, s88, 31
s_mul_i32 s88, s88, 5120
s_add_u32 m0, s88, 0
v_cvt_pk_bf16_f32 v184, v144, v145
v_mfma_f32_16x16x32_bf16 v[152:155], a[152:155], v[204:207], v[152:155]
v_exp_f32 v146, v146
v_mfma_f32_16x16x32_bf16 v[156:159], a[168:171], v[204:207], v[156:159]
ds_read_b128 a[148:151], v2 offset:17408
buffer_load_dwordx4 v11, s[8:11], s89 offen offset:0 lds
v_mfma_f32_16x16x32_bf16 v[152:155], a[156:159], v[236:239], v[152:155]
v_exp_f32 v147, v147
v_mfma_f32_16x16x32_bf16 v[156:159], a[172:175], v[236:239], v[156:159]
ds_read_b128 a[164:167], v2 offset:21504
v_cvt_pk_bf16_f32 v185, v146, v147
v_mfma_f32_16x16x32_bf16 a[12:15], a[208:211], v[188:191], a[12:15]
v_exp_f32 v148, v148
v_mfma_f32_16x16x32_bf16 a[28:31], a[212:215], v[188:191], a[28:31]
ds_read_b128 a[152:155], v2 offset:18432
buffer_load_dwordx4 v12, s[8:11], s89 offen offset:1024 lds
v_mfma_f32_16x16x32_bf16 a[44:47], a[216:219], v[188:191], a[44:47]
v_exp_f32 v149, v149
v_mfma_f32_16x16x32_bf16 a[60:63], a[220:223], v[188:191], a[60:63]
ds_read_b128 a[168:171], v2 offset:22528
v_cvt_pk_bf16_f32 v186, v148, v149
v_mfma_f32_16x16x32_bf16 a[76:79], a[224:227], v[188:191], a[76:79]
v_exp_f32 v150, v150
v_mfma_f32_16x16x32_bf16 a[92:95], a[228:231], v[188:191], a[92:95]
ds_read_b128 a[156:159], v2 offset:19456
buffer_load_dwordx4 v13, s[8:11], s89 offen offset:2048 lds
v_mfma_f32_16x16x32_bf16 a[108:111], a[232:235], v[188:191], a[108:111]
v_exp_f32 v151, v151
v_mfma_f32_16x16x32_bf16 a[124:127], a[236:239], v[188:191], a[124:127]
ds_read_b128 a[172:175], v2 offset:23552
v_cvt_pk_bf16_f32 v187, v150, v151
v_mfma_f32_16x16x32_bf16 a[140:143], a[240:243], v[188:191], a[140:143]
s_waitcnt lgkmcnt(4)
v_mfma_f32_16x16x32_bf16 v[144:147], a[144:147], v[136:139], v[248:251]
v_exp_f32 v152, v152
v_mfma_f32_16x16x32_bf16 v[148:151], a[160:163], v[136:139], v[248:251]
ds_read_b128 a[208:211], v2 offset:24576
buffer_load_dwordx4 v14, s[8:11], s89 offen offset:3072 lds
v_mfma_f32_16x16x32_bf16 v[144:147], a[148:151], v[168:171], v[144:147]
v_exp_f32 v153, v153
v_mfma_f32_16x16x32_bf16 v[148:151], a[164:167], v[168:171], v[148:151]
ds_read_b128 a[212:215], v2 offset:25600
s_add_u32 m0, s88, 4096
v_cvt_pk_bf16_f32 v188, v152, v153
s_waitcnt lgkmcnt(4)
v_mfma_f32_16x16x32_bf16 v[144:147], a[152:155], v[200:203], v[144:147]
v_exp_f32 v154, v154
v_mfma_f32_16x16x32_bf16 v[148:151], a[168:171], v[200:203], v[148:151]
ds_read_b128 a[216:219], v2 offset:26624
buffer_load_dwordx4 v8, s[8:11], s89 offen offset:0 lds
s_waitcnt lgkmcnt(3)
v_mfma_f32_16x16x32_bf16 v[144:147], a[156:159], v[232:235], v[144:147]
v_exp_f32 v155, v155
v_mfma_f32_16x16x32_bf16 v[148:151], a[172:175], v[232:235], v[148:151]
ds_read_b128 a[220:223], v2 offset:27648
s_add_u32 s89, s68, 2
s_and_b32 s89, s89, 7
s_mul_i32 s89, s89, 163840
s_add_u32 s89, s89, s86
s_add_u32 s88, s87, 8
s_and_b32 s88, s88, 31
s_mul_i32 s88, s88, 5120
s_add_u32 m0, s88, 0
v_cvt_pk_bf16_f32 v189, v154, v155
v_mfma_f32_16x16x32_bf16 a[8:11], a[176:179], v[184:187], a[8:11]
v_exp_f32 v156, v156
v_mfma_f32_16x16x32_bf16 a[24:27], a[180:183], v[184:187], a[24:27]
ds_read_b128 a[224:227], v2 offset:28672
buffer_load_dwordx4 v11, s[8:11], s89 offen offset:0 lds
v_mfma_f32_16x16x32_bf16 a[40:43], a[184:187], v[184:187], a[40:43]
v_exp_f32 v157, v157
v_mfma_f32_16x16x32_bf16 a[56:59], a[188:191], v[184:187], a[56:59]
ds_read_b128 a[228:231], v2 offset:29696
v_cvt_pk_bf16_f32 v190, v156, v157
v_mfma_f32_16x16x32_bf16 a[72:75], a[192:195], v[184:187], a[72:75]
v_exp_f32 v158, v158
v_mfma_f32_16x16x32_bf16 a[88:91], a[196:199], v[184:187], a[88:91]
ds_read_b128 a[232:235], v2 offset:30720
buffer_load_dwordx4 v12, s[8:11], s89 offen offset:1024 lds
v_mfma_f32_16x16x32_bf16 a[104:107], a[200:203], v[184:187], a[104:107]
v_exp_f32 v159, v159
v_mfma_f32_16x16x32_bf16 a[120:123], a[204:207], v[184:187], a[120:123]
ds_read_b128 a[236:239], v2 offset:31744
v_cvt_pk_bf16_f32 v191, v158, v159
v_mfma_f32_16x16x32_bf16 a[136:139], a[240:243], v[184:187], a[136:139]
s_cmp_eq_u32 s81, 0
s_cbranch_scc1 L_lsg_12
s_waitcnt vmcnt(12)
v_mov_b32 v16, 1
s_mov_b64 exec, 1
buffer_atomic_add v16, v30, s[44:47], s78 offen sc1
s_mov_b64 exec, -1
s_mov_b32 s81, 0
L_lsg_12:
v_add_f32 v216, v252, v212
v_add_f32 v217, v253, v213
v_add_f32 v218, v254, v214
v_add_f32 v219, v255, v215
s_nop 1
v_mfma_f32_16x16x32_bf16 v[152:155], a[144:147], v[140:143], v[216:219]
v_exp_f32 v144, v144
v_mfma_f32_16x16x32_bf16 v[152:155], a[148:151], v[172:175], v[152:155]
ds_read_b128 a[144:147], v2 offset:32768
buffer_load_dwordx4 v13, s[8:11], s89 offen offset:2048 lds
v_mfma_f32_16x16x32_bf16 v[152:155], a[152:155], v[204:207], v[152:155]
v_exp_f32 v145, v145
v_mfma_f32_16x16x32_bf16 v[152:155], a[156:159], v[236:239], v[152:155]
ds_read_b128 a[160:163], v2 offset:36864
v_cvt_pk_bf16_f32 v184, v144, v145
v_mfma_f32_16x16x32_bf16 a[12:15], a[176:179], v[188:191], a[12:15]
v_exp_f32 v146, v146
v_mfma_f32_16x16x32_bf16 a[28:31], a[180:183], v[188:191], a[28:31]
ds_read_b128 a[148:151], v2 offset:33792
buffer_load_dwordx4 v14, s[8:11], s89 offen offset:3072 lds
v_mfma_f32_16x16x32_bf16 a[44:47], a[184:187], v[188:191], a[44:47]
v_exp_f32 v147, v147
v_mfma_f32_16x16x32_bf16 a[60:63], a[188:191], v[188:191], a[60:63]
ds_read_b128 a[164:167], v2 offset:37888
s_add_u32 m0, s88, 4096
v_cvt_pk_bf16_f32 v185, v146, v147
v_mfma_f32_16x16x32_bf16 a[76:79], a[192:195], v[188:191], a[76:79]
v_exp_f32 v148, v148
v_mfma_f32_16x16x32_bf16 a[92:95], a[196:199], v[188:191], a[92:95]
ds_read_b128 a[152:155], v2 offset:34816
buffer_load_dwordx4 v8, s[8:11], s89 offen offset:0 lds
v_mfma_f32_16x16x32_bf16 a[108:111], a[200:203], v[188:191], a[108:111]
s_add_u32 s89, s68, 3
s_and_b32 s89, s89, 7
s_mul_i32 s89, s89, 163840
s_add_u32 s89, s89, s86
s_add_u32 s88, s87, 12
s_and_b32 s88, s88, 31
s_mul_i32 s88, s88, 5120
s_add_u32 m0, s88, 0
s_nop 0
buffer_load_dwordx4 v11, s[8:11], s89 offen offset:0 lds
v_exp_f32 v149, v149
v_mfma_f32_16x16x32_bf16 a[124:127], a[204:207], v[188:191], a[124:127]
ds_read_b128 a[168:171], v2 offset:38912
v_cvt_pk_bf16_f32 v186, v148, v149
v_mfma_f32_16x16x32_bf16 a[140:143], a[240:243], v[188:191], a[140:143]
v_exp_f32 v150, v150
s_waitcnt lgkmcnt(6)
ds_read_b128 a[156:159], v2 offset:35840
ds_read_b128 a[172:175], v2 offset:39936
v_exp_f32 v151, v151
s_nop 0
v_cvt_pk_bf16_f32 v187, v150, v151
buffer_load_dword v29, v30, s[44:47], s78 offen sc1
v_add_f32 v216, v248, v212
v_add_f32 v217, v249, v213
v_add_f32 v218, v250, v214
v_add_f32 v219, v251, v215
s_waitcnt lgkmcnt(7)
v_mfma_f32_16x16x32_bf16 v[144:147], a[144:147], v[136:139], v[248:251]
v_exp_f32 v152, v152
s_waitcnt lgkmcnt(6)
v_mfma_f32_16x16x32_bf16 v[148:151], a[160:163], v[136:139], v[216:219]
ds_read_b128 a[176:179], v2 offset:40960
buffer_load_dwordx4 v12, s[8:11], s89 offen offset:1024 lds
s_waitcnt lgkmcnt(6)
v_mfma_f32_16x16x32_bf16 v[144:147], a[148:151], v[168:171], v[144:147]
v_exp_f32 v153, v153
s_waitcnt lgkmcnt(5)
v_mfma_f32_16x16x32_bf16 v[148:151], a[164:167], v[168:171], v[148:151]
ds_read_b128 a[180:183], v2 offset:41984
v_cvt_pk_bf16_f32 v188, v152, v153
s_waitcnt lgkmcnt(4)
v_mfma_f32_16x16x32_bf16 v[144:147], a[152:155], v[200:203], v[144:147]
v_exp_f32 v154, v154
v_mfma_f32_16x16x32_bf16 v[148:151], a[168:171], v[200:203], v[148:151]
ds_read_b128 a[184:187], v2 offset:43008
buffer_load_dwordx4 v13, s[8:11], s89 offen offset:2048 lds
s_waitcnt lgkmcnt(3)
v_mfma_f32_16x16x32_bf16 v[144:147], a[156:159], v[232:235], v[144:147]
v_exp_f32 v155, v155
v_mfma_f32_16x16x32_bf16 v[148:151], a[172:175], v[232:235], v[148:151]
ds_read_b128 a[188:191], v2 offset:44032
v_cvt_pk_bf16_f32 v189, v154, v155
v_mfma_f32_16x16x32_bf16 a[8:11], a[208:211], v[184:187], a[8:11]
v_mov_b32 v190, 0
v_mfma_f32_16x16x32_bf16 a[24:27], a[212:215], v[184:187], a[24:27]
ds_read_b128 a[192:195], v2 offset:45056
buffer_load_dwordx4 v14, s[8:11], s89 offen offset:3072 lds
v_mov_b32 v191, 0
v_mfma_f32_16x16x32_bf16 a[40:43], a[216:219], v[184:187], a[40:43]
v_mfma_f32_16x16x32_bf16 a[56:59], a[220:223], v[184:187], a[56:59]
ds_read_b128 a[196:199], v2 offset:46080
v_mfma_f32_16x16x32_bf16 a[72:75], a[224:227], v[184:187], a[72:75]
s_add_u32 m0, s88, 4096
v_mfma_f32_16x16x32_bf16 a[88:91], a[228:231], v[184:187], a[88:91]
ds_read_b128 a[200:203], v2 offset:47104
buffer_load_dwordx4 v8, s[8:11], s89 offen offset:0 lds
v_mfma_f32_16x16x32_bf16 a[104:107], a[232:235], v[184:187], a[104:107]
v_mfma_f32_16x16x32_bf16 a[120:123], a[236:239], v[184:187], a[120:123]
ds_read_b128 a[204:207], v2 offset:48128
v_mfma_f32_16x16x32_bf16 a[136:139], a[240:243], v[184:187], a[136:139]
v_mfma_f32_16x16x32_bf16 a[12:15], a[208:211], v[188:191], a[12:15]
v_exp_f32 v144, v144
v_mfma_f32_16x16x32_bf16 a[28:31], a[212:215], v[188:191], a[28:31]
v_mfma_f32_16x16x32_bf16 a[44:47], a[216:219], v[188:191], a[44:47]
v_exp_f32 v145, v145
v_mfma_f32_16x16x32_bf16 a[60:63], a[220:223], v[188:191], a[60:63]
v_cvt_pk_bf16_f32 v184, v144, v145
v_mfma_f32_16x16x32_bf16 a[76:79], a[224:227], v[188:191], a[76:79]
v_exp_f32 v146, v146
v_mfma_f32_16x16x32_bf16 a[92:95], a[228:231], v[188:191], a[92:95]
v_mfma_f32_16x16x32_bf16 a[108:111], a[232:235], v[188:191], a[108:111]
v_exp_f32 v147, v147
v_mfma_f32_16x16x32_bf16 a[124:127], a[236:239], v[188:191], a[124:127]
v_cvt_pk_bf16_f32 v185, v146, v147
v_mfma_f32_16x16x32_bf16 a[140:143], a[240:243], v[188:191], a[140:143]
v_exp_f32 v148, v148
v_exp_f32 v149, v149
v_exp_f32 v150, v150
v_exp_f32 v151, v151
v_cvt_pk_bf16_f32 v186, v148, v149
v_cvt_pk_bf16_f32 v187, v150, v151
s_waitcnt lgkmcnt(7)
s_nop 0
v_mfma_f32_16x16x32_bf16 a[8:11], a[176:179], v[184:187], a[8:11]
s_waitcnt lgkmcnt(6)
v_mfma_f32_16x16x32_bf16 a[24:27], a[180:183], v[184:187], a[24:27]
s_waitcnt lgkmcnt(5)
v_mfma_f32_16x16x32_bf16 a[40:43], a[184:187], v[184:187], a[40:43]
s_waitcnt lgkmcnt(4)
v_mfma_f32_16x16x32_bf16 a[56:59], a[188:191], v[184:187], a[56:59]
s_waitcnt lgkmcnt(3)
v_mfma_f32_16x16x32_bf16 a[72:75], a[192:195], v[184:187], a[72:75]
s_waitcnt lgkmcnt(2)
v_mfma_f32_16x16x32_bf16 a[88:91], a[196:199], v[184:187], a[88:91]
s_waitcnt lgkmcnt(1)
v_mfma_f32_16x16x32_bf16 a[104:107], a[200:203], v[184:187], a[104:107]
s_waitcnt lgkmcnt(0)
v_mfma_f32_16x16x32_bf16 a[120:123], a[204:207], v[184:187], a[120:123]
v_mfma_f32_16x16x32_bf16 a[136:139], a[240:243], v[184:187], a[136:139]
s_branch L_ld_done
L_ld_3:
v_mfma_f32_16x16x32_bf16 v[144:147], a[144:147], v[136:139], v[248:251]
v_exp_f32 v152, v152
v_mfma_f32_16x16x32_bf16 v[148:151], a[160:163], v[136:139], v[248:251]
ds_read_b128 a[176:179], v2 offset:8192
s_add_u32 s89, s68, 0
s_and_b32 s89, s89, 7
s_mul_i32 s89, s89, 163840
s_add_u32 s89, s89, s86
s_add_u32 s88, s87, 0
s_and_b32 s88, s88, 31
s_mul_i32 s88, s88, 5120
s_add_u32 m0, s88, 0
s_nop 0
buffer_load_dwordx4 v11, s[8:11], s89 offen offset:0 lds
v_mfma_f32_16x16x32_bf16 v[144:147], a[148:151], v[168:171], v[144:147]
v_exp_f32 v153, v153
v_mfma_f32_16x16x32_bf16 v[148:151], a[164:167], v[168:171], v[148:151]
ds_read_b128 a[180:183], v2 offset:9216
v_cvt_pk_bf16_f32 v188, v152, v153
s_waitcnt lgkmcnt(4)
v_mfma_f32_16x16x32_bf16 v[144:147], a[152:155], v[200:203], v[144:147]
v_exp_f32 v154, v154
v_mfma_f32_16x16x32_bf16 v[148:151], a[168:171], v[200:203], v[148:151]
ds_read_b128 a[184:187], v2 offset:10240
buffer_load_dwordx4 v12, s[8:11], s89 offen offset:1024 lds
s_waitcnt lgkmcnt(3)
v_mfma_f32_16x16x32_bf16 v[144:147], a[156:159], v[232:235], v[144:147]
v_exp_f32 v155, v155
v_mfma_f32_16x16x32_bf16 v[148:151], a[172:175], v[232:235], v[148:151]
ds_read_b128 a[188:191], v2 offset:11264
v_cvt_pk_bf16_f32 v189, v154, v155
v_mfma_f32_16x16x32_bf16 a[8:11], a[208:211], v[184:187], a[8:11]
v_exp_f32 v156, v156
v_mfma_f32_16x16x32_bf16 a[24:27], a[212:215], v[184:187], a[24:27]
ds_read_b128 a[192:195], v2 offset:12288
buffer_load_dwordx4 v13, s[8:11], s89 offen offset:2048 lds
v_mfma_f32_16x16x32_bf16 a[40:43], a[216:219], v[184:187], a[40:43]
v_exp_f32 v157, v157
v_mfma_f32_16x16x32_bf16 a[56:59], a[220:223], v[184:187], a[56:59]
ds_read_b128 a[196:199], v2 offset:13312
v_cvt_pk_bf16_f32 v190, v156, v157
v_mfma_f32_16x16x32_bf16 a[72:75], a[224:227], v[184:187], a[72:75]
v_exp_f32 v158, v158
v_mfma_f32_16x16x32_bf16 a[88:91], a[228:231], v[184:187], a[88:91]
ds_read_b128 a[200:203], v2 offset:14336
buffer_load_dwordx4 v14, s[8:11], s89 offen offset:3072 lds
v_mfma_f32_16x16x32_bf16 a[104:107], a[232:235], v[184:187], a[104:107]
v_exp_f32 v159, v159
v_mfma_f32_16x16x32_bf16 a[120:123], a[236:239], v[184:187], a[120:123]
ds_read_b128 a[204:207], v2 offset:15360
v_cvt_pk_bf16_f32 v191, v158, v159
v_mfma_f32_16x16x32_bf16 a[136:139], a[240:243], v[184:187], a[136:139]
v_mfma_f32_16x16x32_bf16 v[152:155], a[144:147], v[140:143], v[252:255]
v_exp_f32 v144, v144
v_mfma_f32_16x16x32_bf16 v[156:159], a[160:163], v[140:143], v[252:255]
ds_read_b128 a[144:147], v2 offset:16384
s_add_u32 m0, s88, 4096
s_nop 0
buffer_load_dwordx4 v8, s[8:11], s89 offen offset:0 lds
v_mfma_f32_16x16x32_bf16 v[152:155], a[148:151], v[172:175], v[152:155]
v_exp_f32 v145, v145
v_mfma_f32_16x16x32_bf16 v[156:159], a[164:167], v[172:175], v[156:159]
ds_read_b128 a[160:163], v2 offset:20480
s_add_u32 s89, s68, 1
s_and_b32 s89, s89, 7
s_mul_i32 s89, s89, 163840
s_add_u32 s89, s89, s86
s_add_u32 s88, s87, 4
s_and_b32 s88, s88, 31
s_mul_i32 s88, s88, 5120
s_add_u32 m0, s88, 0
v_cvt_pk_bf16_f32 v184, v144, v145
v_mfma_f32_16x16x32_bf16 v[152:155], a[152:155], v[204:207], v[152:155]
v_exp_f32 v146, v146
v_mfma_f32_16x16x32_bf16 v[156:159], a[168:171], v[204:207], v[156:159]
ds_read_b128 a[148:151], v2 offset:17408
buffer_load_dwordx4 v11, s[8:11], s89 offen offset:0 lds
v_mfma_f32_16x16x32_bf16 v[152:155], a[156:159], v[236:239], v[152:155]
v_exp_f32 v147, v147
v_mfma_f32_16x16x32_bf16 v[156:159], a[172:175], v[236:239], v[156:159]
ds_read_b128 a[164:167], v2 offset:21504
v_cvt_pk_bf16_f32 v185, v146, v147
v_mfma_f32_16x16x32_bf16 a[12:15], a[208:211], v[188:191], a[12:15]
v_exp_f32 v148, v148
v_mfma_f32_16x16x32_bf16 a[28:31], a[212:215], v[188:191], a[28:31]
ds_read_b128 a[152:155], v2 offset:18432
buffer_load_dwordx4 v12, s[8:11], s89 offen offset:1024 lds
v_mfma_f32_16x16x32_bf16 a[44:47], a[216:219], v[188:191], a[44:47]
v_exp_f32 v149, v149
v_mfma_f32_16x16x32_bf16 a[60:63], a[220:223], v[188:191], a[60:63]
ds_read_b128 a[168:171], v2 offset:22528
v_cvt_pk_bf16_f32 v186, v148, v149
v_mfma_f32_16x16x32_bf16 a[76:79], a[224:227], v[188:191], a[76:79]
v_exp_f32 v150, v150
v_mfma_f32_16x16x32_bf16 a[92:95], a[228:231], v[188:191], a[92:95]
ds_read_b128 a[156:159], v2 offset:19456
buffer_load_dwordx4 v13, s[8:11], s89 offen offset:2048 lds
v_mfma_f32_16x16x32_bf16 a[108:111], a[232:235], v[188:191], a[108:111]
v_exp_f32 v151, v151
v_mfma_f32_16x16x32_bf16 a[124:127], a[236:239], v[188:191], a[124:127]
ds_read_b128 a[172:175], v2 offset:23552
v_cvt_pk_bf16_f32 v187, v150, v151
v_mfma_f32_16x16x32_bf16 a[140:143], a[240:243], v[188:191], a[140:143]
s_waitcnt lgkmcnt(4)
v_mfma_f32_16x16x32_bf16 v[144:147], a[144:147], v[136:139], v[248:251]
v_exp_f32 v152, v152
v_mfma_f32_16x16x32_bf16 v[148:151], a[160:163], v[136:139], v[248:251]
ds_read_b128 a[208:211], v2 offset:24576
buffer_load_dwordx4 v14, s[8:11], s89 offen offset:3072 lds
v_mfma_f32_16x16x32_bf16 v[144:147], a[148:151], v[168:171], v[144:147]
v_exp_f32 v153, v153
v_mfma_f32_16x16x32_bf16 v[148:151], a[164:167], v[168:171], v[148:151]
ds_read_b128 a[212:215], v2 offset:25600
s_add_u32 m0, s88, 4096
v_cvt_pk_bf16_f32 v188, v152, v153
s_waitcnt lgkmcnt(4)
v_mfma_f32_16x16x32_bf16 v[144:147], a[152:155], v[200:203], v[144:147]
v_exp_f32 v154, v154
v_mfma_f32_16x16x32_bf16 v[148:151], a[168:171], v[200:203], v[148:151]
ds_read_b128 a[216:219], v2 offset:26624
buffer_load_dwordx4 v8, s[8:11], s89 offen offset:0 lds
s_waitcnt lgkmcnt(3)
v_mfma_f32_16x16x32_bf16 v[144:147], a[156:159], v[232:235], v[144:147]
v_exp_f32 v155, v155
v_mfma_f32_16x16x32_bf16 v[148:151], a[172:175], v[232:235], v[148:151]
ds_read_b128 a[220:223], v2 offset:27648
s_add_u32 s89, s68, 2
s_and_b32 s89, s89, 7
s_mul_i32 s89, s89, 163840
s_add_u32 s89, s89, s86
s_add_u32 s88, s87, 8
s_and_b32 s88, s88, 31
s_mul_i32 s88, s88, 5120
s_add_u32 m0, s88, 0
v_cvt_pk_bf16_f32 v189, v154, v155
v_mfma_f32_16x16x32_bf16 a[8:11], a[176:179], v[184:187], a[8:11]
v_exp_f32 v156, v156
v_mfma_f32_16x16x32_bf16 a[24:27], a[180:183], v[184:187], a[24:27]
ds_read_b128 a[224:227], v2 offset:28672
buffer_load_dwordx4 v11, s[8:11], s89 offen offset:0 lds
v_mfma_f32_16x16x32_bf16 a[40:43], a[184:187], v[184:187], a[40:43]
v_exp_f32 v157, v157
v_mfma_f32_16x16x32_bf16 a[56:59], a[188:191], v[184:187], a[56:59]
ds_read_b128 a[228:231], v2 offset:29696
v_cvt_pk_bf16_f32 v190, v156, v157
v_mfma_f32_16x16x32_bf16 a[72:75], a[192:195], v[184:187], a[72:75]
v_exp_f32 v158, v158
v_mfma_f32_16x16x32_bf16 a[88:91], a[196:199], v[184:187], a[88:91]
ds_read_b128 a[232:235], v2 offset:30720
buffer_load_dwordx4 v12, s[8:11], s89 offen offset:1024 lds
v_mfma_f32_16x16x32_bf16 a[104:107], a[200:203], v[184:187], a[104:107]
v_exp_f32 v159, v159
v_mfma_f32_16x16x32_bf16 a[120:123], a[204:207], v[184:187], a[120:123]
ds_read_b128 a[236:239], v2 offset:31744
v_cvt_pk_bf16_f32 v191, v158, v159
v_mfma_f32_16x16x32_bf16 a[136:139], a[240:243], v[184:187], a[136:139]
s_cmp_eq_u32 s81, 0
s_cbranch_scc1 L_lsg_13
s_waitcnt vmcnt(12)
v_mov_b32 v16, 1
s_mov_b64 exec, 1
buffer_atomic_add v16, v30, s[44:47], s78 offen sc1
s_mov_b64 exec, -1
s_mov_b32 s81, 0
L_lsg_13:
v_add_f32 v216, v252, v212
v_add_f32 v217, v253, v213
v_add_f32 v218, v254, v214
v_add_f32 v219, v255, v215
v_mfma_f32_16x16x32_bf16 v[152:155], a[144:147], v[140:143], v[252:255]
v_exp_f32 v144, v144
v_mfma_f32_16x16x32_bf16 v[156:159], a[160:163], v[140:143], v[216:219]
ds_read_b128 a[144:147], v2 offset:32768
buffer_load_dwordx4 v13, s[8:11], s89 offen offset:2048 lds
v_mfma_f32_16x16x32_bf16 v[152:155], a[148:151], v[172:175], v[152:155]
v_exp_f32 v145, v145
v_mfma_f32_16x16x32_bf16 v[156:159], a[164:167], v[172:175], v[156:159]
ds_read_b128 a[160:163], v2 offset:36864
v_cvt_pk_bf16_f32 v184, v144, v145
v_mfma_f32_16x16x32_bf16 v[152:155], a[152:155], v[204:207], v[152:155]
v_exp_f32 v146, v146
v_mfma_f32_16x16x32_bf16 v[156:159], a[168:171], v[204:207], v[156:159]
ds_read_b128 a[148:151], v2 offset:33792
buffer_load_dwordx4 v14, s[8:11], s89 offen offset:3072 lds
v_mfma_f32_16x16x32_bf16 v[152:155], a[156:159], v[236:239], v[152:155]
v_exp_f32 v147, v147
v_mfma_f32_16x16x32_bf16 v[156:159], a[172:175], v[236:239], v[156:159]
ds_read_b128 a[164:167], v2 offset:37888
s_add_u32 m0, s88, 4096
v_cvt_pk_bf16_f32 v185, v146, v147
v_mfma_f32_16x16x32_bf16 a[12:15], a[176:179], v[188:191], a[12:15]
v_exp_f32 v148, v148
v_mfma_f32_16x16x32_bf16 a[28:31], a[180:183], v[188:191], a[28:31]
ds_read_b128 a[152:155], v2 offset:34816
buffer_load_dwordx4 v8, s[8:11], s89 offen offset:0 lds
v_mfma_f32_16x16x32_bf16 a[44:47], a[184:187], v[188:191], a[44:47]
v_exp_f32 v149, v149
v_mfma_f32_16x16x32_bf16 a[60:63], a[188:191], v[188:191], a[60:63]
ds_read_b128 a[168:171], v2 offset:38912
s_add_u32 s89, s68, 3
s_and_b32 s89, s89, 7
s_mul_i32 s89, s89, 163840
s_add_u32 s89, s89, s86
s_add_u32 s88, s87, 12
s_and_b32 s88, s88, 31
s_mul_i32 s88, s88, 5120
s_add_u32 m0, s88, 0
v_cvt_pk_bf16_f32 v186, v148, v149
v_mfma_f32_16x16x32_bf16 a[76:79], a[192:195], v[188:191], a[76:79]
v_exp_f32 v150, v150
v_mfma_f32_16x16x32_bf16 a[92:95], a[196:199], v[188:191], a[92:95]
ds_read_b128 a[156:159], v2 offset:35840
buffer_load_dwordx4 v11, s[8:11], s89 offen offset:0 lds
v_mfma_f32_16x16x32_bf16 a[108:111], a[200:203], v[188:191], a[108:111]
v_exp_f32 v151, v151
v_mfma_f32_16x16x32_bf16 a[124:127], a[204:207], v[188:191], a[124:127]
ds_read_b128 a[172:175], v2 offset:39936
v_cvt_pk_bf16_f32 v187, v150, v151
v_mfma_f32_16x16x32_bf16 a[140:143], a[240:243], v[188:191], a[140:143]
s_waitcnt lgkmcnt(4)
buffer_load_dword v29, v30, s[44:47], s78 offen sc1
v_add_f32 v216, v248, v212
v_add_f32 v217, v249, v213
v_add_f32 v218, v250, v214
v_add_f32 v219, v251, v215
s_nop 1
v_mfma_f32_16x16x32_bf16 v[144:147], a[144:147], v[136:139], v[216:219]
v_exp_f32 v152, v152
v_mfma_f32_16x16x32_bf16 v[144:147], a[148:151], v[168:171], v[144:147]
ds_read_b128 a[176:179], v2 offset:40960
buffer_load_dwordx4 v12, s[8:11], s89 offen offset:1024 lds
s_waitcnt lgkmcnt(4)
v_mfma_f32_16x16x32_bf16 v[144:147], a[152:155], v[200:203], v[144:147]
v_exp_f32 v153, v153
s_waitcnt lgkmcnt(2)
v_mfma_f32_16x16x32_bf16 v[144:147], a[156:159], v[232:235], v[144:147]
ds_read_b128 a[180:183], v2 offset:41984
v_cvt_pk_bf16_f32 v188, v152, v153
v_mfma_f32_16x16x32_bf16 a[8:11], a[208:211], v[184:187], a[8:11]
v_exp_f32 v154, v154
v_mfma_f32_16x16x32_bf16 a[24:27], a[212:215], v[184:187], a[24:27]
ds_read_b128 a[184:187], v2 offset:43008
buffer_load_dwordx4 v13, s[8:11], s89 offen offset:2048 lds
v_mfma_f32_16x16x32_bf16 a[40:43], a[216:219], v[184:187], a[40:43]
v_exp_f32 v155, v155
v_mfma_f32_16x16x32_bf16 a[56:59], a[220:223], v[184:187], a[56:59]
ds_read_b128 a[188:191], v2 offset:44032
v_cvt_pk_bf16_f32 v189, v154, v155
v_mfma_f32_16x16x32_bf16 a[72:75], a[224:227], v[184:187], a[72:75]
v_exp_f32 v156, v156
v_mfma_f32_16x16x32_bf16 a[88:91], a[228:231], v[184:187], a[88:91]
ds_read_b128 a[192:195], v2 offset:45056
buffer_load_dwordx4 v14, s[8:11], s89 offen offset:3072 lds
v_mfma_f32_16x16x32_bf16 a[104:107], a[232:235], v[184:187], a[104:107]
s_add_u32 m0, s88, 4096
s_nop 0
buffer_load_dwordx4 v8, s[8:11], s89 offen offset:0 lds
v_exp_f32 v157, v157
v_mfma_f32_16x16x32_bf16 a[120:123], a[236:239], v[184:187], a[120:123]
ds_read_b128 a[196:199], v2 offset:46080
v_cvt_pk_bf16_f32 v190, v156, v157
v_mfma_f32_16x16x32_bf16 a[136:139], a[240:243], v[184:187], a[136:139]
v_exp_f32 v158, v158
ds_read_b128 a[200:203], v2 offset:47104
ds_read_b128 a[204:207], v2 offset:48128
v_exp_f32 v159, v159
s_nop 0
v_cvt_pk_bf16_f32 v191, v158, v159
s_nop 1
v_mfma_f32_16x16x32_bf16 a[12:15], a[208:211], v[188:191], a[12:15]
v_exp_f32 v144, v144
v_mfma_f32_16x16x32_bf16 a[28:31], a[212:215], v[188:191], a[28:31]
v_mfma_f32_16x16x32_bf16 a[44:47], a[216:219], v[188:191], a[44:47]
v_exp_f32 v145, v145
v_mfma_f32_16x16x32_bf16 a[60:63], a[220:223], v[188:191], a[60:63]
v_cvt_pk_bf16_f32 v184, v144, v145
v_mfma_f32_16x16x32_bf16 a[76:79], a[224:227], v[188:191], a[76:79]
v_exp_f32 v146, v146
v_mfma_f32_16x16x32_bf16 a[92:95], a[228:231], v[188:191], a[92:95]
v_mfma_f32_16x16x32_bf16 a[108:111], a[232:235], v[188:191], a[108:111]
v_exp_f32 v147, v147
v_mfma_f32_16x16x32_bf16 a[124:127], a[236:239], v[188:191], a[124:127]
v_cvt_pk_bf16_f32 v185, v146, v147
v_mfma_f32_16x16x32_bf16 a[140:143], a[240:243], v[188:191], a[140:143]
v_mov_b32 v186, 0
v_mov_b32 v187, 0
s_waitcnt lgkmcnt(7)
s_nop 0
v_mfma_f32_16x16x32_bf16 a[8:11], a[176:179], v[184:187], a[8:11]
s_waitcnt lgkmcnt(6)
v_mfma_f32_16x16x32_bf16 a[24:27], a[180:183], v[184:187], a[24:27]
s_waitcnt lgkmcnt(5)
v_mfma_f32_16x16x32_bf16 a[40:43], a[184:187], v[184:187], a[40:43]
s_waitcnt lgkmcnt(4)
v_mfma_f32_16x16x32_bf16 a[56:59], a[188:191], v[184:187], a[56:59]
s_waitcnt lgkmcnt(3)
v_mfma_f32_16x16x32_bf16 a[72:75], a[192:195], v[184:187], a[72:75]
s_waitcnt lgkmcnt(2)
v_mfma_f32_16x16x32_bf16 a[88:91], a[196:199], v[184:187], a[88:91]
s_waitcnt lgkmcnt(1)
v_mfma_f32_16x16x32_bf16 a[104:107], a[200:203], v[184:187], a[104:107]
s_waitcnt lgkmcnt(0)
v_mfma_f32_16x16x32_bf16 a[120:123], a[204:207], v[184:187], a[120:123]
v_mfma_f32_16x16x32_bf16 a[136:139], a[240:243], v[184:187], a[136:139]
L_ld_done:
s_cmp_eq_u32 s81, 0
s_cbranch_scc1 L_sgl_14
s_waitcnt vmcnt(21)
v_mov_b32 v16, 1
s_mov_b64 exec, 1
buffer_atomic_add v16, v30, s[44:47], s78 offen sc1
s_mov_b64 exec, -1
L_sgl_14:
s_waitcnt vmcnt(4)
v_readfirstlane_b32 s70, v29
s_nop 0
s_cmp_ge_u32 s70, 8
s_cbranch_scc1 L_pk_15
v_mov_b32 v29, 0
s_mov_b32 s71, 0
L_spin_16:
buffer_load_dword v28, v29, s[44:47], s78 offen sc1
s_waitcnt vmcnt(0)
v_readfirstlane_b32 s70, v28
s_add_u32 s71, s71, 1
s_cmp_ge_u32 s70, 8
s_cbranch_scc1 L_spine_17
s_sleep 2
s_cmp_lt_u32 s71, 262144
s_cbranch_scc1 L_spin_16
L_spine_17:
L_pk_15:
s_lshl_b32 s74, s92, 17
s_lshl_b32 s70, s67, 15
s_add_u32 s74, s74, s70
s_add_u32 s74, s74, 37748736
s_lshl_b32 s75, s93, 17
s_lshl_b32 s70, s67, 15
s_add_u32 s75, s75, s70
s_add_u32 s75, s75, 37748736
s_lshl_b32 s76, s94, 17
s_lshl_b32 s70, s67, 15
s_add_u32 s76, s76, s70
s_add_u32 s76, s76, 37748736
s_lshl_b32 s77, s95, 17
s_lshl_b32 s70, s67, 15
s_add_u32 s77, s77, s70
s_add_u32 s77, s77, 37748736
s_lshl_b32 s70, s94, 17
s_lshl_b32 s71, s65, 12
s_add_u32 s70, s70, s71
s_add_u32 s72, s70, 37748736
s_lshl_b32 s70, s95, 17
s_lshl_b32 s71, s65, 12
s_add_u32 s70, s70, s71
s_add_u32 s73, s70, 37748736
v_accvgpr_read_b32 v24, a136
v_mov_b32 v16, 0x2b800000
v_mov_b32 v17, 0x67800000
v_cmp_ge_f32 vcc, v24, v16
v_cmp_le_f32 s[14:15], v24, v17
s_nop 0
s_and_b64 vcc, vcc, s[14:15]
s_cmp_eq_u64 vcc, exec
s_cbranch_scc0 L_slow_2
L_slow_ret_2:
v_accvgpr_read_b32 v25, a140
v_mov_b32 v16, 0x2b800000
v_mov_b32 v17, 0x67800000
v_cmp_ge_f32 vcc, v25, v16
v_cmp_le_f32 s[14:15], v25, v17
s_nop 0
s_and_b64 vcc, vcc, s[14:15]
s_cmp_eq_u64 vcc, exec
s_cbranch_scc0 L_slow_3
L_slow_ret_3:
v_accvgpr_read_b32 v24, a136
v_accvgpr_read_b32 v25, a140
v_rcp_f32 v26, v24
v_rcp_f32 v27, v25
v_accvgpr_read_b32 v16, a8
v_accvgpr_read_b32 v17, a9
v_accvgpr_read_b32 v18, a10
v_accvgpr_read_b32 v19, a11
v_accvgpr_read_b32 v20, a24
v_accvgpr_read_b32 v21, a25
v_accvgpr_read_b32 v22, a26
v_accvgpr_read_b32 v23, a27
v_mul_f32 v16, v16, v26
v_mul_f32 v17, v17, v26
v_mul_f32 v18, v18, v26
v_mul_f32 v19, v19, v26
v_mul_f32 v20, v20, v26
v_mul_f32 v21, v21, v26
v_mul_f32 v22, v22, v26
v_mul_f32 v23, v23, v26
v_cvt_pk_bf16_f32 v96, v16, v17
v_cvt_pk_bf16_f32 v97, v18, v19
v_cvt_pk_bf16_f32 v98, v20, v21
v_cvt_pk_bf16_f32 v99, v22, v23
buffer_store_dwordx4 v[96:99], v10, s[44:47], s72 offen offset:0 sc1
s_add_u32 s91, s68, 1
s_and_b32 s91, s91, 7
s_lshl_b32 s91, s91, 12
s_add_u32 s79, s91, s75
s_add_u32 s91, s91, s74
buffer_load_dwordx4 a[0:3], v10, s[44:47], s91 offen offset:0 sc1
buffer_load_dwordx4 a[4:7], v10, s[44:47], s79 offen offset:0 sc1
v_accvgpr_read_b32 v16, a40
v_accvgpr_read_b32 v17, a41
v_accvgpr_read_b32 v18, a42
v_accvgpr_read_b32 v19, a43
v_accvgpr_read_b32 v20, a56
v_accvgpr_read_b32 v21, a57
v_accvgpr_read_b32 v22, a58
v_accvgpr_read_b32 v23, a59
v_mul_f32 v16, v16, v26
v_mul_f32 v17, v17, v26
v_mul_f32 v18, v18, v26
v_mul_f32 v19, v19, v26
v_mul_f32 v20, v20, v26
v_mul_f32 v21, v21, v26
v_mul_f32 v22, v22, v26
v_mul_f32 v23, v23, v26
v_cvt_pk_bf16_f32 v100, v16, v17
v_cvt_pk_bf16_f32 v101, v18, v19
v_cvt_pk_bf16_f32 v102, v20, v21
v_cvt_pk_bf16_f32 v103, v22, v23
buffer_store_dwordx4 v[100:103], v10, s[44:47], s72 offen offset:1024 sc1
buffer_load_dwordx4 a[16:19], v10, s[44:47], s91 offen offset:1024 sc1
buffer_load_dwordx4 a[20:23], v10, s[44:47], s79 offen offset:1024 sc1
v_accvgpr_read_b32 v16, a72
v_accvgpr_read_b32 v17, a73
v_accvgpr_read_b32 v18, a74
v_accvgpr_read_b32 v19, a75
v_accvgpr_read_b32 v20, a88
v_accvgpr_read_b32 v21, a89
v_accvgpr_read_b32 v22, a90
v_accvgpr_read_b32 v23, a91
v_mul_f32 v16, v16, v26
v_mul_f32 v17, v17, v26
v_mul_f32 v18, v18, v26
v_mul_f32 v19, v19, v26
v_mul_f32 v20, v20, v26
v_mul_f32 v21, v21, v26
v_mul_f32 v22, v22, v26
v_mul_f32 v23, v23, v26
v_cvt_pk_bf16_f32 v104, v16, v17
v_cvt_pk_bf16_f32 v105, v18, v19
v_cvt_pk_bf16_f32 v106, v20, v21
v_cvt_pk_bf16_f32 v107, v22, v23
buffer_store_dwordx4 v[104:107], v10, s[44:47], s72 offen offset:2048 sc1
buffer_load_dwordx4 a[32:35], v10, s[44:47], s91 offen offset:2048 sc1
buffer_load_dwordx4 a[36:39], v10, s[44:47], s79 offen offset:2048 sc1
v_accvgpr_read_b32 v16, a104
v_accvgpr_read_b32 v17, a105
v_accvgpr_read_b32 v18, a106
v_accvgpr_read_b32 v19, a107
v_accvgpr_read_b32 v20, a120
v_accvgpr_read_b32 v21, a121
v_accvgpr_read_b32 v22, a122
v_accvgpr_read_b32 v23, a123
v_mul_f32 v16, v16, v26
v_mul_f32 v17, v17, v26
v_mul_f32 v18, v18, v26
v_mul_f32 v19, v19, v26
v_mul_f32 v20, v20, v26
v_mul_f32 v21, v21, v26
v_mul_f32 v22, v22, v26
v_mul_f32 v23, v23, v26
v_cvt_pk_bf16_f32 v108, v16, v17
v_cvt_pk_bf16_f32 v109, v18, v19
v_cvt_pk_bf16_f32 v110, v20, v21
v_cvt_pk_bf16_f32 v111, v22, v23
buffer_store_dwordx4 v[108:111], v10, s[44:47], s72 offen offset:3072 sc1
buffer_load_dwordx4 a[48:51], v10, s[44:47], s91 offen offset:3072 sc1
buffer_load_dwordx4 a[52:55], v10, s[44:47], s79 offen offset:3072 sc1
v_accvgpr_read_b32 v16, a12
v_accvgpr_read_b32 v17, a13
v_accvgpr_read_b32 v18, a14
v_accvgpr_read_b32 v19, a15
v_accvgpr_read_b32 v20, a28
v_accvgpr_read_b32 v21, a29
v_accvgpr_read_b32 v22, a30
v_accvgpr_read_b32 v23, a31
v_mul_f32 v16, v16, v27
v_mul_f32 v17, v17, v27
v_mul_f32 v18, v18, v27
v_mul_f32 v19, v19, v27
v_mul_f32 v20, v20, v27
v_mul_f32 v21, v21, v27
v_mul_f32 v22, v22, v27
v_mul_f32 v23, v23, v27
v_cvt_pk_bf16_f32 v112, v16, v17
v_cvt_pk_bf16_f32 v113, v18, v19
v_cvt_pk_bf16_f32 v114, v20, v21
v_cvt_pk_bf16_f32 v115, v22, v23
buffer_store_dwordx4 v[112:115], v10, s[44:47], s73 offen offset:0 sc1
s_add_u32 s91, s68, 2
s_and_b32 s91, s91, 7
s_lshl_b32 s91, s91, 12
s_add_u32 s79, s91, s75
s_add_u32 s91, s91, s74
buffer_load_dwordx4 a[64:67], v10, s[44:47], s91 offen offset:0 sc1
buffer_load_dwordx4 a[68:71], v10, s[44:47], s79 offen offset:0 sc1
v_accvgpr_read_b32 v16, a44
v_accvgpr_read_b32 v17, a45
v_accvgpr_read_b32 v18, a46
v_accvgpr_read_b32 v19, a47
v_accvgpr_read_b32 v20, a60
v_accvgpr_read_b32 v21, a61
v_accvgpr_read_b32 v22, a62
v_accvgpr_read_b32 v23, a63
v_mul_f32 v16, v16, v27
v_mul_f32 v17, v17, v27
v_mul_f32 v18, v18, v27
v_mul_f32 v19, v19, v27
v_mul_f32 v20, v20, v27
v_mul_f32 v21, v21, v27
v_mul_f32 v22, v22, v27
v_mul_f32 v23, v23, v27
v_cvt_pk_bf16_f32 v116, v16, v17
v_cvt_pk_bf16_f32 v117, v18, v19
v_cvt_pk_bf16_f32 v118, v20, v21
v_cvt_pk_bf16_f32 v119, v22, v23
buffer_store_dwordx4 v[116:119], v10, s[44:47], s73 offen offset:1024 sc1
buffer_load_dwordx4 a[80:83], v10, s[44:47], s91 offen offset:1024 sc1
buffer_load_dwordx4 a[84:87], v10, s[44:47], s79 offen offset:1024 sc1
v_accvgpr_read_b32 v16, a76
v_accvgpr_read_b32 v17, a77
v_accvgpr_read_b32 v18, a78
v_accvgpr_read_b32 v19, a79
v_accvgpr_read_b32 v20, a92
v_accvgpr_read_b32 v21, a93
v_accvgpr_read_b32 v22, a94
v_accvgpr_read_b32 v23, a95
v_mul_f32 v16, v16, v27
v_mul_f32 v17, v17, v27
v_mul_f32 v18, v18, v27
v_mul_f32 v19, v19, v27
v_mul_f32 v20, v20, v27
v_mul_f32 v21, v21, v27
v_mul_f32 v22, v22, v27
v_mul_f32 v23, v23, v27
v_cvt_pk_bf16_f32 v120, v16, v17
v_cvt_pk_bf16_f32 v121, v18, v19
v_cvt_pk_bf16_f32 v122, v20, v21
v_cvt_pk_bf16_f32 v123, v22, v23
buffer_store_dwordx4 v[120:123], v10, s[44:47], s73 offen offset:2048 sc1
buffer_load_dwordx4 a[96:99], v10, s[44:47], s91 offen offset:2048 sc1
buffer_load_dwordx4 a[100:103], v10, s[44:47], s79 offen offset:2048 sc1
v_accvgpr_read_b32 v16, a108
v_accvgpr_read_b32 v17, a109
v_accvgpr_read_b32 v18, a110
v_accvgpr_read_b32 v19, a111
v_accvgpr_read_b32 v20, a124
v_accvgpr_read_b32 v21, a125
v_accvgpr_read_b32 v22, a126
v_accvgpr_read_b32 v23, a127
v_mul_f32 v16, v16, v27
v_mul_f32 v17, v17, v27
v_mul_f32 v18, v18, v27
v_mul_f32 v19, v19, v27
v_mul_f32 v20, v20, v27
v_mul_f32 v21, v21, v27
v_mul_f32 v22, v22, v27
v_mul_f32 v23, v23, v27
v_cvt_pk_bf16_f32 v124, v16, v17
v_cvt_pk_bf16_f32 v125, v18, v19
v_cvt_pk_bf16_f32 v126, v20, v21
v_cvt_pk_bf16_f32 v127, v22, v23
buffer_store_dwordx4 v[124:127], v10, s[44:47], s73 offen offset:3072 sc1
buffer_load_dwordx4 a[112:115], v10, s[44:47], s91 offen offset:3072 sc1
buffer_load_dwordx4 a[116:119], v10, s[44:47], s79 offen offset:3072 sc1
v_and_b32 v16, 15, v1
v_lshrrev_b32 v17, 4, v1
v_lshrrev_b32 v18, 2, v16
v_and_b32 v19, 3, v16
v_lshl_add_u32 v18, v17, 2, v18
v_mul_u32_u24 v18, 160, v18
v_lshl_add_u32 v2, v19, 3, v18
s_lshl_b32 s82, s65, 7
s_add_u32 s82, s82, s92
s_mul_i32 s82, s82, 2560
s_add_u32 s82, s82, 54525952
s_lshl_b32 s83, s65, 7
s_add_u32 s83, s83, s93
s_mul_i32 s83, s83, 2560
s_add_u32 s83, s83, 54525952
s_lshl_b32 s84, s65, 7
s_add_u32 s84, s84, s94
s_mul_i32 s84, s84, 2560
s_add_u32 s84, s84, 54525952
s_lshl_b32 s85, s65, 7
s_add_u32 s85, s85, s95
s_mul_i32 s85, s85, 2560
s_add_u32 s85, s85, 54525952
s_add_u32 s70, s90, 0
s_and_b32 s70, s70, 31
s_mul_i32 s70, s70, 5120
v_add_u32 v16, s70, v2
s_add_u32 s70, s90, 4
s_and_b32 s70, s70, 31
s_mul_i32 s70, s70, 5120
v_add_u32 v17, s70, v2
s_add_u32 s70, s90, 8
s_and_b32 s70, s70, 31
s_mul_i32 s70, s70, 5120
v_add_u32 v18, s70, v2
s_add_u32 s70, s90, 12
s_and_b32 s70, s70, 31
s_mul_i32 s70, s70, 5120
v_add_u32 v19, s70, v2
s_add_u32 s70, s90, 16
s_and_b32 s70, s70, 31
s_mul_i32 s70, s70, 5120
v_add_u32 v20, s70, v2
s_add_u32 s70, s90, 20
s_and_b32 s70, s70, 31
s_mul_i32 s70, s70, 5120
v_add_u32 v21, s70, v2
s_add_u32 s70, s90, 24
s_and_b32 s70, s70, 31
s_mul_i32 s70, s70, 5120
v_add_u32 v22, s70, v2
s_add_u32 s70, s90, 28
s_and_b32 s70, s70, 31
s_mul_i32 s70, s70, 5120
v_add_u32 v23, s70, v2
s_waitcnt vmcnt(24)
s_barrier
ds_read_b64_tr_b16 v[208:209], v16 offset:0
ds_read_b64_tr_b16 v[210:211], v16 offset:2560
ds_read_b64_tr_b16 v[212:213], v16 offset:32
ds_read_b64_tr_b16 v[214:215], v16 offset:2592
ds_read_b64_tr_b16 v[216:217], v16 offset:64
ds_read_b64_tr_b16 v[218:219], v16 offset:2624
ds_read_b64_tr_b16 v[220:221], v16 offset:96
ds_read_b64_tr_b16 v[222:223], v16 offset:2656
ds_read_b64_tr_b16 v[224:225], v16 offset:128
ds_read_b64_tr_b16 v[226:227], v16 offset:2688
v_lshlrev_b32 v5, 3, v1
s_waitcnt lgkmcnt(4)
v_mfma_f32_16x16x32_bf16 v[128:131], v[208:211], v[64:67], 0
ds_read_b64_tr_b16 v[228:229], v16 offset:5120
v_mfma_f32_16x16x32_bf16 v[132:135], v[208:211], v[80:83], 0
s_add_u32 s89, s68, 4
s_and_b32 s89, s89, 7
s_mul_i32 s89, s89, 163840
s_add_u32 s89, s89, s86
s_add_u32 s88, s87, 16
s_and_b32 s88, s88, 31
s_mul_i32 s88, s88, 5120
s_add_u32 m0, s88, 0
s_nop 0
buffer_load_dwordx4 v11, s[8:11], s89 offen offset:0 lds
v_mfma_f32_16x16x32_bf16 v[136:139], v[208:211], v[96:99], 0
ds_read_b64_tr_b16 v[230:231], v16 offset:7680
v_mfma_f32_16x16x32_bf16 v[140:143], v[208:211], v[112:115], 0
v_mfma_f32_16x16x32_bf16 v[144:147], v[212:215], v[64:67], 0
ds_read_b64_tr_b16 v[232:233], v16 offset:5152
s_add_u32 m0, s88, 0
s_nop 0
buffer_load_dwordx4 v12, s[8:11], s89 offen offset:1024 lds
v_mfma_f32_16x16x32_bf16 v[148:151], v[212:215], v[80:83], 0
v_mfma_f32_16x16x32_bf16 v[152:155], v[212:215], v[96:99], 0
ds_read_b64_tr_b16 v[234:235], v16 offset:7712
v_mfma_f32_16x16x32_bf16 v[156:159], v[212:215], v[112:115], 0
s_add_u32 m0, s88, 0
s_nop 0
buffer_load_dwordx4 v13, s[8:11], s89 offen offset:2048 lds
v_mfma_f32_16x16x32_bf16 v[160:163], v[216:219], v[64:67], 0
ds_read_b64_tr_b16 v[236:237], v16 offset:5184
v_mfma_f32_16x16x32_bf16 v[164:167], v[216:219], v[80:83], 0
v_mfma_f32_16x16x32_bf16 v[168:171], v[216:219], v[96:99], 0
ds_read_b64_tr_b16 v[238:239], v16 offset:7744
v_mfma_f32_16x16x32_bf16 v[172:175], v[216:219], v[112:115], 0
s_waitcnt lgkmcnt(6)
v_mfma_f32_16x16x32_bf16 v[176:179], v[220:223], v[64:67], 0
ds_read_b64_tr_b16 v[240:241], v16 offset:5216
v_mfma_f32_16x16x32_bf16 v[180:183], v[220:223], v[80:83], 0
v_mfma_f32_16x16x32_bf16 v[184:187], v[220:223], v[96:99], 0
ds_read_b64_tr_b16 v[242:243], v16 offset:7776
v_mfma_f32_16x16x32_bf16 v[188:191], v[220:223], v[112:115], 0
v_mfma_f32_16x16x32_bf16 v[192:195], v[224:227], v[64:67], 0
ds_read_b64_tr_b16 v[244:245], v16 offset:5248
v_mfma_f32_16x16x32_bf16 v[196:199], v[224:227], v[80:83], 0
v_mfma_f32_16x16x32_bf16 v[200:203], v[224:227], v[96:99], 0
ds_read_b64_tr_b16 v[246:247], v16 offset:7808
v_mfma_f32_16x16x32_bf16 v[204:207], v[224:227], v[112:115], 0
s_waitcnt lgkmcnt(4)
v_mfma_f32_16x16x32_bf16 v[128:131], v[228:231], v[68:71], v[128:131]
ds_read_b64_tr_b16 v[208:209], v16 offset:10240
v_mfma_f32_16x16x32_bf16 v[132:135], v[228:231], v[84:87], v[132:135]
s_add_u32 m0, s88, 0
s_nop 0
buffer_load_dwordx4 v14, s[8:11], s89 offen offset:3072 lds
v_mfma_f32_16x16x32_bf16 v[136:139], v[228:231], v[100:103], v[136:139]
ds_read_b64_tr_b16 v[210:211], v16 offset:12800
v_mfma_f32_16x16x32_bf16 v[140:143], v[228:231], v[116:119], v[140:143]
v_mfma_f32_16x16x32_bf16 v[144:147], v[232:235], v[68:71], v[144:147]
ds_read_b64_tr_b16 v[212:213], v16 offset:10272
s_add_u32 m0, s88, 4096
s_nop 0
buffer_load_dwordx4 v8, s[8:11], s89 offen offset:0 lds
v_mfma_f32_16x16x32_bf16 v[148:151], v[232:235], v[84:87], v[148:151]
s_add_u32 s89, s68, 5
s_and_b32 s89, s89, 7
s_mul_i32 s89, s89, 163840
s_add_u32 s89, s89, s86
s_add_u32 s88, s87, 20
s_and_b32 s88, s88, 31
s_mul_i32 s88, s88, 5120
v_mfma_f32_16x16x32_bf16 v[152:155], v[232:235], v[100:103], v[152:155]
ds_read_b64_tr_b16 v[214:215], v16 offset:12832
v_mfma_f32_16x16x32_bf16 v[156:159], v[232:235], v[116:119], v[156:159]
s_add_u32 m0, s88, 0
s_nop 0
buffer_load_dwordx4 v11, s[8:11], s89 offen offset:0 lds
v_mfma_f32_16x16x32_bf16 v[160:163], v[236:239], v[68:71], v[160:163]
ds_read_b64_tr_b16 v[216:217], v16 offset:10304
v_mfma_f32_16x16x32_bf16 v[164:167], v[236:239], v[84:87], v[164:167]
v_mfma_f32_16x16x32_bf16 v[168:171], v[236:239], v[100:103], v[168:171]
ds_read_b64_tr_b16 v[218:219], v16 offset:12864
v_mfma_f32_16x16x32_bf16 v[172:175], v[236:239], v[116:119], v[172:175]
s_waitcnt lgkmcnt(6)
v_mfma_f32_16x16x32_bf16 v[176:179], v[240:243], v[68:71], v[176:179]
ds_read_b64_tr_b16 v[220:221], v16 offset:10336
v_mfma_f32_16x16x32_bf16 v[180:183], v[240:243], v[84:87], v[180:183]
v_mfma_f32_16x16x32_bf16 v[184:187], v[240:243], v[100:103], v[184:187]
ds_read_b64_tr_b16 v[222:223], v16 offset:12896
v_mfma_f32_16x16x32_bf16 v[188:191], v[240:243], v[116:119], v[188:191]
v_mfma_f32_16x16x32_bf16 v[192:195], v[244:247], v[68:71], v[192:195]
ds_read_b64_tr_b16 v[224:225], v16 offset:10368
v_mfma_f32_16x16x32_bf16 v[196:199], v[244:247], v[84:87], v[196:199]
v_mfma_f32_16x16x32_bf16 v[200:203], v[244:247], v[100:103], v[200:203]
ds_read_b64_tr_b16 v[226:227], v16 offset:12928
v_mfma_f32_16x16x32_bf16 v[204:207], v[244:247], v[116:119], v[204:207]
s_waitcnt lgkmcnt(4)
v_mfma_f32_16x16x32_bf16 v[128:131], v[208:211], v[72:75], v[128:131]
ds_read_b64_tr_b16 v[228:229], v16 offset:15360
v_mfma_f32_16x16x32_bf16 v[132:135], v[208:211], v[88:91], v[132:135]
s_add_u32 m0, s88, 0
s_nop 0
buffer_load_dwordx4 v12, s[8:11], s89 offen offset:1024 lds
v_mfma_f32_16x16x32_bf16 v[136:139], v[208:211], v[104:107], v[136:139]
ds_read_b64_tr_b16 v[230:231], v16 offset:17920
v_mfma_f32_16x16x32_bf16 v[140:143], v[208:211], v[120:123], v[140:143]
v_mfma_f32_16x16x32_bf16 v[144:147], v[212:215], v[72:75], v[144:147]
ds_read_b64_tr_b16 v[232:233], v16 offset:15392
s_add_u32 m0, s88, 0
s_nop 0
buffer_load_dwordx4 v13, s[8:11], s89 offen offset:2048 lds
v_mfma_f32_16x16x32_bf16 v[148:151], v[212:215], v[88:91], v[148:151]
v_mfma_f32_16x16x32_bf16 v[152:155], v[212:215], v[104:107], v[152:155]
ds_read_b64_tr_b16 v[234:235], v16 offset:17952
v_mfma_f32_16x16x32_bf16 v[156:159], v[212:215], v[120:123], v[156:159]
s_add_u32 m0, s88, 0
s_nop 0
buffer_load_dwordx4 v14, s[8:11], s89 offen offset:3072 lds
v_mfma_f32_16x16x32_bf16 v[160:163], v[216:219], v[72:75], v[160:163]
ds_read_b64_tr_b16 v[236:237], v16 offset:15424
v_mfma_f32_16x16x32_bf16 v[164:167], v[216:219], v[88:91], v[164:167]
v_mfma_f32_16x16x32_bf16 v[168:171], v[216:219], v[104:107], v[168:171]
ds_read_b64_tr_b16 v[238:239], v16 offset:17984
v_mfma_f32_16x16x32_bf16 v[172:175], v[216:219], v[120:123], v[172:175]
s_waitcnt lgkmcnt(6)
v_mfma_f32_16x16x32_bf16 v[176:179], v[220:223], v[72:75], v[176:179]
ds_read_b64_tr_b16 v[240:241], v16 offset:15456
v_mfma_f32_16x16x32_bf16 v[180:183], v[220:223], v[88:91], v[180:183]
v_mfma_f32_16x16x32_bf16 v[184:187], v[220:223], v[104:107], v[184:187]
ds_read_b64_tr_b16 v[242:243], v16 offset:18016
v_mfma_f32_16x16x32_bf16 v[188:191], v[220:223], v[120:123], v[188:191]
v_mfma_f32_16x16x32_bf16 v[192:195], v[224:227], v[72:75], v[192:195]
ds_read_b64_tr_b16 v[244:245], v16 offset:15488
v_mfma_f32_16x16x32_bf16 v[196:199], v[224:227], v[88:91], v[196:199]
v_mfma_f32_16x16x32_bf16 v[200:203], v[224:227], v[104:107], v[200:203]
ds_read_b64_tr_b16 v[246:247], v16 offset:18048
v_mfma_f32_16x16x32_bf16 v[204:207], v[224:227], v[120:123], v[204:207]
s_waitcnt lgkmcnt(4)
v_mfma_f32_16x16x32_bf16 v[128:131], v[228:231], v[76:79], v[128:131]
ds_read_b64_tr_b16 v[208:209], v17 offset:0
v_mfma_f32_16x16x32_bf16 v[132:135], v[228:231], v[92:95], v[132:135]
s_add_u32 m0, s88, 4096
s_nop 0
buffer_load_dwordx4 v8, s[8:11], s89 offen offset:0 lds
v_mfma_f32_16x16x32_bf16 v[136:139], v[228:231], v[108:111], v[136:139]
ds_read_b64_tr_b16 v[210:211], v17 offset:2560
s_add_u32 s89, s68, 6
s_and_b32 s89, s89, 7
s_mul_i32 s89, s89, 163840
s_add_u32 s89, s89, s86
s_add_u32 s88, s87, 24
s_and_b32 s88, s88, 31
s_mul_i32 s88, s88, 5120
v_mfma_f32_16x16x32_bf16 v[140:143], v[228:231], v[124:127], v[140:143]
v_mfma_f32_16x16x32_bf16 v[144:147], v[232:235], v[76:79], v[144:147]
ds_read_b64_tr_b16 v[212:213], v17 offset:32
s_add_u32 m0, s88, 0
s_nop 0
buffer_load_dwordx4 v11, s[8:11], s89 offen offset:0 lds
v_mfma_f32_16x16x32_bf16 v[148:151], v[232:235], v[92:95], v[148:151]
v_mfma_f32_16x16x32_bf16 v[152:155], v[232:235], v[108:111], v[152:155]
ds_read_b64_tr_b16 v[214:215], v17 offset:2592
v_mfma_f32_16x16x32_bf16 v[156:159], v[232:235], v[124:127], v[156:159]
s_add_u32 m0, s88, 0
s_nop 0
buffer_load_dwordx4 v12, s[8:11], s89 offen offset:1024 lds
v_mfma_f32_16x16x32_bf16 v[160:163], v[236:239], v[76:79], v[160:163]
ds_read_b64_tr_b16 v[216:217], v17 offset:64
v_mfma_f32_16x16x32_bf16 v[164:167], v[236:239], v[92:95], v[164:167]
v_mfma_f32_16x16x32_bf16 v[168:171], v[236:239], v[108:111], v[168:171]
ds_read_b64_tr_b16 v[218:219], v17 offset:2624
v_mfma_f32_16x16x32_bf16 v[172:175], v[236:239], v[124:127], v[172:175]
s_waitcnt lgkmcnt(6)
v_mfma_f32_16x16x32_bf16 v[176:179], v[240:243], v[76:79], v[176:179]
ds_read_b64_tr_b16 v[220:221], v17 offset:96
v_mfma_f32_16x16x32_bf16 v[180:183], v[240:243], v[92:95], v[180:183]
v_mfma_f32_16x16x32_bf16 v[184:187], v[240:243], v[108:111], v[184:187]
ds_read_b64_tr_b16 v[222:223], v17 offset:2656
v_mfma_f32_16x16x32_bf16 v[188:191], v[240:243], v[124:127], v[188:191]
v_mfma_f32_16x16x32_bf16 v[192:195], v[244:247], v[76:79], v[192:195]
ds_read_b64_tr_b16 v[224:225], v17 offset:128
v_mfma_f32_16x16x32_bf16 v[196:199], v[244:247], v[92:95], v[196:199]
v_mfma_f32_16x16x32_bf16 v[200:203], v[244:247], v[108:111], v[200:203]
ds_read_b64_tr_b16 v[226:227], v17 offset:2688
v_mfma_f32_16x16x32_bf16 v[204:207], v[244:247], v[124:127], v[204:207]
s_waitcnt vmcnt(33)
s_waitcnt lgkmcnt(4)
v_mfma_f32_16x16x32_bf16 v[128:131], v[208:211], a[0:3], v[128:131]
ds_read_b64_tr_b16 v[228:229], v17 offset:5120
v_mfma_f32_16x16x32_bf16 v[132:135], v[208:211], a[4:7], v[132:135]
ds_read_b64_tr_b16 v[230:231], v17 offset:7680
s_add_u32 s91, s68, 3
s_and_b32 s91, s91, 7
s_lshl_b32 s91, s91, 12
s_add_u32 s79, s91, s75
s_add_u32 s91, s91, s74
buffer_load_dwordx4 a[144:147], v10, s[44:47], s91 offen offset:0 sc1
v_mfma_f32_16x16x32_bf16 v[144:147], v[212:215], a[0:3], v[144:147]
ds_read_b64_tr_b16 v[232:233], v17 offset:5152
v_mfma_f32_16x16x32_bf16 v[148:151], v[212:215], a[4:7], v[148:151]
ds_read_b64_tr_b16 v[234:235], v17 offset:7712
v_mfma_f32_16x16x32_bf16 v[160:163], v[216:219], a[0:3], v[160:163]
ds_read_b64_tr_b16 v[236:237], v17 offset:5184
buffer_load_dwordx4 a[148:151], v10, s[44:47], s79 offen offset:0 sc1
v_mfma_f32_16x16x32_bf16 v[164:167], v[216:219], a[4:7], v[164:167]
ds_read_b64_tr_b16 v[238:239], v17 offset:7744
s_waitcnt lgkmcnt(6)
v_mfma_f32_16x16x32_bf16 v[176:179], v[220:223], a[0:3], v[176:179]
ds_read_b64_tr_b16 v[240:241], v17 offset:5216
v_mfma_f32_16x16x32_bf16 v[180:183], v[220:223], a[4:7], v[180:183]
ds_read_b64_tr_b16 v[242:243], v17 offset:7776
buffer_load_dwordx4 a[152:155], v10, s[44:47], s91 offen offset:1024 sc1
v_mfma_f32_16x16x32_bf16 v[192:195], v[224:227], a[0:3], v[192:195]
ds_read_b64_tr_b16 v[244:245], v17 offset:5248
v_mfma_f32_16x16x32_bf16 v[196:199], v[224:227], a[4:7], v[196:199]
ds_read_b64_tr_b16 v[246:247], v17 offset:7808
s_waitcnt vmcnt(33)
s_waitcnt lgkmcnt(4)
v_mfma_f32_16x16x32_bf16 v[128:131], v[228:231], a[16:19], v[128:131]
ds_read_b64_tr_b16 v[208:209], v17 offset:10240
v_mfma_f32_16x16x32_bf16 v[132:135], v[228:231], a[20:23], v[132:135]
ds_read_b64_tr_b16 v[210:211], v17 offset:12800
buffer_load_dwordx4 a[156:159], v10, s[44:47], s79 offen offset:1024 sc1
v_mfma_f32_16x16x32_bf16 v[144:147], v[232:235], a[16:19], v[144:147]
ds_read_b64_tr_b16 v[212:213], v17 offset:10272
v_mfma_f32_16x16x32_bf16 v[148:151], v[232:235], a[20:23], v[148:151]
ds_read_b64_tr_b16 v[214:215], v17 offset:12832
v_mfma_f32_16x16x32_bf16 v[160:163], v[236:239], a[16:19], v[160:163]
ds_read_b64_tr_b16 v[216:217], v17 offset:10304
buffer_load_dwordx4 a[160:163], v10, s[44:47], s91 offen offset:2048 sc1
v_mfma_f32_16x16x32_bf16 v[164:167], v[236:239], a[20:23], v[164:167]
ds_read_b64_tr_b16 v[218:219], v17 offset:12864
s_waitcnt lgkmcnt(6)
v_mfma_f32_16x16x32_bf16 v[176:179], v[240:243], a[16:19], v[176:179]
ds_read_b64_tr_b16 v[220:221], v17 offset:10336
v_mfma_f32_16x16x32_bf16 v[180:183], v[240:243], a[20:23], v[180:183]
ds_read_b64_tr_b16 v[222:223], v17 offset:12896
s_add_u32 m0, s88, 0
s_nop 0
buffer_load_dwordx4 v13, s[8:11], s89 offen offset:2048 lds
v_mfma_f32_16x16x32_bf16 v[192:195], v[244:247], a[16:19], v[192:195]
ds_read_b64_tr_b16 v[224:225], v17 offset:10368
v_mfma_f32_16x16x32_bf16 v[196:199], v[244:247], a[20:23], v[196:199]
ds_read_b64_tr_b16 v[226:227], v17 offset:12928
s_waitcnt vmcnt(33)
s_waitcnt lgkmcnt(4)
v_mfma_f32_16x16x32_bf16 v[128:131], v[208:211], a[32:35], v[128:131]
ds_read_b64_tr_b16 v[228:229], v17 offset:15360
v_mfma_f32_16x16x32_bf16 v[132:135], v[208:211], a[36:39], v[132:135]
ds_read_b64_tr_b16 v[230:231], v17 offset:17920
buffer_load_dwordx4 a[164:167], v10, s[44:47], s79 offen offset:2048 sc1
v_mfma_f32_16x16x32_bf16 v[144:147], v[212:215], a[32:35], v[144:147]
ds_read_b64_tr_b16 v[232:233], v17 offset:15392
v_mfma_f32_16x16x32_bf16 v[148:151], v[212:215], a[36:39], v[148:151]
ds_read_b64_tr_b16 v[234:235], v17 offset:17952
v_mfma_f32_16x16x32_bf16 v[160:163], v[216:219], a[32:35], v[160:163]
ds_read_b64_tr_b16 v[236:237], v17 offset:15424
buffer_load_dwordx4 a[168:171], v10, s[44:47], s91 offen offset:3072 sc1
v_mfma_f32_16x16x32_bf16 v[164:167], v[216:219], a[36:39], v[164:167]
ds_read_b64_tr_b16 v[238:239], v17 offset:17984
s_waitcnt lgkmcnt(6)
v_mfma_f32_16x16x32_bf16 v[176:179], v[220:223], a[32:35], v[176:179]
ds_read_b64_tr_b16 v[240:241], v17 offset:15456
v_mfma_f32_16x16x32_bf16 v[180:183], v[220:223], a[36:39], v[180:183]
ds_read_b64_tr_b16 v[242:243], v17 offset:18016
s_add_u32 m0, s88, 0
s_nop 0
buffer_load_dwordx4 v14, s[8:11], s89 offen offset:3072 lds
v_mfma_f32_16x16x32_bf16 v[192:195], v[224:227], a[32:35], v[192:195]
ds_read_b64_tr_b16 v[244:245], v17 offset:15488
v_mfma_f32_16x16x32_bf16 v[196:199], v[224:227], a[36:39], v[196:199]
ds_read_b64_tr_b16 v[246:247], v17 offset:18048
s_waitcnt vmcnt(33)
s_waitcnt lgkmcnt(4)
v_mfma_f32_16x16x32_bf16 v[128:131], v[228:231], a[48:51], v[128:131]
ds_read_b64_tr_b16 v[208:209], v18 offset:0
v_mfma_f32_16x16x32_bf16 v[132:135], v[228:231], a[52:55], v[132:135]
ds_read_b64_tr_b16 v[210:211], v18 offset:2560
buffer_load_dwordx4 a[172:175], v10, s[44:47], s79 offen offset:3072 sc1
v_mfma_f32_16x16x32_bf16 v[144:147], v[232:235], a[48:51], v[144:147]
ds_read_b64_tr_b16 v[212:213], v18 offset:32
v_mfma_f32_16x16x32_bf16 v[148:151], v[232:235], a[52:55], v[148:151]
ds_read_b64_tr_b16 v[214:215], v18 offset:2592
v_mfma_f32_16x16x32_bf16 v[160:163], v[236:239], a[48:51], v[160:163]
ds_read_b64_tr_b16 v[216:217], v18 offset:64
s_add_u32 m0, s88, 4096
s_nop 0
buffer_load_dwordx4 v8, s[8:11], s89 offen offset:0 lds
v_mfma_f32_16x16x32_bf16 v[164:167], v[236:239], a[52:55], v[164:167]
ds_read_b64_tr_b16 v[218:219], v18 offset:2624
s_waitcnt lgkmcnt(6)
v_mfma_f32_16x16x32_bf16 v[176:179], v[240:243], a[48:51], v[176:179]
ds_read_b64_tr_b16 v[220:221], v18 offset:96
v_mfma_f32_16x16x32_bf16 v[180:183], v[240:243], a[52:55], v[180:183]
ds_read_b64_tr_b16 v[222:223], v18 offset:2656
v_mfma_f32_16x16x32_bf16 v[192:195], v[244:247], a[48:51], v[192:195]
ds_read_b64_tr_b16 v[224:225], v18 offset:128
v_mfma_f32_16x16x32_bf16 v[196:199], v[244:247], a[52:55], v[196:199]
ds_read_b64_tr_b16 v[226:227], v18 offset:2688
s_waitcnt vmcnt(32)
s_waitcnt lgkmcnt(4)
v_mfma_f32_16x16x32_bf16 v[128:131], v[208:211], a[64:67], v[128:131]
ds_read_b64_tr_b16 v[228:229], v18 offset:5120
v_mfma_f32_16x16x32_bf16 v[132:135], v[208:211], a[68:71], v[132:135]
ds_read_b64_tr_b16 v[230:231], v18 offset:7680
s_add_u32 s91, s68, 4
s_and_b32 s91, s91, 7
s_lshl_b32 s91, s91, 12
s_add_u32 s79, s91, s75
s_add_u32 s91, s91, s74
s_add_u32 s89, s68, 7
s_and_b32 s89, s89, 7
s_mul_i32 s89, s89, 163840
s_add_u32 s89, s89, s86
s_add_u32 s88, s87, 28
s_and_b32 s88, s88, 31
s_mul_i32 s88, s88, 5120
buffer_load_dwordx4 a[176:179], v10, s[44:47], s91 offen offset:0 sc1
v_mfma_f32_16x16x32_bf16 v[144:147], v[212:215], a[64:67], v[144:147]
ds_read_b64_tr_b16 v[232:233], v18 offset:5152
v_mfma_f32_16x16x32_bf16 v[148:151], v[212:215], a[68:71], v[148:151]
ds_read_b64_tr_b16 v[234:235], v18 offset:7712
v_mfma_f32_16x16x32_bf16 v[160:163], v[216:219], a[64:67], v[160:163]
ds_read_b64_tr_b16 v[236:237], v18 offset:5184
buffer_load_dwordx4 a[180:183], v10, s[44:47], s79 offen offset:0 sc1
v_mfma_f32_16x16x32_bf16 v[164:167], v[216:219], a[68:71], v[164:167]
ds_read_b64_tr_b16 v[238:239], v18 offset:7744
s_waitcnt lgkmcnt(6)
v_mfma_f32_16x16x32_bf16 v[176:179], v[220:223], a[64:67], v[176:179]
ds_read_b64_tr_b16 v[240:241], v18 offset:5216
v_mfma_f32_16x16x32_bf16 v[180:183], v[220:223], a[68:71], v[180:183]
ds_read_b64_tr_b16 v[242:243], v18 offset:7776
buffer_load_dwordx4 a[184:187], v10, s[44:47], s91 offen offset:1024 sc1
v_mfma_f32_16x16x32_bf16 v[192:195], v[224:227], a[64:67], v[192:195]
ds_read_b64_tr_b16 v[244:245], v18 offset:5248
v_mfma_f32_16x16x32_bf16 v[196:199], v[224:227], a[68:71], v[196:199]
s_waitcnt vmcnt(28)
s_lshl_b32 s78, s67, 3
s_add_u32 s78, s78, s66
s_lshl_b32 s78, s78, 2
s_add_u32 s78, s78, s64
s_lshl_b32 s78, s78, 5
s_add_u32 s78, s78, 69214208
v_mov_b32 v28, 1
v_mov_b32 v29, 0
s_mov_b64 exec, 1
buffer_atomic_add v28, v29, s[44:47], s78 offen sc1
s_mov_b64 exec, -1
ds_read_b64_tr_b16 v[246:247], v18 offset:7808
s_waitcnt lgkmcnt(4)
v_mfma_f32_16x16x32_bf16 v[128:131], v[228:231], a[80:83], v[128:131]
ds_read_b64_tr_b16 v[208:209], v18 offset:10240
v_mfma_f32_16x16x32_bf16 v[132:135], v[228:231], a[84:87], v[132:135]
ds_read_b64_tr_b16 v[210:211], v18 offset:12800
buffer_load_dwordx4 a[188:191], v10, s[44:47], s79 offen offset:1024 sc1
v_mfma_f32_16x16x32_bf16 v[144:147], v[232:235], a[80:83], v[144:147]
ds_read_b64_tr_b16 v[212:213], v18 offset:10272
v_mfma_f32_16x16x32_bf16 v[148:151], v[232:235], a[84:87], v[148:151]
ds_read_b64_tr_b16 v[214:215], v18 offset:12832
v_mfma_f32_16x16x32_bf16 v[160:163], v[236:239], a[80:83], v[160:163]
ds_read_b64_tr_b16 v[216:217], v18 offset:10304
buffer_load_dwordx4 a[192:195], v10, s[44:47], s91 offen offset:2048 sc1
v_mfma_f32_16x16x32_bf16 v[164:167], v[236:239], a[84:87], v[164:167]
ds_read_b64_tr_b16 v[218:219], v18 offset:12864
s_waitcnt lgkmcnt(6)
v_mfma_f32_16x16x32_bf16 v[176:179], v[240:243], a[80:83], v[176:179]
ds_read_b64_tr_b16 v[220:221], v18 offset:10336
v_mfma_f32_16x16x32_bf16 v[180:183], v[240:243], a[84:87], v[180:183]
ds_read_b64_tr_b16 v[222:223], v18 offset:12896
s_add_u32 m0, s88, 0
s_nop 0
buffer_load_dwordx4 v11, s[8:11], s89 offen offset:0 lds
v_mfma_f32_16x16x32_bf16 v[192:195], v[244:247], a[80:83], v[192:195]
ds_read_b64_tr_b16 v[224:225], v18 offset:10368
v_mfma_f32_16x16x32_bf16 v[196:199], v[244:247], a[84:87], v[196:199]
ds_read_b64_tr_b16 v[226:227], v18 offset:12928
s_waitcnt lgkmcnt(4)
v_mfma_f32_16x16x32_bf16 v[128:131], v[208:211], a[96:99], v[128:131]
ds_read_b64_tr_b16 v[228:229], v18 offset:15360
v_mfma_f32_16x16x32_bf16 v[132:135], v[208:211], a[100:103], v[132:135]
ds_read_b64_tr_b16 v[230:231], v18 offset:17920
buffer_load_dwordx4 a[196:199], v10, s[44:47], s79 offen offset:2048 sc1
v_mfma_f32_16x16x32_bf16 v[144:147], v[212:215], a[96:99], v[144:147]
ds_read_b64_tr_b16 v[232:233], v18 offset:15392
v_mfma_f32_16x16x32_bf16 v[148:151], v[212:215], a[100:103], v[148:151]
ds_read_b64_tr_b16 v[234:235], v18 offset:17952
v_mfma_f32_16x16x32_bf16 v[160:163], v[216:219], a[96:99], v[160:163]
ds_read_b64_tr_b16 v[236:237], v18 offset:15424
buffer_load_dwordx4 a[200:203], v10, s[44:47], s91 offen offset:3072 sc1
v_mfma_f32_16x16x32_bf16 v[164:167], v[216:219], a[100:103], v[164:167]
ds_read_b64_tr_b16 v[238:239], v18 offset:17984
s_waitcnt lgkmcnt(6)
v_mfma_f32_16x16x32_bf16 v[176:179], v[220:223], a[96:99], v[176:179]
ds_read_b64_tr_b16 v[240:241], v18 offset:15456
v_mfma_f32_16x16x32_bf16 v[180:183], v[220:223], a[100:103], v[180:183]
ds_read_b64_tr_b16 v[242:243], v18 offset:18016
s_add_u32 m0, s88, 0
s_nop 0
buffer_load_dwordx4 v12, s[8:11], s89 offen offset:1024 lds
v_mfma_f32_16x16x32_bf16 v[192:195], v[224:227], a[96:99], v[192:195]
ds_read_b64_tr_b16 v[244:245], v18 offset:15488
v_mfma_f32_16x16x32_bf16 v[196:199], v[224:227], a[100:103], v[196:199]
ds_read_b64_tr_b16 v[246:247], v18 offset:18048
s_waitcnt vmcnt(33)
s_waitcnt lgkmcnt(4)
v_mfma_f32_16x16x32_bf16 v[128:131], v[228:231], a[112:115], v[128:131]
ds_read_b64_tr_b16 v[208:209], v19 offset:0
v_mfma_f32_16x16x32_bf16 v[132:135], v[228:231], a[116:119], v[132:135]
ds_read_b64_tr_b16 v[210:211], v19 offset:2560
buffer_load_dwordx4 a[204:207], v10, s[44:47], s79 offen offset:3072 sc1
v_mfma_f32_16x16x32_bf16 v[144:147], v[232:235], a[112:115], v[144:147]
ds_read_b64_tr_b16 v[212:213], v19 offset:32
v_mfma_f32_16x16x32_bf16 v[148:151], v[232:235], a[116:119], v[148:151]
ds_read_b64_tr_b16 v[214:215], v19 offset:2592
v_mfma_f32_16x16x32_bf16 v[160:163], v[236:239], a[112:115], v[160:163]
ds_read_b64_tr_b16 v[216:217], v19 offset:64
s_add_u32 m0, s88, 0
s_nop 0
buffer_load_dwordx4 v13, s[8:11], s89 offen offset:2048 lds
v_mfma_f32_16x16x32_bf16 v[164:167], v[236:239], a[116:119], v[164:167]
ds_read_b64_tr_b16 v[218:219], v19 offset:2624
s_waitcnt lgkmcnt(6)
v_mfma_f32_16x16x32_bf16 v[176:179], v[240:243], a[112:115], v[176:179]
ds_read_b64_tr_b16 v[220:221], v19 offset:96
v_mfma_f32_16x16x32_bf16 v[180:183], v[240:243], a[116:119], v[180:183]
ds_read_b64_tr_b16 v[222:223], v19 offset:2656
v_mfma_f32_16x16x32_bf16 v[192:195], v[244:247], a[112:115], v[192:195]
ds_read_b64_tr_b16 v[224:225], v19 offset:128
v_mfma_f32_16x16x32_bf16 v[196:199], v[244:247], a[116:119], v[196:199]
ds_read_b64_tr_b16 v[226:227], v19 offset:2688
s_waitcnt vmcnt(21)
s_waitcnt lgkmcnt(4)
v_mfma_f32_16x16x32_bf16 v[128:131], v[208:211], a[144:147], v[128:131]
ds_read_b64_tr_b16 v[228:229], v19 offset:5120
v_mfma_f32_16x16x32_bf16 v[132:135], v[208:211], a[148:151], v[132:135]
ds_read_b64_tr_b16 v[230:231], v19 offset:7680
s_add_u32 s91, s68, 5
s_and_b32 s91, s91, 7
s_lshl_b32 s91, s91, 12
s_add_u32 s79, s91, s75
s_add_u32 s91, s91, s74
buffer_load_dwordx4 a[0:3], v10, s[44:47], s91 offen offset:0 sc1
v_mfma_f32_16x16x32_bf16 v[144:147], v[212:215], a[144:147], v[144:147]
ds_read_b64_tr_b16 v[232:233], v19 offset:5152
v_mfma_f32_16x16x32_bf16 v[148:151], v[212:215], a[148:151], v[148:151]
ds_read_b64_tr_b16 v[234:235], v19 offset:7712
v_mfma_f32_16x16x32_bf16 v[160:163], v[216:219], a[144:147], v[160:163]
ds_read_b64_tr_b16 v[236:237], v19 offset:5184
buffer_load_dwordx4 a[4:7], v10, s[44:47], s79 offen offset:0 sc1
v_mfma_f32_16x16x32_bf16 v[164:167], v[216:219], a[148:151], v[164:167]
ds_read_b64_tr_b16 v[238:239], v19 offset:7744
s_waitcnt lgkmcnt(6)
v_mfma_f32_16x16x32_bf16 v[176:179], v[220:223], a[144:147], v[176:179]
ds_read_b64_tr_b16 v[240:241], v19 offset:5216
v_mfma_f32_16x16x32_bf16 v[180:183], v[220:223], a[148:151], v[180:183]
ds_read_b64_tr_b16 v[242:243], v19 offset:7776
buffer_load_dwordx4 a[16:19], v10, s[44:47], s91 offen offset:1024 sc1
v_mfma_f32_16x16x32_bf16 v[192:195], v[224:227], a[144:147], v[192:195]
ds_read_b64_tr_b16 v[244:245], v19 offset:5248
v_mfma_f32_16x16x32_bf16 v[196:199], v[224:227], a[148:151], v[196:199]
ds_read_b64_tr_b16 v[246:247], v19 offset:7808
s_waitcnt vmcnt(22)
s_waitcnt lgkmcnt(4)
v_mfma_f32_16x16x32_bf16 v[128:131], v[228:231], a[152:155], v[128:131]
ds_read_b64_tr_b16 v[208:209], v19 offset:10240
v_mfma_f32_16x16x32_bf16 v[132:135], v[228:231], a[156:159], v[132:135]
ds_read_b64_tr_b16 v[210:211], v19 offset:12800
buffer_load_dwordx4 a[20:23], v10, s[44:47], s79 offen offset:1024 sc1
v_mfma_f32_16x16x32_bf16 v[144:147], v[232:235], a[152:155], v[144:147]
ds_read_b64_tr_b16 v[212:213], v19 offset:10272
v_mfma_f32_16x16x32_bf16 v[148:151], v[232:235], a[156:159], v[148:151]
ds_read_b64_tr_b16 v[214:215], v19 offset:12832
v_mfma_f32_16x16x32_bf16 v[160:163], v[236:239], a[152:155], v[160:163]
ds_read_b64_tr_b16 v[216:217], v19 offset:10304
buffer_load_dwordx4 a[32:35], v10, s[44:47], s91 offen offset:2048 sc1
v_mfma_f32_16x16x32_bf16 v[164:167], v[236:239], a[156:159], v[164:167]
ds_read_b64_tr_b16 v[218:219], v19 offset:12864
s_waitcnt lgkmcnt(6)
v_mfma_f32_16x16x32_bf16 v[176:179], v[240:243], a[152:155], v[176:179]
ds_read_b64_tr_b16 v[220:221], v19 offset:10336
v_mfma_f32_16x16x32_bf16 v[180:183], v[240:243], a[156:159], v[180:183]
ds_read_b64_tr_b16 v[222:223], v19 offset:12896
s_add_u32 m0, s88, 0
s_nop 0
buffer_load_dwordx4 v14, s[8:11], s89 offen offset:3072 lds
v_mfma_f32_16x16x32_bf16 v[192:195], v[244:247], a[152:155], v[192:195]
ds_read_b64_tr_b16 v[224:225], v19 offset:10368
v_mfma_f32_16x16x32_bf16 v[196:199], v[244:247], a[156:159], v[196:199]
ds_read_b64_tr_b16 v[226:227], v19 offset:12928
s_waitcnt vmcnt(22)
s_waitcnt lgkmcnt(4)
v_mfma_f32_16x16x32_bf16 v[128:131], v[208:211], a[160:163], v[128:131]
ds_read_b64_tr_b16 v[228:229], v19 offset:15360
v_mfma_f32_16x16x32_bf16 v[132:135], v[208:211], a[164:167], v[132:135]
ds_read_b64_tr_b16 v[230:231], v19 offset:17920
buffer_load_dwordx4 a[36:39], v10, s[44:47], s79 offen offset:2048 sc1
v_mfma_f32_16x16x32_bf16 v[144:147], v[212:215], a[160:163], v[144:147]
ds_read_b64_tr_b16 v[232:233], v19 offset:15392
v_mfma_f32_16x16x32_bf16 v[148:151], v[212:215], a[164:167], v[148:151]
ds_read_b64_tr_b16 v[234:235], v19 offset:17952
v_mfma_f32_16x16x32_bf16 v[160:163], v[216:219], a[160:163], v[160:163]
ds_read_b64_tr_b16 v[236:237], v19 offset:15424
buffer_load_dwordx4 a[48:51], v10, s[44:47], s91 offen offset:3072 sc1
v_mfma_f32_16x16x32_bf16 v[164:167], v[216:219], a[164:167], v[164:167]
ds_read_b64_tr_b16 v[238:239], v19 offset:17984
s_waitcnt lgkmcnt(6)
v_mfma_f32_16x16x32_bf16 v[176:179], v[220:223], a[160:163], v[176:179]
ds_read_b64_tr_b16 v[240:241], v19 offset:15456
v_mfma_f32_16x16x32_bf16 v[180:183], v[220:223], a[164:167], v[180:183]
ds_read_b64_tr_b16 v[242:243], v19 offset:18016
s_add_u32 m0, s88, 4096
s_nop 0
buffer_load_dwordx4 v8, s[8:11], s89 offen offset:0 lds
v_mfma_f32_16x16x32_bf16 v[192:195], v[224:227], a[160:163], v[192:195]
ds_read_b64_tr_b16 v[244:245], v19 offset:15488
v_mfma_f32_16x16x32_bf16 v[196:199], v[224:227], a[164:167], v[196:199]
ds_read_b64_tr_b16 v[246:247], v19 offset:18048
s_waitcnt vmcnt(22)
s_waitcnt lgkmcnt(4)
v_mfma_f32_16x16x32_bf16 v[128:131], v[228:231], a[168:171], v[128:131]
s_waitcnt vmcnt(0)
s_barrier
ds_read_b64_tr_b16 v[208:209], v20 offset:0
v_mfma_f32_16x16x32_bf16 v[132:135], v[228:231], a[172:175], v[132:135]
ds_read_b64_tr_b16 v[210:211], v20 offset:2560
buffer_load_dwordx4 a[52:55], v10, s[44:47], s79 offen offset:3072 sc1
v_mfma_f32_16x16x32_bf16 v[144:147], v[232:235], a[168:171], v[144:147]
ds_read_b64_tr_b16 v[212:213], v20 offset:32
v_mfma_f32_16x16x32_bf16 v[148:151], v[232:235], a[172:175], v[148:151]
ds_read_b64_tr_b16 v[214:215], v20 offset:2592
v_mfma_f32_16x16x32_bf16 v[160:163], v[236:239], a[168:171], v[160:163]
ds_read_b64_tr_b16 v[216:217], v20 offset:64
v_mfma_f32_16x16x32_bf16 v[164:167], v[236:239], a[172:175], v[164:167]
ds_read_b64_tr_b16 v[218:219], v20 offset:2624
s_waitcnt lgkmcnt(6)
v_mfma_f32_16x16x32_bf16 v[176:179], v[240:243], a[168:171], v[176:179]
ds_read_b64_tr_b16 v[220:221], v20 offset:96
v_mfma_f32_16x16x32_bf16 v[180:183], v[240:243], a[172:175], v[180:183]
ds_read_b64_tr_b16 v[222:223], v20 offset:2656
v_mfma_f32_16x16x32_bf16 v[192:195], v[244:247], a[168:171], v[192:195]
ds_read_b64_tr_b16 v[224:225], v20 offset:128
v_mfma_f32_16x16x32_bf16 v[196:199], v[244:247], a[172:175], v[196:199]
ds_read_b64_tr_b16 v[226:227], v20 offset:2688
s_waitcnt lgkmcnt(4)
v_mfma_f32_16x16x32_bf16 v[128:131], v[208:211], a[176:179], v[128:131]
ds_read_b64_tr_b16 v[228:229], v20 offset:5120
v_mfma_f32_16x16x32_bf16 v[132:135], v[208:211], a[180:183], v[132:135]
ds_read_b64_tr_b16 v[230:231], v20 offset:7680
s_add_u32 s91, s68, 6
s_and_b32 s91, s91, 7
s_lshl_b32 s91, s91, 12
s_add_u32 s79, s91, s75
s_add_u32 s91, s91, s74
buffer_load_dwordx4 a[64:67], v10, s[44:47], s91 offen offset:0 sc1
v_mfma_f32_16x16x32_bf16 v[144:147], v[212:215], a[176:179], v[144:147]
ds_read_b64_tr_b16 v[232:233], v20 offset:5152
v_mfma_f32_16x16x32_bf16 v[148:151], v[212:215], a[180:183], v[148:151]
ds_read_b64_tr_b16 v[234:235], v20 offset:7712
v_mfma_f32_16x16x32_bf16 v[160:163], v[216:219], a[176:179], v[160:163]
ds_read_b64_tr_b16 v[236:237], v20 offset:5184
buffer_load_dwordx4 a[68:71], v10, s[44:47], s79 offen offset:0 sc1
v_mfma_f32_16x16x32_bf16 v[164:167], v[216:219], a[180:183], v[164:167]
ds_read_b64_tr_b16 v[238:239], v20 offset:7744
s_waitcnt lgkmcnt(6)
v_mfma_f32_16x16x32_bf16 v[176:179], v[220:223], a[176:179], v[176:179]
ds_read_b64_tr_b16 v[240:241], v20 offset:5216
v_mfma_f32_16x16x32_bf16 v[180:183], v[220:223], a[180:183], v[180:183]
ds_read_b64_tr_b16 v[242:243], v20 offset:7776
buffer_load_dwordx4 a[80:83], v10, s[44:47], s91 offen offset:1024 sc1
v_mfma_f32_16x16x32_bf16 v[192:195], v[224:227], a[176:179], v[192:195]
ds_read_b64_tr_b16 v[244:245], v20 offset:5248
v_mfma_f32_16x16x32_bf16 v[196:199], v[224:227], a[180:183], v[196:199]
ds_read_b64_tr_b16 v[246:247], v20 offset:7808
s_waitcnt lgkmcnt(4)
v_mfma_f32_16x16x32_bf16 v[128:131], v[228:231], a[184:187], v[128:131]
ds_read_b64_tr_b16 v[208:209], v20 offset:10240
v_mfma_f32_16x16x32_bf16 v[132:135], v[228:231], a[188:191], v[132:135]
ds_read_b64_tr_b16 v[210:211], v20 offset:12800
buffer_load_dwordx4 a[84:87], v10, s[44:47], s79 offen offset:1024 sc1
v_mfma_f32_16x16x32_bf16 v[144:147], v[232:235], a[184:187], v[144:147]
ds_read_b64_tr_b16 v[212:213], v20 offset:10272
v_mfma_f32_16x16x32_bf16 v[148:151], v[232:235], a[188:191], v[148:151]
ds_read_b64_tr_b16 v[214:215], v20 offset:12832
v_mfma_f32_16x16x32_bf16 v[160:163], v[236:239], a[184:187], v[160:163]
ds_read_b64_tr_b16 v[216:217], v20 offset:10304
buffer_load_dwordx4 a[96:99], v10, s[44:47], s91 offen offset:2048 sc1
v_mfma_f32_16x16x32_bf16 v[164:167], v[236:239], a[188:191], v[164:167]
ds_read_b64_tr_b16 v[218:219], v20 offset:12864
s_waitcnt lgkmcnt(6)
v_mfma_f32_16x16x32_bf16 v[176:179], v[240:243], a[184:187], v[176:179]
ds_read_b64_tr_b16 v[220:221], v20 offset:10336
v_mfma_f32_16x16x32_bf16 v[180:183], v[240:243], a[188:191], v[180:183]
ds_read_b64_tr_b16 v[222:223], v20 offset:12896
v_mfma_f32_16x16x32_bf16 v[192:195], v[244:247], a[184:187], v[192:195]
ds_read_b64_tr_b16 v[224:225], v20 offset:10368
v_mfma_f32_16x16x32_bf16 v[196:199], v[244:247], a[188:191], v[196:199]
ds_read_b64_tr_b16 v[226:227], v20 offset:12928
s_waitcnt lgkmcnt(4)
v_mfma_f32_16x16x32_bf16 v[128:131], v[208:211], a[192:195], v[128:131]
ds_read_b64_tr_b16 v[228:229], v20 offset:15360
v_mfma_f32_16x16x32_bf16 v[132:135], v[208:211], a[196:199], v[132:135]
ds_read_b64_tr_b16 v[230:231], v20 offset:17920
buffer_load_dwordx4 a[100:103], v10, s[44:47], s79 offen offset:2048 sc1
v_mfma_f32_16x16x32_bf16 v[144:147], v[212:215], a[192:195], v[144:147]
ds_read_b64_tr_b16 v[232:233], v20 offset:15392
v_mfma_f32_16x16x32_bf16 v[148:151], v[212:215], a[196:199], v[148:151]
ds_read_b64_tr_b16 v[234:235], v20 offset:17952
v_mfma_f32_16x16x32_bf16 v[160:163], v[216:219], a[192:195], v[160:163]
ds_read_b64_tr_b16 v[236:237], v20 offset:15424
buffer_load_dwordx4 a[112:115], v10, s[44:47], s91 offen offset:3072 sc1
v_mfma_f32_16x16x32_bf16 v[164:167], v[216:219], a[196:199], v[164:167]
ds_read_b64_tr_b16 v[238:239], v20 offset:17984
s_waitcnt lgkmcnt(6)
v_mfma_f32_16x16x32_bf16 v[176:179], v[220:223], a[192:195], v[176:179]
ds_read_b64_tr_b16 v[240:241], v20 offset:15456
v_mfma_f32_16x16x32_bf16 v[180:183], v[220:223], a[196:199], v[180:183]
ds_read_b64_tr_b16 v[242:243], v20 offset:18016
v_mfma_f32_16x16x32_bf16 v[192:195], v[224:227], a[192:195], v[192:195]
ds_read_b64_tr_b16 v[244:245], v20 offset:15488
v_mfma_f32_16x16x32_bf16 v[196:199], v[224:227], a[196:199], v[196:199]
ds_read_b64_tr_b16 v[246:247], v20 offset:18048
s_waitcnt lgkmcnt(4)
v_mfma_f32_16x16x32_bf16 v[128:131], v[228:231], a[200:203], v[128:131]
ds_read_b64_tr_b16 v[208:209], v21 offset:0
v_mfma_f32_16x16x32_bf16 v[132:135], v[228:231], a[204:207], v[132:135]
ds_read_b64_tr_b16 v[210:211], v21 offset:2560
buffer_load_dwordx4 a[116:119], v10, s[44:47], s79 offen offset:3072 sc1
v_mfma_f32_16x16x32_bf16 v[144:147], v[232:235], a[200:203], v[144:147]
ds_read_b64_tr_b16 v[212:213], v21 offset:32
v_mfma_f32_16x16x32_bf16 v[148:151], v[232:235], a[204:207], v[148:151]
ds_read_b64_tr_b16 v[214:215], v21 offset:2592
v_mfma_f32_16x16x32_bf16 v[160:163], v[236:239], a[200:203], v[160:163]
ds_read_b64_tr_b16 v[216:217], v21 offset:64
v_mfma_f32_16x16x32_bf16 v[164:167], v[236:239], a[204:207], v[164:167]
ds_read_b64_tr_b16 v[218:219], v21 offset:2624
s_waitcnt lgkmcnt(6)
v_mfma_f32_16x16x32_bf16 v[176:179], v[240:243], a[200:203], v[176:179]
ds_read_b64_tr_b16 v[220:221], v21 offset:96
v_mfma_f32_16x16x32_bf16 v[180:183], v[240:243], a[204:207], v[180:183]
ds_read_b64_tr_b16 v[222:223], v21 offset:2656
v_mfma_f32_16x16x32_bf16 v[192:195], v[244:247], a[200:203], v[192:195]
ds_read_b64_tr_b16 v[224:225], v21 offset:128
v_mfma_f32_16x16x32_bf16 v[196:199], v[244:247], a[204:207], v[196:199]
ds_read_b64_tr_b16 v[226:227], v21 offset:2688
s_waitcnt lgkmcnt(4)
v_mfma_f32_16x16x32_bf16 v[128:131], v[208:211], a[0:3], v[128:131]
ds_read_b64_tr_b16 v[228:229], v21 offset:5120
v_mfma_f32_16x16x32_bf16 v[132:135], v[208:211], a[4:7], v[132:135]
ds_read_b64_tr_b16 v[230:231], v21 offset:7680
s_add_u32 s91, s68, 7
s_and_b32 s91, s91, 7
s_lshl_b32 s91, s91, 12
s_add_u32 s79, s91, s75
s_add_u32 s91, s91, s74
buffer_load_dwordx4 a[144:147], v10, s[44:47], s91 offen offset:0 sc1
v_mfma_f32_16x16x32_bf16 v[144:147], v[212:215], a[0:3], v[144:147]
ds_read_b64_tr_b16 v[232:233], v21 offset:5152
v_mfma_f32_16x16x32_bf16 v[148:151], v[212:215], a[4:7], v[148:151]
ds_read_b64_tr_b16 v[234:235], v21 offset:7712
v_mfma_f32_16x16x32_bf16 v[160:163], v[216:219], a[0:3], v[160:163]
ds_read_b64_tr_b16 v[236:237], v21 offset:5184
buffer_load_dwordx4 a[148:151], v10, s[44:47], s79 offen offset:0 sc1
v_mfma_f32_16x16x32_bf16 v[164:167], v[216:219], a[4:7], v[164:167]
ds_read_b64_tr_b16 v[238:239], v21 offset:7744
s_waitcnt lgkmcnt(6)
v_mfma_f32_16x16x32_bf16 v[176:179], v[220:223], a[0:3], v[176:179]
ds_read_b64_tr_b16 v[240:241], v21 offset:5216
v_mfma_f32_16x16x32_bf16 v[180:183], v[220:223], a[4:7], v[180:183]
ds_read_b64_tr_b16 v[242:243], v21 offset:7776
buffer_load_dwordx4 a[152:155], v10, s[44:47], s91 offen offset:1024 sc1
v_mfma_f32_16x16x32_bf16 v[192:195], v[224:227], a[0:3], v[192:195]
ds_read_b64_tr_b16 v[244:245], v21 offset:5248
v_mfma_f32_16x16x32_bf16 v[196:199], v[224:227], a[4:7], v[196:199]
ds_read_b64_tr_b16 v[246:247], v21 offset:7808
s_waitcnt lgkmcnt(4)
v_mfma_f32_16x16x32_bf16 v[128:131], v[228:231], a[16:19], v[128:131]
ds_read_b64_tr_b16 v[208:209], v21 offset:10240
v_mfma_f32_16x16x32_bf16 v[132:135], v[228:231], a[20:23], v[132:135]
ds_read_b64_tr_b16 v[210:211], v21 offset:12800
buffer_load_dwordx4 a[156:159], v10, s[44:47], s79 offen offset:1024 sc1
v_mfma_f32_16x16x32_bf16 v[144:147], v[232:235], a[16:19], v[144:147]
ds_read_b64_tr_b16 v[212:213], v21 offset:10272
v_mfma_f32_16x16x32_bf16 v[148:151], v[232:235], a[20:23], v[148:151]
ds_read_b64_tr_b16 v[214:215], v21 offset:12832
v_mfma_f32_16x16x32_bf16 v[160:163], v[236:239], a[16:19], v[160:163]
ds_read_b64_tr_b16 v[216:217], v21 offset:10304
buffer_load_dwordx4 a[160:163], v10, s[44:47], s91 offen offset:2048 sc1
v_mfma_f32_16x16x32_bf16 v[164:167], v[236:239], a[20:23], v[164:167]
ds_read_b64_tr_b16 v[218:219], v21 offset:12864
s_waitcnt lgkmcnt(6)
v_mfma_f32_16x16x32_bf16 v[176:179], v[240:243], a[16:19], v[176:179]
ds_read_b64_tr_b16 v[220:221], v21 offset:10336
v_mfma_f32_16x16x32_bf16 v[180:183], v[240:243], a[20:23], v[180:183]
ds_read_b64_tr_b16 v[222:223], v21 offset:12896
v_mfma_f32_16x16x32_bf16 v[192:195], v[244:247], a[16:19], v[192:195]
ds_read_b64_tr_b16 v[224:225], v21 offset:10368
v_mfma_f32_16x16x32_bf16 v[196:199], v[244:247], a[20:23], v[196:199]
ds_read_b64_tr_b16 v[226:227], v21 offset:12928
s_waitcnt lgkmcnt(4)
v_mfma_f32_16x16x32_bf16 v[128:131], v[208:211], a[32:35], v[128:131]
ds_read_b64_tr_b16 v[228:229], v21 offset:15360
v_mfma_f32_16x16x32_bf16 v[132:135], v[208:211], a[36:39], v[132:135]
ds_read_b64_tr_b16 v[230:231], v21 offset:17920
buffer_load_dwordx4 a[164:167], v10, s[44:47], s79 offen offset:2048 sc1
v_mfma_f32_16x16x32_bf16 v[144:147], v[212:215], a[32:35], v[144:147]
ds_read_b64_tr_b16 v[232:233], v21 offset:15392
v_mfma_f32_16x16x32_bf16 v[148:151], v[212:215], a[36:39], v[148:151]
ds_read_b64_tr_b16 v[234:235], v21 offset:17952
v_mfma_f32_16x16x32_bf16 v[160:163], v[216:219], a[32:35], v[160:163]
ds_read_b64_tr_b16 v[236:237], v21 offset:15424
buffer_load_dword v29, v30, s[44:47], s78 offen sc1
v_mfma_f32_16x16x32_bf16 v[164:167], v[216:219], a[36:39], v[164:167]
ds_read_b64_tr_b16 v[238:239], v21 offset:17984
s_waitcnt lgkmcnt(6)
v_mfma_f32_16x16x32_bf16 v[176:179], v[220:223], a[32:35], v[176:179]
ds_read_b64_tr_b16 v[240:241], v21 offset:15456
v_mfma_f32_16x16x32_bf16 v[180:183], v[220:223], a[36:39], v[180:183]
ds_read_b64_tr_b16 v[242:243], v21 offset:18016
buffer_load_dwordx4 a[168:171], v10, s[44:47], s91 offen offset:3072 sc1
v_mfma_f32_16x16x32_bf16 v[192:195], v[224:227], a[32:35], v[192:195]
ds_read_b64_tr_b16 v[244:245], v21 offset:15488
v_mfma_f32_16x16x32_bf16 v[196:199], v[224:227], a[36:39], v[196:199]
ds_read_b64_tr_b16 v[246:247], v21 offset:18048
s_waitcnt vmcnt(16)
s_waitcnt lgkmcnt(4)
v_mfma_f32_16x16x32_bf16 v[128:131], v[228:231], a[48:51], v[128:131]
ds_read_b64_tr_b16 v[208:209], v22 offset:0
v_mfma_f32_16x16x32_bf16 v[132:135], v[228:231], a[52:55], v[132:135]
ds_read_b64_tr_b16 v[210:211], v22 offset:2560
buffer_load_dwordx4 a[172:175], v10, s[44:47], s79 offen offset:3072 sc1
v_mfma_f32_16x16x32_bf16 v[144:147], v[232:235], a[48:51], v[144:147]
ds_read_b64_tr_b16 v[212:213], v22 offset:32
v_mfma_f32_16x16x32_bf16 v[148:151], v[232:235], a[52:55], v[148:151]
ds_read_b64_tr_b16 v[214:215], v22 offset:2592
v_mfma_f32_16x16x32_bf16 v[160:163], v[236:239], a[48:51], v[160:163]
ds_read_b64_tr_b16 v[216:217], v22 offset:64
v_mfma_f32_16x16x32_bf16 v[164:167], v[236:239], a[52:55], v[164:167]
ds_read_b64_tr_b16 v[218:219], v22 offset:2624
s_waitcnt lgkmcnt(6)
v_mfma_f32_16x16x32_bf16 v[176:179], v[240:243], a[48:51], v[176:179]
ds_read_b64_tr_b16 v[220:221], v22 offset:96
v_mfma_f32_16x16x32_bf16 v[180:183], v[240:243], a[52:55], v[180:183]
ds_read_b64_tr_b16 v[222:223], v22 offset:2656
v_mfma_f32_16x16x32_bf16 v[192:195], v[244:247], a[48:51], v[192:195]
ds_read_b64_tr_b16 v[224:225], v22 offset:128
v_mfma_f32_16x16x32_bf16 v[196:199], v[244:247], a[52:55], v[196:199]
ds_read_b64_tr_b16 v[226:227], v22 offset:2688
s_waitcnt vmcnt(15)
s_waitcnt lgkmcnt(4)
v_mfma_f32_16x16x32_bf16 v[128:131], v[208:211], a[64:67], v[128:131]
ds_read_b64_tr_b16 v[228:229], v22 offset:5120
v_mfma_f32_16x16x32_bf16 v[132:135], v[208:211], a[68:71], v[132:135]
ds_read_b64_tr_b16 v[230:231], v22 offset:7680
v_mfma_f32_16x16x32_bf16 v[144:147], v[212:215], a[64:67], v[144:147]
ds_read_b64_tr_b16 v[232:233], v22 offset:5152
v_mfma_f32_16x16x32_bf16 v[148:151], v[212:215], a[68:71], v[148:151]
ds_read_b64_tr_b16 v[234:235], v22 offset:7712
v_mfma_f32_16x16x32_bf16 v[160:163], v[216:219], a[64:67], v[160:163]
ds_read_b64_tr_b16 v[236:237], v22 offset:5184
v_mfma_f32_16x16x32_bf16 v[164:167], v[216:219], a[68:71], v[164:167]
ds_read_b64_tr_b16 v[238:239], v22 offset:7744
s_waitcnt lgkmcnt(6)
v_mfma_f32_16x16x32_bf16 v[176:179], v[220:223], a[64:67], v[176:179]
ds_read_b64_tr_b16 v[240:241], v22 offset:5216
v_mfma_f32_16x16x32_bf16 v[180:183], v[220:223], a[68:71], v[180:183]
ds_read_b64_tr_b16 v[242:243], v22 offset:7776
v_mfma_f32_16x16x32_bf16 v[192:195], v[224:227], a[64:67], v[192:195]
ds_read_b64_tr_b16 v[244:245], v22 offset:5248
v_mfma_f32_16x16x32_bf16 v[196:199], v[224:227], a[68:71], v[196:199]
ds_read_b64_tr_b16 v[246:247], v22 offset:7808
s_waitcnt vmcnt(13)
s_waitcnt lgkmcnt(4)
v_mfma_f32_16x16x32_bf16 v[128:131], v[228:231], a[80:83], v[128:131]
ds_read_b64_tr_b16 v[208:209], v22 offset:10240
v_mfma_f32_16x16x32_bf16 v[132:135], v[228:231], a[84:87], v[132:135]
ds_read_b64_tr_b16 v[210:211], v22 offset:12800
v_mfma_f32_16x16x32_bf16 v[144:147], v[232:235], a[80:83], v[144:147]
ds_read_b64_tr_b16 v[212:213], v22 offset:10272
v_mfma_f32_16x16x32_bf16 v[148:151], v[232:235], a[84:87], v[148:151]
ds_read_b64_tr_b16 v[214:215], v22 offset:12832
v_mfma_f32_16x16x32_bf16 v[160:163], v[236:239], a[80:83], v[160:163]
ds_read_b64_tr_b16 v[216:217], v22 offset:10304
v_mfma_f32_16x16x32_bf16 v[164:167], v[236:239], a[84:87], v[164:167]
ds_read_b64_tr_b16 v[218:219], v22 offset:12864
s_waitcnt lgkmcnt(6)
v_mfma_f32_16x16x32_bf16 v[176:179], v[240:243], a[80:83], v[176:179]
ds_read_b64_tr_b16 v[220:221], v22 offset:10336
v_mfma_f32_16x16x32_bf16 v[180:183], v[240:243], a[84:87], v[180:183]
ds_read_b64_tr_b16 v[222:223], v22 offset:12896
v_mfma_f32_16x16x32_bf16 v[192:195], v[244:247], a[80:83], v[192:195]
ds_read_b64_tr_b16 v[224:225], v22 offset:10368
v_mfma_f32_16x16x32_bf16 v[196:199], v[244:247], a[84:87], v[196:199]
ds_read_b64_tr_b16 v[226:227], v22 offset:12928
s_waitcnt vmcnt(11)
s_waitcnt lgkmcnt(4)
s_waitcnt vmcnt(2)
v_readfirstlane_b32 s71, v29
s_nop 0
s_cmp_ge_u32 s71, 8
s_cbranch_scc1 L_pk_19
v_mov_b32 v29, 0
s_mov_b32 s72, 0
L_spin_20:
buffer_load_dword v28, v29, s[44:47], s78 offen sc1
s_waitcnt vmcnt(0)
v_readfirstlane_b32 s71, v28
s_add_u32 s72, s72, 1
s_cmp_ge_u32 s71, 8
s_cbranch_scc1 L_spine_21
s_sleep 2
s_cmp_lt_u32 s72, 262144
s_cbranch_scc1 L_spin_20
L_spine_21:
L_pk_19:
v_mfma_f32_16x16x32_bf16 v[128:131], v[208:211], a[96:99], v[128:131]
ds_read_b64_tr_b16 v[228:229], v22 offset:15360
v_mfma_f32_16x16x32_bf16 v[132:135], v[208:211], a[100:103], v[132:135]
ds_read_b64_tr_b16 v[230:231], v22 offset:17920
s_add_u32 s91, s68, 1
s_and_b32 s91, s91, 7
s_lshl_b32 s91, s91, 12
s_add_u32 s79, s91, s77
s_add_u32 s91, s91, s76
buffer_load_dwordx4 a[176:179], v10, s[44:47], s91 offen offset:0 sc1
v_mfma_f32_16x16x32_bf16 v[144:147], v[212:215], a[96:99], v[144:147]
ds_read_b64_tr_b16 v[232:233], v22 offset:15392
v_mfma_f32_16x16x32_bf16 v[148:151], v[212:215], a[100:103], v[148:151]
ds_read_b64_tr_b16 v[234:235], v22 offset:17952
v_mfma_f32_16x16x32_bf16 v[160:163], v[216:219], a[96:99], v[160:163]
ds_read_b64_tr_b16 v[236:237], v22 offset:15424
buffer_load_dwordx4 a[180:183], v10, s[44:47], s79 offen offset:0 sc1
v_mfma_f32_16x16x32_bf16 v[164:167], v[216:219], a[100:103], v[164:167]
ds_read_b64_tr_b16 v[238:239], v22 offset:17984
s_waitcnt lgkmcnt(6)
v_mfma_f32_16x16x32_bf16 v[176:179], v[220:223], a[96:99], v[176:179]
ds_read_b64_tr_b16 v[240:241], v22 offset:15456
v_mfma_f32_16x16x32_bf16 v[180:183], v[220:223], a[100:103], v[180:183]
ds_read_b64_tr_b16 v[242:243], v22 offset:18016
buffer_load_dwordx4 a[184:187], v10, s[44:47], s91 offen offset:1024 sc1
v_mfma_f32_16x16x32_bf16 v[192:195], v[224:227], a[96:99], v[192:195]
ds_read_b64_tr_b16 v[244:245], v22 offset:15488
v_mfma_f32_16x16x32_bf16 v[196:199], v[224:227], a[100:103], v[196:199]
ds_read_b64_tr_b16 v[246:247], v22 offset:18048
s_waitcnt lgkmcnt(4)
v_mfma_f32_16x16x32_bf16 v[128:131], v[228:231], a[112:115], v[128:131]
ds_read_b64_tr_b16 v[208:209], v23 offset:0
v_mfma_f32_16x16x32_bf16 v[132:135], v[228:231], a[116:119], v[132:135]
ds_read_b64_tr_b16 v[210:211], v23 offset:2560
buffer_load_dwordx4 a[188:191], v10, s[44:47], s79 offen offset:1024 sc1
v_mfma_f32_16x16x32_bf16 v[144:147], v[232:235], a[112:115], v[144:147]
ds_read_b64_tr_b16 v[212:213], v23 offset:32
v_mfma_f32_16x16x32_bf16 v[148:151], v[232:235], a[116:119], v[148:151]
ds_read_b64_tr_b16 v[214:215], v23 offset:2592
v_mfma_f32_16x16x32_bf16 v[160:163], v[236:239], a[112:115], v[160:163]
ds_read_b64_tr_b16 v[216:217], v23 offset:64
buffer_load_dwordx4 a[192:195], v10, s[44:47], s91 offen offset:2048 sc1
v_mfma_f32_16x16x32_bf16 v[164:167], v[236:239], a[116:119], v[164:167]
ds_read_b64_tr_b16 v[218:219], v23 offset:2624
s_waitcnt lgkmcnt(6)
v_mfma_f32_16x16x32_bf16 v[176:179], v[240:243], a[112:115], v[176:179]
ds_read_b64_tr_b16 v[220:221], v23 offset:96
v_mfma_f32_16x16x32_bf16 v[180:183], v[240:243], a[116:119], v[180:183]
ds_read_b64_tr_b16 v[222:223], v23 offset:2656
buffer_load_dwordx4 a[196:199], v10, s[44:47], s79 offen offset:2048 sc1
v_mfma_f32_16x16x32_bf16 v[192:195], v[244:247], a[112:115], v[192:195]
ds_read_b64_tr_b16 v[224:225], v23 offset:128
v_mfma_f32_16x16x32_bf16 v[196:199], v[244:247], a[116:119], v[196:199]
ds_read_b64_tr_b16 v[226:227], v23 offset:2688
s_waitcnt lgkmcnt(4)
v_mfma_f32_16x16x32_bf16 v[128:131], v[208:211], a[144:147], v[128:131]
ds_read_b64_tr_b16 v[228:229], v23 offset:5120
v_mfma_f32_16x16x32_bf16 v[132:135], v[208:211], a[148:151], v[132:135]
ds_read_b64_tr_b16 v[230:231], v23 offset:7680
buffer_load_dwordx4 a[200:203], v10, s[44:47], s91 offen offset:3072 sc1
v_mfma_f32_16x16x32_bf16 v[144:147], v[212:215], a[144:147], v[144:147]
ds_read_b64_tr_b16 v[232:233], v23 offset:5152
v_mfma_f32_16x16x32_bf16 v[148:151], v[212:215], a[148:151], v[148:151]
ds_read_b64_tr_b16 v[234:235], v23 offset:7712
v_mfma_f32_16x16x32_bf16 v[160:163], v[216:219], a[144:147], v[160:163]
ds_read_b64_tr_b16 v[236:237], v23 offset:5184
buffer_load_dwordx4 a[204:207], v10, s[44:47], s79 offen offset:3072 sc1
v_mfma_f32_16x16x32_bf16 v[164:167], v[216:219], a[148:151], v[164:167]
ds_read_b64_tr_b16 v[238:239], v23 offset:7744
s_add_u32 s91, s68, 2
s_and_b32 s91, s91, 7
s_lshl_b32 s91, s91, 12
s_add_u32 s79, s91, s77
s_add_u32 s91, s91, s76
s_waitcnt lgkmcnt(6)
v_mfma_f32_16x16x32_bf16 v[176:179], v[220:223], a[144:147], v[176:179]
ds_read_b64_tr_b16 v[240:241], v23 offset:5216
v_mfma_f32_16x16x32_bf16 v[180:183], v[220:223], a[148:151], v[180:183]
ds_read_b64_tr_b16 v[242:243], v23 offset:7776
buffer_load_dwordx4 a[208:211], v10, s[44:47], s91 offen offset:0 sc1
v_mfma_f32_16x16x32_bf16 v[192:195], v[224:227], a[144:147], v[192:195]
ds_read_b64_tr_b16 v[244:245], v23 offset:5248
v_mfma_f32_16x16x32_bf16 v[196:199], v[224:227], a[148:151], v[196:199]
ds_read_b64_tr_b16 v[246:247], v23 offset:7808
s_waitcnt lgkmcnt(4)
v_mfma_f32_16x16x32_bf16 v[128:131], v[228:231], a[152:155], v[128:131]
ds_read_b64_tr_b16 v[208:209], v23 offset:10240
v_mfma_f32_16x16x32_bf16 v[132:135], v[228:231], a[156:159], v[132:135]
ds_read_b64_tr_b16 v[210:211], v23 offset:12800
buffer_load_dwordx4 a[212:215], v10, s[44:47], s79 offen offset:0 sc1
v_mfma_f32_16x16x32_bf16 v[144:147], v[232:235], a[152:155], v[144:147]
ds_read_b64_tr_b16 v[212:213], v23 offset:10272
v_mfma_f32_16x16x32_bf16 v[148:151], v[232:235], a[156:159], v[148:151]
ds_read_b64_tr_b16 v[214:215], v23 offset:12832
v_mfma_f32_16x16x32_bf16 v[160:163], v[236:239], a[152:155], v[160:163]
ds_read_b64_tr_b16 v[216:217], v23 offset:10304
buffer_load_dwordx4 a[216:219], v10, s[44:47], s91 offen offset:1024 sc1
v_mfma_f32_16x16x32_bf16 v[164:167], v[236:239], a[156:159], v[164:167]
ds_read_b64_tr_b16 v[218:219], v23 offset:12864
s_waitcnt lgkmcnt(6)
v_mfma_f32_16x16x32_bf16 v[176:179], v[240:243], a[152:155], v[176:179]
ds_read_b64_tr_b16 v[220:221], v23 offset:10336
v_mfma_f32_16x16x32_bf16 v[180:183], v[240:243], a[156:159], v[180:183]
ds_read_b64_tr_b16 v[222:223], v23 offset:12896
buffer_load_dwordx4 a[220:223], v10, s[44:47], s79 offen offset:1024 sc1
v_mfma_f32_16x16x32_bf16 v[192:195], v[244:247], a[152:155], v[192:195]
ds_read_b64_tr_b16 v[224:225], v23 offset:10368
v_mfma_f32_16x16x32_bf16 v[196:199], v[244:247], a[156:159], v[196:199]
ds_read_b64_tr_b16 v[226:227], v23 offset:12928
s_waitcnt lgkmcnt(4)
v_mfma_f32_16x16x32_bf16 v[128:131], v[208:211], a[160:163], v[128:131]
ds_read_b64_tr_b16 v[228:229], v23 offset:15360
v_mfma_f32_16x16x32_bf16 v[132:135], v[208:211], a[164:167], v[132:135]
ds_read_b64_tr_b16 v[230:231], v23 offset:17920
buffer_load_dwordx4 a[224:227], v10, s[44:47], s91 offen offset:2048 sc1
v_mfma_f32_16x16x32_bf16 v[144:147], v[212:215], a[160:163], v[144:147]
ds_read_b64_tr_b16 v[232:233], v23 offset:15392
v_mfma_f32_16x16x32_bf16 v[148:151], v[212:215], a[164:167], v[148:151]
ds_read_b64_tr_b16 v[234:235], v23 offset:17952
v_mfma_f32_16x16x32_bf16 v[160:163], v[216:219], a[160:163], v[160:163]
ds_read_b64_tr_b16 v[236:237], v23 offset:15424
buffer_load_dwordx4 a[228:231], v10, s[44:47], s79 offen offset:2048 sc1
v_mfma_f32_16x16x32_bf16 v[164:167], v[216:219], a[164:167], v[164:167]
ds_read_b64_tr_b16 v[238:239], v23 offset:17984
s_waitcnt lgkmcnt(6)
v_mfma_f32_16x16x32_bf16 v[176:179], v[220:223], a[160:163], v[176:179]
ds_read_b64_tr_b16 v[240:241], v23 offset:15456
v_mfma_f32_16x16x32_bf16 v[180:183], v[220:223], a[164:167], v[180:183]
ds_read_b64_tr_b16 v[242:243], v23 offset:18016
v_mfma_f32_16x16x32_bf16 v[192:195], v[224:227], a[160:163], v[192:195]
ds_read_b64_tr_b16 v[244:245], v23 offset:15488
v_mfma_f32_16x16x32_bf16 v[196:199], v[224:227], a[164:167], v[196:199]
ds_read_b64_tr_b16 v[246:247], v23 offset:18048
s_waitcnt vmcnt(14)
s_waitcnt lgkmcnt(4)
v_mfma_f32_16x16x32_bf16 v[128:131], v[228:231], a[168:171], v[128:131]
ds_read_b64_tr_b16 v[208:209], v17 offset:0
v_mfma_f32_16x16x32_bf16 v[132:135], v[228:231], a[172:175], v[132:135]
ds_read_b64_tr_b16 v[210:211], v17 offset:2560
buffer_load_dwordx4 a[232:235], v10, s[44:47], s91 offen offset:3072 sc1
v_mfma_f32_16x16x32_bf16 v[144:147], v[232:235], a[168:171], v[144:147]
ds_read_b64_tr_b16 v[212:213], v17 offset:32
v_mfma_f32_16x16x32_bf16 v[148:151], v[232:235], a[172:175], v[148:151]
ds_read_b64_tr_b16 v[214:215], v17 offset:2592
v_mfma_f32_16x16x32_bf16 v[160:163], v[236:239], a[168:171], v[160:163]
ds_read_b64_tr_b16 v[216:217], v17 offset:64
buffer_load_dwordx4 a[236:239], v10, s[44:47], s79 offen offset:3072 sc1
v_mfma_f32_16x16x32_bf16 v[164:167], v[236:239], a[172:175], v[164:167]
ds_read_b64_tr_b16 v[218:219], v17 offset:2624
s_waitcnt lgkmcnt(6)
v_mfma_f32_16x16x32_bf16 v[176:179], v[240:243], a[168:171], v[176:179]
ds_read_b64_tr_b16 v[220:221], v17 offset:96
v_mfma_f32_16x16x32_bf16 v[180:183], v[240:243], a[172:175], v[180:183]
ds_read_b64_tr_b16 v[222:223], v17 offset:2656
v_mfma_f32_16x16x32_bf16 v[192:195], v[244:247], a[168:171], v[192:195]
ds_read_b64_tr_b16 v[224:225], v17 offset:128
v_mfma_f32_16x16x32_bf16 v[196:199], v[244:247], a[172:175], v[196:199]
ds_read_b64_tr_b16 v[226:227], v17 offset:2688
s_waitcnt vmcnt(14)
s_waitcnt lgkmcnt(4)
v_mfma_f32_16x16x32_bf16 v[136:139], v[208:211], a[176:179], v[136:139]
ds_read_b64_tr_b16 v[228:229], v17 offset:5120
v_mfma_f32_16x16x32_bf16 v[140:143], v[208:211], a[180:183], v[140:143]
ds_read_b64_tr_b16 v[230:231], v17 offset:7680
s_add_u32 s91, s68, 3
s_and_b32 s91, s91, 7
s_lshl_b32 s91, s91, 12
s_add_u32 s79, s91, s77
s_add_u32 s91, s91, s76
buffer_load_dwordx4 a[0:3], v10, s[44:47], s91 offen offset:0 sc1
v_mfma_f32_16x16x32_bf16 v[152:155], v[212:215], a[176:179], v[152:155]
ds_read_b64_tr_b16 v[232:233], v17 offset:5152
v_mfma_f32_16x16x32_bf16 v[156:159], v[212:215], a[180:183], v[156:159]
ds_read_b64_tr_b16 v[234:235], v17 offset:7712
v_mfma_f32_16x16x32_bf16 v[168:171], v[216:219], a[176:179], v[168:171]
ds_read_b64_tr_b16 v[236:237], v17 offset:5184
buffer_load_dwordx4 a[4:7], v10, s[44:47], s79 offen offset:0 sc1
v_mfma_f32_16x16x32_bf16 v[172:175], v[216:219], a[180:183], v[172:175]
ds_read_b64_tr_b16 v[238:239], v17 offset:7744
s_waitcnt lgkmcnt(6)
v_mfma_f32_16x16x32_bf16 v[184:187], v[220:223], a[176:179], v[184:187]
ds_read_b64_tr_b16 v[240:241], v17 offset:5216
v_mfma_f32_16x16x32_bf16 v[188:191], v[220:223], a[180:183], v[188:191]
ds_read_b64_tr_b16 v[242:243], v17 offset:7776
buffer_load_dwordx4 a[16:19], v10, s[44:47], s91 offen offset:1024 sc1
v_mfma_f32_16x16x32_bf16 v[200:203], v[224:227], a[176:179], v[200:203]
ds_read_b64_tr_b16 v[244:245], v17 offset:5248
v_mfma_f32_16x16x32_bf16 v[204:207], v[224:227], a[180:183], v[204:207]
ds_read_b64_tr_b16 v[246:247], v17 offset:7808
s_waitcnt vmcnt(15)
s_waitcnt lgkmcnt(4)
v_mfma_f32_16x16x32_bf16 v[136:139], v[228:231], a[184:187], v[136:139]
ds_read_b64_tr_b16 v[208:209], v17 offset:10240
v_mfma_f32_16x16x32_bf16 v[140:143], v[228:231], a[188:191], v[140:143]
ds_read_b64_tr_b16 v[210:211], v17 offset:12800
buffer_load_dwordx4 a[20:23], v10, s[44:47], s79 offen offset:1024 sc1
v_mfma_f32_16x16x32_bf16 v[152:155], v[232:235], a[184:187], v[152:155]
ds_read_b64_tr_b16 v[212:213], v17 offset:10272
v_cvt_pk_bf16_f32 v128, v128, v129
v_mfma_f32_16x16x32_bf16 v[156:159], v[232:235], a[188:191], v[156:159]
ds_read_b64_tr_b16 v[214:215], v17 offset:12832
v_cvt_pk_bf16_f32 v129, v130, v131
v_mfma_f32_16x16x32_bf16 v[168:171], v[236:239], a[184:187], v[168:171]
ds_read_b64_tr_b16 v[216:217], v17 offset:10304
buffer_load_dwordx4 a[32:35], v10, s[44:47], s91 offen offset:2048 sc1
v_mfma_f32_16x16x32_bf16 v[172:175], v[236:239], a[188:191], v[172:175]
ds_read_b64_tr_b16 v[218:219], v17 offset:12864
v_cvt_pk_bf16_f32 v130, v144, v145
s_waitcnt lgkmcnt(6)
v_mfma_f32_16x16x32_bf16 v[184:187], v[240:243], a[184:187], v[184:187]
ds_read_b64_tr_b16 v[220:221], v17 offset:10336
v_cvt_pk_bf16_f32 v131, v146, v147
v_mfma_f32_16x16x32_bf16 v[188:191], v[240:243], a[188:191], v[188:191]
ds_read_b64_tr_b16 v[222:223], v17 offset:12896
buffer_store_dwordx4 v[128:131], v10, s[44:47], s82 offen offset:0 sc1
v_mfma_f32_16x16x32_bf16 v[200:203], v[244:247], a[184:187], v[200:203]
ds_read_b64_tr_b16 v[224:225], v17 offset:10368
v_mfma_f32_16x16x32_bf16 v[204:207], v[244:247], a[188:191], v[204:207]
ds_read_b64_tr_b16 v[226:227], v17 offset:12928
s_waitcnt vmcnt(16)
s_waitcnt lgkmcnt(4)
v_mfma_f32_16x16x32_bf16 v[136:139], v[208:211], a[192:195], v[136:139]
ds_read_b64_tr_b16 v[228:229], v17 offset:15360
v_mfma_f32_16x16x32_bf16 v[140:143], v[208:211], a[196:199], v[140:143]
ds_read_b64_tr_b16 v[230:231], v17 offset:17920
buffer_load_dwordx4 a[36:39], v10, s[44:47], s79 offen offset:2048 sc1
v_mfma_f32_16x16x32_bf16 v[152:155], v[212:215], a[192:195], v[152:155]
ds_read_b64_tr_b16 v[232:233], v17 offset:15392
v_cvt_pk_bf16_f32 v160, v160, v161
v_mfma_f32_16x16x32_bf16 v[156:159], v[212:215], a[196:199], v[156:159]
ds_read_b64_tr_b16 v[234:235], v17 offset:17952
v_cvt_pk_bf16_f32 v161, v162, v163
v_mfma_f32_16x16x32_bf16 v[168:171], v[216:219], a[192:195], v[168:171]
ds_read_b64_tr_b16 v[236:237], v17 offset:15424
buffer_load_dwordx4 a[48:51], v10, s[44:47], s91 offen offset:3072 sc1
v_mfma_f32_16x16x32_bf16 v[172:175], v[216:219], a[196:199], v[172:175]
ds_read_b64_tr_b16 v[238:239], v17 offset:17984
v_cvt_pk_bf16_f32 v162, v176, v177
s_waitcnt lgkmcnt(6)
v_mfma_f32_16x16x32_bf16 v[184:187], v[220:223], a[192:195], v[184:187]
ds_read_b64_tr_b16 v[240:241], v17 offset:15456
v_cvt_pk_bf16_f32 v163, v178, v179
v_mfma_f32_16x16x32_bf16 v[188:191], v[220:223], a[196:199], v[188:191]
ds_read_b64_tr_b16 v[242:243], v17 offset:18016
buffer_store_dwordx4 v[160:163], v10, s[44:47], s82 offen offset:1024 sc1
v_mfma_f32_16x16x32_bf16 v[200:203], v[224:227], a[192:195], v[200:203]
ds_read_b64_tr_b16 v[244:245], v17 offset:15488
v_mfma_f32_16x16x32_bf16 v[204:207], v[224:227], a[196:199], v[204:207]
ds_read_b64_tr_b16 v[246:247], v17 offset:18048
s_waitcnt vmcnt(17)
s_waitcnt lgkmcnt(4)
v_mfma_f32_16x16x32_bf16 v[136:139], v[228:231], a[200:203], v[136:139]
ds_read_b64_tr_b16 v[208:209], v18 offset:0
v_mfma_f32_16x16x32_bf16 v[140:143], v[228:231], a[204:207], v[140:143]
ds_read_b64_tr_b16 v[210:211], v18 offset:2560
buffer_load_dwordx4 a[52:55], v10, s[44:47], s79 offen offset:3072 sc1
v_mfma_f32_16x16x32_bf16 v[152:155], v[232:235], a[200:203], v[152:155]
ds_read_b64_tr_b16 v[212:213], v18 offset:32
v_cvt_pk_bf16_f32 v192, v192, v193
v_mfma_f32_16x16x32_bf16 v[156:159], v[232:235], a[204:207], v[156:159]
ds_read_b64_tr_b16 v[214:215], v18 offset:2592
v_cvt_pk_bf16_f32 v193, v194, v195
v_mfma_f32_16x16x32_bf16 v[168:171], v[236:239], a[200:203], v[168:171]
ds_read_b64_tr_b16 v[216:217], v18 offset:64
buffer_store_dwordx2 v[192:193], v5, s[44:47], s82 offen offset:2048 sc1
v_mfma_f32_16x16x32_bf16 v[172:175], v[236:239], a[204:207], v[172:175]
ds_read_b64_tr_b16 v[218:219], v18 offset:2624
s_waitcnt lgkmcnt(6)
v_mfma_f32_16x16x32_bf16 v[184:187], v[240:243], a[200:203], v[184:187]
ds_read_b64_tr_b16 v[220:221], v18 offset:96
v_mfma_f32_16x16x32_bf16 v[188:191], v[240:243], a[204:207], v[188:191]
ds_read_b64_tr_b16 v[222:223], v18 offset:2656
v_mfma_f32_16x16x32_bf16 v[200:203], v[244:247], a[200:203], v[200:203]
ds_read_b64_tr_b16 v[224:225], v18 offset:128
v_mfma_f32_16x16x32_bf16 v[204:207], v[244:247], a[204:207], v[204:207]
ds_read_b64_tr_b16 v[226:227], v18 offset:2688
s_waitcnt vmcnt(17)
s_waitcnt lgkmcnt(4)
v_mfma_f32_16x16x32_bf16 v[136:139], v[208:211], a[208:211], v[136:139]
ds_read_b64_tr_b16 v[228:229], v18 offset:5120
v_mfma_f32_16x16x32_bf16 v[140:143], v[208:211], a[212:215], v[140:143]
ds_read_b64_tr_b16 v[230:231], v18 offset:7680
s_add_u32 s91, s68, 4
s_and_b32 s91, s91, 7
s_lshl_b32 s91, s91, 12
s_add_u32 s79, s91, s77
s_add_u32 s91, s91, s76
buffer_load_dwordx4 a[64:67], v10, s[44:47], s91 offen offset:0 sc1
v_mfma_f32_16x16x32_bf16 v[152:155], v[212:215], a[208:211], v[152:155]
ds_read_b64_tr_b16 v[232:233], v18 offset:5152
v_cvt_pk_bf16_f32 v132, v132, v133
v_mfma_f32_16x16x32_bf16 v[156:159], v[212:215], a[212:215], v[156:159]
ds_read_b64_tr_b16 v[234:235], v18 offset:7712
v_cvt_pk_bf16_f32 v133, v134, v135
v_mfma_f32_16x16x32_bf16 v[168:171], v[216:219], a[208:211], v[168:171]
ds_read_b64_tr_b16 v[236:237], v18 offset:5184
buffer_load_dwordx4 a[68:71], v10, s[44:47], s79 offen offset:0 sc1
v_mfma_f32_16x16x32_bf16 v[172:175], v[216:219], a[212:215], v[172:175]
ds_read_b64_tr_b16 v[238:239], v18 offset:7744
v_cvt_pk_bf16_f32 v134, v148, v149
s_waitcnt lgkmcnt(6)
v_mfma_f32_16x16x32_bf16 v[184:187], v[220:223], a[208:211], v[184:187]
ds_read_b64_tr_b16 v[240:241], v18 offset:5216
v_cvt_pk_bf16_f32 v135, v150, v151
v_mfma_f32_16x16x32_bf16 v[188:191], v[220:223], a[212:215], v[188:191]
ds_read_b64_tr_b16 v[242:243], v18 offset:7776
buffer_load_dwordx4 a[80:83], v10, s[44:47], s91 offen offset:1024 sc1
v_mfma_f32_16x16x32_bf16 v[200:203], v[224:227], a[208:211], v[200:203]
ds_read_b64_tr_b16 v[244:245], v18 offset:5248
v_mfma_f32_16x16x32_bf16 v[204:207], v[224:227], a[212:215], v[204:207]
ds_read_b64_tr_b16 v[246:247], v18 offset:7808
s_waitcnt vmcnt(18)
s_waitcnt lgkmcnt(4)
v_mfma_f32_16x16x32_bf16 v[136:139], v[228:231], a[216:219], v[136:139]
ds_read_b64_tr_b16 v[208:209], v18 offset:10240
v_mfma_f32_16x16x32_bf16 v[140:143], v[228:231], a[220:223], v[140:143]
ds_read_b64_tr_b16 v[210:211], v18 offset:12800
buffer_load_dwordx4 a[84:87], v10, s[44:47], s79 offen offset:1024 sc1
v_mfma_f32_16x16x32_bf16 v[152:155], v[232:235], a[216:219], v[152:155]
ds_read_b64_tr_b16 v[212:213], v18 offset:10272
v_mfma_f32_16x16x32_bf16 v[156:159], v[232:235], a[220:223], v[156:159]
ds_read_b64_tr_b16 v[214:215], v18 offset:12832
v_mfma_f32_16x16x32_bf16 v[168:171], v[236:239], a[216:219], v[168:171]
ds_read_b64_tr_b16 v[216:217], v18 offset:10304
buffer_load_dwordx4 a[96:99], v10, s[44:47], s91 offen offset:2048 sc1
v_mfma_f32_16x16x32_bf16 v[172:175], v[236:239], a[220:223], v[172:175]
ds_read_b64_tr_b16 v[218:219], v18 offset:12864
s_waitcnt lgkmcnt(6)
v_mfma_f32_16x16x32_bf16 v[184:187], v[240:243], a[216:219], v[184:187]
ds_read_b64_tr_b16 v[220:221], v18 offset:10336
v_mfma_f32_16x16x32_bf16 v[188:191], v[240:243], a[220:223], v[188:191]
ds_read_b64_tr_b16 v[222:223], v18 offset:12896
buffer_store_dwordx4 v[132:135], v10, s[44:47], s83 offen offset:0 sc1
v_mfma_f32_16x16x32_bf16 v[200:203], v[244:247], a[216:219], v[200:203]
ds_read_b64_tr_b16 v[224:225], v18 offset:10368
v_mfma_f32_16x16x32_bf16 v[204:207], v[244:247], a[220:223], v[204:207]
ds_read_b64_tr_b16 v[226:227], v18 offset:12928
s_waitcnt vmcnt(19)
s_waitcnt lgkmcnt(4)
v_mfma_f32_16x16x32_bf16 v[136:139], v[208:211], a[224:227], v[136:139]
ds_read_b64_tr_b16 v[228:229], v18 offset:15360
v_mfma_f32_16x16x32_bf16 v[140:143], v[208:211], a[228:231], v[140:143]
ds_read_b64_tr_b16 v[230:231], v18 offset:17920
buffer_load_dwordx4 a[100:103], v10, s[44:47], s79 offen offset:2048 sc1
v_mfma_f32_16x16x32_bf16 v[152:155], v[212:215], a[224:227], v[152:155]
ds_read_b64_tr_b16 v[232:233], v18 offset:15392
v_cvt_pk_bf16_f32 v164, v164, v165
v_mfma_f32_16x16x32_bf16 v[156:159], v[212:215], a[228:231], v[156:159]
ds_read_b64_tr_b16 v[234:235], v18 offset:17952
v_cvt_pk_bf16_f32 v165, v166, v167
v_mfma_f32_16x16x32_bf16 v[168:171], v[216:219], a[224:227], v[168:171]
ds_read_b64_tr_b16 v[236:237], v18 offset:15424
buffer_load_dwordx4 a[112:115], v10, s[44:47], s91 offen offset:3072 sc1
v_mfma_f32_16x16x32_bf16 v[172:175], v[216:219], a[228:231], v[172:175]
ds_read_b64_tr_b16 v[238:239], v18 offset:17984
v_cvt_pk_bf16_f32 v166, v180, v181
s_waitcnt lgkmcnt(6)
v_mfma_f32_16x16x32_bf16 v[184:187], v[220:223], a[224:227], v[184:187]
ds_read_b64_tr_b16 v[240:241], v18 offset:15456
v_cvt_pk_bf16_f32 v167, v182, v183
v_mfma_f32_16x16x32_bf16 v[188:191], v[220:223], a[228:231], v[188:191]
ds_read_b64_tr_b16 v[242:243], v18 offset:18016
buffer_store_dwordx4 v[164:167], v10, s[44:47], s83 offen offset:1024 sc1
v_mfma_f32_16x16x32_bf16 v[200:203], v[224:227], a[224:227], v[200:203]
ds_read_b64_tr_b16 v[244:245], v18 offset:15488
v_mfma_f32_16x16x32_bf16 v[204:207], v[224:227], a[228:231], v[204:207]
ds_read_b64_tr_b16 v[246:247], v18 offset:18048
s_waitcnt vmcnt(20)
s_waitcnt lgkmcnt(4)
v_mfma_f32_16x16x32_bf16 v[136:139], v[228:231], a[232:235], v[136:139]
ds_read_b64_tr_b16 v[208:209], v19 offset:0
v_mfma_f32_16x16x32_bf16 v[140:143], v[228:231], a[236:239], v[140:143]
ds_read_b64_tr_b16 v[210:211], v19 offset:2560
buffer_load_dwordx4 a[116:119], v10, s[44:47], s79 offen offset:3072 sc1
v_mfma_f32_16x16x32_bf16 v[152:155], v[232:235], a[232:235], v[152:155]
ds_read_b64_tr_b16 v[212:213], v19 offset:32
v_cvt_pk_bf16_f32 v196, v196, v197
v_mfma_f32_16x16x32_bf16 v[156:159], v[232:235], a[236:239], v[156:159]
ds_read_b64_tr_b16 v[214:215], v19 offset:2592
v_cvt_pk_bf16_f32 v197, v198, v199
v_mfma_f32_16x16x32_bf16 v[168:171], v[236:239], a[232:235], v[168:171]
ds_read_b64_tr_b16 v[216:217], v19 offset:64
buffer_store_dwordx2 v[196:197], v5, s[44:47], s83 offen offset:2048 sc1
v_mfma_f32_16x16x32_bf16 v[172:175], v[236:239], a[236:239], v[172:175]
ds_read_b64_tr_b16 v[218:219], v19 offset:2624
s_waitcnt lgkmcnt(6)
v_mfma_f32_16x16x32_bf16 v[184:187], v[240:243], a[232:235], v[184:187]
ds_read_b64_tr_b16 v[220:221], v19 offset:96
v_mfma_f32_16x16x32_bf16 v[188:191], v[240:243], a[236:239], v[188:191]
ds_read_b64_tr_b16 v[222:223], v19 offset:2656
v_mfma_f32_16x16x32_bf16 v[200:203], v[244:247], a[232:235], v[200:203]
ds_read_b64_tr_b16 v[224:225], v19 offset:128
v_mfma_f32_16x16x32_bf16 v[204:207], v[244:247], a[236:239], v[204:207]
ds_read_b64_tr_b16 v[226:227], v19 offset:2688
s_waitcnt vmcnt(20)
s_waitcnt lgkmcnt(4)
v_mfma_f32_16x16x32_bf16 v[136:139], v[208:211], a[0:3], v[136:139]
ds_read_b64_tr_b16 v[228:229], v19 offset:5120
v_mfma_f32_16x16x32_bf16 v[140:143], v[208:211], a[4:7], v[140:143]
ds_read_b64_tr_b16 v[230:231], v19 offset:7680
s_add_u32 s91, s68, 5
s_and_b32 s91, s91, 7
s_lshl_b32 s91, s91, 12
s_add_u32 s79, s91, s77
s_add_u32 s91, s91, s76
buffer_load_dwordx4 a[176:179], v10, s[44:47], s91 offen offset:0 sc1
v_mfma_f32_16x16x32_bf16 v[152:155], v[212:215], a[0:3], v[152:155]
ds_read_b64_tr_b16 v[232:233], v19 offset:5152
v_mfma_f32_16x16x32_bf16 v[156:159], v[212:215], a[4:7], v[156:159]
ds_read_b64_tr_b16 v[234:235], v19 offset:7712
v_mfma_f32_16x16x32_bf16 v[168:171], v[216:219], a[0:3], v[168:171]
ds_read_b64_tr_b16 v[236:237], v19 offset:5184
buffer_load_dwordx4 a[180:183], v10, s[44:47], s79 offen offset:0 sc1
v_mfma_f32_16x16x32_bf16 v[172:175], v[216:219], a[4:7], v[172:175]
ds_read_b64_tr_b16 v[238:239], v19 offset:7744
s_waitcnt lgkmcnt(6)
v_mfma_f32_16x16x32_bf16 v[184:187], v[220:223], a[0:3], v[184:187]
ds_read_b64_tr_b16 v[240:241], v19 offset:5216
v_mfma_f32_16x16x32_bf16 v[188:191], v[220:223], a[4:7], v[188:191]
ds_read_b64_tr_b16 v[242:243], v19 offset:7776
buffer_load_dwordx4 a[184:187], v10, s[44:47], s91 offen offset:1024 sc1
v_mfma_f32_16x16x32_bf16 v[200:203], v[224:227], a[0:3], v[200:203]
ds_read_b64_tr_b16 v[244:245], v19 offset:5248
v_mfma_f32_16x16x32_bf16 v[204:207], v[224:227], a[4:7], v[204:207]
ds_read_b64_tr_b16 v[246:247], v19 offset:7808
s_waitcnt vmcnt(21)
s_waitcnt lgkmcnt(4)
v_mfma_f32_16x16x32_bf16 v[136:139], v[228:231], a[16:19], v[136:139]
ds_read_b64_tr_b16 v[208:209], v19 offset:10240
v_mfma_f32_16x16x32_bf16 v[140:143], v[228:231], a[20:23], v[140:143]
ds_read_b64_tr_b16 v[210:211], v19 offset:12800
buffer_load_dwordx4 a[188:191], v10, s[44:47], s79 offen offset:1024 sc1
v_mfma_f32_16x16x32_bf16 v[152:155], v[232:235], a[16:19], v[152:155]
ds_read_b64_tr_b16 v[212:213], v19 offset:10272
v_mfma_f32_16x16x32_bf16 v[156:159], v[232:235], a[20:23], v[156:159]
ds_read_b64_tr_b16 v[214:215], v19 offset:12832
v_mfma_f32_16x16x32_bf16 v[168:171], v[236:239], a[16:19], v[168:171]
ds_read_b64_tr_b16 v[216:217], v19 offset:10304
buffer_load_dwordx4 a[192:195], v10, s[44:47], s91 offen offset:2048 sc1
v_mfma_f32_16x16x32_bf16 v[172:175], v[236:239], a[20:23], v[172:175]
ds_read_b64_tr_b16 v[218:219], v19 offset:12864
s_waitcnt lgkmcnt(6)
v_mfma_f32_16x16x32_bf16 v[184:187], v[240:243], a[16:19], v[184:187]
ds_read_b64_tr_b16 v[220:221], v19 offset:10336
v_mfma_f32_16x16x32_bf16 v[188:191], v[240:243], a[20:23], v[188:191]
ds_read_b64_tr_b16 v[222:223], v19 offset:12896
v_mfma_f32_16x16x32_bf16 v[200:203], v[244:247], a[16:19], v[200:203]
ds_read_b64_tr_b16 v[224:225], v19 offset:10368
v_mfma_f32_16x16x32_bf16 v[204:207], v[244:247], a[20:23], v[204:207]
ds_read_b64_tr_b16 v[226:227], v19 offset:12928
s_waitcnt vmcnt(20)
s_waitcnt lgkmcnt(4)
v_mfma_f32_16x16x32_bf16 v[136:139], v[208:211], a[32:35], v[136:139]
ds_read_b64_tr_b16 v[228:229], v19 offset:15360
v_mfma_f32_16x16x32_bf16 v[140:143], v[208:211], a[36:39], v[140:143]
ds_read_b64_tr_b16 v[230:231], v19 offset:17920
buffer_load_dwordx4 a[196:199], v10, s[44:47], s79 offen offset:2048 sc1
v_mfma_f32_16x16x32_bf16 v[152:155], v[212:215], a[32:35], v[152:155]
ds_read_b64_tr_b16 v[232:233], v19 offset:15392
v_mfma_f32_16x16x32_bf16 v[156:159], v[212:215], a[36:39], v[156:159]
ds_read_b64_tr_b16 v[234:235], v19 offset:17952
v_mfma_f32_16x16x32_bf16 v[168:171], v[216:219], a[32:35], v[168:171]
ds_read_b64_tr_b16 v[236:237], v19 offset:15424
buffer_load_dwordx4 a[200:203], v10, s[44:47], s91 offen offset:3072 sc1
v_mfma_f32_16x16x32_bf16 v[172:175], v[216:219], a[36:39], v[172:175]
ds_read_b64_tr_b16 v[238:239], v19 offset:17984
s_waitcnt lgkmcnt(6)
v_mfma_f32_16x16x32_bf16 v[184:187], v[220:223], a[32:35], v[184:187]
ds_read_b64_tr_b16 v[240:241], v19 offset:15456
v_mfma_f32_16x16x32_bf16 v[188:191], v[220:223], a[36:39], v[188:191]
ds_read_b64_tr_b16 v[242:243], v19 offset:18016
v_mfma_f32_16x16x32_bf16 v[200:203], v[224:227], a[32:35], v[200:203]
ds_read_b64_tr_b16 v[244:245], v19 offset:15488
v_mfma_f32_16x16x32_bf16 v[204:207], v[224:227], a[36:39], v[204:207]
ds_read_b64_tr_b16 v[246:247], v19 offset:18048
s_waitcnt vmcnt(19)
s_waitcnt lgkmcnt(4)
v_mfma_f32_16x16x32_bf16 v[136:139], v[228:231], a[48:51], v[136:139]
ds_read_b64_tr_b16 v[208:209], v20 offset:0
v_mfma_f32_16x16x32_bf16 v[140:143], v[228:231], a[52:55], v[140:143]
ds_read_b64_tr_b16 v[210:211], v20 offset:2560
buffer_load_dwordx4 a[204:207], v10, s[44:47], s79 offen offset:3072 sc1
v_mfma_f32_16x16x32_bf16 v[152:155], v[232:235], a[48:51], v[152:155]
ds_read_b64_tr_b16 v[212:213], v20 offset:32
v_mfma_f32_16x16x32_bf16 v[156:159], v[232:235], a[52:55], v[156:159]
ds_read_b64_tr_b16 v[214:215], v20 offset:2592
v_mfma_f32_16x16x32_bf16 v[168:171], v[236:239], a[48:51], v[168:171]
ds_read_b64_tr_b16 v[216:217], v20 offset:64
v_mfma_f32_16x16x32_bf16 v[172:175], v[236:239], a[52:55], v[172:175]
ds_read_b64_tr_b16 v[218:219], v20 offset:2624
s_waitcnt lgkmcnt(6)
v_mfma_f32_16x16x32_bf16 v[184:187], v[240:243], a[48:51], v[184:187]
ds_read_b64_tr_b16 v[220:221], v20 offset:96
v_mfma_f32_16x16x32_bf16 v[188:191], v[240:243], a[52:55], v[188:191]
ds_read_b64_tr_b16 v[222:223], v20 offset:2656
v_mfma_f32_16x16x32_bf16 v[200:203], v[244:247], a[48:51], v[200:203]
ds_read_b64_tr_b16 v[224:225], v20 offset:128
v_mfma_f32_16x16x32_bf16 v[204:207], v[244:247], a[52:55], v[204:207]
ds_read_b64_tr_b16 v[226:227], v20 offset:2688
s_waitcnt vmcnt(17)
s_waitcnt lgkmcnt(4)
v_mfma_f32_16x16x32_bf16 v[136:139], v[208:211], a[64:67], v[136:139]
ds_read_b64_tr_b16 v[228:229], v20 offset:5120
v_mfma_f32_16x16x32_bf16 v[140:143], v[208:211], a[68:71], v[140:143]
ds_read_b64_tr_b16 v[230:231], v20 offset:7680
s_add_u32 s91, s68, 6
s_and_b32 s91, s91, 7
s_lshl_b32 s91, s91, 12
s_add_u32 s79, s91, s77
s_add_u32 s91, s91, s76
buffer_load_dwordx4 a[208:211], v10, s[44:47], s91 offen offset:0 sc1
v_mfma_f32_16x16x32_bf16 v[152:155], v[212:215], a[64:67], v[152:155]
ds_read_b64_tr_b16 v[232:233], v20 offset:5152
v_mfma_f32_16x16x32_bf16 v[156:159], v[212:215], a[68:71], v[156:159]
ds_read_b64_tr_b16 v[234:235], v20 offset:7712
v_mfma_f32_16x16x32_bf16 v[168:171], v[216:219], a[64:67], v[168:171]
ds_read_b64_tr_b16 v[236:237], v20 offset:5184
buffer_load_dwordx4 a[212:215], v10, s[44:47], s79 offen offset:0 sc1
v_mfma_f32_16x16x32_bf16 v[172:175], v[216:219], a[68:71], v[172:175]
ds_read_b64_tr_b16 v[238:239], v20 offset:7744
s_waitcnt lgkmcnt(6)
v_mfma_f32_16x16x32_bf16 v[184:187], v[220:223], a[64:67], v[184:187]
ds_read_b64_tr_b16 v[240:241], v20 offset:5216
v_mfma_f32_16x16x32_bf16 v[188:191], v[220:223], a[68:71], v[188:191]
ds_read_b64_tr_b16 v[242:243], v20 offset:7776
buffer_load_dwordx4 a[216:219], v10, s[44:47], s91 offen offset:1024 sc1
v_mfma_f32_16x16x32_bf16 v[200:203], v[224:227], a[64:67], v[200:203]
ds_read_b64_tr_b16 v[244:245], v20 offset:5248
v_mfma_f32_16x16x32_bf16 v[204:207], v[224:227], a[68:71], v[204:207]
s_waitcnt vmcnt(11)
s_lshl_b32 s71, s66, 7
s_add_u32 s71, s71, 69218304
v_mov_b32 v28, 1
v_mov_b32 v29, 0
s_mov_b64 exec, 1
buffer_atomic_add v28, v29, s[44:47], s71 offen sc1
s_mov_b64 exec, -1
ds_read_b64_tr_b16 v[246:247], v20 offset:7808
s_waitcnt lgkmcnt(4)
v_mfma_f32_16x16x32_bf16 v[136:139], v[228:231], a[80:83], v[136:139]
ds_read_b64_tr_b16 v[208:209], v20 offset:10240
v_mfma_f32_16x16x32_bf16 v[140:143], v[228:231], a[84:87], v[140:143]
ds_read_b64_tr_b16 v[210:211], v20 offset:12800
buffer_load_dwordx4 a[220:223], v10, s[44:47], s79 offen offset:1024 sc1
v_mfma_f32_16x16x32_bf16 v[152:155], v[232:235], a[80:83], v[152:155]
ds_read_b64_tr_b16 v[212:213], v20 offset:10272
v_mfma_f32_16x16x32_bf16 v[156:159], v[232:235], a[84:87], v[156:159]
ds_read_b64_tr_b16 v[214:215], v20 offset:12832
v_mfma_f32_16x16x32_bf16 v[168:171], v[236:239], a[80:83], v[168:171]
ds_read_b64_tr_b16 v[216:217], v20 offset:10304
buffer_load_dwordx4 a[224:227], v10, s[44:47], s91 offen offset:2048 sc1
v_mfma_f32_16x16x32_bf16 v[172:175], v[236:239], a[84:87], v[172:175]
ds_read_b64_tr_b16 v[218:219], v20 offset:12864
s_waitcnt lgkmcnt(6)
v_mfma_f32_16x16x32_bf16 v[184:187], v[240:243], a[80:83], v[184:187]
ds_read_b64_tr_b16 v[220:221], v20 offset:10336
v_mfma_f32_16x16x32_bf16 v[188:191], v[240:243], a[84:87], v[188:191]
ds_read_b64_tr_b16 v[222:223], v20 offset:12896
v_mfma_f32_16x16x32_bf16 v[200:203], v[244:247], a[80:83], v[200:203]
ds_read_b64_tr_b16 v[224:225], v20 offset:10368
v_mfma_f32_16x16x32_bf16 v[204:207], v[244:247], a[84:87], v[204:207]
ds_read_b64_tr_b16 v[226:227], v20 offset:12928
s_waitcnt lgkmcnt(4)
v_mfma_f32_16x16x32_bf16 v[136:139], v[208:211], a[96:99], v[136:139]
ds_read_b64_tr_b16 v[228:229], v20 offset:15360
v_mfma_f32_16x16x32_bf16 v[140:143], v[208:211], a[100:103], v[140:143]
ds_read_b64_tr_b16 v[230:231], v20 offset:17920
buffer_load_dwordx4 a[228:231], v10, s[44:47], s79 offen offset:2048 sc1
v_mfma_f32_16x16x32_bf16 v[152:155], v[212:215], a[96:99], v[152:155]
ds_read_b64_tr_b16 v[232:233], v20 offset:15392
v_mfma_f32_16x16x32_bf16 v[156:159], v[212:215], a[100:103], v[156:159]
ds_read_b64_tr_b16 v[234:235], v20 offset:17952
v_mfma_f32_16x16x32_bf16 v[168:171], v[216:219], a[96:99], v[168:171]
ds_read_b64_tr_b16 v[236:237], v20 offset:15424
buffer_load_dwordx4 a[232:235], v10, s[44:47], s91 offen offset:3072 sc1
v_mfma_f32_16x16x32_bf16 v[172:175], v[216:219], a[100:103], v[172:175]
ds_read_b64_tr_b16 v[238:239], v20 offset:17984
s_waitcnt lgkmcnt(6)
v_mfma_f32_16x16x32_bf16 v[184:187], v[220:223], a[96:99], v[184:187]
ds_read_b64_tr_b16 v[240:241], v20 offset:15456
v_mfma_f32_16x16x32_bf16 v[188:191], v[220:223], a[100:103], v[188:191]
ds_read_b64_tr_b16 v[242:243], v20 offset:18016
v_mfma_f32_16x16x32_bf16 v[200:203], v[224:227], a[96:99], v[200:203]
ds_read_b64_tr_b16 v[244:245], v20 offset:15488
v_mfma_f32_16x16x32_bf16 v[204:207], v[224:227], a[100:103], v[204:207]
ds_read_b64_tr_b16 v[246:247], v20 offset:18048
s_waitcnt lgkmcnt(4)
v_mfma_f32_16x16x32_bf16 v[136:139], v[228:231], a[112:115], v[136:139]
ds_read_b64_tr_b16 v[208:209], v21 offset:0
v_mfma_f32_16x16x32_bf16 v[140:143], v[228:231], a[116:119], v[140:143]
ds_read_b64_tr_b16 v[210:211], v21 offset:2560
buffer_load_dwordx4 a[236:239], v10, s[44:47], s79 offen offset:3072 sc1
v_mfma_f32_16x16x32_bf16 v[152:155], v[232:235], a[112:115], v[152:155]
ds_read_b64_tr_b16 v[212:213], v21 offset:32
v_mfma_f32_16x16x32_bf16 v[156:159], v[232:235], a[116:119], v[156:159]
ds_read_b64_tr_b16 v[214:215], v21 offset:2592
v_mfma_f32_16x16x32_bf16 v[168:171], v[236:239], a[112:115], v[168:171]
ds_read_b64_tr_b16 v[216:217], v21 offset:64
v_mfma_f32_16x16x32_bf16 v[172:175], v[236:239], a[116:119], v[172:175]
ds_read_b64_tr_b16 v[218:219], v21 offset:2624
s_waitcnt lgkmcnt(6)
v_mfma_f32_16x16x32_bf16 v[184:187], v[240:243], a[112:115], v[184:187]
ds_read_b64_tr_b16 v[220:221], v21 offset:96
v_mfma_f32_16x16x32_bf16 v[188:191], v[240:243], a[116:119], v[188:191]
ds_read_b64_tr_b16 v[222:223], v21 offset:2656
v_mfma_f32_16x16x32_bf16 v[200:203], v[244:247], a[112:115], v[200:203]
ds_read_b64_tr_b16 v[224:225], v21 offset:128
v_mfma_f32_16x16x32_bf16 v[204:207], v[244:247], a[116:119], v[204:207]
ds_read_b64_tr_b16 v[226:227], v21 offset:2688
s_waitcnt vmcnt(15)
s_waitcnt lgkmcnt(4)
v_mfma_f32_16x16x32_bf16 v[136:139], v[208:211], a[176:179], v[136:139]
ds_read_b64_tr_b16 v[228:229], v21 offset:5120
v_mfma_f32_16x16x32_bf16 v[140:143], v[208:211], a[180:183], v[140:143]
ds_read_b64_tr_b16 v[230:231], v21 offset:7680
s_add_u32 s91, s68, 7
s_and_b32 s91, s91, 7
s_lshl_b32 s91, s91, 12
s_add_u32 s79, s91, s77
s_add_u32 s91, s91, s76
buffer_load_dwordx4 a[0:3], v10, s[44:47], s91 offen offset:0 sc1
v_mfma_f32_16x16x32_bf16 v[152:155], v[212:215], a[176:179], v[152:155]
ds_read_b64_tr_b16 v[232:233], v21 offset:5152
v_mfma_f32_16x16x32_bf16 v[156:159], v[212:215], a[180:183], v[156:159]
ds_read_b64_tr_b16 v[234:235], v21 offset:7712
v_mfma_f32_16x16x32_bf16 v[168:171], v[216:219], a[176:179], v[168:171]
ds_read_b64_tr_b16 v[236:237], v21 offset:5184
buffer_load_dwordx4 a[4:7], v10, s[44:47], s79 offen offset:0 sc1
v_mfma_f32_16x16x32_bf16 v[172:175], v[216:219], a[180:183], v[172:175]
ds_read_b64_tr_b16 v[238:239], v21 offset:7744
s_waitcnt lgkmcnt(6)
v_mfma_f32_16x16x32_bf16 v[184:187], v[220:223], a[176:179], v[184:187]
ds_read_b64_tr_b16 v[240:241], v21 offset:5216
v_mfma_f32_16x16x32_bf16 v[188:191], v[220:223], a[180:183], v[188:191]
ds_read_b64_tr_b16 v[242:243], v21 offset:7776
buffer_load_dwordx4 a[16:19], v10, s[44:47], s91 offen offset:1024 sc1
v_mfma_f32_16x16x32_bf16 v[200:203], v[224:227], a[176:179], v[200:203]
ds_read_b64_tr_b16 v[244:245], v21 offset:5248
v_mfma_f32_16x16x32_bf16 v[204:207], v[224:227], a[180:183], v[204:207]
ds_read_b64_tr_b16 v[246:247], v21 offset:7808
s_waitcnt vmcnt(16)
s_waitcnt lgkmcnt(4)
v_mfma_f32_16x16x32_bf16 v[136:139], v[228:231], a[184:187], v[136:139]
ds_read_b64_tr_b16 v[208:209], v21 offset:10240
v_mfma_f32_16x16x32_bf16 v[140:143], v[228:231], a[188:191], v[140:143]
ds_read_b64_tr_b16 v[210:211], v21 offset:12800
buffer_load_dwordx4 a[20:23], v10, s[44:47], s79 offen offset:1024 sc1
v_mfma_f32_16x16x32_bf16 v[152:155], v[232:235], a[184:187], v[152:155]
ds_read_b64_tr_b16 v[212:213], v21 offset:10272
v_mfma_f32_16x16x32_bf16 v[156:159], v[232:235], a[188:191], v[156:159]
ds_read_b64_tr_b16 v[214:215], v21 offset:12832
v_mfma_f32_16x16x32_bf16 v[168:171], v[236:239], a[184:187], v[168:171]
ds_read_b64_tr_b16 v[216:217], v21 offset:10304
buffer_load_dwordx4 a[32:35], v10, s[44:47], s91 offen offset:2048 sc1
v_mfma_f32_16x16x32_bf16 v[172:175], v[236:239], a[188:191], v[172:175]
ds_read_b64_tr_b16 v[218:219], v21 offset:12864
s_waitcnt lgkmcnt(6)
v_mfma_f32_16x16x32_bf16 v[184:187], v[240:243], a[184:187], v[184:187]
ds_read_b64_tr_b16 v[220:221], v21 offset:10336
v_mfma_f32_16x16x32_bf16 v[188:191], v[240:243], a[188:191], v[188:191]
ds_read_b64_tr_b16 v[222:223], v21 offset:12896
v_mfma_f32_16x16x32_bf16 v[200:203], v[244:247], a[184:187], v[200:203]
ds_read_b64_tr_b16 v[224:225], v21 offset:10368
v_mfma_f32_16x16x32_bf16 v[204:207], v[244:247], a[188:191], v[204:207]
ds_read_b64_tr_b16 v[226:227], v21 offset:12928
s_waitcnt vmcnt(16)
s_waitcnt lgkmcnt(4)
v_mfma_f32_16x16x32_bf16 v[136:139], v[208:211], a[192:195], v[136:139]
ds_read_b64_tr_b16 v[228:229], v21 offset:15360
v_mfma_f32_16x16x32_bf16 v[140:143], v[208:211], a[196:199], v[140:143]
ds_read_b64_tr_b16 v[230:231], v21 offset:17920
buffer_load_dwordx4 a[36:39], v10, s[44:47], s79 offen offset:2048 sc1
v_mfma_f32_16x16x32_bf16 v[152:155], v[212:215], a[192:195], v[152:155]
ds_read_b64_tr_b16 v[232:233], v21 offset:15392
v_mfma_f32_16x16x32_bf16 v[156:159], v[212:215], a[196:199], v[156:159]
ds_read_b64_tr_b16 v[234:235], v21 offset:17952
v_mfma_f32_16x16x32_bf16 v[168:171], v[216:219], a[192:195], v[168:171]
ds_read_b64_tr_b16 v[236:237], v21 offset:15424
buffer_load_dwordx4 a[48:51], v10, s[44:47], s91 offen offset:3072 sc1
v_mfma_f32_16x16x32_bf16 v[172:175], v[216:219], a[196:199], v[172:175]
ds_read_b64_tr_b16 v[238:239], v21 offset:17984
s_waitcnt lgkmcnt(6)
v_mfma_f32_16x16x32_bf16 v[184:187], v[220:223], a[192:195], v[184:187]
ds_read_b64_tr_b16 v[240:241], v21 offset:15456
v_mfma_f32_16x16x32_bf16 v[188:191], v[220:223], a[196:199], v[188:191]
ds_read_b64_tr_b16 v[242:243], v21 offset:18016
v_mfma_f32_16x16x32_bf16 v[200:203], v[224:227], a[192:195], v[200:203]
ds_read_b64_tr_b16 v[244:245], v21 offset:15488
v_mfma_f32_16x16x32_bf16 v[204:207], v[224:227], a[196:199], v[204:207]
ds_read_b64_tr_b16 v[246:247], v21 offset:18048
s_waitcnt vmcnt(16)
s_waitcnt lgkmcnt(4)
v_mfma_f32_16x16x32_bf16 v[136:139], v[228:231], a[200:203], v[136:139]
ds_read_b64_tr_b16 v[208:209], v22 offset:0
v_mfma_f32_16x16x32_bf16 v[140:143], v[228:231], a[204:207], v[140:143]
ds_read_b64_tr_b16 v[210:211], v22 offset:2560
buffer_load_dwordx4 a[52:55], v10, s[44:47], s79 offen offset:3072 sc1
v_mfma_f32_16x16x32_bf16 v[152:155], v[232:235], a[200:203], v[152:155]
ds_read_b64_tr_b16 v[212:213], v22 offset:32
v_mfma_f32_16x16x32_bf16 v[156:159], v[232:235], a[204:207], v[156:159]
ds_read_b64_tr_b16 v[214:215], v22 offset:2592
v_mfma_f32_16x16x32_bf16 v[168:171], v[236:239], a[200:203], v[168:171]
ds_read_b64_tr_b16 v[216:217], v22 offset:64
v_mfma_f32_16x16x32_bf16 v[172:175], v[236:239], a[204:207], v[172:175]
ds_read_b64_tr_b16 v[218:219], v22 offset:2624
s_waitcnt lgkmcnt(6)
v_mfma_f32_16x16x32_bf16 v[184:187], v[240:243], a[200:203], v[184:187]
ds_read_b64_tr_b16 v[220:221], v22 offset:96
v_mfma_f32_16x16x32_bf16 v[188:191], v[240:243], a[204:207], v[188:191]
ds_read_b64_tr_b16 v[222:223], v22 offset:2656
v_mfma_f32_16x16x32_bf16 v[200:203], v[244:247], a[200:203], v[200:203]
ds_read_b64_tr_b16 v[224:225], v22 offset:128
v_mfma_f32_16x16x32_bf16 v[204:207], v[244:247], a[204:207], v[204:207]
ds_read_b64_tr_b16 v[226:227], v22 offset:2688
s_waitcnt vmcnt(15)
s_waitcnt lgkmcnt(4)
v_mfma_f32_16x16x32_bf16 v[136:139], v[208:211], a[208:211], v[136:139]
ds_read_b64_tr_b16 v[228:229], v22 offset:5120
v_mfma_f32_16x16x32_bf16 v[140:143], v[208:211], a[212:215], v[140:143]
ds_read_b64_tr_b16 v[230:231], v22 offset:7680
v_mfma_f32_16x16x32_bf16 v[152:155], v[212:215], a[208:211], v[152:155]
ds_read_b64_tr_b16 v[232:233], v22 offset:5152
v_mfma_f32_16x16x32_bf16 v[156:159], v[212:215], a[212:215], v[156:159]
ds_read_b64_tr_b16 v[234:235], v22 offset:7712
v_mfma_f32_16x16x32_bf16 v[168:171], v[216:219], a[208:211], v[168:171]
ds_read_b64_tr_b16 v[236:237], v22 offset:5184
v_mfma_f32_16x16x32_bf16 v[172:175], v[216:219], a[212:215], v[172:175]
ds_read_b64_tr_b16 v[238:239], v22 offset:7744
s_waitcnt lgkmcnt(6)
v_mfma_f32_16x16x32_bf16 v[184:187], v[220:223], a[208:211], v[184:187]
ds_read_b64_tr_b16 v[240:241], v22 offset:5216
v_mfma_f32_16x16x32_bf16 v[188:191], v[220:223], a[212:215], v[188:191]
ds_read_b64_tr_b16 v[242:243], v22 offset:7776
v_mfma_f32_16x16x32_bf16 v[200:203], v[224:227], a[208:211], v[200:203]
ds_read_b64_tr_b16 v[244:245], v22 offset:5248
v_mfma_f32_16x16x32_bf16 v[204:207], v[224:227], a[212:215], v[204:207]
ds_read_b64_tr_b16 v[246:247], v22 offset:7808
s_waitcnt vmcnt(12)
s_waitcnt lgkmcnt(4)
v_mfma_f32_16x16x32_bf16 v[136:139], v[228:231], a[216:219], v[136:139]
ds_read_b64_tr_b16 v[208:209], v22 offset:10240
v_mfma_f32_16x16x32_bf16 v[140:143], v[228:231], a[220:223], v[140:143]
ds_read_b64_tr_b16 v[210:211], v22 offset:12800
v_mfma_f32_16x16x32_bf16 v[152:155], v[232:235], a[216:219], v[152:155]
ds_read_b64_tr_b16 v[212:213], v22 offset:10272
v_mfma_f32_16x16x32_bf16 v[156:159], v[232:235], a[220:223], v[156:159]
ds_read_b64_tr_b16 v[214:215], v22 offset:12832
v_mfma_f32_16x16x32_bf16 v[168:171], v[236:239], a[216:219], v[168:171]
ds_read_b64_tr_b16 v[216:217], v22 offset:10304
v_mfma_f32_16x16x32_bf16 v[172:175], v[236:239], a[220:223], v[172:175]
ds_read_b64_tr_b16 v[218:219], v22 offset:12864
s_waitcnt lgkmcnt(6)
v_mfma_f32_16x16x32_bf16 v[184:187], v[240:243], a[216:219], v[184:187]
ds_read_b64_tr_b16 v[220:221], v22 offset:10336
v_mfma_f32_16x16x32_bf16 v[188:191], v[240:243], a[220:223], v[188:191]
ds_read_b64_tr_b16 v[222:223], v22 offset:12896
v_mfma_f32_16x16x32_bf16 v[200:203], v[244:247], a[216:219], v[200:203]
ds_read_b64_tr_b16 v[224:225], v22 offset:10368
v_mfma_f32_16x16x32_bf16 v[204:207], v[244:247], a[220:223], v[204:207]
ds_read_b64_tr_b16 v[226:227], v22 offset:12928
s_waitcnt vmcnt(10)
s_waitcnt lgkmcnt(4)
v_mfma_f32_16x16x32_bf16 v[136:139], v[208:211], a[224:227], v[136:139]
ds_read_b64_tr_b16 v[228:229], v22 offset:15360
v_mfma_f32_16x16x32_bf16 v[140:143], v[208:211], a[228:231], v[140:143]
ds_read_b64_tr_b16 v[230:231], v22 offset:17920
v_mfma_f32_16x16x32_bf16 v[152:155], v[212:215], a[224:227], v[152:155]
ds_read_b64_tr_b16 v[232:233], v22 offset:15392
v_mfma_f32_16x16x32_bf16 v[156:159], v[212:215], a[228:231], v[156:159]
ds_read_b64_tr_b16 v[234:235], v22 offset:17952
v_mfma_f32_16x16x32_bf16 v[168:171], v[216:219], a[224:227], v[168:171]
ds_read_b64_tr_b16 v[236:237], v22 offset:15424
v_mfma_f32_16x16x32_bf16 v[172:175], v[216:219], a[228:231], v[172:175]
ds_read_b64_tr_b16 v[238:239], v22 offset:17984
s_waitcnt lgkmcnt(6)
v_mfma_f32_16x16x32_bf16 v[184:187], v[220:223], a[224:227], v[184:187]
ds_read_b64_tr_b16 v[240:241], v22 offset:15456
v_mfma_f32_16x16x32_bf16 v[188:191], v[220:223], a[228:231], v[188:191]
ds_read_b64_tr_b16 v[242:243], v22 offset:18016
v_mfma_f32_16x16x32_bf16 v[200:203], v[224:227], a[224:227], v[200:203]
ds_read_b64_tr_b16 v[244:245], v22 offset:15488
v_mfma_f32_16x16x32_bf16 v[204:207], v[224:227], a[228:231], v[204:207]
ds_read_b64_tr_b16 v[246:247], v22 offset:18048
s_waitcnt vmcnt(8)
s_waitcnt lgkmcnt(4)
v_mfma_f32_16x16x32_bf16 v[136:139], v[228:231], a[232:235], v[136:139]
ds_read_b64_tr_b16 v[208:209], v23 offset:0
v_mfma_f32_16x16x32_bf16 v[140:143], v[228:231], a[236:239], v[140:143]
ds_read_b64_tr_b16 v[210:211], v23 offset:2560
v_mfma_f32_16x16x32_bf16 v[152:155], v[232:235], a[232:235], v[152:155]
ds_read_b64_tr_b16 v[212:213], v23 offset:32
v_mfma_f32_16x16x32_bf16 v[156:159], v[232:235], a[236:239], v[156:159]
ds_read_b64_tr_b16 v[214:215], v23 offset:2592
v_mfma_f32_16x16x32_bf16 v[168:171], v[236:239], a[232:235], v[168:171]
ds_read_b64_tr_b16 v[216:217], v23 offset:64
v_mfma_f32_16x16x32_bf16 v[172:175], v[236:239], a[236:239], v[172:175]
ds_read_b64_tr_b16 v[218:219], v23 offset:2624
s_waitcnt lgkmcnt(6)
v_mfma_f32_16x16x32_bf16 v[184:187], v[240:243], a[232:235], v[184:187]
ds_read_b64_tr_b16 v[220:221], v23 offset:96
v_mfma_f32_16x16x32_bf16 v[188:191], v[240:243], a[236:239], v[188:191]
ds_read_b64_tr_b16 v[222:223], v23 offset:2656
v_mfma_f32_16x16x32_bf16 v[200:203], v[244:247], a[232:235], v[200:203]
ds_read_b64_tr_b16 v[224:225], v23 offset:128
v_mfma_f32_16x16x32_bf16 v[204:207], v[244:247], a[236:239], v[204:207]
ds_read_b64_tr_b16 v[226:227], v23 offset:2688
s_waitcnt vmcnt(6)
s_waitcnt lgkmcnt(4)
v_mfma_f32_16x16x32_bf16 v[136:139], v[208:211], a[0:3], v[136:139]
ds_read_b64_tr_b16 v[228:229], v23 offset:5120
v_mfma_f32_16x16x32_bf16 v[140:143], v[208:211], a[4:7], v[140:143]
ds_read_b64_tr_b16 v[230:231], v23 offset:7680
v_mfma_f32_16x16x32_bf16 v[152:155], v[212:215], a[0:3], v[152:155]
ds_read_b64_tr_b16 v[232:233], v23 offset:5152
v_mfma_f32_16x16x32_bf16 v[156:159], v[212:215], a[4:7], v[156:159]
ds_read_b64_tr_b16 v[234:235], v23 offset:7712
v_mfma_f32_16x16x32_bf16 v[168:171], v[216:219], a[0:3], v[168:171]
ds_read_b64_tr_b16 v[236:237], v23 offset:5184
v_mfma_f32_16x16x32_bf16 v[172:175], v[216:219], a[4:7], v[172:175]
ds_read_b64_tr_b16 v[238:239], v23 offset:7744
s_waitcnt lgkmcnt(6)
v_mfma_f32_16x16x32_bf16 v[184:187], v[220:223], a[0:3], v[184:187]
ds_read_b64_tr_b16 v[240:241], v23 offset:5216
v_mfma_f32_16x16x32_bf16 v[188:191], v[220:223], a[4:7], v[188:191]
ds_read_b64_tr_b16 v[242:243], v23 offset:7776
v_mfma_f32_16x16x32_bf16 v[200:203], v[224:227], a[0:3], v[200:203]
ds_read_b64_tr_b16 v[244:245], v23 offset:5248
v_mfma_f32_16x16x32_bf16 v[204:207], v[224:227], a[4:7], v[204:207]
ds_read_b64_tr_b16 v[246:247], v23 offset:7808
s_waitcnt vmcnt(4)
s_waitcnt lgkmcnt(4)
v_mfma_f32_16x16x32_bf16 v[136:139], v[228:231], a[16:19], v[136:139]
ds_read_b64_tr_b16 v[208:209], v23 offset:10240
v_mfma_f32_16x16x32_bf16 v[140:143], v[228:231], a[20:23], v[140:143]
ds_read_b64_tr_b16 v[210:211], v23 offset:12800
v_mfma_f32_16x16x32_bf16 v[152:155], v[232:235], a[16:19], v[152:155]
ds_read_b64_tr_b16 v[212:213], v23 offset:10272
v_mfma_f32_16x16x32_bf16 v[156:159], v[232:235], a[20:23], v[156:159]
ds_read_b64_tr_b16 v[214:215], v23 offset:12832
v_mfma_f32_16x16x32_bf16 v[168:171], v[236:239], a[16:19], v[168:171]
ds_read_b64_tr_b16 v[216:217], v23 offset:10304
v_mfma_f32_16x16x32_bf16 v[172:175], v[236:239], a[20:23], v[172:175]
ds_read_b64_tr_b16 v[218:219], v23 offset:12864
s_waitcnt lgkmcnt(6)
v_mfma_f32_16x16x32_bf16 v[184:187], v[240:243], a[16:19], v[184:187]
ds_read_b64_tr_b16 v[220:221], v23 offset:10336
v_mfma_f32_16x16x32_bf16 v[188:191], v[240:243], a[20:23], v[188:191]
ds_read_b64_tr_b16 v[222:223], v23 offset:12896
v_mfma_f32_16x16x32_bf16 v[200:203], v[244:247], a[16:19], v[200:203]
ds_read_b64_tr_b16 v[224:225], v23 offset:10368
v_mfma_f32_16x16x32_bf16 v[204:207], v[244:247], a[20:23], v[204:207]
ds_read_b64_tr_b16 v[226:227], v23 offset:12928
s_waitcnt vmcnt(2)
s_waitcnt lgkmcnt(4)
v_mfma_f32_16x16x32_bf16 v[136:139], v[208:211], a[32:35], v[136:139]
ds_read_b64_tr_b16 v[228:229], v23 offset:15360
v_mfma_f32_16x16x32_bf16 v[140:143], v[208:211], a[36:39], v[140:143]
ds_read_b64_tr_b16 v[230:231], v23 offset:17920
v_mfma_f32_16x16x32_bf16 v[152:155], v[212:215], a[32:35], v[152:155]
ds_read_b64_tr_b16 v[232:233], v23 offset:15392
v_mfma_f32_16x16x32_bf16 v[156:159], v[212:215], a[36:39], v[156:159]
ds_read_b64_tr_b16 v[234:235], v23 offset:17952
v_mfma_f32_16x16x32_bf16 v[168:171], v[216:219], a[32:35], v[168:171]
ds_read_b64_tr_b16 v[236:237], v23 offset:15424
v_mfma_f32_16x16x32_bf16 v[172:175], v[216:219], a[36:39], v[172:175]
ds_read_b64_tr_b16 v[238:239], v23 offset:17984
s_waitcnt lgkmcnt(6)
v_mfma_f32_16x16x32_bf16 v[184:187], v[220:223], a[32:35], v[184:187]
ds_read_b64_tr_b16 v[240:241], v23 offset:15456
v_mfma_f32_16x16x32_bf16 v[188:191], v[220:223], a[36:39], v[188:191]
ds_read_b64_tr_b16 v[242:243], v23 offset:18016
v_mfma_f32_16x16x32_bf16 v[200:203], v[224:227], a[32:35], v[200:203]
ds_read_b64_tr_b16 v[244:245], v23 offset:15488
v_mfma_f32_16x16x32_bf16 v[204:207], v[224:227], a[36:39], v[204:207]
ds_read_b64_tr_b16 v[246:247], v23 offset:18048
s_waitcnt vmcnt(0)
s_waitcnt lgkmcnt(4)
v_mfma_f32_16x16x32_bf16 v[136:139], v[228:231], a[48:51], v[136:139]
v_mfma_f32_16x16x32_bf16 v[140:143], v[228:231], a[52:55], v[140:143]
v_mfma_f32_16x16x32_bf16 v[152:155], v[232:235], a[48:51], v[152:155]
v_mfma_f32_16x16x32_bf16 v[156:159], v[232:235], a[52:55], v[156:159]
v_mfma_f32_16x16x32_bf16 v[168:171], v[236:239], a[48:51], v[168:171]
v_mfma_f32_16x16x32_bf16 v[172:175], v[236:239], a[52:55], v[172:175]
s_waitcnt lgkmcnt(0)
v_mfma_f32_16x16x32_bf16 v[184:187], v[240:243], a[48:51], v[184:187]
v_mfma_f32_16x16x32_bf16 v[188:191], v[240:243], a[52:55], v[188:191]
v_mfma_f32_16x16x32_bf16 v[200:203], v[244:247], a[48:51], v[200:203]
v_mfma_f32_16x16x32_bf16 v[204:207], v[244:247], a[52:55], v[204:207]
s_nop 3
v_cvt_pk_bf16_f32 v136, v136, v137
v_cvt_pk_bf16_f32 v137, v138, v139
v_cvt_pk_bf16_f32 v138, v152, v153
v_cvt_pk_bf16_f32 v139, v154, v155
buffer_store_dwordx4 v[136:139], v10, s[44:47], s84 offen offset:0 sc1
v_cvt_pk_bf16_f32 v168, v168, v169
v_cvt_pk_bf16_f32 v169, v170, v171
v_cvt_pk_bf16_f32 v170, v184, v185
v_cvt_pk_bf16_f32 v171, v186, v187
buffer_store_dwordx4 v[168:171], v10, s[44:47], s84 offen offset:1024 sc1
v_cvt_pk_bf16_f32 v200, v200, v201
v_cvt_pk_bf16_f32 v201, v202, v203
buffer_store_dwordx2 v[200:201], v5, s[44:47], s84 offen offset:2048 sc1
v_cvt_pk_bf16_f32 v140, v140, v141
v_cvt_pk_bf16_f32 v141, v142, v143
v_cvt_pk_bf16_f32 v142, v156, v157
v_cvt_pk_bf16_f32 v143, v158, v159
buffer_store_dwordx4 v[140:143], v10, s[44:47], s85 offen offset:0 sc1
v_cvt_pk_bf16_f32 v172, v172, v173
v_cvt_pk_bf16_f32 v173, v174, v175
v_cvt_pk_bf16_f32 v174, v188, v189
v_cvt_pk_bf16_f32 v175, v190, v191
buffer_store_dwordx4 v[172:175], v10, s[44:47], s85 offen offset:1024 sc1
v_cvt_pk_bf16_f32 v204, v204, v205
v_cvt_pk_bf16_f32 v205, v206, v207
buffer_store_dwordx2 v[204:205], v5, s[44:47], s85 offen offset:2048 sc1
s_waitcnt vmcnt(0)
s_barrier
s_lshl_b32 s71, s66, 7
s_add_u32 s71, s71, 69218368
s_cmp_lg_u32 s64, 0
s_cbranch_scc1 L_sig_23
v_mov_b32 v28, 1
v_mov_b32 v29, 0
s_mov_b64 exec, 1
buffer_atomic_add v28, v29, s[44:47], s71 offen sc1
s_mov_b64 exec, -1
L_sig_23:
s_and_b32 s14, s69, 7
s_lshr_b32 s15, s69, 3
s_lshr_b32 s70, s14, 1
s_mul_i32 s12, s70, 27
s_add_u32 s12, s12, s15
s_mul_i32 s13, s70, 20
s_add_u32 s13, s13, s15
s_and_b32 s14, s14, 1
s_cmp_eq_u32 s14, 1
s_cselect_b32 s15, 64, s15
s_cmp_lt_u32 s15, 27
s_cselect_b32 s12, s12, -1
s_cmp_lt_u32 s15, 20
s_cselect_b32 s13, s13, -1
s_mov_b32 s48, s32
s_and_b32 s49, s33, 0xffff
s_mov_b32 s50, 0x21c000
s_mov_b32 s51, 0x20000
s_mov_b32 s4, s34
s_and_b32 s5, s35, 0xffff
s_mov_b32 s6, 0x21c000
s_mov_b32 s7, 0x20000
s_mov_b32 s8, s36
s_and_b32 s9, s37, 0xffff
s_mov_b32 s10, 0x21c000
s_mov_b32 s11, 0x20000
v_lshrrev_b32 v16, 1, v0
v_mul_u32_u24 v16, 3456, v16
v_and_b32 v17, 1, v0
v_lshl_add_u32 v16, v17, 4, v16
s_lshl_b32 s14, s12, 5
s_cmp_eq_u32 s12, -1
s_cselect_b32 s14, 536870912, s14
s_add_u32 s71, s14, 0
buffer_load_dwordx4 v[32:35], v16, s[48:51], s71 offen
buffer_load_dwordx4 v[36:39], v16, s[4:7], s71 offen
s_add_u32 s71, s14, 442368
buffer_load_dwordx4 v[40:43], v16, s[48:51], s71 offen
buffer_load_dwordx4 v[44:47], v16, s[4:7], s71 offen
s_add_u32 s71, s14, 884736
buffer_load_dwordx4 v[48:51], v16, s[48:51], s71 offen
buffer_load_dwordx4 v[52:55], v16, s[4:7], s71 offen
s_add_u32 s71, s14, 1327104
buffer_load_dwordx4 v[56:59], v16, s[48:51], s71 offen
buffer_load_dwordx4 v[60:63], v16, s[4:7], s71 offen
s_add_u32 s71, s14, 1769472
buffer_load_dwordx4 v[64:67], v16, s[48:51], s71 offen
buffer_load_dwordx4 v[68:71], v16, s[4:7], s71 offen
v_mul_u32_u24 v17, 0x334, v0
v_lshrrev_b32 v17, 16, v17
v_mul_u32_u24 v18, 80, v17
v_sub_u32 v18, v0, v18
v_mul_u32_u24 v17, 10240, v17
v_lshl_add_u32 v17, v18, 4, v17
v_cmp_gt_u32 vcc, 160, v0
v_mov_b32 v18, 536870912
s_nop 0
v_cndmask_b32 v17, v18, v17, vcc
s_mul_i32 s15, s12, 20480
s_cmp_eq_u32 s12, -1
s_cselect_b32 s15, 536870912, s15
s_add_u32 s71, s15, 0
buffer_load_dwordx4 v[212:215], v17, s[8:11], s71 offen
s_add_u32 s71, s15, 1280
buffer_load_dwordx4 v[216:219], v17, s[8:11], s71 offen
s_add_u32 s71, s15, 2560
buffer_load_dwordx4 v[220:223], v17, s[8:11], s71 offen
s_add_u32 s71, s15, 3840
buffer_load_dwordx4 v[224:227], v17, s[8:11], s71 offen
s_add_u32 s71, s15, 5120
buffer_load_dwordx4 v[228:231], v17, s[8:11], s71 offen
s_add_u32 s71, s15, 6400
buffer_load_dwordx4 v[232:235], v17, s[8:11], s71 offen
s_add_u32 s71, s15, 7680
buffer_load_dwordx4 v[236:239], v17, s[8:11], s71 offen
s_add_u32 s71, s15, 8960
buffer_load_dwordx4 v[240:243], v17, s[8:11], s71 offen
s_mov_b32 s52, s16
s_and_b32 s53, s17, 0xffff
s_mov_b32 s54, 0x280000
s_mov_b32 s55, 0x20000
s_mov_b32 s56, s30
s_and_b32 s57, s31, 0xffff
s_mov_b32 s58, 0x500
s_mov_b32 s59, 0x20000
s_mov_b32 s60, s38
s_and_b32 s61, s39, 0xffff
s_mov_b32 s62, 0x280000
s_mov_b32 s63, 0x20000
v_and_b32 v2, 7, v0
v_bfe_u32 v3, v0, 3, 2
v_lshrrev_b32 v4, 5, v0
s_lshr_b32 s70, s65, 1
s_lshl_b32 s71, s66, 3
s_sub_u32 s72, 112, s71
s_cmp_lt_u32 s70, 8
s_cselect_b32 s71, s71, s72
s_add_u32 s74, s71, s70
s_and_b32 s73, s65, 1
s_lshl_b32 s73, s73, 3
s_lshl_b32 s75, s74, 4
s_add_u32 s75, s75, s73
v_lshl_add_u32 v5, v3, 4, v2
v_add_u32 v5, s73, v5
s_mov_b32 s70, 327680
v_mul_lo_u32 v16, v4, s70
v_lshl_add_u32 v6, v5, 4, v16
v_lshl_add_u32 v7, v5, 3, v16
v_mul_u32_u24 v9, 160, v4
v_lshl_add_u32 v9, v3, 3, v9
v_mul_u32_u24 v8, 1280, v2
v_add_u32 v8, v8, v9
s_mul_i32 s76, s75, 1280
buffer_load_dwordx2 v[200:201], v8, s[52:55], s76 offen offset:0
buffer_load_dwordx2 v[82:83], v9, s[56:59], 0 offen offset:0
buffer_load_dwordx2 v[202:203], v8, s[52:55], s76 offen offset:32
buffer_load_dwordx2 v[84:85], v9, s[56:59], 0 offen offset:32
buffer_load_dwordx2 v[204:205], v8, s[52:55], s76 offen offset:64
buffer_load_dwordx2 v[86:87], v9, s[56:59], 0 offen offset:64
buffer_load_dwordx2 v[206:207], v8, s[52:55], s76 offen offset:96
buffer_load_dwordx2 v[88:89], v9, s[56:59], 0 offen offset:96
buffer_load_dwordx2 v[208:209], v8, s[52:55], s76 offen offset:128
buffer_load_dwordx2 v[90:91], v9, s[56:59], 0 offen offset:128
v_lshlrev_b32 v12, 2, v2
s_lshl_b32 s70, s64, 5
v_add_u32 v11, s70, v12
s_lshl_b32 s70, s66, 7
s_add_u32 s70, s70, 69218304
s_add_u32 s72, s70, 64
s_cmp_lt_u32 s65, 16
s_cselect_b32 s70, s70, s72
s_cselect_b32 s73, 128, 32
s_cmp_lg_u32 s64, 0
s_cbranch_scc1 L_p6w_24
v_mov_b32 v17, 0
s_mov_b32 s72, 0
L_spin_25:
buffer_load_dword v16, v17, s[44:47], s70 offen sc1
s_waitcnt vmcnt(0)
v_readfirstlane_b32 s71, v16
s_add_u32 s72, s72, 1
s_cmp_ge_u32 s71, s73
s_cbranch_scc1 L_spine_26
s_sleep 1
s_cmp_lt_u32 s72, 262144
s_cbranch_scc1 L_spin_25
L_spine_26:
L_p6w_24:
s_barrier
s_mul_i32 s70, s74, 2560
s_add_u32 s70, s70, 54525952
buffer_load_dwordx4 v[160:163], v6, s[44:47], s70 offen sc1
buffer_load_dwordx4 v[164:167], v6, s[44:47], s70 offen offset:1024 sc1
buffer_load_dwordx2 v[168:169], v7, s[44:47], s70 offen offset:2048 sc1
s_add_u32 s70, s70, 2621440
buffer_load_dwordx4 v[170:173], v6, s[44:47], s70 offen sc1
buffer_load_dwordx4 v[174:177], v6, s[44:47], s70 offen offset:1024 sc1
buffer_load_dwordx2 v[178:179], v7, s[44:47], s70 offen offset:2048 sc1
s_add_u32 s70, s70, 2621440
buffer_load_dwordx4 v[180:183], v6, s[44:47], s70 offen sc1
buffer_load_dwordx4 v[184:187], v6, s[44:47], s70 offen offset:1024 sc1
buffer_load_dwordx2 v[188:189], v7, s[44:47], s70 offen offset:2048 sc1
s_add_u32 s70, s70, 2621440
buffer_load_dwordx4 v[190:193], v6, s[44:47], s70 offen sc1
buffer_load_dwordx4 v[194:197], v6, s[44:47], s70 offen offset:1024 sc1
buffer_load_dwordx2 v[198:199], v7, s[44:47], s70 offen offset:2048 sc1
s_waitcnt vmcnt(21)
v_lshlrev_b32 v116, 16, v200
v_and_b32 v117, 0xffff0000, v200
v_lshlrev_b32 v118, 16, v201
v_and_b32 v119, 0xffff0000, v201
s_waitcnt vmcnt(19)
v_lshlrev_b32 v120, 16, v202
v_and_b32 v121, 0xffff0000, v202
v_lshlrev_b32 v122, 16, v203
v_and_b32 v123, 0xffff0000, v203
s_waitcnt vmcnt(17)
v_lshlrev_b32 v124, 16, v204
v_and_b32 v125, 0xffff0000, v204
v_lshlrev_b32 v126, 16, v205
v_and_b32 v127, 0xffff0000, v205
s_waitcnt vmcnt(15)
v_lshlrev_b32 v128, 16, v206
v_and_b32 v129, 0xffff0000, v206
v_lshlrev_b32 v130, 16, v207
v_and_b32 v131, 0xffff0000, v207
s_waitcnt vmcnt(13)
v_lshlrev_b32 v132, 16, v208
v_and_b32 v133, 0xffff0000, v208
v_lshlrev_b32 v134, 16, v209
v_and_b32 v135, 0xffff0000, v209
s_waitcnt vmcnt(11)
v_lshlrev_b32 v96, 16, v160
v_and_b32 v97, 0xffff0000, v160
s_waitcnt vmcnt(8)
v_lshlrev_b32 v144, 16, v170
v_and_b32 v145, 0xffff0000, v170
v_add_f32 v96, v96, v144
v_add_f32 v97, v97, v145
s_waitcnt vmcnt(5)
v_lshlrev_b32 v146, 16, v180
v_and_b32 v147, 0xffff0000, v180
v_add_f32 v96, v96, v146
v_add_f32 v97, v97, v147
s_waitcnt vmcnt(2)
v_lshlrev_b32 v144, 16, v190
v_and_b32 v145, 0xffff0000, v190
v_add_f32 v96, v96, v144
v_add_f32 v97, v97, v145
v_cvt_pk_bf16_f32 v144, v96, v97
v_lshlrev_b32 v96, 16, v144
v_and_b32 v97, 0xffff0000, v144
v_add_f32 v96, v96, v116
v_add_f32 v97, v97, v117
v_cvt_pk_bf16_f32 v160, v96, v97
v_lshlrev_b32 v96, 16, v160
v_and_b32 v97, 0xffff0000, v160
v_add_f32 v136, v96, v97
v_lshlrev_b32 v98, 16, v161
v_and_b32 v99, 0xffff0000, v161
v_lshlrev_b32 v144, 16, v171
v_and_b32 v145, 0xffff0000, v171
v_add_f32 v98, v98, v144
v_add_f32 v99, v99, v145
v_lshlrev_b32 v146, 16, v181
v_and_b32 v147, 0xffff0000, v181
v_add_f32 v98, v98, v146
v_add_f32 v99, v99, v147
v_lshlrev_b32 v144, 16, v191
v_and_b32 v145, 0xffff0000, v191
v_add_f32 v98, v98, v144
v_add_f32 v99, v99, v145
v_cvt_pk_bf16_f32 v144, v98, v99
v_lshlrev_b32 v98, 16, v144
v_and_b32 v99, 0xffff0000, v144
v_add_f32 v98, v98, v118
v_add_f32 v99, v99, v119
v_cvt_pk_bf16_f32 v161, v98, v99
v_lshlrev_b32 v98, 16, v161
v_and_b32 v99, 0xffff0000, v161
v_add_f32 v136, v136, v98
v_add_f32 v136, v136, v99
v_lshlrev_b32 v100, 16, v162
v_and_b32 v101, 0xffff0000, v162
v_lshlrev_b32 v144, 16, v172
v_and_b32 v145, 0xffff0000, v172
v_add_f32 v100, v100, v144
v_add_f32 v101, v101, v145
v_lshlrev_b32 v146, 16, v182
v_and_b32 v147, 0xffff0000, v182
v_add_f32 v100, v100, v146
v_add_f32 v101, v101, v147
v_lshlrev_b32 v144, 16, v192
v_and_b32 v145, 0xffff0000, v192
v_add_f32 v100, v100, v144
v_add_f32 v101, v101, v145
v_cvt_pk_bf16_f32 v144, v100, v101
v_lshlrev_b32 v100, 16, v144
v_and_b32 v101, 0xffff0000, v144
v_add_f32 v100, v100, v120
v_add_f32 v101, v101, v121
v_cvt_pk_bf16_f32 v162, v100, v101
v_lshlrev_b32 v100, 16, v162
v_and_b32 v101, 0xffff0000, v162
v_add_f32 v136, v136, v100
v_add_f32 v136, v136, v101
v_lshlrev_b32 v102, 16, v163
v_and_b32 v103, 0xffff0000, v163
v_lshlrev_b32 v144, 16, v173
v_and_b32 v145, 0xffff0000, v173
v_add_f32 v102, v102, v144
v_add_f32 v103, v103, v145
v_lshlrev_b32 v146, 16, v183
v_and_b32 v147, 0xffff0000, v183
v_add_f32 v102, v102, v146
v_add_f32 v103, v103, v147
v_lshlrev_b32 v144, 16, v193
v_and_b32 v145, 0xffff0000, v193
v_add_f32 v102, v102, v144
v_add_f32 v103, v103, v145
v_cvt_pk_bf16_f32 v144, v102, v103
v_lshlrev_b32 v102, 16, v144
v_and_b32 v103, 0xffff0000, v144
v_add_f32 v102, v102, v122
v_add_f32 v103, v103, v123
v_cvt_pk_bf16_f32 v163, v102, v103
v_lshlrev_b32 v102, 16, v163
v_and_b32 v103, 0xffff0000, v163
v_add_f32 v136, v136, v102
v_add_f32 v136, v136, v103
v_lshlrev_b32 v104, 16, v164
v_and_b32 v105, 0xffff0000, v164
v_lshlrev_b32 v144, 16, v174
v_and_b32 v145, 0xffff0000, v174
v_add_f32 v104, v104, v144
v_add_f32 v105, v105, v145
v_lshlrev_b32 v146, 16, v184
v_and_b32 v147, 0xffff0000, v184
v_add_f32 v104, v104, v146
v_add_f32 v105, v105, v147
s_waitcnt vmcnt(1)
v_lshlrev_b32 v144, 16, v194
v_and_b32 v145, 0xffff0000, v194
v_add_f32 v104, v104, v144
v_add_f32 v105, v105, v145
v_cvt_pk_bf16_f32 v144, v104, v105
v_lshlrev_b32 v104, 16, v144
v_and_b32 v105, 0xffff0000, v144
v_add_f32 v104, v104, v124
v_add_f32 v105, v105, v125
v_cvt_pk_bf16_f32 v164, v104, v105
v_lshlrev_b32 v104, 16, v164
v_and_b32 v105, 0xffff0000, v164
v_add_f32 v136, v136, v104
v_add_f32 v136, v136, v105
v_lshlrev_b32 v106, 16, v165
v_and_b32 v107, 0xffff0000, v165
v_lshlrev_b32 v144, 16, v175
v_and_b32 v145, 0xffff0000, v175
v_add_f32 v106, v106, v144
v_add_f32 v107, v107, v145
v_lshlrev_b32 v146, 16, v185
v_and_b32 v147, 0xffff0000, v185
v_add_f32 v106, v106, v146
v_add_f32 v107, v107, v147
v_lshlrev_b32 v144, 16, v195
v_and_b32 v145, 0xffff0000, v195
v_add_f32 v106, v106, v144
v_add_f32 v107, v107, v145
v_cvt_pk_bf16_f32 v144, v106, v107
v_lshlrev_b32 v106, 16, v144
v_and_b32 v107, 0xffff0000, v144
v_add_f32 v106, v106, v126
v_add_f32 v107, v107, v127
v_cvt_pk_bf16_f32 v165, v106, v107
v_lshlrev_b32 v106, 16, v165
v_and_b32 v107, 0xffff0000, v165
v_add_f32 v136, v136, v106
v_add_f32 v136, v136, v107
v_lshlrev_b32 v108, 16, v166
v_and_b32 v109, 0xffff0000, v166
v_lshlrev_b32 v144, 16, v176
v_and_b32 v145, 0xffff0000, v176
v_add_f32 v108, v108, v144
v_add_f32 v109, v109, v145
v_lshlrev_b32 v146, 16, v186
v_and_b32 v147, 0xffff0000, v186
v_add_f32 v108, v108, v146
v_add_f32 v109, v109, v147
v_lshlrev_b32 v144, 16, v196
v_and_b32 v145, 0xffff0000, v196
v_add_f32 v108, v108, v144
v_add_f32 v109, v109, v145
v_cvt_pk_bf16_f32 v144, v108, v109
v_lshlrev_b32 v108, 16, v144
v_and_b32 v109, 0xffff0000, v144
v_add_f32 v108, v108, v128
v_add_f32 v109, v109, v129
v_cvt_pk_bf16_f32 v166, v108, v109
v_lshlrev_b32 v108, 16, v166
v_and_b32 v109, 0xffff0000, v166
v_add_f32 v136, v136, v108
v_add_f32 v136, v136, v109
v_lshlrev_b32 v110, 16, v167
v_and_b32 v111, 0xffff0000, v167
v_lshlrev_b32 v144, 16, v177
v_and_b32 v145, 0xffff0000, v177
v_add_f32 v110, v110, v144
v_add_f32 v111, v111, v145
v_lshlrev_b32 v146, 16, v187
v_and_b32 v147, 0xffff0000, v187
v_add_f32 v110, v110, v146
v_add_f32 v111, v111, v147
v_lshlrev_b32 v144, 16, v197
v_and_b32 v145, 0xffff0000, v197
v_add_f32 v110, v110, v144
v_add_f32 v111, v111, v145
v_cvt_pk_bf16_f32 v144, v110, v111
v_lshlrev_b32 v110, 16, v144
v_and_b32 v111, 0xffff0000, v144
v_add_f32 v110, v110, v130
v_add_f32 v111, v111, v131
v_cvt_pk_bf16_f32 v167, v110, v111
v_lshlrev_b32 v110, 16, v167
v_and_b32 v111, 0xffff0000, v167
v_add_f32 v136, v136, v110
v_add_f32 v136, v136, v111
v_lshlrev_b32 v112, 16, v168
v_and_b32 v113, 0xffff0000, v168
v_lshlrev_b32 v144, 16, v178
v_and_b32 v145, 0xffff0000, v178
v_add_f32 v112, v112, v144
v_add_f32 v113, v113, v145
v_lshlrev_b32 v146, 16, v188
v_and_b32 v147, 0xffff0000, v188
v_add_f32 v112, v112, v146
v_add_f32 v113, v113, v147
s_waitcnt vmcnt(0)
v_lshlrev_b32 v144, 16, v198
v_and_b32 v145, 0xffff0000, v198
v_add_f32 v112, v112, v144
v_add_f32 v113, v113, v145
v_cvt_pk_bf16_f32 v144, v112, v113
v_lshlrev_b32 v112, 16, v144
v_and_b32 v113, 0xffff0000, v144
v_add_f32 v112, v112, v132
v_add_f32 v113, v113, v133
v_cvt_pk_bf16_f32 v168, v112, v113
v_lshlrev_b32 v112, 16, v168
v_and_b32 v113, 0xffff0000, v168
v_add_f32 v136, v136, v112
v_add_f32 v136, v136, v113
v_lshlrev_b32 v114, 16, v169
v_and_b32 v115, 0xffff0000, v169
v_lshlrev_b32 v144, 16, v179
v_and_b32 v145, 0xffff0000, v179
v_add_f32 v114, v114, v144
v_add_f32 v115, v115, v145
v_lshlrev_b32 v146, 16, v189
v_and_b32 v147, 0xffff0000, v189
v_add_f32 v114, v114, v146
v_add_f32 v115, v115, v147
v_lshlrev_b32 v144, 16, v199
v_and_b32 v145, 0xffff0000, v199
v_add_f32 v114, v114, v144
v_add_f32 v115, v115, v145
v_cvt_pk_bf16_f32 v144, v114, v115
v_lshlrev_b32 v114, 16, v144
v_and_b32 v115, 0xffff0000, v144
v_add_f32 v114, v114, v134
v_add_f32 v115, v115, v135
v_cvt_pk_bf16_f32 v169, v114, v115
v_lshlrev_b32 v114, 16, v169
v_and_b32 v115, 0xffff0000, v169
v_add_f32 v136, v136, v114
v_add_f32 v136, v136, v115
s_nop 1
v_add_f32_dpp v136, v136, v136 row_ror:8 row_mask:0xf bank_mask:0xf
v_mov_b32 v144, v136
s_nop 1
v_permlane16_swap_b32 v136, v144
v_add_f32 v136, v136, v144
v_mov_b32 v144, v136
s_nop 1
v_permlane32_swap_b32 v136, v144
v_add_f32 v136, v136, v144
ds_write_b32 v11, v136 offset:0
s_waitcnt lgkmcnt(0)
s_barrier
ds_read_b32 v145, v12 offset:0
ds_read_b32 v146, v12 offset:32
ds_read_b32 v147, v12 offset:64
ds_read_b32 v148, v12 offset:96
s_waitcnt lgkmcnt(0)
v_add_f32 v136, v145, v146
v_add_f32 v144, v147, v148
v_add_f32 v136, v136, v144
v_mul_f32 v137, 0.0015625, v136
v_cvt_pk_bf16_f32 v138, v137, v137
v_lshlrev_b32 v138, 16, v138
v_mov_b32 v139, 0
v_mov_b32 v141, 0
v_sub_f32 v144, v96, v137
v_fmac_f32 v139, v144, v144
v_sub_f32 v145, v97, v137
v_fmac_f32 v141, v145, v145
v_sub_f32 v144, v98, v137
v_fmac_f32 v139, v144, v144
v_sub_f32 v145, v99, v137
v_fmac_f32 v141, v145, v145
v_sub_f32 v144, v100, v137
v_fmac_f32 v139, v144, v144
v_sub_f32 v145, v101, v137
v_fmac_f32 v141, v145, v145
v_sub_f32 v144, v102, v137
v_fmac_f32 v139, v144, v144
v_sub_f32 v145, v103, v137
v_fmac_f32 v141, v145, v145
v_sub_f32 v144, v104, v137
v_fmac_f32 v139, v144, v144
v_sub_f32 v145, v105, v137
v_fmac_f32 v141, v145, v145
v_sub_f32 v144, v106, v137
v_fmac_f32 v139, v144, v144
v_sub_f32 v145, v107, v137
v_fmac_f32 v141, v145, v145
v_sub_f32 v144, v108, v137
v_fmac_f32 v139, v144, v144
v_sub_f32 v145, v109, v137
v_fmac_f32 v141, v145, v145
v_sub_f32 v144, v110, v137
v_fmac_f32 v139, v144, v144
v_sub_f32 v145, v111, v137
v_fmac_f32 v141, v145, v145
v_sub_f32 v144, v112, v137
v_fmac_f32 v139, v144, v144
v_sub_f32 v145, v113, v137
v_fmac_f32 v141, v145, v145
v_sub_f32 v144, v114, v137
v_fmac_f32 v139, v144, v144
v_sub_f32 v145, v115, v137
v_fmac_f32 v141, v145, v145
v_add_f32 v139, v139, v141
v_sub_f32 v116, v96, v138
v_sub_f32 v117, v97, v138
v_cvt_pk_bf16_f32 v190, v116, v117
v_lshlrev_b32 v116, 16, v190
v_and_b32 v117, 0xffff0000, v190
v_sub_f32 v118, v98, v138
v_sub_f32 v119, v99, v138
v_cvt_pk_bf16_f32 v191, v118, v119
v_lshlrev_b32 v118, 16, v191
v_and_b32 v119, 0xffff0000, v191
v_sub_f32 v120, v100, v138
v_sub_f32 v121, v101, v138
v_cvt_pk_bf16_f32 v192, v120, v121
v_lshlrev_b32 v120, 16, v192
v_and_b32 v121, 0xffff0000, v192
v_sub_f32 v122, v102, v138
v_sub_f32 v123, v103, v138
v_cvt_pk_bf16_f32 v193, v122, v123
v_lshlrev_b32 v122, 16, v193
v_and_b32 v123, 0xffff0000, v193
v_sub_f32 v124, v104, v138
v_sub_f32 v125, v105, v138
v_cvt_pk_bf16_f32 v194, v124, v125
v_lshlrev_b32 v124, 16, v194
v_and_b32 v125, 0xffff0000, v194
v_sub_f32 v126, v106, v138
v_sub_f32 v127, v107, v138
v_cvt_pk_bf16_f32 v195, v126, v127
v_lshlrev_b32 v126, 16, v195
v_and_b32 v127, 0xffff0000, v195
v_sub_f32 v128, v108, v138
v_sub_f32 v129, v109, v138
v_cvt_pk_bf16_f32 v196, v128, v129
v_lshlrev_b32 v128, 16, v196
v_and_b32 v129, 0xffff0000, v196
v_sub_f32 v130, v110, v138
v_sub_f32 v131, v111, v138
v_cvt_pk_bf16_f32 v197, v130, v131
v_lshlrev_b32 v130, 16, v197
v_and_b32 v131, 0xffff0000, v197
v_sub_f32 v132, v112, v138
v_sub_f32 v133, v113, v138
v_cvt_pk_bf16_f32 v198, v132, v133
v_lshlrev_b32 v132, 16, v198
v_and_b32 v133, 0xffff0000, v198
v_sub_f32 v134, v114, v138
v_sub_f32 v135, v115, v138
v_cvt_pk_bf16_f32 v199, v134, v135
v_lshlrev_b32 v134, 16, v199
v_and_b32 v135, 0xffff0000, v199
v_add_f32_dpp v139, v139, v139 row_ror:8 row_mask:0xf bank_mask:0xf
v_mov_b32 v144, v139
s_nop 1
v_permlane16_swap_b32 v139, v144
v_add_f32 v139, v139, v144
v_mov_b32 v144, v139
s_nop 1
v_permlane32_swap_b32 v139, v144
v_add_f32 v139, v139, v144
ds_write_b32 v11, v139 offset:128
s_waitcnt lgkmcnt(0)
s_barrier
ds_read_b32 v145, v12 offset:128
ds_read_b32 v146, v12 offset:160
ds_read_b32 v147, v12 offset:192
ds_read_b32 v148, v12 offset:224
s_waitcnt lgkmcnt(0)
v_add_f32 v139, v145, v146
v_add_f32 v144, v147, v148
v_add_f32 v139, v139, v144
v_mul_f32 v139, 0.0015625, v139
v_cvt_pk_bf16_f32 v139, v139, v139
v_lshlrev_b32 v139, 16, v139
v_add_f32 v139, 1e-05, v139
v_cvt_pk_bf16_f32 v139, v139, v139
v_lshlrev_b32 v139, 16, v139
v_sqrt_f32 v139, v139
s_nop 0
v_cvt_pk_bf16_f32 v139, v139, v139
v_lshlrev_b32 v139, 16, v139
v_rcp_f32 v140, v139
v_mov_b32 v141, 0
v_mov_b32 v136, 0
v_mul_f32 v116, v116, v140
v_mul_f32 v117, v117, v140
v_cvt_pk_bf16_f32 v170, v116, v117
v_lshlrev_b32 v116, 16, v170
v_and_b32 v117, 0xffff0000, v170
v_lshlrev_b32 v144, 16, v82
v_and_b32 v145, 0xffff0000, v82
v_fmac_f32 v141, v116, v144
v_fmac_f32 v136, v117, v145
v_mul_f32 v118, v118, v140
v_mul_f32 v119, v119, v140
v_cvt_pk_bf16_f32 v171, v118, v119
v_lshlrev_b32 v118, 16, v171
v_and_b32 v119, 0xffff0000, v171
v_lshlrev_b32 v144, 16, v83
v_and_b32 v145, 0xffff0000, v83
v_fmac_f32 v141, v118, v144
v_fmac_f32 v136, v119, v145
v_mul_f32 v120, v120, v140
v_mul_f32 v121, v121, v140
v_cvt_pk_bf16_f32 v172, v120, v121
v_lshlrev_b32 v120, 16, v172
v_and_b32 v121, 0xffff0000, v172
v_lshlrev_b32 v144, 16, v84
v_and_b32 v145, 0xffff0000, v84
v_fmac_f32 v141, v120, v144
v_fmac_f32 v136, v121, v145
v_mul_f32 v122, v122, v140
v_mul_f32 v123, v123, v140
v_cvt_pk_bf16_f32 v173, v122, v123
v_lshlrev_b32 v122, 16, v173
v_and_b32 v123, 0xffff0000, v173
v_lshlrev_b32 v144, 16, v85
v_and_b32 v145, 0xffff0000, v85
v_fmac_f32 v141, v122, v144
v_fmac_f32 v136, v123, v145
v_mul_f32 v124, v124, v140
v_mul_f32 v125, v125, v140
v_cvt_pk_bf16_f32 v174, v124, v125
v_lshlrev_b32 v124, 16, v174
v_and_b32 v125, 0xffff0000, v174
v_lshlrev_b32 v144, 16, v86
v_and_b32 v145, 0xffff0000, v86
v_fmac_f32 v141, v124, v144
v_fmac_f32 v136, v125, v145
v_mul_f32 v126, v126, v140
v_mul_f32 v127, v127, v140
v_cvt_pk_bf16_f32 v175, v126, v127
v_lshlrev_b32 v126, 16, v175
v_and_b32 v127, 0xffff0000, v175
v_lshlrev_b32 v144, 16, v87
v_and_b32 v145, 0xffff0000, v87
v_fmac_f32 v141, v126, v144
v_fmac_f32 v136, v127, v145
v_mul_f32 v128, v128, v140
v_mul_f32 v129, v129, v140
v_cvt_pk_bf16_f32 v176, v128, v129
v_lshlrev_b32 v128, 16, v176
v_and_b32 v129, 0xffff0000, v176
v_lshlrev_b32 v144, 16, v88
v_and_b32 v145, 0xffff0000, v88
v_fmac_f32 v141, v128, v144
v_fmac_f32 v136, v129, v145
v_mul_f32 v130, v130, v140
v_mul_f32 v131, v131, v140
v_cvt_pk_bf16_f32 v177, v130, v131
v_lshlrev_b32 v130, 16, v177
v_and_b32 v131, 0xffff0000, v177
v_lshlrev_b32 v144, 16, v89
v_and_b32 v145, 0xffff0000, v89
v_fmac_f32 v141, v130, v144
v_fmac_f32 v136, v131, v145
v_mul_f32 v132, v132, v140
v_mul_f32 v133, v133, v140
v_cvt_pk_bf16_f32 v178, v132, v133
v_lshlrev_b32 v132, 16, v178
v_and_b32 v133, 0xffff0000, v178
v_lshlrev_b32 v144, 16, v90
v_and_b32 v145, 0xffff0000, v90
v_fmac_f32 v141, v132, v144
v_fmac_f32 v136, v133, v145
v_mul_f32 v134, v134, v140
v_mul_f32 v135, v135, v140
v_cvt_pk_bf16_f32 v179, v134, v135
v_lshlrev_b32 v134, 16, v179
v_and_b32 v135, 0xffff0000, v179
v_lshlrev_b32 v144, 16, v91
v_and_b32 v145, 0xffff0000, v91
v_fmac_f32 v141, v134, v144
v_fmac_f32 v136, v135, v145
v_add_f32 v141, v141, v136
s_nop 1
v_add_f32_dpp v141, v141, v141 row_ror:8 row_mask:0xf bank_mask:0xf
v_mov_b32 v144, v141
s_nop 1
v_permlane16_swap_b32 v141, v144
v_add_f32 v141, v141, v144
v_mov_b32 v144, v141
s_nop 1
v_permlane32_swap_b32 v141, v144
v_add_f32 v141, v141, v144
ds_write_b32 v11, v141 offset:256
v_add_f32 v144, v96, v116
v_add_f32 v145, v97, v117
v_cvt_pk_bf16_f32 v180, v144, v145
v_add_f32 v144, v98, v118
v_add_f32 v145, v99, v119
v_cvt_pk_bf16_f32 v181, v144, v145
v_add_f32 v144, v100, v120
v_add_f32 v145, v101, v121
v_cvt_pk_bf16_f32 v182, v144, v145
v_add_f32 v144, v102, v122
v_add_f32 v145, v103, v123
v_cvt_pk_bf16_f32 v183, v144, v145
v_add_f32 v144, v104, v124
v_add_f32 v145, v105, v125
v_cvt_pk_bf16_f32 v184, v144, v145
v_add_f32 v144, v106, v126
v_add_f32 v145, v107, v127
v_cvt_pk_bf16_f32 v185, v144, v145
v_add_f32 v144, v108, v128
v_add_f32 v145, v109, v129
v_cvt_pk_bf16_f32 v186, v144, v145
v_add_f32 v144, v110, v130
v_add_f32 v145, v111, v131
v_cvt_pk_bf16_f32 v187, v144, v145
v_add_f32 v144, v112, v132
v_add_f32 v145, v113, v133
v_cvt_pk_bf16_f32 v188, v144, v145
v_add_f32 v144, v114, v134
v_add_f32 v145, v115, v135
v_cvt_pk_bf16_f32 v189, v144, v145
s_waitcnt lgkmcnt(0)
s_barrier
ds_read_b128 v[96:99], v30 offset:256
ds_read_b128 v[100:103], v30 offset:272
ds_read_b128 v[104:107], v30 offset:288
ds_read_b128 v[108:111], v30 offset:304
ds_read_b128 v[112:115], v30 offset:320
ds_read_b128 v[116:119], v30 offset:336
ds_read_b128 v[120:123], v30 offset:352
ds_read_b128 v[124:127], v30 offset:368
s_waitcnt lgkmcnt(0)
v_add_f32 v96, v96, v104
v_add_f32 v112, v112, v120
v_add_f32 v97, v97, v105
v_add_f32 v113, v113, v121
v_add_f32 v98, v98, v106
v_add_f32 v114, v114, v122
v_add_f32 v99, v99, v107
v_add_f32 v115, v115, v123
v_add_f32 v100, v100, v108
v_add_f32 v116, v116, v124
v_add_f32 v101, v101, v109
v_add_f32 v117, v117, v125
v_add_f32 v102, v102, v110
v_add_f32 v118, v118, v126
v_add_f32 v103, v103, v111
v_add_f32 v119, v119, v127
v_add_f32 v96, v96, v112
v_add_f32 v97, v97, v113
v_add_f32 v98, v98, v114
v_add_f32 v99, v99, v115
v_add_f32 v100, v100, v116
v_add_f32 v101, v101, v117
v_add_f32 v102, v102, v118
v_add_f32 v103, v103, v119
v_cvt_pk_bf16_f32 v104, v96, v97
v_cvt_pk_bf16_f32 v105, v98, v99
v_cvt_pk_bf16_f32 v106, v100, v101
v_cvt_pk_bf16_f32 v107, v102, v103
v_lshlrev_b32 v96, 16, v104
v_and_b32 v97, 0xffff0000, v104
v_lshlrev_b32 v98, 16, v105
v_and_b32 v99, 0xffff0000, v105
v_lshlrev_b32 v100, 16, v106
v_and_b32 v101, 0xffff0000, v106
v_lshlrev_b32 v102, 16, v107
v_and_b32 v103, 0xffff0000, v107
v_mov_b32 v153, v96
v_mov_b32 v154, 0
v_cmp_gt_f32 vcc, v97, v153
v_mov_b32 v155, 1
s_nop 0
v_cndmask_b32 v153, v153, v97, vcc
v_cndmask_b32 v154, v154, v155, vcc
v_cmp_gt_f32 vcc, v98, v153
v_mov_b32 v155, 2
s_nop 0
v_cndmask_b32 v153, v153, v98, vcc
v_cndmask_b32 v154, v154, v155, vcc
v_cmp_gt_f32 vcc, v99, v153
v_mov_b32 v155, 3
s_nop 0
v_cndmask_b32 v153, v153, v99, vcc
v_cndmask_b32 v154, v154, v155, vcc
v_cmp_gt_f32 vcc, v100, v153
v_mov_b32 v155, 4
s_nop 0
v_cndmask_b32 v153, v153, v100, vcc
v_cndmask_b32 v154, v154, v155, vcc
v_cmp_gt_f32 vcc, v101, v153
v_mov_b32 v155, 5
s_nop 0
v_cndmask_b32 v153, v153, v101, vcc
v_cndmask_b32 v154, v154, v155, vcc
v_cmp_gt_f32 vcc, v102, v153
v_mov_b32 v155, 6
s_nop 0
v_cndmask_b32 v153, v153, v102, vcc
v_cndmask_b32 v154, v154, v155, vcc
v_cmp_gt_f32 vcc, v103, v153
v_mov_b32 v155, 7
s_nop 0
v_cndmask_b32 v153, v153, v103, vcc
v_cndmask_b32 v154, v154, v155, vcc
v_ashrrev_i32 v155, 31, v153
v_or_b32 v155, 0x80000000, v155
v_xor_b32 v157, v153, v155
v_or_b32 v157, 1, v157
v_add_u32 v155, s75, v154
v_sub_u32 v155, 2047, v155
v_lshlrev_b32 v155, 8, v155
v_or_b32 v155, s69, v155
v_or_b32 v156, 0x80000000, v155
s_cmp_lg_u32 s64, 0
s_cbranch_scc1 L_key_27
s_lshl_b32 s70, s69, 3
s_add_u32 s70, s70, 69219328
s_mov_b64 exec, 1
buffer_store_dwordx2 v[156:157], v30, s[44:47], s70 offen sc1
s_mov_b64 exec, -1
L_key_27:
s_mul_i32 s70, s69, 5120
s_add_u32 s70, s70, 67108864
v_cmp_eq_u32 vcc, v2, v154
v_lshlrev_b32 v144, 1, v9
v_mov_b32 v155, 536870912
v_cndmask_b32 v155, v155, v144, vcc
v_mov_b32 v145, 536870912
v_cndmask_b32 v158, v8, v145, vcc
v_cndmask_b32 v159, v145, v8, vcc
s_mov_b32 s71, 0xffff
s_mov_b32 s72, 0x10000
v_and_b32 v96, 0xffff, v170
v_lshrrev_b32 v97, 16, v170
v_or_b32 v96, 0x10000, v96
v_or_b32 v97, 0x10000, v97
v_and_b32 v98, 0xffff, v171
v_lshrrev_b32 v99, 16, v171
v_or_b32 v98, 0x10000, v98
v_or_b32 v99, 0x10000, v99
buffer_store_dwordx4 v[96:99], v155, s[44:47], s70 offen offset:0 sc1
v_and_b32 v100, 0xffff, v172
v_lshrrev_b32 v101, 16, v172
v_or_b32 v100, 0x10000, v100
v_or_b32 v101, 0x10000, v101
v_and_b32 v102, 0xffff, v173
v_lshrrev_b32 v103, 16, v173
v_or_b32 v102, 0x10000, v102
v_or_b32 v103, 0x10000, v103
buffer_store_dwordx4 v[100:103], v155, s[44:47], s70 offen offset:64 sc1
v_and_b32 v104, 0xffff, v174
v_lshrrev_b32 v105, 16, v174
v_or_b32 v104, 0x10000, v104
v_or_b32 v105, 0x10000, v105
v_and_b32 v106, 0xffff, v175
v_lshrrev_b32 v107, 16, v175
v_or_b32 v106, 0x10000, v106
v_or_b32 v107, 0x10000, v107
buffer_store_dwordx4 v[104:107], v155, s[44:47], s70 offen offset:128 sc1
v_and_b32 v108, 0xffff, v176
v_lshrrev_b32 v109, 16, v176
v_or_b32 v108, 0x10000, v108
v_or_b32 v109, 0x10000, v109
v_and_b32 v110, 0xffff, v177
v_lshrrev_b32 v111, 16, v177
v_or_b32 v110, 0x10000, v110
v_or_b32 v111, 0x10000, v111
buffer_store_dwordx4 v[108:111], v155, s[44:47], s70 offen offset:192 sc1
v_and_b32 v96, 0xffff, v178
v_lshrrev_b32 v97, 16, v178
v_or_b32 v96, 0x10000, v96
v_or_b32 v97, 0x10000, v97
v_and_b32 v98, 0xffff, v179
v_lshrrev_b32 v99, 16, v179
v_or_b32 v98, 0x10000, v98
v_or_b32 v99, 0x10000, v99
buffer_store_dwordx4 v[96:99], v155, s[44:47], s70 offen offset:256 sc1
v_and_b32 v116, 0xffff, v160
v_lshrrev_b32 v117, 16, v160
v_or_b32 v116, 0x10000, v116
v_or_b32 v117, 0x10000, v117
v_and_b32 v118, 0xffff, v161
v_lshrrev_b32 v119, 16, v161
v_or_b32 v118, 0x10000, v118
v_or_b32 v119, 0x10000, v119
buffer_store_dwordx4 v[116:119], v155, s[44:47], s70 offen offset:2560 sc1
v_and_b32 v120, 0xffff, v162
v_lshrrev_b32 v121, 16, v162
v_or_b32 v120, 0x10000, v120
v_or_b32 v121, 0x10000, v121
v_and_b32 v122, 0xffff, v163
v_lshrrev_b32 v123, 16, v163
v_or_b32 v122, 0x10000, v122
v_or_b32 v123, 0x10000, v123
buffer_store_dwordx4 v[120:123], v155, s[44:47], s70 offen offset:2624 sc1
v_and_b32 v124, 0xffff, v164
v_lshrrev_b32 v125, 16, v164
v_or_b32 v124, 0x10000, v124
v_or_b32 v125, 0x10000, v125
v_and_b32 v126, 0xffff, v165
v_lshrrev_b32 v127, 16, v165
v_or_b32 v126, 0x10000, v126
v_or_b32 v127, 0x10000, v127
buffer_store_dwordx4 v[124:127], v155, s[44:47], s70 offen offset:2688 sc1
v_and_b32 v128, 0xffff, v166
v_lshrrev_b32 v129, 16, v166
v_or_b32 v128, 0x10000, v128
v_or_b32 v129, 0x10000, v129
v_and_b32 v130, 0xffff, v167
v_lshrrev_b32 v131, 16, v167
v_or_b32 v130, 0x10000, v130
v_or_b32 v131, 0x10000, v131
buffer_store_dwordx4 v[128:131], v155, s[44:47], s70 offen offset:2752 sc1
v_and_b32 v116, 0xffff, v168
v_lshrrev_b32 v117, 16, v168
v_or_b32 v116, 0x10000, v116
v_or_b32 v117, 0x10000, v117
v_and_b32 v118, 0xffff, v169
v_lshrrev_b32 v119, 16, v169
v_or_b32 v118, 0x10000, v118
v_or_b32 v119, 0x10000, v119
buffer_store_dwordx4 v[116:119], v155, s[44:47], s70 offen offset:2816 sc1
buffer_store_dwordx2 v[180:181], v158, s[60:63], s76 offen offset:0 sc1
buffer_store_dwordx2 v[182:183], v158, s[60:63], s76 offen offset:32 sc1
buffer_store_dwordx2 v[184:185], v158, s[60:63], s76 offen offset:64 sc1
buffer_store_dwordx2 v[186:187], v158, s[60:63], s76 offen offset:96 sc1
buffer_store_dwordx2 v[188:189], v158, s[60:63], s76 offen offset:128 sc1
v_lshlrev_b32 v16, 5, v1
s_mov_b32 s70, 69219328
s_mov_b32 s71, 0
s_cmp_eq_u32 s12, -1
s_cbranch_scc0 L_role
s_cmp_lg_u32 s64, 0
s_cbranch_scc1 L_kw_28
L_keypoll:
buffer_load_dwordx4 v[96:99], v16, s[44:47], s70 offen sc1
buffer_load_dwordx4 v[100:103], v16, s[44:47], s70 offen offset:16 sc1
s_waitcnt vmcnt(0)
v_and_b32 v104, v96, v98
v_and_b32 v105, v100, v102
v_and_b32 v104, v104, v105
v_min_u32 v105, v97, v99
v_min_u32 v106, v101, v103
v_min_u32 v105, v105, v106
v_cmp_eq_u32 vcc, 0, v105
s_nop 1
v_cndmask_b32_e64 v104, v104, 0, vcc
v_cmp_gt_i32 vcc, 0, v104
s_add_u32 s71, s71, 1
s_cmp_eq_u64 vcc, exec
s_cbranch_scc1 L_keyok
s_sleep 4
s_cmp_lt_u32 s71, 262144
s_cbranch_scc1 L_keypoll
L_keyok:
v_mov_b32 v108, v96
v_mov_b32 v109, v97
v_cmp_gt_u64 vcc, v[98:99], v[108:109]
s_nop 1
v_cndmask_b32 v108, v108, v98, vcc
v_cndmask_b32 v109, v109, v99, vcc
v_cmp_gt_u64 vcc, v[100:101], v[108:109]
s_nop 1
v_cndmask_b32 v108, v108, v100, vcc
v_cndmask_b32 v109, v109, v101, vcc
v_cmp_gt_u64 vcc, v[102:103], v[108:109]
s_nop 1
v_cndmask_b32 v108, v108, v102, vcc
v_cndmask_b32 v109, v109, v103, vcc
s_nop 0
v_mov_b32_dpp v110, v108 quad_perm:[1,0,3,2] row_mask:0xf bank_mask:0xf
v_mov_b32_dpp v111, v109 quad_perm:[1,0,3,2] row_mask:0xf bank_mask:0xf
v_cmp_gt_u64 vcc, v[110:111], v[108:109]
s_nop 1
v_cndmask_b32 v108, v108, v110, vcc
v_cndmask_b32 v109, v109, v111, vcc
s_nop 0
v_mov_b32_dpp v110, v108 quad_perm:[2,3,0,1] row_mask:0xf bank_mask:0xf
v_mov_b32_dpp v111, v109 quad_perm:[2,3,0,1] row_mask:0xf bank_mask:0xf
v_cmp_gt_u64 vcc, v[110:111], v[108:109]
s_nop 1
v_cndmask_b32 v108, v108, v110, vcc
v_cndmask_b32 v109, v109, v111, vcc
s_nop 0
v_mov_b32_dpp v110, v108 row_ror:4 row_mask:0xf bank_mask:0xf
v_mov_b32_dpp v111, v109 row_ror:4 row_mask:0xf bank_mask:0xf
v_cmp_gt_u64 vcc, v[110:111], v[108:109]
s_nop 1
v_cndmask_b32 v108, v108, v110, vcc
v_cndmask_b32 v109, v109, v111, vcc
s_nop 0
v_mov_b32_dpp v110, v108 row_ror:8 row_mask:0xf bank_mask:0xf
v_mov_b32_dpp v111, v109 row_ror:8 row_mask:0xf bank_mask:0xf
v_cmp_gt_u64 vcc, v[110:111], v[108:109]
s_nop 1
v_cndmask_b32 v108, v108, v110, vcc
v_cndmask_b32 v109, v109, v111, vcc
v_mov_b32 v110, v108
v_mov_b32 v111, v109
s_nop 0
v_permlane16_swap_b32 v108, v110
v_permlane16_swap_b32 v109, v111
v_cmp_gt_u64 vcc, v[110:111], v[108:109]
s_nop 1
v_cndmask_b32 v108, v108, v110, vcc
v_cndmask_b32 v109, v109, v111, vcc
v_mov_b32 v110, v108
v_mov_b32 v111, v109
s_nop 0
v_permlane32_swap_b32 v108, v110
v_permlane32_swap_b32 v109, v111
v_cmp_gt_u64 vcc, v[110:111], v[108:109]
s_nop 1
v_cndmask_b32 v108, v108, v110, vcc
v_cndmask_b32 v109, v109, v111, vcc
ds_write_b64 v30, v[108:109] offset:512
s_waitcnt lgkmcnt(0)
L_kw_28:
s_barrier
ds_read_b64 v[108:109], v30 offset:512
s_waitcnt lgkmcnt(0)
v_readfirstlane_b32 s77, v108
s_nop 0
s_and_b32 s79, s77, 0xff
s_cmp_eq_u32 s79, s69
s_cbranch_scc1 L_done
buffer_store_dwordx2 v[180:181], v159, s[60:63], s76 offen offset:0 sc1
buffer_store_dwordx2 v[182:183], v159, s[60:63], s76 offen offset:32 sc1
buffer_store_dwordx2 v[184:185], v159, s[60:63], s76 offen offset:64 sc1
buffer_store_dwordx2 v[186:187], v159, s[60:63], s76 offen offset:96 sc1
buffer_store_dwordx2 v[188:189], v159, s[60:63], s76 offen offset:128 sc1
s_branch L_done
L_role:
v_lshrrev_b32 v17, 1, v0
v_lshlrev_b32 v17, 2, v17
s_mov_b32 s79, 536870912
L_rpoll:
buffer_load_dwordx4 v[96:99], v16, s[44:47], s70 offen sc1
buffer_load_dwordx4 v[100:103], v16, s[44:47], s70 offen offset:16 sc1
buffer_load_dword v114, v17, s[44:47], s79 offen offset:0 sc1
buffer_load_dword v115, v17, s[44:47], s79 offen offset:512 sc1
buffer_load_dword v116, v17, s[44:47], s79 offen offset:1024 sc1
buffer_load_dword v117, v17, s[44:47], s79 offen offset:1536 sc1
buffer_load_dword v118, v17, s[44:47], s79 offen offset:2048 sc1
s_waitcnt vmcnt(0)
v_and_b32 v104, v96, v98
v_and_b32 v105, v100, v102
v_and_b32 v104, v104, v105
v_min_u32 v105, v97, v99
v_min_u32 v106, v101, v103
v_min_u32 v105, v105, v106
v_cmp_eq_u32 vcc, 0, v105
s_nop 1
v_cndmask_b32_e64 v104, v104, 0, vcc
v_and_b32 v105, v114, v115
v_and_b32 v106, v116, v117
v_and_b32 v105, v105, v118
v_and_b32 v105, v105, v106
v_lshlrev_b32 v105, 15, v105
v_and_b32 v104, v104, v105
v_cmp_gt_i32 s[74:75], 0, v104
v_mov_b32 v108, v96
v_mov_b32 v109, v97
v_cmp_gt_u64 vcc, v[98:99], v[108:109]
s_nop 1
v_cndmask_b32 v108, v108, v98, vcc
v_cndmask_b32 v109, v109, v99, vcc
v_cmp_gt_u64 vcc, v[100:101], v[108:109]
s_nop 1
v_cndmask_b32 v108, v108, v100, vcc
v_cndmask_b32 v109, v109, v101, vcc
v_cmp_gt_u64 vcc, v[102:103], v[108:109]
s_nop 1
v_cndmask_b32 v108, v108, v102, vcc
v_cndmask_b32 v109, v109, v103, vcc
s_nop 0
v_mov_b32_dpp v110, v108 quad_perm:[1,0,3,2] row_mask:0xf bank_mask:0xf
v_mov_b32_dpp v111, v109 quad_perm:[1,0,3,2] row_mask:0xf bank_mask:0xf
v_cmp_gt_u64 vcc, v[110:111], v[108:109]
s_nop 1
v_cndmask_b32 v108, v108, v110, vcc
v_cndmask_b32 v109, v109, v111, vcc
s_nop 0
v_mov_b32_dpp v110, v108 quad_perm:[2,3,0,1] row_mask:0xf bank_mask:0xf
v_mov_b32_dpp v111, v109 quad_perm:[2,3,0,1] row_mask:0xf bank_mask:0xf
v_cmp_gt_u64 vcc, v[110:111], v[108:109]
s_nop 1
v_cndmask_b32 v108, v108, v110, vcc
v_cndmask_b32 v109, v109, v111, vcc
s_nop 0
v_mov_b32_dpp v110, v108 row_ror:4 row_mask:0xf bank_mask:0xf
v_mov_b32_dpp v111, v109 row_ror:4 row_mask:0xf bank_mask:0xf
v_cmp_gt_u64 vcc, v[110:111], v[108:109]
s_nop 1
v_cndmask_b32 v108, v108, v110, vcc
v_cndmask_b32 v109, v109, v111, vcc
s_nop 0
v_mov_b32_dpp v110, v108 row_ror:8 row_mask:0xf bank_mask:0xf
v_mov_b32_dpp v111, v109 row_ror:8 row_mask:0xf bank_mask:0xf
v_cmp_gt_u64 vcc, v[110:111], v[108:109]
s_nop 1
v_cndmask_b32 v108, v108, v110, vcc
v_cndmask_b32 v109, v109, v111, vcc
v_mov_b32 v110, v108
v_mov_b32 v111, v109
s_nop 0
v_permlane16_swap_b32 v108, v110
v_permlane16_swap_b32 v109, v111
v_cmp_gt_u64 vcc, v[110:111], v[108:109]
s_nop 1
v_cndmask_b32 v108, v108, v110, vcc
v_cndmask_b32 v109, v109, v111, vcc
v_mov_b32 v110, v108
v_mov_b32 v111, v109
s_nop 0
v_permlane32_swap_b32 v108, v110
v_permlane32_swap_b32 v109, v111
v_cmp_gt_u64 vcc, v[110:111], v[108:109]
s_nop 1
v_cndmask_b32 v108, v108, v110, vcc
v_cndmask_b32 v109, v109, v111, vcc
v_readfirstlane_b32 s77, v108
v_readfirstlane_b32 s78, v109
s_and_b32 s72, s77, 0xff
s_mul_i32 s73, s72, 5120
s_add_u32 s73, s73, 67108864
s_add_u32 s71, s71, 1
s_cmp_eq_u32 s73, s79
s_mov_b32 s79, s73
s_cbranch_scc0 L_rnext
s_cmp_eq_u64 s[74:75], exec
s_cbranch_scc1 L_xok2
L_rnext:
s_cmp_lt_u32 s71, 262144
s_cbranch_scc1 L_rpoll
L_xok2:
s_bfe_u32 s80, s77, 0xb0008
s_sub_u32 s80, 2047, s80
s_cmp_eq_u32 s72, s69
s_cbranch_scc1 L_lose_29
buffer_store_dwordx2 v[180:181], v159, s[60:63], s76 offen offset:0 sc1
buffer_store_dwordx2 v[182:183], v159, s[60:63], s76 offen offset:32 sc1
buffer_store_dwordx2 v[184:185], v159, s[60:63], s76 offen offset:64 sc1
buffer_store_dwordx2 v[186:187], v159, s[60:63], s76 offen offset:96 sc1
buffer_store_dwordx2 v[188:189], v159, s[60:63], s76 offen offset:128 sc1
L_lose_29:
v_mov_b32 v96, v114
v_mov_b32 v97, v115
v_mov_b32 v98, v116
v_mov_b32 v99, v117
v_mov_b32 v100, v118
v_mov_b32 v128, 0
v_mov_b32 v129, 0
v_mov_b32 v130, 0
v_mov_b32 v131, 0
v_mov_b32 v132, 0
v_mov_b32 v133, 0
v_mov_b32 v134, 0
v_mov_b32 v135, 0
v_mov_b32 v136, 0
v_mov_b32 v137, 0
v_mov_b32 v138, 0
v_mov_b32 v139, 0
v_mov_b32 v140, 0
v_mov_b32 v141, 0
v_mov_b32 v142, 0
v_mov_b32 v143, 0
v_lshlrev_b32 v96, 16, v96
v_lshlrev_b32 v97, 16, v97
v_lshlrev_b32 v98, 16, v98
v_lshlrev_b32 v99, 16, v99
v_lshlrev_b32 v100, 16, v100
v_lshlrev_b32 v102, 16, v32
v_and_b32 v103, 0xffff0000, v32
v_fmac_f32 v128, v96, v102
v_fmac_f32 v129, v96, v103
v_lshlrev_b32 v104, 16, v33
v_and_b32 v105, 0xffff0000, v33
v_fmac_f32 v130, v96, v104
v_fmac_f32 v131, v96, v105
v_lshlrev_b32 v102, 16, v34
v_and_b32 v103, 0xffff0000, v34
v_fmac_f32 v132, v96, v102
v_fmac_f32 v133, v96, v103
v_lshlrev_b32 v104, 16, v35
v_and_b32 v105, 0xffff0000, v35
v_fmac_f32 v134, v96, v104
v_fmac_f32 v135, v96, v105
v_lshlrev_b32 v102, 16, v36
v_and_b32 v103, 0xffff0000, v36
v_fmac_f32 v136, v96, v102
v_fmac_f32 v137, v96, v103
v_lshlrev_b32 v104, 16, v37
v_and_b32 v105, 0xffff0000, v37
v_fmac_f32 v138, v96, v104
v_fmac_f32 v139, v96, v105
v_lshlrev_b32 v102, 16, v38
v_and_b32 v103, 0xffff0000, v38
v_fmac_f32 v140, v96, v102
v_fmac_f32 v141, v96, v103
v_lshlrev_b32 v104, 16, v39
v_and_b32 v105, 0xffff0000, v39
v_fmac_f32 v142, v96, v104
v_fmac_f32 v143, v96, v105
v_lshlrev_b32 v102, 16, v40
v_and_b32 v103, 0xffff0000, v40
v_fmac_f32 v128, v97, v102
v_fmac_f32 v129, v97, v103
v_lshlrev_b32 v104, 16, v41
v_and_b32 v105, 0xffff0000, v41
v_fmac_f32 v130, v97, v104
v_fmac_f32 v131, v97, v105
v_lshlrev_b32 v102, 16, v42
v_and_b32 v103, 0xffff0000, v42
v_fmac_f32 v132, v97, v102
v_fmac_f32 v133, v97, v103
v_lshlrev_b32 v104, 16, v43
v_and_b32 v105, 0xffff0000, v43
v_fmac_f32 v134, v97, v104
v_fmac_f32 v135, v97, v105
v_lshlrev_b32 v102, 16, v44
v_and_b32 v103, 0xffff0000, v44
v_fmac_f32 v136, v97, v102
v_fmac_f32 v137, v97, v103
v_lshlrev_b32 v104, 16, v45
v_and_b32 v105, 0xffff0000, v45
v_fmac_f32 v138, v97, v104
v_fmac_f32 v139, v97, v105
v_lshlrev_b32 v102, 16, v46
v_and_b32 v103, 0xffff0000, v46
v_fmac_f32 v140, v97, v102
v_fmac_f32 v141, v97, v103
v_lshlrev_b32 v104, 16, v47
v_and_b32 v105, 0xffff0000, v47
v_fmac_f32 v142, v97, v104
v_fmac_f32 v143, v97, v105
v_lshlrev_b32 v102, 16, v48
v_and_b32 v103, 0xffff0000, v48
v_fmac_f32 v128, v98, v102
v_fmac_f32 v129, v98, v103
v_lshlrev_b32 v104, 16, v49
v_and_b32 v105, 0xffff0000, v49
v_fmac_f32 v130, v98, v104
v_fmac_f32 v131, v98, v105
v_lshlrev_b32 v102, 16, v50
v_and_b32 v103, 0xffff0000, v50
v_fmac_f32 v132, v98, v102
v_fmac_f32 v133, v98, v103
v_lshlrev_b32 v104, 16, v51
v_and_b32 v105, 0xffff0000, v51
v_fmac_f32 v134, v98, v104
v_fmac_f32 v135, v98, v105
v_lshlrev_b32 v102, 16, v52
v_and_b32 v103, 0xffff0000, v52
v_fmac_f32 v136, v98, v102
v_fmac_f32 v137, v98, v103
v_lshlrev_b32 v104, 16, v53
v_and_b32 v105, 0xffff0000, v53
v_fmac_f32 v138, v98, v104
v_fmac_f32 v139, v98, v105
v_lshlrev_b32 v102, 16, v54
v_and_b32 v103, 0xffff0000, v54
v_fmac_f32 v140, v98, v102
v_fmac_f32 v141, v98, v103
v_lshlrev_b32 v104, 16, v55
v_and_b32 v105, 0xffff0000, v55
v_fmac_f32 v142, v98, v104
v_fmac_f32 v143, v98, v105
v_lshlrev_b32 v102, 16, v56
v_and_b32 v103, 0xffff0000, v56
v_fmac_f32 v128, v99, v102
v_fmac_f32 v129, v99, v103
v_lshlrev_b32 v104, 16, v57
v_and_b32 v105, 0xffff0000, v57
v_fmac_f32 v130, v99, v104
v_fmac_f32 v131, v99, v105
v_lshlrev_b32 v102, 16, v58
v_and_b32 v103, 0xffff0000, v58
v_fmac_f32 v132, v99, v102
v_fmac_f32 v133, v99, v103
v_lshlrev_b32 v104, 16, v59
v_and_b32 v105, 0xffff0000, v59
v_fmac_f32 v134, v99, v104
v_fmac_f32 v135, v99, v105
v_lshlrev_b32 v102, 16, v60
v_and_b32 v103, 0xffff0000, v60
v_fmac_f32 v136, v99, v102
v_fmac_f32 v137, v99, v103
v_lshlrev_b32 v104, 16, v61
v_and_b32 v105, 0xffff0000, v61
v_fmac_f32 v138, v99, v104
v_fmac_f32 v139, v99, v105
v_lshlrev_b32 v102, 16, v62
v_and_b32 v103, 0xffff0000, v62
v_fmac_f32 v140, v99, v102
v_fmac_f32 v141, v99, v103
v_lshlrev_b32 v104, 16, v63
v_and_b32 v105, 0xffff0000, v63
v_fmac_f32 v142, v99, v104
v_fmac_f32 v143, v99, v105
v_lshlrev_b32 v102, 16, v64
v_and_b32 v103, 0xffff0000, v64
v_fmac_f32 v128, v100, v102
v_fmac_f32 v129, v100, v103
v_lshlrev_b32 v104, 16, v65
v_and_b32 v105, 0xffff0000, v65
v_fmac_f32 v130, v100, v104
v_fmac_f32 v131, v100, v105
v_lshlrev_b32 v102, 16, v66
v_and_b32 v103, 0xffff0000, v66
v_fmac_f32 v132, v100, v102
v_fmac_f32 v133, v100, v103
v_lshlrev_b32 v104, 16, v67
v_and_b32 v105, 0xffff0000, v67
v_fmac_f32 v134, v100, v104
v_fmac_f32 v135, v100, v105
v_lshlrev_b32 v102, 16, v68
v_and_b32 v103, 0xffff0000, v68
v_fmac_f32 v136, v100, v102
v_fmac_f32 v137, v100, v103
v_lshlrev_b32 v104, 16, v69
v_and_b32 v105, 0xffff0000, v69
v_fmac_f32 v138, v100, v104
v_fmac_f32 v139, v100, v105
v_lshlrev_b32 v102, 16, v70
v_and_b32 v103, 0xffff0000, v70
v_fmac_f32 v140, v100, v102
v_fmac_f32 v141, v100, v103
v_lshlrev_b32 v104, 16, v71
v_and_b32 v105, 0xffff0000, v71
v_fmac_f32 v142, v100, v104
v_fmac_f32 v143, v100, v105
v_permlane32_swap_b32 v128, v136
v_permlane32_swap_b32 v129, v137
v_permlane32_swap_b32 v130, v138
v_permlane32_swap_b32 v131, v139
v_permlane32_swap_b32 v132, v140
v_permlane32_swap_b32 v133, v141
v_permlane32_swap_b32 v134, v142
v_permlane32_swap_b32 v135, v143
v_add_f32 v128, v128, v136
v_add_f32 v129, v129, v137
v_add_f32 v130, v130, v138
v_add_f32 v131, v131, v139
v_add_f32 v132, v132, v140
v_add_f32 v133, v133, v141
v_add_f32 v134, v134, v142
v_add_f32 v135, v135, v143
v_permlane16_swap_b32 v128, v132
v_permlane16_swap_b32 v129, v133
v_permlane16_swap_b32 v130, v134
v_permlane16_swap_b32 v131, v135
v_add_f32 v128, v128, v132
v_add_f32 v129, v129, v133
v_add_f32 v130, v130, v134
v_add_f32 v131, v131, v135
v_add_f32_dpp v128, v128, v128 row_ror:8 row_mask:0xf bank_mask:0xf
v_add_f32_dpp v129, v129, v129 row_ror:8 row_mask:0xf bank_mask:0xf
v_add_f32_dpp v130, v130, v130 row_ror:8 row_mask:0xf bank_mask:0xf
v_add_f32_dpp v131, v131, v131 row_ror:8 row_mask:0xf bank_mask:0xf
v_add_f32_dpp v128, v128, v128 row_ror:4 row_mask:0xf bank_mask:0xf
v_add_f32_dpp v129, v129, v129 row_ror:4 row_mask:0xf bank_mask:0xf
v_add_f32_dpp v130, v130, v130 row_ror:4 row_mask:0xf bank_mask:0xf
v_add_f32_dpp v131, v131, v131 row_ror:4 row_mask:0xf bank_mask:0xf
v_add_f32_dpp v128, v128, v128 row_ror:2 row_mask:0xf bank_mask:0xf
v_add_f32_dpp v129, v129, v129 row_ror:2 row_mask:0xf bank_mask:0xf
v_add_f32_dpp v130, v130, v130 row_ror:2 row_mask:0xf bank_mask:0xf
v_add_f32_dpp v131, v131, v131 row_ror:2 row_mask:0xf bank_mask:0xf
v_lshrrev_b32 v106, 4, v1
v_lshlrev_b32 v106, 4, v106
v_and_b32 v107, 1, v1
v_lshl_add_u32 v106, v107, 6, v106
s_lshl_b32 s70, s64, 7
v_add_u32 v106, s70, v106
ds_write_b128 v106, v[128:131] offset:1024
s_waitcnt lgkmcnt(0)
s_barrier
s_cmp_lg_u32 s64, 0
s_cbranch_scc1 L_f1_30
v_and_b32 v100, 7, v1
v_lshlrev_b32 v100, 2, v100
v_bfe_u32 v101, v1, 3, 1
v_lshl_add_u32 v100, v101, 6, v100
ds_read_b32 v104, v100 offset:1024
ds_read_b32 v108, v100 offset:1056
ds_read_b32 v105, v100 offset:1152
ds_read_b32 v109, v100 offset:1184
ds_read_b32 v106, v100 offset:1280
ds_read_b32 v110, v100 offset:1312
ds_read_b32 v107, v100 offset:1408
ds_read_b32 v111, v100 offset:1440
v_and_b32 v112, 15, v1
v_lshlrev_b32 v112, 2, v112
s_waitcnt lgkmcnt(0)
v_add_f32 v104, v104, v105
v_add_f32 v106, v106, v107
v_add_f32 v108, v108, v109
v_add_f32 v110, v110, v111
v_add_f32 v104, v104, v106
v_add_f32 v108, v108, v110
v_cvt_pk_bf16_f32 v104, v104, v104
v_lshlrev_b32 v104, 16, v104
v_cvt_pk_bf16_f32 v108, v108, v108
v_lshlrev_b32 v108, 16, v108
v_mul_f32 v105, -1.4426950408889634, v104
v_exp_f32 v105, v105
s_nop 0
v_add_f32 v105, 1.0, v105
v_rcp_f32 v105, v105
s_nop 0
v_mul_f32 v104, v104, v105
v_cvt_pk_bf16_f32 v104, v104, v104
v_lshlrev_b32 v104, 16, v104
v_mul_f32 v104, v104, v108
v_cvt_pk_bf16_f32 v104, v104, v104
v_lshlrev_b32 v104, 16, v104
ds_write_b32 v112, v104 offset:1536
s_waitcnt lgkmcnt(0)
L_f1_30:
s_barrier
v_mul_u32_u24 v96, 0x334, v0
v_lshrrev_b32 v96, 16, v96
v_mul_u32_u24 v97, 80, v96
v_sub_u32 v97, v0, v97
v_and_b32 v98, 1, v96
v_lshlrev_b32 v98, 5, v98
ds_read_b128 v[100:103], v98 offset:1536
ds_read_b128 v[104:107], v98 offset:1552
v_mov_b32 v128, 0
v_mov_b32 v129, 0
v_mov_b32 v130, 0
v_mov_b32 v131, 0
v_mov_b32 v132, 0
v_mov_b32 v133, 0
v_mov_b32 v134, 0
v_mov_b32 v135, 0
s_waitcnt lgkmcnt(0)
v_lshlrev_b32 v108, 16, v212
v_and_b32 v109, 0xffff0000, v212
v_fmac_f32 v128, v100, v108
v_fmac_f32 v129, v100, v109
v_lshlrev_b32 v110, 16, v213
v_and_b32 v111, 0xffff0000, v213
v_fmac_f32 v130, v100, v110
v_fmac_f32 v131, v100, v111
v_lshlrev_b32 v108, 16, v214
v_and_b32 v109, 0xffff0000, v214
v_fmac_f32 v132, v100, v108
v_fmac_f32 v133, v100, v109
v_lshlrev_b32 v110, 16, v215
v_and_b32 v111, 0xffff0000, v215
v_fmac_f32 v134, v100, v110
v_fmac_f32 v135, v100, v111
v_lshlrev_b32 v108, 16, v216
v_and_b32 v109, 0xffff0000, v216
v_fmac_f32 v128, v101, v108
v_fmac_f32 v129, v101, v109
v_lshlrev_b32 v110, 16, v217
v_and_b32 v111, 0xffff0000, v217
v_fmac_f32 v130, v101, v110
v_fmac_f32 v131, v101, v111
v_lshlrev_b32 v108, 16, v218
v_and_b32 v109, 0xffff0000, v218
v_fmac_f32 v132, v101, v108
v_fmac_f32 v133, v101, v109
v_lshlrev_b32 v110, 16, v219
v_and_b32 v111, 0xffff0000, v219
v_fmac_f32 v134, v101, v110
v_fmac_f32 v135, v101, v111
v_lshlrev_b32 v108, 16, v220
v_and_b32 v109, 0xffff0000, v220
v_fmac_f32 v128, v102, v108
v_fmac_f32 v129, v102, v109
v_lshlrev_b32 v110, 16, v221
v_and_b32 v111, 0xffff0000, v221
v_fmac_f32 v130, v102, v110
v_fmac_f32 v131, v102, v111
v_lshlrev_b32 v108, 16, v222
v_and_b32 v109, 0xffff0000, v222
v_fmac_f32 v132, v102, v108
v_fmac_f32 v133, v102, v109
v_lshlrev_b32 v110, 16, v223
v_and_b32 v111, 0xffff0000, v223
v_fmac_f32 v134, v102, v110
v_fmac_f32 v135, v102, v111
v_lshlrev_b32 v108, 16, v224
v_and_b32 v109, 0xffff0000, v224
v_fmac_f32 v128, v103, v108
v_fmac_f32 v129, v103, v109
v_lshlrev_b32 v110, 16, v225
v_and_b32 v111, 0xffff0000, v225
v_fmac_f32 v130, v103, v110
v_fmac_f32 v131, v103, v111
v_lshlrev_b32 v108, 16, v226
v_and_b32 v109, 0xffff0000, v226
v_fmac_f32 v132, v103, v108
v_fmac_f32 v133, v103, v109
v_lshlrev_b32 v110, 16, v227
v_and_b32 v111, 0xffff0000, v227
v_fmac_f32 v134, v103, v110
v_fmac_f32 v135, v103, v111
v_lshlrev_b32 v108, 16, v228
v_and_b32 v109, 0xffff0000, v228
v_fmac_f32 v128, v104, v108
v_fmac_f32 v129, v104, v109
v_lshlrev_b32 v110, 16, v229
v_and_b32 v111, 0xffff0000, v229
v_fmac_f32 v130, v104, v110
v_fmac_f32 v131, v104, v111
v_lshlrev_b32 v108, 16, v230
v_and_b32 v109, 0xffff0000, v230
v_fmac_f32 v132, v104, v108
v_fmac_f32 v133, v104, v109
v_lshlrev_b32 v110, 16, v231
v_and_b32 v111, 0xffff0000, v231
v_fmac_f32 v134, v104, v110
v_fmac_f32 v135, v104, v111
v_lshlrev_b32 v108, 16, v232
v_and_b32 v109, 0xffff0000, v232
v_fmac_f32 v128, v105, v108
v_fmac_f32 v129, v105, v109
v_lshlrev_b32 v110, 16, v233
v_and_b32 v111, 0xffff0000, v233
v_fmac_f32 v130, v105, v110
v_fmac_f32 v131, v105, v111
v_lshlrev_b32 v108, 16, v234
v_and_b32 v109, 0xffff0000, v234
v_fmac_f32 v132, v105, v108
v_fmac_f32 v133, v105, v109
v_lshlrev_b32 v110, 16, v235
v_and_b32 v111, 0xffff0000, v235
v_fmac_f32 v134, v105, v110
v_fmac_f32 v135, v105, v111
v_lshlrev_b32 v108, 16, v236
v_and_b32 v109, 0xffff0000, v236
v_fmac_f32 v128, v106, v108
v_fmac_f32 v129, v106, v109
v_lshlrev_b32 v110, 16, v237
v_and_b32 v111, 0xffff0000, v237
v_fmac_f32 v130, v106, v110
v_fmac_f32 v131, v106, v111
v_lshlrev_b32 v108, 16, v238
v_and_b32 v109, 0xffff0000, v238
v_fmac_f32 v132, v106, v108
v_fmac_f32 v133, v106, v109
v_lshlrev_b32 v110, 16, v239
v_and_b32 v111, 0xffff0000, v239
v_fmac_f32 v134, v106, v110
v_fmac_f32 v135, v106, v111
v_lshlrev_b32 v108, 16, v240
v_and_b32 v109, 0xffff0000, v240
v_fmac_f32 v128, v107, v108
v_fmac_f32 v129, v107, v109
v_lshlrev_b32 v110, 16, v241
v_and_b32 v111, 0xffff0000, v241
v_fmac_f32 v130, v107, v110
v_fmac_f32 v131, v107, v111
v_lshlrev_b32 v108, 16, v242
v_and_b32 v109, 0xffff0000, v242
v_fmac_f32 v132, v107, v108
v_fmac_f32 v133, v107, v109
v_lshlrev_b32 v110, 16, v243
v_and_b32 v111, 0xffff0000, v243
v_fmac_f32 v134, v107, v110
v_fmac_f32 v135, v107, v111
v_lshlrev_b32 v98, 5, v97
v_cmp_eq_u32 vcc, 1, v96
v_mov_b32 v99, 0x3000
s_nop 0
v_cndmask_b32 v99, v99, v98, vcc
ds_write_b128 v99, v[128:131] offset:4096
ds_write_b128 v99, v[132:135] offset:4112
s_waitcnt lgkmcnt(0)
s_barrier
ds_read_b128 v[100:103], v98 offset:4096
ds_read_b128 v[104:107], v98 offset:4112
s_waitcnt lgkmcnt(0)
v_add_f32 v108, v128, v100
v_or_b32 v108, 1, v108
v_add_f32 v109, v129, v101
v_or_b32 v109, 1, v109
v_add_f32 v110, v130, v102
v_or_b32 v110, 1, v110
v_add_f32 v111, v131, v103
v_or_b32 v111, 1, v111
v_add_f32 v112, v132, v104
v_or_b32 v112, 1, v112
v_add_f32 v113, v133, v105
v_or_b32 v113, 1, v113
v_add_f32 v114, v134, v106
v_or_b32 v114, 1, v114
v_add_f32 v115, v135, v107
v_or_b32 v115, 1, v115
v_lshlrev_b32 v98, 5, v97
v_cmp_gt_u32 vcc, 80, v0
v_mov_b32 v99, 536870912
s_nop 0
v_cndmask_b32 v98, v99, v98, vcc
s_mul_i32 s70, s12, 2560
s_add_u32 s70, s70, 68681728
buffer_store_dwordx4 v[108:111], v98, s[44:47], s70 offen offset:0 sc1
buffer_store_dwordx4 v[112:115], v98, s[44:47], s70 offen offset:16 sc1
s_cmp_eq_u32 s13, -1
s_cbranch_scc1 L_done
v_lshrrev_b32 v96, 1, v0
v_mul_u32_u24 v97, 2560, v96
v_and_b32 v98, 1, v0
v_lshl_add_u32 v97, v98, 4, v97
v_cmp_gt_u32 vcc, 108, v96
v_mov_b32 v99, 536870912
s_nop 0
v_cndmask_b32 v97, v99, v97, vcc
v_mov_b32 v120, 1
v_cndmask_b32_e64 v120, v120, 0, vcc
s_lshl_b32 s70, s13, 5
s_add_u32 s70, s70, 68681728
s_mov_b32 s71, 0
v_and_b32 v116, 7, v1
v_lshlrev_b32 v119, 2, v116
v_lshlrev_b32 v116, 1, v116
s_lshl_b32 s72, s13, 5
s_add_u32 s72, s72, s79
L_actpoll:
buffer_load_dword v118, v119, s[44:47], s72 offen sc1
buffer_load_dword v117, v119, s[44:47], s72 offen offset:2560 sc1
buffer_load_dwordx4 v[100:103], v97, s[44:47], s70 offen sc1
s_waitcnt vmcnt(0)
v_and_b32 v108, v100, v101
v_and_b32 v109, v102, v103
v_and_b32 v108, v108, v109
v_or_b32 v108, v108, v120
v_and_b32 v109, v117, v118
v_lshrrev_b32 v109, 16, v109
v_and_b32 v108, v108, v109
v_and_b32 v108, 1, v108
v_cmp_ne_u32 vcc, 0, v108
s_add_u32 s71, s71, 1
s_cmp_eq_u64 vcc, exec
s_cbranch_scc1 L_actok
s_sleep 1
s_cmp_lt_u32 s71, 262144
s_cbranch_scc1 L_actpoll
L_actok:
v_mov_b32 v128, v100
v_mov_b32 v129, v101
v_mov_b32 v130, v102
v_mov_b32 v131, v103
v_add_f32_dpp v128, v128, v128 row_ror:8 row_mask:0xf bank_mask:0xf
v_add_f32_dpp v129, v129, v129 row_ror:8 row_mask:0xf bank_mask:0xf
v_add_f32_dpp v130, v130, v130 row_ror:8 row_mask:0xf bank_mask:0xf
v_add_f32_dpp v131, v131, v131 row_ror:8 row_mask:0xf bank_mask:0xf
v_add_f32_dpp v128, v128, v128 row_ror:4 row_mask:0xf bank_mask:0xf
v_add_f32_dpp v129, v129, v129 row_ror:4 row_mask:0xf bank_mask:0xf
v_add_f32_dpp v130, v130, v130 row_ror:4 row_mask:0xf bank_mask:0xf
v_add_f32_dpp v131, v131, v131 row_ror:4 row_mask:0xf bank_mask:0xf
v_add_f32_dpp v128, v128, v128 row_ror:2 row_mask:0xf bank_mask:0xf
v_add_f32_dpp v129, v129, v129 row_ror:2 row_mask:0xf bank_mask:0xf
v_add_f32_dpp v130, v130, v130 row_ror:2 row_mask:0xf bank_mask:0xf
v_add_f32_dpp v131, v131, v131 row_ror:2 row_mask:0xf bank_mask:0xf
v_mov_b32 v132, v128
v_mov_b32 v133, v129
v_mov_b32 v134, v130
v_mov_b32 v135, v131
v_permlane16_swap_b32 v128, v132
v_permlane16_swap_b32 v129, v133
v_permlane16_swap_b32 v130, v134
v_permlane16_swap_b32 v131, v135
v_add_f32 v128, v128, v132
v_add_f32 v129, v129, v133
v_add_f32 v130, v130, v134
v_add_f32 v131, v131, v135
v_mov_b32 v132, v128
v_mov_b32 v133, v129
v_mov_b32 v134, v130
v_mov_b32 v135, v131
v_permlane32_swap_b32 v128, v132
v_permlane32_swap_b32 v129, v133
v_permlane32_swap_b32 v130, v134
v_permlane32_swap_b32 v131, v135
v_add_f32 v128, v128, v132
v_add_f32 v129, v129, v133
v_add_f32 v130, v130, v134
v_add_f32 v131, v131, v135
v_and_b32 v100, 1, v1
v_lshlrev_b32 v100, 4, v100
s_lshl_b32 s70, s64, 5
v_add_u32 v100, s70, v100
ds_write_b128 v100, v[128:131] offset:2048
s_waitcnt lgkmcnt(0)
s_barrier
s_cmp_lg_u32 s64, 0
s_cbranch_scc1 L_done
v_and_b32 v100, 7, v1
v_lshlrev_b32 v100, 2, v100
ds_read_b32 v104, v100 offset:2048
ds_read_b32 v105, v100 offset:2080
ds_read_b32 v106, v100 offset:2112
ds_read_b32 v107, v100 offset:2144
v_mov_b32 v110, s78
v_ashrrev_i32 v111, 31, v110
v_not_b32 v111, v111
v_or_b32 v111, 0x80000000, v111
v_xor_b32 v110, v110, v111
v_and_b32 v110, 0xffff0000, v110
v_mul_f32 v110, -1.4426950408889634, v110
v_exp_f32 v110, v110
s_nop 0
v_add_f32 v110, 1.0, v110
v_rcp_f32 v110, v110
s_nop 0
v_cvt_pk_bf16_f32 v110, v110, v110
v_lshlrev_b32 v110, 16, v110
s_waitcnt lgkmcnt(0)
v_add_f32 v104, v104, v105
v_add_f32 v106, v106, v107
v_add_f32 v104, v104, v106
v_cvt_pk_bf16_f32 v104, v104, v104
v_lshlrev_b32 v104, 16, v104
v_mul_f32 v104, v104, v110
v_cvt_pk_bf16_f32 v104, v104, v104
v_lshlrev_b32 v104, 16, v104
v_lshlrev_b32 v117, 16, v117
v_lshlrev_b32 v118, 16, v118
v_add_f32 v104, v118, v104
v_cvt_pk_bf16_f32 v104, v104, v104
v_lshlrev_b32 v104, 16, v104
v_add_f32 v104, v117, v104
v_cvt_pk_bf16_f32 v104, v104, v104
s_mul_i32 s70, s80, 1280
s_lshl_b32 s71, s13, 4
s_add_u32 s70, s70, s71
s_mov_b64 exec, 0xff
buffer_store_short v104, v116, s[60:63], s70 offen sc1
s_mov_b64 exec, -1
L_done:
L_exit:
s_endpgm
L_slow_0:
s_waitcnt vmcnt(0)
s_lshr_b32 s13, s92, 1
s_mov_b32 s12, 0
s_nop 7
v_accvgpr_write_b32 a0, 0
v_accvgpr_write_b32 a1, 0
v_accvgpr_write_b32 a2, 0
v_accvgpr_write_b32 a3, 0
v_accvgpr_write_b32 a16, 0
v_accvgpr_write_b32 a17, 0
v_accvgpr_write_b32 a18, 0
v_accvgpr_write_b32 a19, 0
v_accvgpr_write_b32 a32, 0
v_accvgpr_write_b32 a33, 0
v_accvgpr_write_b32 a34, 0
v_accvgpr_write_b32 a35, 0
v_accvgpr_write_b32 a48, 0
v_accvgpr_write_b32 a49, 0
v_accvgpr_write_b32 a50, 0
v_accvgpr_write_b32 a51, 0
v_accvgpr_write_b32 a64, 0
v_accvgpr_write_b32 a65, 0
v_accvgpr_write_b32 a66, 0
v_accvgpr_write_b32 a67, 0
v_accvgpr_write_b32 a80, 0
v_accvgpr_write_b32 a81, 0
v_accvgpr_write_b32 a82, 0
v_accvgpr_write_b32 a83, 0
v_accvgpr_write_b32 a96, 0
v_accvgpr_write_b32 a97, 0
v_accvgpr_write_b32 a98, 0
v_accvgpr_write_b32 a99, 0
v_accvgpr_write_b32 a112, 0
v_accvgpr_write_b32 a113, 0
v_accvgpr_write_b32 a114, 0
v_accvgpr_write_b32 a115, 0
v_accvgpr_write_b32 a128, 0
v_accvgpr_write_b32 a129, 0
v_accvgpr_write_b32 a130, 0
v_accvgpr_write_b32 a131, 0
v_mov_b32 v182, 0xff800000
v_mov_b32 v176, v182
v_and_b32 v181, 15, v1
v_lshrrev_b32 v178, 4, v1
v_lshlrev_b32 v178, 2, v178
v_sub_u32 v181, v181, v178
s_lshl_b32 s14, s92, 4
v_add_u32 v181, s14, v181
L_slow_loop_0:
s_lshl_b32 s14, s12, 14
buffer_load_dwordx4 v[32:35], v4, s[56:59], s14 offen offset:0 sc1
buffer_load_dwordx4 v[96:99], v6, s[56:59], s14 offen offset:0 sc1
buffer_load_dwordx4 v[36:39], v4, s[56:59], s14 offen offset:1024 sc1
buffer_load_dwordx4 v[100:103], v6, s[56:59], s14 offen offset:1024 sc1
buffer_load_dwordx4 v[40:43], v4, s[56:59], s14 offen offset:2048 sc1
buffer_load_dwordx4 v[104:107], v6, s[56:59], s14 offen offset:2048 sc1
buffer_load_dwordx4 v[44:47], v4, s[56:59], s14 offen offset:3072 sc1
buffer_load_dwordx4 v[108:111], v6, s[56:59], s14 offen offset:3072 sc1
buffer_load_dwordx4 v[48:51], v5, s[56:59], s14 offen offset:0 sc1
buffer_load_dwordx4 v[112:115], v7, s[56:59], s14 offen offset:0 sc1
buffer_load_dwordx4 v[52:55], v5, s[56:59], s14 offen offset:1024 sc1
buffer_load_dwordx4 v[116:119], v7, s[56:59], s14 offen offset:1024 sc1
buffer_load_dwordx4 v[56:59], v5, s[56:59], s14 offen offset:2048 sc1
buffer_load_dwordx4 v[120:123], v7, s[56:59], s14 offen offset:2048 sc1
buffer_load_dwordx4 v[60:63], v5, s[56:59], s14 offen offset:3072 sc1
buffer_load_dwordx4 v[124:127], v7, s[56:59], s14 offen offset:3072 sc1
s_waitcnt vmcnt(0)
v_mfma_f32_16x16x32_bf16 v[144:147], v[32:35], v[128:131], 0
v_mfma_f32_16x16x32_bf16 v[148:151], v[48:51], v[128:131], 0
v_mfma_f32_16x16x32_bf16 v[144:147], v[36:39], v[160:163], v[144:147]
v_mfma_f32_16x16x32_bf16 v[148:151], v[52:55], v[160:163], v[148:151]
v_mfma_f32_16x16x32_bf16 v[144:147], v[40:43], v[192:195], v[144:147]
v_mfma_f32_16x16x32_bf16 v[148:151], v[56:59], v[192:195], v[148:151]
v_mfma_f32_16x16x32_bf16 v[144:147], v[44:47], v[224:227], v[144:147]
v_mfma_f32_16x16x32_bf16 v[148:151], v[60:63], v[224:227], v[148:151]
s_lshl_b32 s15, s12, 5
v_subrev_u32 v180, s15, v181
s_nop 7
v_cmp_le_i32 vcc, 0, v180
s_nop 1
v_cndmask_b32 v144, v182, v144, vcc
v_cmp_le_i32 vcc, 1, v180
s_nop 1
v_cndmask_b32 v145, v182, v145, vcc
v_cmp_le_i32 vcc, 2, v180
s_nop 1
v_cndmask_b32 v146, v182, v146, vcc
v_cmp_le_i32 vcc, 3, v180
s_nop 1
v_cndmask_b32 v147, v182, v147, vcc
v_cmp_le_i32 vcc, 16, v180
s_nop 1
v_cndmask_b32 v148, v182, v148, vcc
v_cmp_le_i32 vcc, 17, v180
s_nop 1
v_cndmask_b32 v149, v182, v149, vcc
v_cmp_le_i32 vcc, 18, v180
s_nop 1
v_cndmask_b32 v150, v182, v150, vcc
v_cmp_le_i32 vcc, 19, v180
s_nop 1
v_cndmask_b32 v151, v182, v151, vcc
v_max3_f32 v177, v144, v145, v146
v_max3_f32 v177, v177, v147, v148
v_max3_f32 v177, v177, v149, v150
v_max3_f32 v177, v177, v151, v176
v_mov_b32 v178, v177
s_nop 1
v_permlane16_swap_b32 v177, v178
v_max_f32 v177, v177, v178
v_mov_b32 v178, v177
s_nop 1
v_permlane32_swap_b32 v177, v178
v_max_f32 v177, v177, v178
v_sub_f32 v179, v176, v177
v_exp_f32 v179, v179
v_mov_b32 v176, v177
v_sub_f32 v144, v144, v176
v_sub_f32 v145, v145, v176
v_sub_f32 v146, v146, v176
v_sub_f32 v147, v147, v176
v_sub_f32 v148, v148, v176
v_sub_f32 v149, v149, v176
v_sub_f32 v150, v150, v176
v_sub_f32 v151, v151, v176
v_exp_f32 v144, v144
v_exp_f32 v145, v145
v_exp_f32 v146, v146
v_exp_f32 v147, v147
v_exp_f32 v148, v148
v_exp_f32 v149, v149
v_exp_f32 v150, v150
v_exp_f32 v151, v151
v_cvt_pk_bf16_f32 v188, v144, v145
v_cvt_pk_bf16_f32 v189, v146, v147
v_cvt_pk_bf16_f32 v190, v148, v149
v_cvt_pk_bf16_f32 v191, v150, v151
v_accvgpr_read_b32 v144, a0
v_accvgpr_read_b32 v145, a1
v_accvgpr_read_b32 v146, a2
v_accvgpr_read_b32 v147, a3
v_mul_f32 v144, v144, v179
v_mul_f32 v145, v145, v179
v_mul_f32 v146, v146, v179
v_mul_f32 v147, v147, v179
v_accvgpr_write_b32 a0, v144
v_accvgpr_write_b32 a1, v145
v_accvgpr_write_b32 a2, v146
v_accvgpr_write_b32 a3, v147
v_accvgpr_read_b32 v144, a16
v_accvgpr_read_b32 v145, a17
v_accvgpr_read_b32 v146, a18
v_accvgpr_read_b32 v147, a19
v_mul_f32 v144, v144, v179
v_mul_f32 v145, v145, v179
v_mul_f32 v146, v146, v179
v_mul_f32 v147, v147, v179
v_accvgpr_write_b32 a16, v144
v_accvgpr_write_b32 a17, v145
v_accvgpr_write_b32 a18, v146
v_accvgpr_write_b32 a19, v147
v_accvgpr_read_b32 v144, a32
v_accvgpr_read_b32 v145, a33
v_accvgpr_read_b32 v146, a34
v_accvgpr_read_b32 v147, a35
v_mul_f32 v144, v144, v179
v_mul_f32 v145, v145, v179
v_mul_f32 v146, v146, v179
v_mul_f32 v147, v147, v179
v_accvgpr_write_b32 a32, v144
v_accvgpr_write_b32 a33, v145
v_accvgpr_write_b32 a34, v146
v_accvgpr_write_b32 a35, v147
v_accvgpr_read_b32 v144, a48
v_accvgpr_read_b32 v145, a49
v_accvgpr_read_b32 v146, a50
v_accvgpr_read_b32 v147, a51
v_mul_f32 v144, v144, v179
v_mul_f32 v145, v145, v179
v_mul_f32 v146, v146, v179
v_mul_f32 v147, v147, v179
v_accvgpr_write_b32 a48, v144
v_accvgpr_write_b32 a49, v145
v_accvgpr_write_b32 a50, v146
v_accvgpr_write_b32 a51, v147
v_accvgpr_read_b32 v144, a64
v_accvgpr_read_b32 v145, a65
v_accvgpr_read_b32 v146, a66
v_accvgpr_read_b32 v147, a67
v_mul_f32 v144, v144, v179
v_mul_f32 v145, v145, v179
v_mul_f32 v146, v146, v179
v_mul_f32 v147, v147, v179
v_accvgpr_write_b32 a64, v144
v_accvgpr_write_b32 a65, v145
v_accvgpr_write_b32 a66, v146
v_accvgpr_write_b32 a67, v147
v_accvgpr_read_b32 v144, a80
v_accvgpr_read_b32 v145, a81
v_accvgpr_read_b32 v146, a82
v_accvgpr_read_b32 v147, a83
v_mul_f32 v144, v144, v179
v_mul_f32 v145, v145, v179
v_mul_f32 v146, v146, v179
v_mul_f32 v147, v147, v179
v_accvgpr_write_b32 a80, v144
v_accvgpr_write_b32 a81, v145
v_accvgpr_write_b32 a82, v146
v_accvgpr_write_b32 a83, v147
v_accvgpr_read_b32 v144, a96
v_accvgpr_read_b32 v145, a97
v_accvgpr_read_b32 v146, a98
v_accvgpr_read_b32 v147, a99
v_mul_f32 v144, v144, v179
v_mul_f32 v145, v145, v179
v_mul_f32 v146, v146, v179
v_mul_f32 v147, v147, v179
v_accvgpr_write_b32 a96, v144
v_accvgpr_write_b32 a97, v145
v_accvgpr_write_b32 a98, v146
v_accvgpr_write_b32 a99, v147
v_accvgpr_read_b32 v144, a112
v_accvgpr_read_b32 v145, a113
v_accvgpr_read_b32 v146, a114
v_accvgpr_read_b32 v147, a115
v_mul_f32 v144, v144, v179
v_mul_f32 v145, v145, v179
v_mul_f32 v146, v146, v179
v_mul_f32 v147, v147, v179
v_accvgpr_write_b32 a112, v144
v_accvgpr_write_b32 a113, v145
v_accvgpr_write_b32 a114, v146
v_accvgpr_write_b32 a115, v147
v_accvgpr_read_b32 v144, a128
v_accvgpr_read_b32 v145, a129
v_accvgpr_read_b32 v146, a130
v_accvgpr_read_b32 v147, a131
v_mul_f32 v144, v144, v179
v_mul_f32 v145, v145, v179
v_mul_f32 v146, v146, v179
v_mul_f32 v147, v147, v179
v_accvgpr_write_b32 a128, v144
v_accvgpr_write_b32 a129, v145
v_accvgpr_write_b32 a130, v146
v_accvgpr_write_b32 a131, v147
s_nop 1
v_mfma_f32_16x16x32_bf16 a[0:3], v[96:99], v[188:191], a[0:3]
v_mfma_f32_16x16x32_bf16 a[16:19], v[100:103], v[188:191], a[16:19]
v_mfma_f32_16x16x32_bf16 a[32:35], v[104:107], v[188:191], a[32:35]
v_mfma_f32_16x16x32_bf16 a[48:51], v[108:111], v[188:191], a[48:51]
v_mfma_f32_16x16x32_bf16 a[64:67], v[112:115], v[188:191], a[64:67]
v_mfma_f32_16x16x32_bf16 a[80:83], v[116:119], v[188:191], a[80:83]
v_mfma_f32_16x16x32_bf16 a[96:99], v[120:123], v[188:191], a[96:99]
v_mfma_f32_16x16x32_bf16 a[112:115], v[124:127], v[188:191], a[112:115]
v_mfma_f32_16x16x32_bf16 a[128:131], a[240:243], v[188:191], a[128:131]
s_nop 9
s_add_u32 s12, s12, 1
s_cmp_le_u32 s12, s13
s_cbranch_scc1 L_slow_loop_0
s_branch L_slow_ret_0
L_slow_1:
s_waitcnt vmcnt(0)
s_lshr_b32 s13, s93, 1
s_mov_b32 s12, 0
s_nop 7
v_accvgpr_write_b32 a4, 0
v_accvgpr_write_b32 a5, 0
v_accvgpr_write_b32 a6, 0
v_accvgpr_write_b32 a7, 0
v_accvgpr_write_b32 a20, 0
v_accvgpr_write_b32 a21, 0
v_accvgpr_write_b32 a22, 0
v_accvgpr_write_b32 a23, 0
v_accvgpr_write_b32 a36, 0
v_accvgpr_write_b32 a37, 0
v_accvgpr_write_b32 a38, 0
v_accvgpr_write_b32 a39, 0
v_accvgpr_write_b32 a52, 0
v_accvgpr_write_b32 a53, 0
v_accvgpr_write_b32 a54, 0
v_accvgpr_write_b32 a55, 0
v_accvgpr_write_b32 a68, 0
v_accvgpr_write_b32 a69, 0
v_accvgpr_write_b32 a70, 0
v_accvgpr_write_b32 a71, 0
v_accvgpr_write_b32 a84, 0
v_accvgpr_write_b32 a85, 0
v_accvgpr_write_b32 a86, 0
v_accvgpr_write_b32 a87, 0
v_accvgpr_write_b32 a100, 0
v_accvgpr_write_b32 a101, 0
v_accvgpr_write_b32 a102, 0
v_accvgpr_write_b32 a103, 0
v_accvgpr_write_b32 a116, 0
v_accvgpr_write_b32 a117, 0
v_accvgpr_write_b32 a118, 0
v_accvgpr_write_b32 a119, 0
v_accvgpr_write_b32 a132, 0
v_accvgpr_write_b32 a133, 0
v_accvgpr_write_b32 a134, 0
v_accvgpr_write_b32 a135, 0
v_mov_b32 v182, 0xff800000
v_mov_b32 v176, v182
v_and_b32 v181, 15, v1
v_lshrrev_b32 v178, 4, v1
v_lshlrev_b32 v178, 2, v178
v_sub_u32 v181, v181, v178
s_lshl_b32 s14, s93, 4
v_add_u32 v181, s14, v181
L_slow_loop_1:
s_lshl_b32 s14, s12, 14
buffer_load_dwordx4 v[32:35], v4, s[56:59], s14 offen offset:0 sc1
buffer_load_dwordx4 v[96:99], v6, s[56:59], s14 offen offset:0 sc1
buffer_load_dwordx4 v[36:39], v4, s[56:59], s14 offen offset:1024 sc1
buffer_load_dwordx4 v[100:103], v6, s[56:59], s14 offen offset:1024 sc1
buffer_load_dwordx4 v[40:43], v4, s[56:59], s14 offen offset:2048 sc1
buffer_load_dwordx4 v[104:107], v6, s[56:59], s14 offen offset:2048 sc1
buffer_load_dwordx4 v[44:47], v4, s[56:59], s14 offen offset:3072 sc1
buffer_load_dwordx4 v[108:111], v6, s[56:59], s14 offen offset:3072 sc1
buffer_load_dwordx4 v[48:51], v5, s[56:59], s14 offen offset:0 sc1
buffer_load_dwordx4 v[112:115], v7, s[56:59], s14 offen offset:0 sc1
buffer_load_dwordx4 v[52:55], v5, s[56:59], s14 offen offset:1024 sc1
buffer_load_dwordx4 v[116:119], v7, s[56:59], s14 offen offset:1024 sc1
buffer_load_dwordx4 v[56:59], v5, s[56:59], s14 offen offset:2048 sc1
buffer_load_dwordx4 v[120:123], v7, s[56:59], s14 offen offset:2048 sc1
buffer_load_dwordx4 v[60:63], v5, s[56:59], s14 offen offset:3072 sc1
buffer_load_dwordx4 v[124:127], v7, s[56:59], s14 offen offset:3072 sc1
s_waitcnt vmcnt(0)
v_mfma_f32_16x16x32_bf16 v[144:147], v[32:35], v[132:135], 0
v_mfma_f32_16x16x32_bf16 v[148:151], v[48:51], v[132:135], 0
v_mfma_f32_16x16x32_bf16 v[144:147], v[36:39], v[164:167], v[144:147]
v_mfma_f32_16x16x32_bf16 v[148:151], v[52:55], v[164:167], v[148:151]
v_mfma_f32_16x16x32_bf16 v[144:147], v[40:43], v[196:199], v[144:147]
v_mfma_f32_16x16x32_bf16 v[148:151], v[56:59], v[196:199], v[148:151]
v_mfma_f32_16x16x32_bf16 v[144:147], v[44:47], v[228:231], v[144:147]
v_mfma_f32_16x16x32_bf16 v[148:151], v[60:63], v[228:231], v[148:151]
s_lshl_b32 s15, s12, 5
v_subrev_u32 v180, s15, v181
s_nop 7
v_cmp_le_i32 vcc, 0, v180
s_nop 1
v_cndmask_b32 v144, v182, v144, vcc
v_cmp_le_i32 vcc, 1, v180
s_nop 1
v_cndmask_b32 v145, v182, v145, vcc
v_cmp_le_i32 vcc, 2, v180
s_nop 1
v_cndmask_b32 v146, v182, v146, vcc
v_cmp_le_i32 vcc, 3, v180
s_nop 1
v_cndmask_b32 v147, v182, v147, vcc
v_cmp_le_i32 vcc, 16, v180
s_nop 1
v_cndmask_b32 v148, v182, v148, vcc
v_cmp_le_i32 vcc, 17, v180
s_nop 1
v_cndmask_b32 v149, v182, v149, vcc
v_cmp_le_i32 vcc, 18, v180
s_nop 1
v_cndmask_b32 v150, v182, v150, vcc
v_cmp_le_i32 vcc, 19, v180
s_nop 1
v_cndmask_b32 v151, v182, v151, vcc
v_max3_f32 v177, v144, v145, v146
v_max3_f32 v177, v177, v147, v148
v_max3_f32 v177, v177, v149, v150
v_max3_f32 v177, v177, v151, v176
v_mov_b32 v178, v177
s_nop 1
v_permlane16_swap_b32 v177, v178
v_max_f32 v177, v177, v178
v_mov_b32 v178, v177
s_nop 1
v_permlane32_swap_b32 v177, v178
v_max_f32 v177, v177, v178
v_sub_f32 v179, v176, v177
v_exp_f32 v179, v179
v_mov_b32 v176, v177
v_sub_f32 v144, v144, v176
v_sub_f32 v145, v145, v176
v_sub_f32 v146, v146, v176
v_sub_f32 v147, v147, v176
v_sub_f32 v148, v148, v176
v_sub_f32 v149, v149, v176
v_sub_f32 v150, v150, v176
v_sub_f32 v151, v151, v176
v_exp_f32 v144, v144
v_exp_f32 v145, v145
v_exp_f32 v146, v146
v_exp_f32 v147, v147
v_exp_f32 v148, v148
v_exp_f32 v149, v149
v_exp_f32 v150, v150
v_exp_f32 v151, v151
v_cvt_pk_bf16_f32 v188, v144, v145
v_cvt_pk_bf16_f32 v189, v146, v147
v_cvt_pk_bf16_f32 v190, v148, v149
v_cvt_pk_bf16_f32 v191, v150, v151
v_accvgpr_read_b32 v144, a4
v_accvgpr_read_b32 v145, a5
v_accvgpr_read_b32 v146, a6
v_accvgpr_read_b32 v147, a7
v_mul_f32 v144, v144, v179
v_mul_f32 v145, v145, v179
v_mul_f32 v146, v146, v179
v_mul_f32 v147, v147, v179
v_accvgpr_write_b32 a4, v144
v_accvgpr_write_b32 a5, v145
v_accvgpr_write_b32 a6, v146
v_accvgpr_write_b32 a7, v147
v_accvgpr_read_b32 v144, a20
v_accvgpr_read_b32 v145, a21
v_accvgpr_read_b32 v146, a22
v_accvgpr_read_b32 v147, a23
v_mul_f32 v144, v144, v179
v_mul_f32 v145, v145, v179
v_mul_f32 v146, v146, v179
v_mul_f32 v147, v147, v179
v_accvgpr_write_b32 a20, v144
v_accvgpr_write_b32 a21, v145
v_accvgpr_write_b32 a22, v146
v_accvgpr_write_b32 a23, v147
v_accvgpr_read_b32 v144, a36
v_accvgpr_read_b32 v145, a37
v_accvgpr_read_b32 v146, a38
v_accvgpr_read_b32 v147, a39
v_mul_f32 v144, v144, v179
v_mul_f32 v145, v145, v179
v_mul_f32 v146, v146, v179
v_mul_f32 v147, v147, v179
v_accvgpr_write_b32 a36, v144
v_accvgpr_write_b32 a37, v145
v_accvgpr_write_b32 a38, v146
v_accvgpr_write_b32 a39, v147
v_accvgpr_read_b32 v144, a52
v_accvgpr_read_b32 v145, a53
v_accvgpr_read_b32 v146, a54
v_accvgpr_read_b32 v147, a55
v_mul_f32 v144, v144, v179
v_mul_f32 v145, v145, v179
v_mul_f32 v146, v146, v179
v_mul_f32 v147, v147, v179
v_accvgpr_write_b32 a52, v144
v_accvgpr_write_b32 a53, v145
v_accvgpr_write_b32 a54, v146
v_accvgpr_write_b32 a55, v147
v_accvgpr_read_b32 v144, a68
v_accvgpr_read_b32 v145, a69
v_accvgpr_read_b32 v146, a70
v_accvgpr_read_b32 v147, a71
v_mul_f32 v144, v144, v179
v_mul_f32 v145, v145, v179
v_mul_f32 v146, v146, v179
v_mul_f32 v147, v147, v179
v_accvgpr_write_b32 a68, v144
v_accvgpr_write_b32 a69, v145
v_accvgpr_write_b32 a70, v146
v_accvgpr_write_b32 a71, v147
v_accvgpr_read_b32 v144, a84
v_accvgpr_read_b32 v145, a85
v_accvgpr_read_b32 v146, a86
v_accvgpr_read_b32 v147, a87
v_mul_f32 v144, v144, v179
v_mul_f32 v145, v145, v179
v_mul_f32 v146, v146, v179
v_mul_f32 v147, v147, v179
v_accvgpr_write_b32 a84, v144
v_accvgpr_write_b32 a85, v145
v_accvgpr_write_b32 a86, v146
v_accvgpr_write_b32 a87, v147
v_accvgpr_read_b32 v144, a100
v_accvgpr_read_b32 v145, a101
v_accvgpr_read_b32 v146, a102
v_accvgpr_read_b32 v147, a103
v_mul_f32 v144, v144, v179
v_mul_f32 v145, v145, v179
v_mul_f32 v146, v146, v179
v_mul_f32 v147, v147, v179
v_accvgpr_write_b32 a100, v144
v_accvgpr_write_b32 a101, v145
v_accvgpr_write_b32 a102, v146
v_accvgpr_write_b32 a103, v147
v_accvgpr_read_b32 v144, a116
v_accvgpr_read_b32 v145, a117
v_accvgpr_read_b32 v146, a118
v_accvgpr_read_b32 v147, a119
v_mul_f32 v144, v144, v179
v_mul_f32 v145, v145, v179
v_mul_f32 v146, v146, v179
v_mul_f32 v147, v147, v179
v_accvgpr_write_b32 a116, v144
v_accvgpr_write_b32 a117, v145
v_accvgpr_write_b32 a118, v146
v_accvgpr_write_b32 a119, v147
v_accvgpr_read_b32 v144, a132
v_accvgpr_read_b32 v145, a133
v_accvgpr_read_b32 v146, a134
v_accvgpr_read_b32 v147, a135
v_mul_f32 v144, v144, v179
v_mul_f32 v145, v145, v179
v_mul_f32 v146, v146, v179
v_mul_f32 v147, v147, v179
v_accvgpr_write_b32 a132, v144
v_accvgpr_write_b32 a133, v145
v_accvgpr_write_b32 a134, v146
v_accvgpr_write_b32 a135, v147
s_nop 1
v_mfma_f32_16x16x32_bf16 a[4:7], v[96:99], v[188:191], a[4:7]
v_mfma_f32_16x16x32_bf16 a[20:23], v[100:103], v[188:191], a[20:23]
v_mfma_f32_16x16x32_bf16 a[36:39], v[104:107], v[188:191], a[36:39]
v_mfma_f32_16x16x32_bf16 a[52:55], v[108:111], v[188:191], a[52:55]
v_mfma_f32_16x16x32_bf16 a[68:71], v[112:115], v[188:191], a[68:71]
v_mfma_f32_16x16x32_bf16 a[84:87], v[116:119], v[188:191], a[84:87]
v_mfma_f32_16x16x32_bf16 a[100:103], v[120:123], v[188:191], a[100:103]
v_mfma_f32_16x16x32_bf16 a[116:119], v[124:127], v[188:191], a[116:119]
v_mfma_f32_16x16x32_bf16 a[132:135], a[240:243], v[188:191], a[132:135]
s_nop 9
s_add_u32 s12, s12, 1
s_cmp_le_u32 s12, s13
s_cbranch_scc1 L_slow_loop_1
s_branch L_slow_ret_1
L_slow_2:
s_waitcnt vmcnt(0)
s_lshr_b32 s13, s94, 1
s_mov_b32 s12, 0
s_nop 7
v_accvgpr_write_b32 a8, 0
v_accvgpr_write_b32 a9, 0
v_accvgpr_write_b32 a10, 0
v_accvgpr_write_b32 a11, 0
v_accvgpr_write_b32 a24, 0
v_accvgpr_write_b32 a25, 0
v_accvgpr_write_b32 a26, 0
v_accvgpr_write_b32 a27, 0
v_accvgpr_write_b32 a40, 0
v_accvgpr_write_b32 a41, 0
v_accvgpr_write_b32 a42, 0
v_accvgpr_write_b32 a43, 0
v_accvgpr_write_b32 a56, 0
v_accvgpr_write_b32 a57, 0
v_accvgpr_write_b32 a58, 0
v_accvgpr_write_b32 a59, 0
v_accvgpr_write_b32 a72, 0
v_accvgpr_write_b32 a73, 0
v_accvgpr_write_b32 a74, 0
v_accvgpr_write_b32 a75, 0
v_accvgpr_write_b32 a88, 0
v_accvgpr_write_b32 a89, 0
v_accvgpr_write_b32 a90, 0
v_accvgpr_write_b32 a91, 0
v_accvgpr_write_b32 a104, 0
v_accvgpr_write_b32 a105, 0
v_accvgpr_write_b32 a106, 0
v_accvgpr_write_b32 a107, 0
v_accvgpr_write_b32 a120, 0
v_accvgpr_write_b32 a121, 0
v_accvgpr_write_b32 a122, 0
v_accvgpr_write_b32 a123, 0
v_accvgpr_write_b32 a136, 0
v_accvgpr_write_b32 a137, 0
v_accvgpr_write_b32 a138, 0
v_accvgpr_write_b32 a139, 0
v_mov_b32 v182, 0xff800000
v_mov_b32 v176, v182
v_and_b32 v181, 15, v1
v_lshrrev_b32 v178, 4, v1
v_lshlrev_b32 v178, 2, v178
v_sub_u32 v181, v181, v178
s_lshl_b32 s14, s94, 4
v_add_u32 v181, s14, v181
L_slow_loop_2:
s_lshl_b32 s14, s12, 14
buffer_load_dwordx4 v[32:35], v4, s[56:59], s14 offen offset:0 sc1
buffer_load_dwordx4 v[96:99], v6, s[56:59], s14 offen offset:0 sc1
buffer_load_dwordx4 v[36:39], v4, s[56:59], s14 offen offset:1024 sc1
buffer_load_dwordx4 v[100:103], v6, s[56:59], s14 offen offset:1024 sc1
buffer_load_dwordx4 v[40:43], v4, s[56:59], s14 offen offset:2048 sc1
buffer_load_dwordx4 v[104:107], v6, s[56:59], s14 offen offset:2048 sc1
buffer_load_dwordx4 v[44:47], v4, s[56:59], s14 offen offset:3072 sc1
buffer_load_dwordx4 v[108:111], v6, s[56:59], s14 offen offset:3072 sc1
buffer_load_dwordx4 v[48:51], v5, s[56:59], s14 offen offset:0 sc1
buffer_load_dwordx4 v[112:115], v7, s[56:59], s14 offen offset:0 sc1
buffer_load_dwordx4 v[52:55], v5, s[56:59], s14 offen offset:1024 sc1
buffer_load_dwordx4 v[116:119], v7, s[56:59], s14 offen offset:1024 sc1
buffer_load_dwordx4 v[56:59], v5, s[56:59], s14 offen offset:2048 sc1
buffer_load_dwordx4 v[120:123], v7, s[56:59], s14 offen offset:2048 sc1
buffer_load_dwordx4 v[60:63], v5, s[56:59], s14 offen offset:3072 sc1
buffer_load_dwordx4 v[124:127], v7, s[56:59], s14 offen offset:3072 sc1
s_waitcnt vmcnt(0)
v_mfma_f32_16x16x32_bf16 v[144:147], v[32:35], v[136:139], 0
v_mfma_f32_16x16x32_bf16 v[148:151], v[48:51], v[136:139], 0
v_mfma_f32_16x16x32_bf16 v[144:147], v[36:39], v[168:171], v[144:147]
v_mfma_f32_16x16x32_bf16 v[148:151], v[52:55], v[168:171], v[148:151]
v_mfma_f32_16x16x32_bf16 v[144:147], v[40:43], v[200:203], v[144:147]
v_mfma_f32_16x16x32_bf16 v[148:151], v[56:59], v[200:203], v[148:151]
v_mfma_f32_16x16x32_bf16 v[144:147], v[44:47], v[232:235], v[144:147]
v_mfma_f32_16x16x32_bf16 v[148:151], v[60:63], v[232:235], v[148:151]
s_lshl_b32 s15, s12, 5
v_subrev_u32 v180, s15, v181
s_nop 7
v_cmp_le_i32 vcc, 0, v180
s_nop 1
v_cndmask_b32 v144, v182, v144, vcc
v_cmp_le_i32 vcc, 1, v180
s_nop 1
v_cndmask_b32 v145, v182, v145, vcc
v_cmp_le_i32 vcc, 2, v180
s_nop 1
v_cndmask_b32 v146, v182, v146, vcc
v_cmp_le_i32 vcc, 3, v180
s_nop 1
v_cndmask_b32 v147, v182, v147, vcc
v_cmp_le_i32 vcc, 16, v180
s_nop 1
v_cndmask_b32 v148, v182, v148, vcc
v_cmp_le_i32 vcc, 17, v180
s_nop 1
v_cndmask_b32 v149, v182, v149, vcc
v_cmp_le_i32 vcc, 18, v180
s_nop 1
v_cndmask_b32 v150, v182, v150, vcc
v_cmp_le_i32 vcc, 19, v180
s_nop 1
v_cndmask_b32 v151, v182, v151, vcc
v_max3_f32 v177, v144, v145, v146
v_max3_f32 v177, v177, v147, v148
v_max3_f32 v177, v177, v149, v150
v_max3_f32 v177, v177, v151, v176
v_mov_b32 v178, v177
s_nop 1
v_permlane16_swap_b32 v177, v178
v_max_f32 v177, v177, v178
v_mov_b32 v178, v177
s_nop 1
v_permlane32_swap_b32 v177, v178
v_max_f32 v177, v177, v178
v_sub_f32 v179, v176, v177
v_exp_f32 v179, v179
v_mov_b32 v176, v177
v_sub_f32 v144, v144, v176
v_sub_f32 v145, v145, v176
v_sub_f32 v146, v146, v176
v_sub_f32 v147, v147, v176
v_sub_f32 v148, v148, v176
v_sub_f32 v149, v149, v176
v_sub_f32 v150, v150, v176
v_sub_f32 v151, v151, v176
v_exp_f32 v144, v144
v_exp_f32 v145, v145
v_exp_f32 v146, v146
v_exp_f32 v147, v147
v_exp_f32 v148, v148
v_exp_f32 v149, v149
v_exp_f32 v150, v150
v_exp_f32 v151, v151
v_cvt_pk_bf16_f32 v188, v144, v145
v_cvt_pk_bf16_f32 v189, v146, v147
v_cvt_pk_bf16_f32 v190, v148, v149
v_cvt_pk_bf16_f32 v191, v150, v151
v_accvgpr_read_b32 v144, a8
v_accvgpr_read_b32 v145, a9
v_accvgpr_read_b32 v146, a10
v_accvgpr_read_b32 v147, a11
v_mul_f32 v144, v144, v179
v_mul_f32 v145, v145, v179
v_mul_f32 v146, v146, v179
v_mul_f32 v147, v147, v179
v_accvgpr_write_b32 a8, v144
v_accvgpr_write_b32 a9, v145
v_accvgpr_write_b32 a10, v146
v_accvgpr_write_b32 a11, v147
v_accvgpr_read_b32 v144, a24
v_accvgpr_read_b32 v145, a25
v_accvgpr_read_b32 v146, a26
v_accvgpr_read_b32 v147, a27
v_mul_f32 v144, v144, v179
v_mul_f32 v145, v145, v179
v_mul_f32 v146, v146, v179
v_mul_f32 v147, v147, v179
v_accvgpr_write_b32 a24, v144
v_accvgpr_write_b32 a25, v145
v_accvgpr_write_b32 a26, v146
v_accvgpr_write_b32 a27, v147
v_accvgpr_read_b32 v144, a40
v_accvgpr_read_b32 v145, a41
v_accvgpr_read_b32 v146, a42
v_accvgpr_read_b32 v147, a43
v_mul_f32 v144, v144, v179
v_mul_f32 v145, v145, v179
v_mul_f32 v146, v146, v179
v_mul_f32 v147, v147, v179
v_accvgpr_write_b32 a40, v144
v_accvgpr_write_b32 a41, v145
v_accvgpr_write_b32 a42, v146
v_accvgpr_write_b32 a43, v147
v_accvgpr_read_b32 v144, a56
v_accvgpr_read_b32 v145, a57
v_accvgpr_read_b32 v146, a58
v_accvgpr_read_b32 v147, a59
v_mul_f32 v144, v144, v179
v_mul_f32 v145, v145, v179
v_mul_f32 v146, v146, v179
v_mul_f32 v147, v147, v179
v_accvgpr_write_b32 a56, v144
v_accvgpr_write_b32 a57, v145
v_accvgpr_write_b32 a58, v146
v_accvgpr_write_b32 a59, v147
v_accvgpr_read_b32 v144, a72
v_accvgpr_read_b32 v145, a73
v_accvgpr_read_b32 v146, a74
v_accvgpr_read_b32 v147, a75
v_mul_f32 v144, v144, v179
v_mul_f32 v145, v145, v179
v_mul_f32 v146, v146, v179
v_mul_f32 v147, v147, v179
v_accvgpr_write_b32 a72, v144
v_accvgpr_write_b32 a73, v145
v_accvgpr_write_b32 a74, v146
v_accvgpr_write_b32 a75, v147
v_accvgpr_read_b32 v144, a88
v_accvgpr_read_b32 v145, a89
v_accvgpr_read_b32 v146, a90
v_accvgpr_read_b32 v147, a91
v_mul_f32 v144, v144, v179
v_mul_f32 v145, v145, v179
v_mul_f32 v146, v146, v179
v_mul_f32 v147, v147, v179
v_accvgpr_write_b32 a88, v144
v_accvgpr_write_b32 a89, v145
v_accvgpr_write_b32 a90, v146
v_accvgpr_write_b32 a91, v147
v_accvgpr_read_b32 v144, a104
v_accvgpr_read_b32 v145, a105
v_accvgpr_read_b32 v146, a106
v_accvgpr_read_b32 v147, a107
v_mul_f32 v144, v144, v179
v_mul_f32 v145, v145, v179
v_mul_f32 v146, v146, v179
v_mul_f32 v147, v147, v179
v_accvgpr_write_b32 a104, v144
v_accvgpr_write_b32 a105, v145
v_accvgpr_write_b32 a106, v146
v_accvgpr_write_b32 a107, v147
v_accvgpr_read_b32 v144, a120
v_accvgpr_read_b32 v145, a121
v_accvgpr_read_b32 v146, a122
v_accvgpr_read_b32 v147, a123
v_mul_f32 v144, v144, v179
v_mul_f32 v145, v145, v179
v_mul_f32 v146, v146, v179
v_mul_f32 v147, v147, v179
v_accvgpr_write_b32 a120, v144
v_accvgpr_write_b32 a121, v145
v_accvgpr_write_b32 a122, v146
v_accvgpr_write_b32 a123, v147
v_accvgpr_read_b32 v144, a136
v_accvgpr_read_b32 v145, a137
v_accvgpr_read_b32 v146, a138
v_accvgpr_read_b32 v147, a139
v_mul_f32 v144, v144, v179
v_mul_f32 v145, v145, v179
v_mul_f32 v146, v146, v179
v_mul_f32 v147, v147, v179
v_accvgpr_write_b32 a136, v144
v_accvgpr_write_b32 a137, v145
v_accvgpr_write_b32 a138, v146
v_accvgpr_write_b32 a139, v147
s_nop 1
v_mfma_f32_16x16x32_bf16 a[8:11], v[96:99], v[188:191], a[8:11]
v_mfma_f32_16x16x32_bf16 a[24:27], v[100:103], v[188:191], a[24:27]
v_mfma_f32_16x16x32_bf16 a[40:43], v[104:107], v[188:191], a[40:43]
v_mfma_f32_16x16x32_bf16 a[56:59], v[108:111], v[188:191], a[56:59]
v_mfma_f32_16x16x32_bf16 a[72:75], v[112:115], v[188:191], a[72:75]
v_mfma_f32_16x16x32_bf16 a[88:91], v[116:119], v[188:191], a[88:91]
v_mfma_f32_16x16x32_bf16 a[104:107], v[120:123], v[188:191], a[104:107]
v_mfma_f32_16x16x32_bf16 a[120:123], v[124:127], v[188:191], a[120:123]
v_mfma_f32_16x16x32_bf16 a[136:139], a[240:243], v[188:191], a[136:139]
s_nop 9
s_add_u32 s12, s12, 1
s_cmp_le_u32 s12, s13
s_cbranch_scc1 L_slow_loop_2
s_branch L_slow_ret_2
L_slow_3:
s_waitcnt vmcnt(0)
s_lshr_b32 s13, s95, 1
s_mov_b32 s12, 0
s_nop 7
v_accvgpr_write_b32 a12, 0
v_accvgpr_write_b32 a13, 0
v_accvgpr_write_b32 a14, 0
v_accvgpr_write_b32 a15, 0
v_accvgpr_write_b32 a28, 0
v_accvgpr_write_b32 a29, 0
v_accvgpr_write_b32 a30, 0
v_accvgpr_write_b32 a31, 0
v_accvgpr_write_b32 a44, 0
v_accvgpr_write_b32 a45, 0
v_accvgpr_write_b32 a46, 0
v_accvgpr_write_b32 a47, 0
v_accvgpr_write_b32 a60, 0
v_accvgpr_write_b32 a61, 0
v_accvgpr_write_b32 a62, 0
v_accvgpr_write_b32 a63, 0
v_accvgpr_write_b32 a76, 0
v_accvgpr_write_b32 a77, 0
v_accvgpr_write_b32 a78, 0
v_accvgpr_write_b32 a79, 0
v_accvgpr_write_b32 a92, 0
v_accvgpr_write_b32 a93, 0
v_accvgpr_write_b32 a94, 0
v_accvgpr_write_b32 a95, 0
v_accvgpr_write_b32 a108, 0
v_accvgpr_write_b32 a109, 0
v_accvgpr_write_b32 a110, 0
v_accvgpr_write_b32 a111, 0
v_accvgpr_write_b32 a124, 0
v_accvgpr_write_b32 a125, 0
v_accvgpr_write_b32 a126, 0
v_accvgpr_write_b32 a127, 0
v_accvgpr_write_b32 a140, 0
v_accvgpr_write_b32 a141, 0
v_accvgpr_write_b32 a142, 0
v_accvgpr_write_b32 a143, 0
v_mov_b32 v182, 0xff800000
v_mov_b32 v176, v182
v_and_b32 v181, 15, v1
v_lshrrev_b32 v178, 4, v1
v_lshlrev_b32 v178, 2, v178
v_sub_u32 v181, v181, v178
s_lshl_b32 s14, s95, 4
v_add_u32 v181, s14, v181
L_slow_loop_3:
s_lshl_b32 s14, s12, 14
buffer_load_dwordx4 v[32:35], v4, s[56:59], s14 offen offset:0 sc1
buffer_load_dwordx4 v[96:99], v6, s[56:59], s14 offen offset:0 sc1
buffer_load_dwordx4 v[36:39], v4, s[56:59], s14 offen offset:1024 sc1
buffer_load_dwordx4 v[100:103], v6, s[56:59], s14 offen offset:1024 sc1
buffer_load_dwordx4 v[40:43], v4, s[56:59], s14 offen offset:2048 sc1
buffer_load_dwordx4 v[104:107], v6, s[56:59], s14 offen offset:2048 sc1
buffer_load_dwordx4 v[44:47], v4, s[56:59], s14 offen offset:3072 sc1
buffer_load_dwordx4 v[108:111], v6, s[56:59], s14 offen offset:3072 sc1
buffer_load_dwordx4 v[48:51], v5, s[56:59], s14 offen offset:0 sc1
buffer_load_dwordx4 v[112:115], v7, s[56:59], s14 offen offset:0 sc1
buffer_load_dwordx4 v[52:55], v5, s[56:59], s14 offen offset:1024 sc1
buffer_load_dwordx4 v[116:119], v7, s[56:59], s14 offen offset:1024 sc1
buffer_load_dwordx4 v[56:59], v5, s[56:59], s14 offen offset:2048 sc1
buffer_load_dwordx4 v[120:123], v7, s[56:59], s14 offen offset:2048 sc1
buffer_load_dwordx4 v[60:63], v5, s[56:59], s14 offen offset:3072 sc1
buffer_load_dwordx4 v[124:127], v7, s[56:59], s14 offen offset:3072 sc1
s_waitcnt vmcnt(0)
v_mfma_f32_16x16x32_bf16 v[144:147], v[32:35], v[140:143], 0
v_mfma_f32_16x16x32_bf16 v[148:151], v[48:51], v[140:143], 0
v_mfma_f32_16x16x32_bf16 v[144:147], v[36:39], v[172:175], v[144:147]
v_mfma_f32_16x16x32_bf16 v[148:151], v[52:55], v[172:175], v[148:151]
v_mfma_f32_16x16x32_bf16 v[144:147], v[40:43], v[204:207], v[144:147]
v_mfma_f32_16x16x32_bf16 v[148:151], v[56:59], v[204:207], v[148:151]
v_mfma_f32_16x16x32_bf16 v[144:147], v[44:47], v[236:239], v[144:147]
v_mfma_f32_16x16x32_bf16 v[148:151], v[60:63], v[236:239], v[148:151]
s_lshl_b32 s15, s12, 5
v_subrev_u32 v180, s15, v181
s_nop 7
v_cmp_le_i32 vcc, 0, v180
s_nop 1
v_cndmask_b32 v144, v182, v144, vcc
v_cmp_le_i32 vcc, 1, v180
s_nop 1
v_cndmask_b32 v145, v182, v145, vcc
v_cmp_le_i32 vcc, 2, v180
s_nop 1
v_cndmask_b32 v146, v182, v146, vcc
v_cmp_le_i32 vcc, 3, v180
s_nop 1
v_cndmask_b32 v147, v182, v147, vcc
v_cmp_le_i32 vcc, 16, v180
s_nop 1
v_cndmask_b32 v148, v182, v148, vcc
v_cmp_le_i32 vcc, 17, v180
s_nop 1
v_cndmask_b32 v149, v182, v149, vcc
v_cmp_le_i32 vcc, 18, v180
s_nop 1
v_cndmask_b32 v150, v182, v150, vcc
v_cmp_le_i32 vcc, 19, v180
s_nop 1
v_cndmask_b32 v151, v182, v151, vcc
v_max3_f32 v177, v144, v145, v146
v_max3_f32 v177, v177, v147, v148
v_max3_f32 v177, v177, v149, v150
v_max3_f32 v177, v177, v151, v176
v_mov_b32 v178, v177
s_nop 1
v_permlane16_swap_b32 v177, v178
v_max_f32 v177, v177, v178
v_mov_b32 v178, v177
s_nop 1
v_permlane32_swap_b32 v177, v178
v_max_f32 v177, v177, v178
v_sub_f32 v179, v176, v177
v_exp_f32 v179, v179
v_mov_b32 v176, v177
v_sub_f32 v144, v144, v176
v_sub_f32 v145, v145, v176
v_sub_f32 v146, v146, v176
v_sub_f32 v147, v147, v176
v_sub_f32 v148, v148, v176
v_sub_f32 v149, v149, v176
v_sub_f32 v150, v150, v176
v_sub_f32 v151, v151, v176
v_exp_f32 v144, v144
v_exp_f32 v145, v145
v_exp_f32 v146, v146
v_exp_f32 v147, v147
v_exp_f32 v148, v148
v_exp_f32 v149, v149
v_exp_f32 v150, v150
v_exp_f32 v151, v151
v_cvt_pk_bf16_f32 v188, v144, v145
v_cvt_pk_bf16_f32 v189, v146, v147
v_cvt_pk_bf16_f32 v190, v148, v149
v_cvt_pk_bf16_f32 v191, v150, v151
v_accvgpr_read_b32 v144, a12
v_accvgpr_read_b32 v145, a13
v_accvgpr_read_b32 v146, a14
v_accvgpr_read_b32 v147, a15
v_mul_f32 v144, v144, v179
v_mul_f32 v145, v145, v179
v_mul_f32 v146, v146, v179
v_mul_f32 v147, v147, v179
v_accvgpr_write_b32 a12, v144
v_accvgpr_write_b32 a13, v145
v_accvgpr_write_b32 a14, v146
v_accvgpr_write_b32 a15, v147
v_accvgpr_read_b32 v144, a28
v_accvgpr_read_b32 v145, a29
v_accvgpr_read_b32 v146, a30
v_accvgpr_read_b32 v147, a31
v_mul_f32 v144, v144, v179
v_mul_f32 v145, v145, v179
v_mul_f32 v146, v146, v179
v_mul_f32 v147, v147, v179
v_accvgpr_write_b32 a28, v144
v_accvgpr_write_b32 a29, v145
v_accvgpr_write_b32 a30, v146
v_accvgpr_write_b32 a31, v147
v_accvgpr_read_b32 v144, a44
v_accvgpr_read_b32 v145, a45
v_accvgpr_read_b32 v146, a46
v_accvgpr_read_b32 v147, a47
v_mul_f32 v144, v144, v179
v_mul_f32 v145, v145, v179
v_mul_f32 v146, v146, v179
v_mul_f32 v147, v147, v179
v_accvgpr_write_b32 a44, v144
v_accvgpr_write_b32 a45, v145
v_accvgpr_write_b32 a46, v146
v_accvgpr_write_b32 a47, v147
v_accvgpr_read_b32 v144, a60
v_accvgpr_read_b32 v145, a61
v_accvgpr_read_b32 v146, a62
v_accvgpr_read_b32 v147, a63
v_mul_f32 v144, v144, v179
v_mul_f32 v145, v145, v179
v_mul_f32 v146, v146, v179
v_mul_f32 v147, v147, v179
v_accvgpr_write_b32 a60, v144
v_accvgpr_write_b32 a61, v145
v_accvgpr_write_b32 a62, v146
v_accvgpr_write_b32 a63, v147
v_accvgpr_read_b32 v144, a76
v_accvgpr_read_b32 v145, a77
v_accvgpr_read_b32 v146, a78
v_accvgpr_read_b32 v147, a79
v_mul_f32 v144, v144, v179
v_mul_f32 v145, v145, v179
v_mul_f32 v146, v146, v179
v_mul_f32 v147, v147, v179
v_accvgpr_write_b32 a76, v144
v_accvgpr_write_b32 a77, v145
v_accvgpr_write_b32 a78, v146
v_accvgpr_write_b32 a79, v147
v_accvgpr_read_b32 v144, a92
v_accvgpr_read_b32 v145, a93
v_accvgpr_read_b32 v146, a94
v_accvgpr_read_b32 v147, a95
v_mul_f32 v144, v144, v179
v_mul_f32 v145, v145, v179
v_mul_f32 v146, v146, v179
v_mul_f32 v147, v147, v179
v_accvgpr_write_b32 a92, v144
v_accvgpr_write_b32 a93, v145
v_accvgpr_write_b32 a94, v146
v_accvgpr_write_b32 a95, v147
v_accvgpr_read_b32 v144, a108
v_accvgpr_read_b32 v145, a109
v_accvgpr_read_b32 v146, a110
v_accvgpr_read_b32 v147, a111
v_mul_f32 v144, v144, v179
v_mul_f32 v145, v145, v179
v_mul_f32 v146, v146, v179
v_mul_f32 v147, v147, v179
v_accvgpr_write_b32 a108, v144
v_accvgpr_write_b32 a109, v145
v_accvgpr_write_b32 a110, v146
v_accvgpr_write_b32 a111, v147
v_accvgpr_read_b32 v144, a124
v_accvgpr_read_b32 v145, a125
v_accvgpr_read_b32 v146, a126
v_accvgpr_read_b32 v147, a127
v_mul_f32 v144, v144, v179
v_mul_f32 v145, v145, v179
v_mul_f32 v146, v146, v179
v_mul_f32 v147, v147, v179
v_accvgpr_write_b32 a124, v144
v_accvgpr_write_b32 a125, v145
v_accvgpr_write_b32 a126, v146
v_accvgpr_write_b32 a127, v147
v_accvgpr_read_b32 v144, a140
v_accvgpr_read_b32 v145, a141
v_accvgpr_read_b32 v146, a142
v_accvgpr_read_b32 v147, a143
v_mul_f32 v144, v144, v179
v_mul_f32 v145, v145, v179
v_mul_f32 v146, v146, v179
v_mul_f32 v147, v147, v179
v_accvgpr_write_b32 a140, v144
v_accvgpr_write_b32 a141, v145
v_accvgpr_write_b32 a142, v146
v_accvgpr_write_b32 a143, v147
s_nop 1
v_mfma_f32_16x16x32_bf16 a[12:15], v[96:99], v[188:191], a[12:15]
v_mfma_f32_16x16x32_bf16 a[28:31], v[100:103], v[188:191], a[28:31]
v_mfma_f32_16x16x32_bf16 a[44:47], v[104:107], v[188:191], a[44:47]
v_mfma_f32_16x16x32_bf16 a[60:63], v[108:111], v[188:191], a[60:63]
v_mfma_f32_16x16x32_bf16 a[76:79], v[112:115], v[188:191], a[76:79]
v_mfma_f32_16x16x32_bf16 a[92:95], v[116:119], v[188:191], a[92:95]
v_mfma_f32_16x16x32_bf16 a[108:111], v[120:123], v[188:191], a[108:111]
v_mfma_f32_16x16x32_bf16 a[124:127], v[124:127], v[188:191], a[124:127]
v_mfma_f32_16x16x32_bf16 a[140:143], a[240:243], v[188:191], a[140:143]
s_nop 9
s_add_u32 s12, s12, 1
s_cmp_le_u32 s12, s13
s_cbranch_scc1 L_slow_loop_3
s_branch L_slow_ret_3
L_code_end:
.section .rodata,"a"
.p2align 6
.amdhsa_kernel sequential_preLN__compressed_kv_cla__moe_arch_mod__prompt_kernel
  .amdhsa_next_free_vgpr 512
  .amdhsa_next_free_sgpr 102
  .amdhsa_accum_offset 256
  .amdhsa_group_segment_fixed_size 0
  .amdhsa_kernarg_size 112
  .amdhsa_user_sgpr_count 2
  .amdhsa_user_sgpr_kernarg_segment_ptr 1
  .amdhsa_system_sgpr_workgroup_id_x 1
.end_amdhsa_kernel
```
